```python
import torch

def _softmax(x, axis=-1):
    return torch.softmax(x, dim=axis)
def _gelu(x):
    return torch.nn.functional.gelu(x, approximate="tanh")
def _silu(x):
    return torch.nn.functional.silu(x)
def _sigmoid(x):
    return torch.sigmoid(x)
def _layernorm(x, axis=-1, eps=1e-5):
    m = x.mean(dim=axis, keepdim=True)
    v = x.var(dim=axis, keepdim=True, unbiased=False)
    return (x - m) / torch.sqrt(v + eps)
def _scatter_add(tgt, idx, src, axis=0):
    return tgt.clone().index_add_(axis, idx, src)
def _segment_sum(src, seg, n):
    out = torch.zeros((n,) + src.shape[1:], dtype=src.dtype)
    return out.index_add_(0, seg, src)
def _pad(x, pw):
    flat = tuple(v for pair in reversed(pw) for v in pair)
    return torch.nn.functional.pad(x, flat)

kernel_name = 'standalone__mha_block_cached__near_ridge'

def setup_inputs():

    _w = (lambda a: (lambda t: t.to(torch.bfloat16) if t.is_floating_point() else t)(torch.as_tensor(a)))
    B, Sq, D = 32, 128, 448
    H, Sk, Dh = 16, 512, 256
    return {
        "x": _w((lambda *s: torch.randn(*s, dtype=torch.bfloat16) * 0.8)(B, Sq, D)),
        "k_cache": _w((lambda *s: torch.randn(*s, dtype=torch.bfloat16) * 0.8)(B, H, Sk, Dh)),
        "v_cache": _w((lambda *s: torch.randn(*s, dtype=torch.bfloat16) * 0.05)(B, H, Sk, Dh)),
        "wq": _w((lambda *s: torch.randn(*s, dtype=torch.bfloat16) * 0.8)(D, H * Dh) * (D ** -0.5)),
        "wo": _w((lambda *s: torch.randn(*s, dtype=torch.bfloat16) * 0.05)(H * Dh, D) * ((H * Dh) ** -0.5)),
    }

def reference(x, k_cache, v_cache, wq, wo):
    B, Sq, D = x.shape
    H, Dh = 16, 256
    q = (lambda x, *d: x.permute(*d))((x @ wq).reshape(B, Sq, H, Dh), 0, 2, 1, 3)
    scores = torch.einsum("bhqd,bhkd->bhqk", q, k_cache) * (Dh ** -0.5)
    p = _softmax(scores, axis=-1)
    o = torch.einsum("bhqk,bhkd->bhqd", p, v_cache)
    return (lambda x, *d: x.permute(*d))(o, 0, 2, 1, 3).reshape(B, Sq, H * Dh) @ wo
```

```asm
; @launch grid=(256,1,1) block=(256,1,1) lds=163840
.amdgcn_target "amdgcn-amd-amdhsa--gfx950"
.text
.globl standalone__mha_block_cached__near_ridge_kernel
.p2align 8
.type standalone__mha_block_cached__near_ridge_kernel,@function
standalone__mha_block_cached__near_ridge_kernel:
s_cmp_ge_u32 s2, 256
s_cbranch_scc1 L_end
s_load_dwordx16 s[36:51], s[0:1], 0
v_lshrrev_b32 v40, 6, v0
v_and_b32 v41, 63, v0
s_lshr_b32 s33, s2, 3
s_getpc_b64 s[94:95]
L_pc:
s_lshl_b32 s32, s33, 12
v_lshl_add_u32 v42, v0, 4, s32
v_min_u32 v42, L_end-L_pc, v42
v_mov_b32 v49, s95
v_add_co_u32 v48, vcc, s94, v42
v_addc_co_u32 v49, vcc, 0, v49, vcc
global_load_dword v20, v[48:49], off
v_readfirstlane_b32 s3, v40
s_and_b32 s34, s2, 7
s_mov_b32 s35, s33
s_add_u32 s52, s34, 0
s_sub_u32 s59, s52, 7
s_cselect_b32 s52, s52, s59
s_lshl_b32 s59, s52, 7
s_lshl_b32 s52, s52, 19
s_mul_i32 s32, s33, 14
v_min_u32 v44, 223, v0
v_lshrrev_b32 v42, 4, v44
v_add_u32 v42, s32, v42
v_and_b32 v43, 15, v44
v_lshlrev_b32 v43, 4, v43
v_lshl_add_u32 v18, v42, 13, v43
s_lshl_b32 s4, s3, 12
v_lshrrev_b32 v50, 3, v41
v_and_b32 v51, 7, v41
v_lshrrev_b32 v52, 4, v41
v_lshlrev_b32 v53, 1, v52
v_xor_b32 v53, v51, v53
v_lshlrev_b32 v53, 4, v53
v_lshl_add_u32 v42, v40, 5, v50
v_mul_u32_u24 v42, 896, v42
v_xor_b32 v43, v51, v52
v_lshlrev_b32 v43, 4, v43
v_add_u32 v17, v42, v43
v_lshrrev_b32 v44, 1, v40
v_lshl_add_u32 v44, v44, 7, v53
v_and_b32 v42, 1, v40
v_lshl_add_u32 v42, v42, 5, v50
v_and_b32 v45, 4, v50
v_add_u32 v45, v42, v45
v_lshl_add_u32 v16, v45, 13, v44
s_lshl_b32 s5, s34, 10
s_sub_u32 s22, 3670016, s5
s_mov_b32 s23, 0x20000
s_mul_i32 s32, s35, 114688
s_mov_b32 s10, 114688
s_mov_b32 s11, 0x20000
s_waitcnt lgkmcnt(0)
s_add_u32 s20, s42, s5
s_addc_u32 s21, s43, 0
s_add_u32 s8, s36, s32
s_addc_u32 s9, s37, 0
s_mov_b32 s5, 0
buffer_load_dword v20, v18, s[20:23], s5 offen
s_mov_b32 s5, 256
buffer_load_dword v20, v18, s[20:23], s5 offen
s_add_u32 m0, s4, 49152
s_add_u32 s5, s59, 0
buffer_load_dwordx4 v17, s[8:11], s5 offen lds
s_add_u32 s5, s59, 6144
buffer_load_dwordx4 v17, s[8:11], s5 offen offset:1024 lds
s_add_u32 s5, s59, 12288
buffer_load_dwordx4 v17, s[8:11], s5 offen offset:2048 lds
s_add_u32 s5, s59, 18432
buffer_load_dwordx4 v17, s[8:11], s5 offen offset:3072 lds
s_add_u32 m0, s4, 32768
s_add_u32 s5, s52, 0
buffer_load_dwordx4 v16, s[20:23], s5 offen lds
s_add_u32 s5, s52, 130048
buffer_load_dwordx4 v16, s[20:23], s5 offen offset:1024 lds
s_add_u32 s5, s52, 30720
buffer_load_dwordx4 v16, s[20:23], s5 offen offset:2048 lds
s_add_u32 s5, s52, 160768
buffer_load_dwordx4 v16, s[20:23], s5 offen offset:3072 lds
v_mov_b32 v13, 0
s_add_u32 s53, s34, 1
s_sub_u32 s60, s53, 7
s_cselect_b32 s53, s53, s60
s_lshl_b32 s60, s53, 7
s_lshl_b32 s53, s53, 19
s_add_u32 s54, s34, 2
s_sub_u32 s61, s54, 7
s_cselect_b32 s54, s54, s61
s_lshl_b32 s61, s54, 7
s_lshl_b32 s54, s54, 19
s_add_u32 s55, s34, 3
s_sub_u32 s62, s55, 7
s_cselect_b32 s55, s55, s62
s_lshl_b32 s62, s55, 7
s_lshl_b32 s55, s55, 19
s_add_u32 s56, s34, 4
s_sub_u32 s63, s56, 7
s_cselect_b32 s56, s56, s63
s_lshl_b32 s63, s56, 7
s_lshl_b32 s56, s56, 19
s_add_u32 s57, s34, 5
s_sub_u32 s100, s57, 7
s_cselect_b32 s57, s57, s100
s_lshl_b32 s100, s57, 7
s_lshl_b32 s57, s57, 19
s_add_u32 s58, s34, 6
s_sub_u32 s101, s58, 7
s_cselect_b32 s58, s58, s101
s_lshl_b32 s101, s58, 7
s_lshl_b32 s58, s58, 19
v_mul_u32_u24 v42, 896, v42
v_add_u32 v9, v42, v44
v_and_b32 v42, 1, v50
v_lshl_add_u32 v42, v52, 3, v42
v_lshl_add_u32 v44, v40, 7, v43
v_lshl_add_u32 v6, v42, 9, v44
v_xor_b32 v7, 64, v6
v_lshl_add_u32 v42, v40, 5, v42
v_lshl_add_u32 v8, v42, 9, v53
v_lshlrev_b32 v28, 10, v41
v_lshlrev_b32 v29, 6, v0
v_min_u32 v29, 7104, v29
s_mul_i32 s0, s33, 7168
s_add_u32 s0, s0, 229376
s_mul_i32 s5, s34, 458752
s_add_u32 s24, s44, s5
s_addc_u32 s25, s45, 0
s_mov_b32 s26, 458752
s_mov_b32 s27, 0x20000
s_add_u32 s76, s46, s32
s_addc_u32 s77, s47, 0
s_mov_b32 s78, 114688
s_mov_b32 s79, 0x20000
s_lshl_b32 s33, s35, 3
s_add_u32 s33, s33, s34
s_lshl_b32 s32, s33, 19
s_add_u32 s16, s40, s32
s_addc_u32 s17, s41, 0
s_mov_b32 s18, 524288
s_mov_b32 s19, 0x20000
s_add_u32 s12, s38, s32
s_addc_u32 s13, s39, 0
s_mov_b32 s14, 524288
s_mov_b32 s15, 0x20000
s_lshl_b32 s32, s33, 17
s_add_u32 s28, s50, s32
s_addc_u32 s29, s51, 0
s_mov_b32 s30, 131072
s_mov_b32 s31, 0x20000
s_lshl_b32 s32, s35, 20
s_add_u32 s72, s50, s32
s_addc_u32 s73, s51, 0
s_mov_b32 s74, 1048576
s_mov_b32 s75, 0x20000
s_lshl_b32 s32, s35, 10
s_add_u32 s32, s32, 0x2000000
s_add_u32 s68, s50, s32
s_addc_u32 s69, s51, 0
s_mov_b32 s70, 1024
s_mov_b32 s71, 0x20000
s_lshl_b32 s32, s35, 3
s_add_u32 s64, s48, s32
s_addc_u32 s65, s49, 0
s_mov_b32 s66, 4
s_mov_b32 s67, 0x20000
s_mov_b32 s6, 0x3db8aa3b
s_mov_b32 s7, 0xff7fff80
s_lshl_b32 s89, s3, 6
s_add_u32 s89, s89, s34
s_lshl_b32 s89, s89, 2
s_lshl_b32 s1, s3, 8
s_lshl_b32 s85, 1, s34
s_lshl_b32 s32, s3, 3
s_add_u32 s32, s32, s34
s_mul_i32 s87, s32, 3584
s_and_b32 s33, s2, 56
s_lshr_b32 s88, s3, 1
s_mul_i32 s88, s88, 0x7f000000
v_and_b32 v45, 15, v41
v_bfe_u32 v42, v45, 1, 2
v_xor_b32 v42, v42, v52
v_lshlrev_b32 v42, 4, v42
v_lshl_add_u32 v42, v45, 7, v42
v_lshl_add_u32 v22, v40, 12, v42
v_lshrrev_b32 v42, 1, v45
v_xor_b32 v42, v42, v52
v_lshlrev_b32 v42, 4, v42
v_lshl_add_u32 v4, v45, 7, v42
v_xor_b32 v5, 64, v4
v_lshrrev_b32 v42, 2, v41
v_and_b32 v43, 3, v50
v_lshlrev_b32 v43, 5, v43
v_lshl_add_u32 v43, v42, 7, v43
v_and_b32 v44, 3, v41
v_lshl_add_u32 v0, v44, 3, v43
v_xor_b32 v1, 32, v0
v_xor_b32 v2, 64, v0
v_xor_b32 v3, 96, v0
v_mov_b32 v23, 0
v_mov_b32 v21, 0
buffer_store_dword v13, v28, s[68:71], s89 offen sc1
buffer_load_dword v20, v13, s[12:15], 0 offen nt
buffer_load_dword v20, v13, s[16:19], 0 offen nt
buffer_load_dword v20, v13, s[24:27], 0 offen nt
buffer_load_dword v20, v13, s[72:75], 0 offen nt
buffer_load_dword v20, v13, s[76:79], 0 offen nt
s_cmp_eq_u32 s3, 0
s_cbranch_scc1 L_pg1
s_cmp_eq_u32 s3, 1
s_cbranch_scc1 L_pg2
s_cmp_eq_u32 s3, 2
s_cbranch_scc1 L_pg3
s_cmp_eq_u32 s3, 3
s_cbranch_scc1 L_pg4
s_branch L_tdone
.p2align 12
L_pg1:
s_branch L_pg5
L_tdone:
s_cmp_eq_u32 s3, 77
s_add_u32 m0, s4, 16384
s_add_u32 s5, s52, 256
buffer_load_dwordx4 v16, s[20:23], s5 offen lds
s_add_u32 s5, s52, 130304
buffer_load_dwordx4 v16, s[20:23], s5 offen offset:1024 lds
s_add_u32 s5, s52, 30976
buffer_load_dwordx4 v16, s[20:23], s5 offen offset:2048 lds
s_add_u32 s5, s52, 161024
buffer_load_dwordx4 v16, s[20:23], s5 offen offset:3072 lds
s_add_u32 m0, s4, 81920
s_add_u32 s5, s60, 0
buffer_load_dwordx4 v17, s[8:11], s5 offen lds
s_add_u32 s5, s60, 6144
buffer_load_dwordx4 v17, s[8:11], s5 offen offset:1024 lds
s_add_u32 s5, s60, 12288
buffer_load_dwordx4 v17, s[8:11], s5 offen offset:2048 lds
s_add_u32 s5, s60, 18432
buffer_load_dwordx4 v17, s[8:11], s5 offen offset:3072 lds
s_add_u32 m0, s4, 0
s_add_u32 s5, s53, 0
buffer_load_dwordx4 v16, s[20:23], s5 offen lds
s_add_u32 s5, s53, 130048
buffer_load_dwordx4 v16, s[20:23], s5 offen offset:1024 lds
s_add_u32 s5, s53, 30720
buffer_load_dwordx4 v16, s[20:23], s5 offen offset:2048 lds
s_add_u32 s5, s53, 160768
buffer_load_dwordx4 v16, s[20:23], s5 offen offset:3072 lds
s_waitcnt vmcnt(18)
s_barrier
ds_read_b128 a[0:3], v22 offset:49152
ds_read_b128 a[4:7], v22 offset:51200
ds_read_b128 a[8:11], v22 offset:49216
ds_read_b128 a[12:15], v22 offset:51264
ds_read_b64_tr_b16 a[224:225], v0 offset:32768
ds_read_b64_tr_b16 a[226:227], v0 offset:34816
ds_read_b64_tr_b16 a[228:229], v1 offset:32768
ds_read_b64_tr_b16 a[230:231], v1 offset:34816
ds_read_b64_tr_b16 a[232:233], v2 offset:32768
ds_read_b64_tr_b16 a[234:235], v2 offset:34816
ds_read_b64_tr_b16 a[236:237], v3 offset:32768
ds_read_b64_tr_b16 a[238:239], v3 offset:34816
ds_read_b64_tr_b16 a[240:241], v0 offset:40960
ds_read_b64_tr_b16 a[242:243], v0 offset:43008
ds_read_b64_tr_b16 a[244:245], v1 offset:40960
ds_read_b64_tr_b16 a[246:247], v1 offset:43008
ds_read_b64_tr_b16 a[248:249], v2 offset:40960
ds_read_b64_tr_b16 a[250:251], v2 offset:43008
L_step_0:
s_waitcnt lgkmcnt(6)
v_mfma_f32_16x16x32_bf16 v[128:131], a[224:227], a[0:3], 0
ds_read_b64_tr_b16 a[252:253], v3 offset:40960
ds_read_b64_tr_b16 a[254:255], v3 offset:43008
v_mfma_f32_16x16x32_bf16 v[136:139], a[224:227], a[4:7], 0
s_add_u32 m0, s4, 65536
s_add_u32 s5, s53, 256
v_mfma_f32_16x16x32_bf16 v[132:135], a[228:231], a[0:3], 0
ds_read_b64_tr_b16 a[224:225], v0 offset:36864
ds_read_b64_tr_b16 a[226:227], v0 offset:38912
v_mfma_f32_16x16x32_bf16 v[140:143], a[228:231], a[4:7], 0
buffer_load_dwordx4 v16, s[20:23], s5 offen lds
v_mfma_f32_16x16x32_bf16 v[144:147], a[232:235], a[0:3], 0
ds_read_b64_tr_b16 a[228:229], v1 offset:36864
v_mfma_f32_16x16x32_bf16 v[152:155], a[232:235], a[4:7], 0
ds_read_b64_tr_b16 a[230:231], v1 offset:38912
s_add_u32 s5, s53, 130304
v_mfma_f32_16x16x32_bf16 v[148:151], a[236:239], a[0:3], 0
ds_read_b64_tr_b16 a[232:233], v2 offset:36864
v_mfma_f32_16x16x32_bf16 v[156:159], a[236:239], a[4:7], 0
ds_read_b64_tr_b16 a[234:235], v2 offset:38912
s_waitcnt lgkmcnt(6)
v_mfma_f32_16x16x32_bf16 v[160:163], a[240:243], a[0:3], 0
ds_read_b64_tr_b16 a[236:237], v3 offset:36864
ds_read_b64_tr_b16 a[238:239], v3 offset:38912
v_mfma_f32_16x16x32_bf16 v[168:171], a[240:243], a[4:7], 0
buffer_load_dwordx4 v16, s[20:23], s5 offen offset:1024 lds
s_add_u32 s5, s53, 30976
v_mfma_f32_16x16x32_bf16 v[164:167], a[244:247], a[0:3], 0
ds_read_b64_tr_b16 a[240:241], v0 offset:45056
ds_read_b64_tr_b16 a[242:243], v0 offset:47104
v_mfma_f32_16x16x32_bf16 v[172:175], a[244:247], a[4:7], 0
buffer_load_dwordx4 v16, s[20:23], s5 offen offset:2048 lds
s_add_u32 s5, s53, 161024
v_mfma_f32_16x16x32_bf16 v[176:179], a[248:251], a[0:3], 0
ds_read_b64_tr_b16 a[244:245], v1 offset:45056
ds_read_b64_tr_b16 a[246:247], v1 offset:47104
v_mfma_f32_16x16x32_bf16 v[184:187], a[248:251], a[4:7], 0
buffer_load_dwordx4 v16, s[20:23], s5 offen offset:3072 lds
s_add_u32 m0, s4, 131072
s_add_u32 s5, s61, 0
v_mfma_f32_16x16x32_bf16 v[180:183], a[252:255], a[0:3], 0
ds_read_b64_tr_b16 a[248:249], v2 offset:45056
ds_read_b64_tr_b16 a[250:251], v2 offset:47104
buffer_load_dwordx4 v17, s[8:11], s5 offen lds
v_mfma_f32_16x16x32_bf16 v[188:191], a[252:255], a[4:7], 0
s_add_u32 s5, s61, 6144
buffer_load_dwordx4 v17, s[8:11], s5 offen offset:1024 lds
s_waitcnt lgkmcnt(6)
v_mfma_f32_16x16x32_bf16 v[128:131], a[224:227], a[8:11], v[128:131]
ds_read_b64_tr_b16 a[252:253], v3 offset:45056
ds_read_b64_tr_b16 a[254:255], v3 offset:47104
s_add_u32 s5, s61, 12288
v_mfma_f32_16x16x32_bf16 v[136:139], a[224:227], a[12:15], v[136:139]
buffer_load_dwordx4 v17, s[8:11], s5 offen offset:2048 lds
s_add_u32 s5, s61, 18432
buffer_load_dwordx4 v17, s[8:11], s5 offen offset:3072 lds
v_mfma_f32_16x16x32_bf16 v[132:135], a[228:231], a[8:11], v[132:135]
s_waitcnt vmcnt(16)
s_barrier
v_mfma_f32_16x16x32_bf16 v[140:143], a[228:231], a[12:15], v[140:143]
ds_read_b64_tr_b16 a[224:225], v0 offset:16384
ds_read_b64_tr_b16 a[226:227], v0 offset:18432
v_mfma_f32_16x16x32_bf16 v[144:147], a[232:235], a[8:11], v[144:147]
ds_read_b64_tr_b16 a[228:229], v1 offset:16384
ds_read_b64_tr_b16 a[230:231], v1 offset:18432
v_mfma_f32_16x16x32_bf16 v[152:155], a[232:235], a[12:15], v[152:155]
s_add_u32 m0, s4, 49152
s_add_u32 s5, s54, 0
v_mfma_f32_16x16x32_bf16 v[148:151], a[236:239], a[8:11], v[148:151]
ds_read_b64_tr_b16 a[232:233], v2 offset:16384
v_mfma_f32_16x16x32_bf16 v[156:159], a[236:239], a[12:15], v[156:159]
ds_read_b64_tr_b16 a[234:235], v2 offset:18432
s_waitcnt lgkmcnt(6)
v_mfma_f32_16x16x32_bf16 v[160:163], a[240:243], a[8:11], v[160:163]
ds_read_b64_tr_b16 a[236:237], v3 offset:16384
ds_read_b64_tr_b16 a[238:239], v3 offset:18432
v_mfma_f32_16x16x32_bf16 v[168:171], a[240:243], a[12:15], v[168:171]
buffer_load_dwordx4 v16, s[20:23], s5 offen lds
v_mfma_f32_16x16x32_bf16 v[164:167], a[244:247], a[8:11], v[164:167]
ds_read_b64_tr_b16 a[240:241], v0 offset:24576
ds_read_b64_tr_b16 a[242:243], v0 offset:26624
v_mfma_f32_16x16x32_bf16 v[172:175], a[244:247], a[12:15], v[172:175]
s_add_u32 s5, s54, 130048
v_add_u32 v22, 0x14000, v22
v_mfma_f32_16x16x32_bf16 v[176:179], a[248:251], a[8:11], v[176:179]
ds_read_b64_tr_b16 a[244:245], v1 offset:24576
ds_read_b64_tr_b16 a[246:247], v1 offset:26624
v_mfma_f32_16x16x32_bf16 v[184:187], a[248:251], a[12:15], v[184:187]
buffer_load_dwordx4 v16, s[20:23], s5 offen offset:1024 lds
v_mfma_f32_16x16x32_bf16 v[180:183], a[252:255], a[8:11], v[180:183]
ds_read_b64_tr_b16 a[248:249], v2 offset:24576
ds_read_b64_tr_b16 a[250:251], v2 offset:26624
v_mfma_f32_16x16x32_bf16 v[188:191], a[252:255], a[12:15], v[188:191]
s_add_u32 s5, s54, 30720
L_step_1:
s_waitcnt lgkmcnt(6)
v_mfma_f32_16x16x32_bf16 v[192:195], a[224:227], a[0:3], 0
ds_read_b64_tr_b16 a[252:253], v3 offset:24576
ds_read_b64_tr_b16 a[254:255], v3 offset:26624
v_mfma_f32_16x16x32_bf16 v[200:203], a[224:227], a[4:7], 0
buffer_load_dwordx4 v16, s[20:23], s5 offen offset:2048 lds
v_mfma_f32_16x16x32_bf16 v[196:199], a[228:231], a[0:3], 0
ds_read_b64_tr_b16 a[224:225], v0 offset:20480
v_mfma_f32_16x16x32_bf16 v[204:207], a[228:231], a[4:7], 0
ds_read_b64_tr_b16 a[226:227], v0 offset:22528
s_add_u32 s5, s54, 160768
v_mfma_f32_16x16x32_bf16 v[208:211], a[232:235], a[0:3], 0
ds_read_b64_tr_b16 a[228:229], v1 offset:20480
ds_read_b64_tr_b16 a[230:231], v1 offset:22528
v_mfma_f32_16x16x32_bf16 v[216:219], a[232:235], a[4:7], 0
buffer_load_dwordx4 v16, s[20:23], s5 offen offset:3072 lds
v_mfma_f32_16x16x32_bf16 v[212:215], a[236:239], a[0:3], 0
ds_read_b64_tr_b16 a[232:233], v2 offset:20480
ds_read_b64_tr_b16 a[234:235], v2 offset:22528
v_mfma_f32_16x16x32_bf16 v[220:223], a[236:239], a[4:7], 0
s_add_u32 m0, s4, 98304
s_add_u32 s5, s62, 0
s_waitcnt lgkmcnt(6)
v_mfma_f32_16x16x32_bf16 v[224:227], a[240:243], a[0:3], 0
ds_read_b64_tr_b16 a[236:237], v3 offset:20480
ds_read_b64_tr_b16 a[238:239], v3 offset:22528
v_mfma_f32_16x16x32_bf16 v[232:235], a[240:243], a[4:7], 0
buffer_load_dwordx4 v17, s[8:11], s5 offen lds
v_mfma_f32_16x16x32_bf16 v[228:231], a[244:247], a[0:3], 0
ds_read_b64_tr_b16 a[240:241], v0 offset:28672
ds_read_b64_tr_b16 a[242:243], v0 offset:30720
v_mfma_f32_16x16x32_bf16 v[236:239], a[244:247], a[4:7], 0
s_add_u32 s5, s62, 6144
buffer_load_dwordx4 v17, s[8:11], s5 offen offset:1024 lds
v_mfma_f32_16x16x32_bf16 v[240:243], a[248:251], a[0:3], 0
ds_read_b64_tr_b16 a[244:245], v1 offset:28672
v_mfma_f32_16x16x32_bf16 v[248:251], a[248:251], a[4:7], 0
ds_read_b64_tr_b16 a[246:247], v1 offset:30720
s_add_u32 s5, s62, 12288
v_mfma_f32_16x16x32_bf16 v[244:247], a[252:255], a[0:3], 0
ds_read_b64_tr_b16 a[248:249], v2 offset:28672
ds_read_b64_tr_b16 a[250:251], v2 offset:30720
v_mfma_f32_16x16x32_bf16 v[252:255], a[252:255], a[4:7], 0
buffer_load_dwordx4 v17, s[8:11], s5 offen offset:2048 lds
s_waitcnt lgkmcnt(6)
v_mfma_f32_16x16x32_bf16 v[192:195], a[224:227], a[8:11], v[192:195]
ds_read_b64_tr_b16 a[252:253], v3 offset:28672
ds_read_b64_tr_b16 a[254:255], v3 offset:30720
v_mfma_f32_16x16x32_bf16 v[200:203], a[224:227], a[12:15], v[200:203]
s_add_u32 s5, s62, 18432
buffer_load_dwordx4 v17, s[8:11], s5 offen offset:3072 lds
v_mfma_f32_16x16x32_bf16 v[196:199], a[228:231], a[8:11], v[196:199]
s_waitcnt vmcnt(16)
s_barrier
v_mfma_f32_16x16x32_bf16 v[204:207], a[228:231], a[12:15], v[204:207]
ds_read_b128 a[16:19], v22 offset:0
ds_read_b64_tr_b16 a[224:225], v0 offset:0
ds_read_b64_tr_b16 a[226:227], v0 offset:2048
v_mfma_f32_16x16x32_bf16 v[208:211], a[232:235], a[8:11], v[208:211]
ds_read_b128 a[20:23], v22 offset:2048
ds_read_b64_tr_b16 a[228:229], v1 offset:0
v_mfma_f32_16x16x32_bf16 v[216:219], a[232:235], a[12:15], v[216:219]
ds_read_b64_tr_b16 a[230:231], v1 offset:2048
s_add_u32 m0, s4, 32768
v_mfma_f32_16x16x32_bf16 v[212:215], a[236:239], a[8:11], v[212:215]
ds_read_b128 a[24:27], v22 offset:64
ds_read_b64_tr_b16 a[232:233], v2 offset:0
v_mfma_f32_16x16x32_bf16 v[220:223], a[236:239], a[12:15], v[220:223]
ds_read_b64_tr_b16 a[234:235], v2 offset:2048
s_waitcnt lgkmcnt(9)
v_mfma_f32_16x16x32_bf16 v[224:227], a[240:243], a[8:11], v[224:227]
ds_read_b128 a[28:31], v22 offset:2112
ds_read_b64_tr_b16 a[236:237], v3 offset:0
v_mfma_f32_16x16x32_bf16 v[232:235], a[240:243], a[12:15], v[232:235]
ds_read_b64_tr_b16 a[238:239], v3 offset:2048
s_add_u32 s5, s54, 256
v_mfma_f32_16x16x32_bf16 v[228:231], a[244:247], a[8:11], v[228:231]
ds_read_b64_tr_b16 a[240:241], v0 offset:8192
ds_read_b64_tr_b16 a[242:243], v0 offset:10240
v_mfma_f32_16x16x32_bf16 v[236:239], a[244:247], a[12:15], v[236:239]
buffer_load_dwordx4 v16, s[20:23], s5 offen lds
v_mfma_f32_16x16x32_bf16 v[240:243], a[248:251], a[8:11], v[240:243]
ds_read_b64_tr_b16 a[244:245], v1 offset:8192
ds_read_b64_tr_b16 a[246:247], v1 offset:10240
v_mfma_f32_16x16x32_bf16 v[248:251], a[248:251], a[12:15], v[248:251]
s_add_u32 s5, s54, 130304
buffer_load_dwordx4 v16, s[20:23], s5 offen offset:1024 lds
v_mfma_f32_16x16x32_bf16 v[244:247], a[252:255], a[8:11], v[244:247]
ds_read_b64_tr_b16 a[248:249], v2 offset:8192
ds_read_b64_tr_b16 a[250:251], v2 offset:10240
v_mfma_f32_16x16x32_bf16 v[252:255], a[252:255], a[12:15], v[252:255]
s_add_u32 s5, s54, 30976
L_step_2:
s_waitcnt lgkmcnt(6)
v_mfma_f32_16x16x32_bf16 v[128:131], a[224:227], a[16:19], v[128:131]
ds_read_b64_tr_b16 a[252:253], v3 offset:8192
ds_read_b64_tr_b16 a[254:255], v3 offset:10240
v_mfma_f32_16x16x32_bf16 v[136:139], a[224:227], a[20:23], v[136:139]
buffer_load_dwordx4 v16, s[20:23], s5 offen offset:2048 lds
v_mfma_f32_16x16x32_bf16 v[132:135], a[228:231], a[16:19], v[132:135]
ds_read_b64_tr_b16 a[224:225], v0 offset:4096
v_mfma_f32_16x16x32_bf16 v[140:143], a[228:231], a[20:23], v[140:143]
ds_read_b64_tr_b16 a[226:227], v0 offset:6144
s_add_u32 s5, s54, 161024
v_mfma_f32_16x16x32_bf16 v[144:147], a[232:235], a[16:19], v[144:147]
ds_read_b64_tr_b16 a[228:229], v1 offset:4096
ds_read_b64_tr_b16 a[230:231], v1 offset:6144
v_mfma_f32_16x16x32_bf16 v[152:155], a[232:235], a[20:23], v[152:155]
buffer_load_dwordx4 v16, s[20:23], s5 offen offset:3072 lds
v_mfma_f32_16x16x32_bf16 v[148:151], a[236:239], a[16:19], v[148:151]
ds_read_b64_tr_b16 a[232:233], v2 offset:4096
ds_read_b64_tr_b16 a[234:235], v2 offset:6144
v_mfma_f32_16x16x32_bf16 v[156:159], a[236:239], a[20:23], v[156:159]
s_add_u32 m0, s4, 114688
s_add_u32 s5, s63, 0
s_waitcnt lgkmcnt(6)
v_mfma_f32_16x16x32_bf16 v[160:163], a[240:243], a[16:19], v[160:163]
ds_read_b64_tr_b16 a[236:237], v3 offset:4096
ds_read_b64_tr_b16 a[238:239], v3 offset:6144
v_mfma_f32_16x16x32_bf16 v[168:171], a[240:243], a[20:23], v[168:171]
buffer_load_dwordx4 v17, s[8:11], s5 offen lds
v_mfma_f32_16x16x32_bf16 v[164:167], a[244:247], a[16:19], v[164:167]
ds_read_b64_tr_b16 a[240:241], v0 offset:12288
ds_read_b64_tr_b16 a[242:243], v0 offset:14336
v_mfma_f32_16x16x32_bf16 v[172:175], a[244:247], a[20:23], v[172:175]
s_add_u32 s5, s63, 6144
buffer_load_dwordx4 v17, s[8:11], s5 offen offset:1024 lds
v_mfma_f32_16x16x32_bf16 v[176:179], a[248:251], a[16:19], v[176:179]
ds_read_b64_tr_b16 a[244:245], v1 offset:12288
ds_read_b64_tr_b16 a[246:247], v1 offset:14336
v_mfma_f32_16x16x32_bf16 v[184:187], a[248:251], a[20:23], v[184:187]
s_add_u32 s5, s63, 12288
buffer_load_dwordx4 v17, s[8:11], s5 offen offset:2048 lds
v_mfma_f32_16x16x32_bf16 v[180:183], a[252:255], a[16:19], v[180:183]
ds_read_b64_tr_b16 a[248:249], v2 offset:12288
ds_read_b64_tr_b16 a[250:251], v2 offset:14336
v_mfma_f32_16x16x32_bf16 v[188:191], a[252:255], a[20:23], v[188:191]
v_add_u32 v0, 0x8000, v0
s_add_u32 s5, s63, 18432
s_waitcnt lgkmcnt(6)
v_mfma_f32_16x16x32_bf16 v[128:131], a[224:227], a[24:27], v[128:131]
ds_read_b64_tr_b16 a[252:253], v3 offset:12288
ds_read_b64_tr_b16 a[254:255], v3 offset:14336
v_mfma_f32_16x16x32_bf16 v[136:139], a[224:227], a[28:31], v[136:139]
buffer_load_dwordx4 v17, s[8:11], s5 offen offset:3072 lds
v_mfma_f32_16x16x32_bf16 v[132:135], a[228:231], a[24:27], v[132:135]
s_waitcnt vmcnt(20)
s_barrier
v_mfma_f32_16x16x32_bf16 v[140:143], a[228:231], a[28:31], v[140:143]
ds_read_b64_tr_b16 a[224:225], v0 offset:32768
ds_read_b64_tr_b16 a[226:227], v0 offset:34816
v_add_u32 v1, 0x8000, v1
v_mfma_f32_16x16x32_bf16 v[144:147], a[232:235], a[24:27], v[144:147]
ds_read_b64_tr_b16 a[228:229], v1 offset:32768
ds_read_b64_tr_b16 a[230:231], v1 offset:34816
v_mfma_f32_16x16x32_bf16 v[152:155], a[232:235], a[28:31], v[152:155]
v_add_u32 v2, 0x8000, v2
v_add_u32 v3, 0x8000, v3
s_add_u32 m0, s4, 147456
v_mfma_f32_16x16x32_bf16 v[148:151], a[236:239], a[24:27], v[148:151]
ds_read_b64_tr_b16 a[232:233], v2 offset:32768
ds_read_b64_tr_b16 a[234:235], v2 offset:34816
v_mfma_f32_16x16x32_bf16 v[156:159], a[236:239], a[28:31], v[156:159]
s_mov_b32 s35, 0
s_waitcnt lgkmcnt(6)
v_mfma_f32_16x16x32_bf16 v[160:163], a[240:243], a[24:27], v[160:163]
ds_read_b64_tr_b16 a[236:237], v3 offset:32768
ds_read_b64_tr_b16 a[238:239], v3 offset:34816
v_mfma_f32_16x16x32_bf16 v[168:171], a[240:243], a[28:31], v[168:171]
buffer_load_dwordx4 v6, s[12:15], s35 offen nt lds
s_add_u32 m0, s4, 81920
v_mfma_f32_16x16x32_bf16 v[164:167], a[244:247], a[24:27], v[164:167]
ds_read_b64_tr_b16 a[240:241], v0 offset:40960
ds_read_b64_tr_b16 a[242:243], v0 offset:43008
v_mfma_f32_16x16x32_bf16 v[172:175], a[244:247], a[28:31], v[172:175]
s_add_u32 s5, s55, 0
buffer_load_dwordx4 v16, s[20:23], s5 offen lds
v_mfma_f32_16x16x32_bf16 v[176:179], a[248:251], a[24:27], v[176:179]
ds_read_b64_tr_b16 a[244:245], v1 offset:40960
v_mfma_f32_16x16x32_bf16 v[184:187], a[248:251], a[28:31], v[184:187]
ds_read_b64_tr_b16 a[246:247], v1 offset:43008
s_add_u32 s5, s55, 130048
v_mfma_f32_16x16x32_bf16 v[180:183], a[252:255], a[24:27], v[180:183]
ds_read_b64_tr_b16 a[248:249], v2 offset:40960
v_mfma_f32_16x16x32_bf16 v[188:191], a[252:255], a[28:31], v[188:191]
ds_read_b64_tr_b16 a[250:251], v2 offset:43008
L_step_3:
s_waitcnt lgkmcnt(6)
v_mfma_f32_16x16x32_bf16 v[192:195], a[224:227], a[16:19], v[192:195]
ds_read_b64_tr_b16 a[252:253], v3 offset:40960
ds_read_b64_tr_b16 a[254:255], v3 offset:43008
v_mfma_f32_16x16x32_bf16 v[200:203], a[224:227], a[20:23], v[200:203]
buffer_load_dwordx4 v16, s[20:23], s5 offen offset:1024 lds
v_mfma_f32_16x16x32_bf16 v[196:199], a[228:231], a[16:19], v[196:199]
ds_read_b64_tr_b16 a[224:225], v0 offset:36864
v_mfma_f32_16x16x32_bf16 v[204:207], a[228:231], a[20:23], v[204:207]
ds_read_b64_tr_b16 a[226:227], v0 offset:38912
s_add_u32 m0, s4, 147456
v_mfma_f32_16x16x32_bf16 v[208:211], a[232:235], a[16:19], v[208:211]
ds_read_b64_tr_b16 a[228:229], v1 offset:36864
ds_read_b64_tr_b16 a[230:231], v1 offset:38912
v_mfma_f32_16x16x32_bf16 v[216:219], a[232:235], a[20:23], v[216:219]
buffer_load_dwordx4 v7, s[12:15], s35 offen offset:1024 nt lds
v_mfma_f32_16x16x32_bf16 v[212:215], a[236:239], a[16:19], v[212:215]
ds_read_b64_tr_b16 a[232:233], v2 offset:36864
ds_read_b64_tr_b16 a[234:235], v2 offset:38912
v_mfma_f32_16x16x32_bf16 v[220:223], a[236:239], a[20:23], v[220:223]
s_add_u32 m0, s4, 81920
s_waitcnt lgkmcnt(6)
v_mfma_f32_16x16x32_bf16 v[224:227], a[240:243], a[16:19], v[224:227]
ds_read_b64_tr_b16 a[236:237], v3 offset:36864
ds_read_b64_tr_b16 a[238:239], v3 offset:38912
v_mfma_f32_16x16x32_bf16 v[232:235], a[240:243], a[20:23], v[232:235]
s_add_u32 s5, s55, 30720
buffer_load_dwordx4 v16, s[20:23], s5 offen offset:2048 lds
v_mfma_f32_16x16x32_bf16 v[228:231], a[244:247], a[16:19], v[228:231]
ds_read_b64_tr_b16 a[240:241], v0 offset:45056
v_mfma_f32_16x16x32_bf16 v[236:239], a[244:247], a[20:23], v[236:239]
ds_read_b64_tr_b16 a[242:243], v0 offset:47104
s_add_u32 s5, s55, 160768
v_mfma_f32_16x16x32_bf16 v[240:243], a[248:251], a[16:19], v[240:243]
ds_read_b64_tr_b16 a[244:245], v1 offset:45056
ds_read_b64_tr_b16 a[246:247], v1 offset:47104
v_mfma_f32_16x16x32_bf16 v[248:251], a[248:251], a[20:23], v[248:251]
buffer_load_dwordx4 v16, s[20:23], s5 offen offset:3072 lds
v_mfma_f32_16x16x32_bf16 v[244:247], a[252:255], a[16:19], v[244:247]
ds_read_b64_tr_b16 a[248:249], v2 offset:45056
ds_read_b64_tr_b16 a[250:251], v2 offset:47104
v_mfma_f32_16x16x32_bf16 v[252:255], a[252:255], a[20:23], v[252:255]
s_add_u32 m0, s4, 147456
s_waitcnt lgkmcnt(6)
v_mfma_f32_16x16x32_bf16 v[192:195], a[224:227], a[24:27], v[192:195]
ds_read_b64_tr_b16 a[252:253], v3 offset:45056
v_mfma_f32_16x16x32_bf16 v[200:203], a[224:227], a[28:31], v[200:203]
ds_read_b64_tr_b16 a[254:255], v3 offset:47104
v_mfma_f32_16x16x32_bf16 v[196:199], a[228:231], a[24:27], v[196:199]
s_waitcnt vmcnt(18)
s_barrier
v_mfma_f32_16x16x32_bf16 v[204:207], a[228:231], a[28:31], v[204:207]
ds_read_b128 a[32:35], v22 offset:49152
ds_read_b64_tr_b16 a[224:225], v0 offset:16384
ds_read_b64_tr_b16 a[226:227], v0 offset:18432
v_mfma_f32_16x16x32_bf16 v[208:211], a[232:235], a[24:27], v[208:211]
ds_read_b128 a[36:39], v22 offset:51200
v_mfma_f32_16x16x32_bf16 v[216:219], a[232:235], a[28:31], v[216:219]
ds_read_b64_tr_b16 a[228:229], v1 offset:16384
ds_read_b64_tr_b16 a[230:231], v1 offset:18432
v_mfma_f32_16x16x32_bf16 v[212:215], a[236:239], a[24:27], v[212:215]
ds_read_b128 a[40:43], v22 offset:49216
ds_read_b64_tr_b16 a[232:233], v2 offset:16384
v_mfma_f32_16x16x32_bf16 v[220:223], a[236:239], a[28:31], v[220:223]
ds_read_b64_tr_b16 a[234:235], v2 offset:18432
s_waitcnt lgkmcnt(9)
v_mfma_f32_16x16x32_bf16 v[224:227], a[240:243], a[24:27], v[224:227]
ds_read_b128 a[44:47], v22 offset:51264
ds_read_b64_tr_b16 a[236:237], v3 offset:16384
v_mfma_f32_16x16x32_bf16 v[232:235], a[240:243], a[28:31], v[232:235]
ds_read_b64_tr_b16 a[238:239], v3 offset:18432
buffer_load_dwordx4 v6, s[12:15], s35 offen offset:2048 nt lds
v_mfma_f32_16x16x32_bf16 v[228:231], a[244:247], a[24:27], v[228:231]
ds_read_b64_tr_b16 a[240:241], v0 offset:24576
ds_read_b64_tr_b16 a[242:243], v0 offset:26624
s_add_u32 m0, s4, 16384
v_mfma_f32_16x16x32_bf16 v[236:239], a[244:247], a[28:31], v[236:239]
s_add_u32 s5, s55, 256
buffer_load_dwordx4 v16, s[20:23], s5 offen lds
v_mfma_f32_16x16x32_bf16 v[240:243], a[248:251], a[24:27], v[240:243]
ds_read_b64_tr_b16 a[244:245], v1 offset:24576
ds_read_b64_tr_b16 a[246:247], v1 offset:26624
v_mfma_f32_16x16x32_bf16 v[248:251], a[248:251], a[28:31], v[248:251]
s_add_u32 s5, s55, 130304
buffer_load_dwordx4 v16, s[20:23], s5 offen offset:1024 lds
v_mfma_f32_16x16x32_bf16 v[244:247], a[252:255], a[24:27], v[244:247]
ds_read_b64_tr_b16 a[248:249], v2 offset:24576
ds_read_b64_tr_b16 a[250:251], v2 offset:26624
v_mfma_f32_16x16x32_bf16 v[252:255], a[252:255], a[28:31], v[252:255]
s_add_u32 s5, s55, 30976
L_step_4:
s_waitcnt lgkmcnt(6)
v_mfma_f32_16x16x32_bf16 v[128:131], a[224:227], a[32:35], v[128:131]
ds_read_b64_tr_b16 a[252:253], v3 offset:24576
ds_read_b64_tr_b16 a[254:255], v3 offset:26624
v_mfma_f32_16x16x32_bf16 v[136:139], a[224:227], a[36:39], v[136:139]
buffer_load_dwordx4 v16, s[20:23], s5 offen offset:2048 lds
v_mfma_f32_16x16x32_bf16 v[132:135], a[228:231], a[32:35], v[132:135]
ds_read_b64_tr_b16 a[224:225], v0 offset:20480
v_mfma_f32_16x16x32_bf16 v[140:143], a[228:231], a[36:39], v[140:143]
ds_read_b64_tr_b16 a[226:227], v0 offset:22528
s_add_u32 s5, s55, 161024
v_mfma_f32_16x16x32_bf16 v[144:147], a[232:235], a[32:35], v[144:147]
ds_read_b64_tr_b16 a[228:229], v1 offset:20480
ds_read_b64_tr_b16 a[230:231], v1 offset:22528
v_mfma_f32_16x16x32_bf16 v[152:155], a[232:235], a[36:39], v[152:155]
buffer_load_dwordx4 v16, s[20:23], s5 offen offset:3072 lds
s_add_u32 m0, s4, 0
v_mfma_f32_16x16x32_bf16 v[148:151], a[236:239], a[32:35], v[148:151]
ds_read_b64_tr_b16 a[232:233], v2 offset:20480
ds_read_b64_tr_b16 a[234:235], v2 offset:22528
s_add_u32 s5, s100, 0
v_mfma_f32_16x16x32_bf16 v[156:159], a[236:239], a[36:39], v[156:159]
buffer_load_dwordx4 v17, s[8:11], s5 offen lds
s_waitcnt lgkmcnt(6)
v_mfma_f32_16x16x32_bf16 v[160:163], a[240:243], a[32:35], v[160:163]
ds_read_b64_tr_b16 a[236:237], v3 offset:20480
ds_read_b64_tr_b16 a[238:239], v3 offset:22528
v_mfma_f32_16x16x32_bf16 v[168:171], a[240:243], a[36:39], v[168:171]
s_add_u32 m0, s4, 147456
s_nop 0
buffer_load_dwordx4 v7, s[12:15], s35 offen offset:3072 nt lds
v_mfma_f32_16x16x32_bf16 v[164:167], a[244:247], a[32:35], v[164:167]
ds_read_b64_tr_b16 a[240:241], v0 offset:28672
ds_read_b64_tr_b16 a[242:243], v0 offset:30720
s_add_u32 m0, s4, 0
v_mfma_f32_16x16x32_bf16 v[172:175], a[244:247], a[36:39], v[172:175]
s_add_u32 s5, s100, 6144
buffer_load_dwordx4 v17, s[8:11], s5 offen offset:1024 lds
v_mfma_f32_16x16x32_bf16 v[176:179], a[248:251], a[32:35], v[176:179]
ds_read_b64_tr_b16 a[244:245], v1 offset:28672
v_mfma_f32_16x16x32_bf16 v[184:187], a[248:251], a[36:39], v[184:187]
ds_read_b64_tr_b16 a[246:247], v1 offset:30720
s_add_u32 s5, s100, 12288
v_mfma_f32_16x16x32_bf16 v[180:183], a[252:255], a[32:35], v[180:183]
ds_read_b64_tr_b16 a[248:249], v2 offset:28672
ds_read_b64_tr_b16 a[250:251], v2 offset:30720
v_mfma_f32_16x16x32_bf16 v[188:191], a[252:255], a[36:39], v[188:191]
buffer_load_dwordx4 v17, s[8:11], s5 offen offset:2048 lds
s_waitcnt lgkmcnt(6)
v_mfma_f32_16x16x32_bf16 v[128:131], a[224:227], a[40:43], v[128:131]
ds_read_b64_tr_b16 a[252:253], v3 offset:28672
ds_read_b64_tr_b16 a[254:255], v3 offset:30720
v_mfma_f32_16x16x32_bf16 v[136:139], a[224:227], a[44:47], v[136:139]
s_add_u32 s5, s100, 18432
buffer_load_dwordx4 v17, s[8:11], s5 offen offset:3072 lds
v_mfma_f32_16x16x32_bf16 v[132:135], a[228:231], a[40:43], v[132:135]
s_waitcnt vmcnt(20)
s_barrier
v_mfma_f32_16x16x32_bf16 v[140:143], a[228:231], a[44:47], v[140:143]
ds_read_b64_tr_b16 a[224:225], v0 offset:0
ds_read_b64_tr_b16 a[226:227], v0 offset:2048
v_mfma_f32_16x16x32_bf16 v[144:147], a[232:235], a[40:43], v[144:147]
ds_read_b64_tr_b16 a[228:229], v1 offset:0
ds_read_b64_tr_b16 a[230:231], v1 offset:2048
v_mfma_f32_16x16x32_bf16 v[152:155], a[232:235], a[44:47], v[152:155]
s_add_u32 m0, s4, 65536
s_add_u32 s5, s56, 0
v_mfma_f32_16x16x32_bf16 v[148:151], a[236:239], a[40:43], v[148:151]
ds_read_b64_tr_b16 a[232:233], v2 offset:0
v_mfma_f32_16x16x32_bf16 v[156:159], a[236:239], a[44:47], v[156:159]
ds_read_b64_tr_b16 a[234:235], v2 offset:2048
s_waitcnt lgkmcnt(6)
v_mfma_f32_16x16x32_bf16 v[160:163], a[240:243], a[40:43], v[160:163]
ds_read_b64_tr_b16 a[236:237], v3 offset:0
ds_read_b64_tr_b16 a[238:239], v3 offset:2048
v_mfma_f32_16x16x32_bf16 v[168:171], a[240:243], a[44:47], v[168:171]
buffer_load_dwordx4 v16, s[20:23], s5 offen lds
v_mfma_f32_16x16x32_bf16 v[164:167], a[244:247], a[40:43], v[164:167]
ds_read_b64_tr_b16 a[240:241], v0 offset:8192
v_mfma_f32_16x16x32_bf16 v[172:175], a[244:247], a[44:47], v[172:175]
ds_read_b64_tr_b16 a[242:243], v0 offset:10240
s_add_u32 s5, s56, 130048
v_mfma_f32_16x16x32_bf16 v[176:179], a[248:251], a[40:43], v[176:179]
ds_read_b64_tr_b16 a[244:245], v1 offset:8192
ds_read_b64_tr_b16 a[246:247], v1 offset:10240
v_mfma_f32_16x16x32_bf16 v[184:187], a[248:251], a[44:47], v[184:187]
buffer_load_dwordx4 v16, s[20:23], s5 offen offset:1024 lds
v_mfma_f32_16x16x32_bf16 v[180:183], a[252:255], a[40:43], v[180:183]
ds_read_b64_tr_b16 a[248:249], v2 offset:8192
ds_read_b64_tr_b16 a[250:251], v2 offset:10240
v_mfma_f32_16x16x32_bf16 v[188:191], a[252:255], a[44:47], v[188:191]
s_add_u32 s5, s56, 30720
L_step_5:
s_waitcnt lgkmcnt(6)
v_mfma_f32_16x16x32_bf16 v[192:195], a[224:227], a[32:35], v[192:195]
ds_read_b64_tr_b16 a[252:253], v3 offset:8192
v_mfma_f32_16x16x32_bf16 v[200:203], a[224:227], a[36:39], v[200:203]
ds_read_b64_tr_b16 a[254:255], v3 offset:10240
v_mfma_f32_16x16x32_bf16 v[196:199], a[228:231], a[32:35], v[196:199]
ds_read_b64_tr_b16 a[224:225], v0 offset:4096
ds_read_b64_tr_b16 a[226:227], v0 offset:6144
v_mfma_f32_16x16x32_bf16 v[204:207], a[228:231], a[36:39], v[204:207]
buffer_load_dwordx4 v16, s[20:23], s5 offen offset:2048 lds
v_mfma_f32_16x16x32_bf16 v[208:211], a[232:235], a[32:35], v[208:211]
ds_read_b64_tr_b16 a[228:229], v1 offset:4096
v_mfma_f32_16x16x32_bf16 v[216:219], a[232:235], a[36:39], v[216:219]
ds_read_b64_tr_b16 a[230:231], v1 offset:6144
s_add_u32 s5, s56, 160768
v_mfma_f32_16x16x32_bf16 v[212:215], a[236:239], a[32:35], v[212:215]
ds_read_b64_tr_b16 a[232:233], v2 offset:4096
v_mfma_f32_16x16x32_bf16 v[220:223], a[236:239], a[36:39], v[220:223]
ds_read_b64_tr_b16 a[234:235], v2 offset:6144
s_waitcnt lgkmcnt(6)
v_mfma_f32_16x16x32_bf16 v[224:227], a[240:243], a[32:35], v[224:227]
ds_read_b64_tr_b16 a[236:237], v3 offset:4096
ds_read_b64_tr_b16 a[238:239], v3 offset:6144
v_mfma_f32_16x16x32_bf16 v[232:235], a[240:243], a[36:39], v[232:235]
buffer_load_dwordx4 v16, s[20:23], s5 offen offset:3072 lds
v_mfma_f32_16x16x32_bf16 v[228:231], a[244:247], a[32:35], v[228:231]
L_pg2:
s_cbranch_scc1 L_pg6
ds_read_b64_tr_b16 a[240:241], v0 offset:12288
v_mfma_f32_16x16x32_bf16 v[236:239], a[244:247], a[36:39], v[236:239]
ds_read_b64_tr_b16 a[242:243], v0 offset:14336
v_mfma_f32_16x16x32_bf16 v[240:243], a[248:251], a[32:35], v[240:243]
ds_read_b64_tr_b16 a[244:245], v1 offset:12288
v_mfma_f32_16x16x32_bf16 v[248:251], a[248:251], a[36:39], v[248:251]
ds_read_b64_tr_b16 a[246:247], v1 offset:14336
v_mfma_f32_16x16x32_bf16 v[244:247], a[252:255], a[32:35], v[244:247]
ds_read_b64_tr_b16 a[248:249], v2 offset:12288
ds_read_b64_tr_b16 a[250:251], v2 offset:14336
v_mfma_f32_16x16x32_bf16 v[252:255], a[252:255], a[36:39], v[252:255]
s_add_u32 m0, s4, 49152
s_waitcnt lgkmcnt(6)
v_mfma_f32_16x16x32_bf16 v[192:195], a[224:227], a[40:43], v[192:195]
ds_read_b64_tr_b16 a[252:253], v3 offset:12288
v_mfma_f32_16x16x32_bf16 v[200:203], a[224:227], a[44:47], v[200:203]
ds_read_b64_tr_b16 a[254:255], v3 offset:14336
s_add_u32 s5, s56, 256
v_mfma_f32_16x16x32_bf16 v[196:199], a[228:231], a[40:43], v[196:199]
s_waitcnt vmcnt(14)
s_barrier
v_mfma_f32_16x16x32_bf16 v[204:207], a[228:231], a[44:47], v[204:207]
ds_read_b128 a[48:51], v22 offset:16384
ds_read_b64_tr_b16 a[224:225], v0 offset:49152
ds_read_b64_tr_b16 a[226:227], v0 offset:51200
v_mfma_f32_16x16x32_bf16 v[208:211], a[232:235], a[40:43], v[208:211]
ds_read_b128 a[52:55], v22 offset:18432
v_mfma_f32_16x16x32_bf16 v[216:219], a[232:235], a[44:47], v[216:219]
ds_read_b64_tr_b16 a[228:229], v1 offset:49152
ds_read_b64_tr_b16 a[230:231], v1 offset:51200
v_mfma_f32_16x16x32_bf16 v[212:215], a[236:239], a[40:43], v[212:215]
ds_read_b128 a[56:59], v22 offset:16448
ds_read_b64_tr_b16 a[232:233], v2 offset:49152
v_mfma_f32_16x16x32_bf16 v[220:223], a[236:239], a[44:47], v[220:223]
ds_read_b64_tr_b16 a[234:235], v2 offset:51200
s_waitcnt lgkmcnt(9)
v_mfma_f32_16x16x32_bf16 v[224:227], a[240:243], a[40:43], v[224:227]
ds_read_b128 a[60:63], v22 offset:18496
v_mfma_f32_16x16x32_bf16 v[232:235], a[240:243], a[44:47], v[232:235]
ds_read_b64_tr_b16 a[236:237], v3 offset:49152
ds_read_b64_tr_b16 a[238:239], v3 offset:51200
v_mfma_f32_16x16x32_bf16 v[228:231], a[244:247], a[40:43], v[228:231]
ds_read_b64_tr_b16 a[240:241], v0 offset:57344
ds_read_b64_tr_b16 a[242:243], v0 offset:59392
v_mfma_f32_16x16x32_bf16 v[236:239], a[244:247], a[44:47], v[236:239]
buffer_load_dwordx4 v16, s[20:23], s5 offen lds
v_mfma_f32_16x16x32_bf16 v[240:243], a[248:251], a[40:43], v[240:243]
ds_read_b64_tr_b16 a[244:245], v1 offset:57344
ds_read_b64_tr_b16 a[246:247], v1 offset:59392
v_mfma_f32_16x16x32_bf16 v[248:251], a[248:251], a[44:47], v[248:251]
s_add_u32 s5, s56, 130304
buffer_load_dwordx4 v16, s[20:23], s5 offen offset:1024 lds
v_mfma_f32_16x16x32_bf16 v[244:247], a[252:255], a[40:43], v[244:247]
ds_read_b64_tr_b16 a[248:249], v2 offset:57344
ds_read_b64_tr_b16 a[250:251], v2 offset:59392
v_mfma_f32_16x16x32_bf16 v[252:255], a[252:255], a[44:47], v[252:255]
s_add_u32 s5, s56, 30976
L_step_6:
s_waitcnt lgkmcnt(6)
v_mfma_f32_16x16x32_bf16 v[128:131], a[224:227], a[48:51], v[128:131]
ds_read_b64_tr_b16 a[252:253], v3 offset:57344
ds_read_b64_tr_b16 a[254:255], v3 offset:59392
v_mfma_f32_16x16x32_bf16 v[136:139], a[224:227], a[52:55], v[136:139]
buffer_load_dwordx4 v16, s[20:23], s5 offen offset:2048 lds
v_mfma_f32_16x16x32_bf16 v[132:135], a[228:231], a[48:51], v[132:135]
ds_read_b64_tr_b16 a[224:225], v0 offset:53248
v_mfma_f32_16x16x32_bf16 v[140:143], a[228:231], a[52:55], v[140:143]
ds_read_b64_tr_b16 a[226:227], v0 offset:55296
s_add_u32 s5, s56, 161024
v_mfma_f32_16x16x32_bf16 v[144:147], a[232:235], a[48:51], v[144:147]
ds_read_b64_tr_b16 a[228:229], v1 offset:53248
ds_read_b64_tr_b16 a[230:231], v1 offset:55296
v_mfma_f32_16x16x32_bf16 v[152:155], a[232:235], a[52:55], v[152:155]
buffer_load_dwordx4 v16, s[20:23], s5 offen offset:3072 lds
v_mfma_f32_16x16x32_bf16 v[148:151], a[236:239], a[48:51], v[148:151]
ds_read_b64_tr_b16 a[232:233], v2 offset:53248
ds_read_b64_tr_b16 a[234:235], v2 offset:55296
v_mfma_f32_16x16x32_bf16 v[156:159], a[236:239], a[52:55], v[156:159]
s_add_u32 m0, s4, 131072
s_add_u32 s5, s101, 0
s_waitcnt lgkmcnt(6)
v_mfma_f32_16x16x32_bf16 v[160:163], a[240:243], a[48:51], v[160:163]
ds_read_b64_tr_b16 a[236:237], v3 offset:53248
ds_read_b64_tr_b16 a[238:239], v3 offset:55296
v_mfma_f32_16x16x32_bf16 v[168:171], a[240:243], a[52:55], v[168:171]
buffer_load_dwordx4 v17, s[8:11], s5 offen lds
v_mfma_f32_16x16x32_bf16 v[164:167], a[244:247], a[48:51], v[164:167]
ds_read_b64_tr_b16 a[240:241], v0 offset:61440
ds_read_b64_tr_b16 a[242:243], v0 offset:63488
v_mfma_f32_16x16x32_bf16 v[172:175], a[244:247], a[52:55], v[172:175]
s_add_u32 s5, s101, 6144
buffer_load_dwordx4 v17, s[8:11], s5 offen offset:1024 lds
v_mfma_f32_16x16x32_bf16 v[176:179], a[248:251], a[48:51], v[176:179]
ds_read_b64_tr_b16 a[244:245], v1 offset:61440
ds_read_b64_tr_b16 a[246:247], v1 offset:63488
v_mfma_f32_16x16x32_bf16 v[184:187], a[248:251], a[52:55], v[184:187]
s_add_u32 s5, s101, 12288
buffer_load_dwordx4 v17, s[8:11], s5 offen offset:2048 lds
v_mfma_f32_16x16x32_bf16 v[180:183], a[252:255], a[48:51], v[180:183]
ds_read_b64_tr_b16 a[248:249], v2 offset:61440
ds_read_b64_tr_b16 a[250:251], v2 offset:63488
v_mfma_f32_16x16x32_bf16 v[188:191], a[252:255], a[52:55], v[188:191]
v_add_u32 v0, 0xffffc000, v0
s_add_u32 s5, s101, 18432
s_waitcnt lgkmcnt(6)
v_mfma_f32_16x16x32_bf16 v[128:131], a[224:227], a[56:59], v[128:131]
ds_read_b64_tr_b16 a[252:253], v3 offset:61440
ds_read_b64_tr_b16 a[254:255], v3 offset:63488
v_mfma_f32_16x16x32_bf16 v[136:139], a[224:227], a[60:63], v[136:139]
buffer_load_dwordx4 v17, s[8:11], s5 offen offset:3072 lds
v_mfma_f32_16x16x32_bf16 v[132:135], a[228:231], a[56:59], v[132:135]
s_waitcnt vmcnt(17)
s_barrier
v_mfma_f32_16x16x32_bf16 v[140:143], a[228:231], a[60:63], v[140:143]
ds_read_b64_tr_b16 a[224:225], v0 offset:0
ds_read_b64_tr_b16 a[226:227], v0 offset:2048
v_add_u32 v1, 0xffffc000, v1
v_mfma_f32_16x16x32_bf16 v[144:147], a[232:235], a[56:59], v[144:147]
ds_read_b64_tr_b16 a[228:229], v1 offset:0
ds_read_b64_tr_b16 a[230:231], v1 offset:2048
v_mfma_f32_16x16x32_bf16 v[152:155], a[232:235], a[60:63], v[152:155]
v_add_u32 v2, 0xffffc000, v2
v_add_u32 v3, 0xffffc000, v3
s_add_u32 m0, s4, 32768
v_mfma_f32_16x16x32_bf16 v[148:151], a[236:239], a[56:59], v[148:151]
ds_read_b64_tr_b16 a[232:233], v2 offset:0
ds_read_b64_tr_b16 a[234:235], v2 offset:2048
v_mfma_f32_16x16x32_bf16 v[156:159], a[236:239], a[60:63], v[156:159]
s_mov_b32 s35, 16384
s_waitcnt lgkmcnt(6)
v_mfma_f32_16x16x32_bf16 v[160:163], a[240:243], a[56:59], v[160:163]
ds_read_b64_tr_b16 a[236:237], v3 offset:0
ds_read_b64_tr_b16 a[238:239], v3 offset:2048
v_mfma_f32_16x16x32_bf16 v[168:171], a[240:243], a[60:63], v[168:171]
buffer_load_dwordx4 v6, s[12:15], s35 offen nt lds
s_add_u32 m0, s4, 98304
v_mfma_f32_16x16x32_bf16 v[164:167], a[244:247], a[56:59], v[164:167]
ds_read_b64_tr_b16 a[240:241], v0 offset:8192
ds_read_b64_tr_b16 a[242:243], v0 offset:10240
v_mfma_f32_16x16x32_bf16 v[172:175], a[244:247], a[60:63], v[172:175]
s_add_u32 s5, s57, 0
buffer_load_dwordx4 v16, s[20:23], s5 offen lds
v_mfma_f32_16x16x32_bf16 v[176:179], a[248:251], a[56:59], v[176:179]
ds_read_b64_tr_b16 a[244:245], v1 offset:8192
v_mfma_f32_16x16x32_bf16 v[184:187], a[248:251], a[60:63], v[184:187]
ds_read_b64_tr_b16 a[246:247], v1 offset:10240
s_add_u32 s5, s57, 130048
v_mfma_f32_16x16x32_bf16 v[180:183], a[252:255], a[56:59], v[180:183]
ds_read_b64_tr_b16 a[248:249], v2 offset:8192
ds_read_b64_tr_b16 a[250:251], v2 offset:10240
v_mfma_f32_16x16x32_bf16 v[188:191], a[252:255], a[60:63], v[188:191]
buffer_load_dwordx4 v16, s[20:23], s5 offen offset:1024 lds
L_step_7:
s_waitcnt lgkmcnt(6)
v_mfma_f32_16x16x32_bf16 v[192:195], a[224:227], a[48:51], v[192:195]
ds_read_b64_tr_b16 a[252:253], v3 offset:8192
v_mfma_f32_16x16x32_bf16 v[200:203], a[224:227], a[52:55], v[200:203]
ds_read_b64_tr_b16 a[254:255], v3 offset:10240
s_add_u32 s5, s57, 30720
v_mfma_f32_16x16x32_bf16 v[196:199], a[228:231], a[48:51], v[196:199]
ds_read_b64_tr_b16 a[224:225], v0 offset:4096
ds_read_b64_tr_b16 a[226:227], v0 offset:6144
v_mfma_f32_16x16x32_bf16 v[204:207], a[228:231], a[52:55], v[204:207]
buffer_load_dwordx4 v16, s[20:23], s5 offen offset:2048 lds
v_mfma_f32_16x16x32_bf16 v[208:211], a[232:235], a[48:51], v[208:211]
ds_read_b64_tr_b16 a[228:229], v1 offset:4096
v_mfma_f32_16x16x32_bf16 v[216:219], a[232:235], a[52:55], v[216:219]
ds_read_b64_tr_b16 a[230:231], v1 offset:6144
s_add_u32 m0, s4, 32768
v_mfma_f32_16x16x32_bf16 v[212:215], a[236:239], a[48:51], v[212:215]
ds_read_b64_tr_b16 a[232:233], v2 offset:4096
v_mfma_f32_16x16x32_bf16 v[220:223], a[236:239], a[52:55], v[220:223]
ds_read_b64_tr_b16 a[234:235], v2 offset:6144
s_waitcnt lgkmcnt(6)
v_mfma_f32_16x16x32_bf16 v[224:227], a[240:243], a[48:51], v[224:227]
ds_read_b64_tr_b16 a[236:237], v3 offset:4096
ds_read_b64_tr_b16 a[238:239], v3 offset:6144
v_mfma_f32_16x16x32_bf16 v[232:235], a[240:243], a[52:55], v[232:235]
buffer_load_dwordx4 v7, s[12:15], s35 offen offset:1024 nt lds
s_add_u32 m0, s4, 98304
v_mfma_f32_16x16x32_bf16 v[228:231], a[244:247], a[48:51], v[228:231]
ds_read_b64_tr_b16 a[240:241], v0 offset:12288
ds_read_b64_tr_b16 a[242:243], v0 offset:14336
v_mfma_f32_16x16x32_bf16 v[236:239], a[244:247], a[52:55], v[236:239]
s_add_u32 s5, s57, 160768
buffer_load_dwordx4 v16, s[20:23], s5 offen offset:3072 lds
v_mfma_f32_16x16x32_bf16 v[240:243], a[248:251], a[48:51], v[240:243]
ds_read_b64_tr_b16 a[244:245], v1 offset:12288
v_mfma_f32_16x16x32_bf16 v[248:251], a[248:251], a[52:55], v[248:251]
ds_read_b64_tr_b16 a[246:247], v1 offset:14336
s_mov_b32 s5, 512
v_mfma_f32_16x16x32_bf16 v[244:247], a[252:255], a[48:51], v[244:247]
ds_read_b64_tr_b16 a[248:249], v2 offset:12288
v_mfma_f32_16x16x32_bf16 v[252:255], a[252:255], a[52:55], v[252:255]
ds_read_b64_tr_b16 a[250:251], v2 offset:14336
s_waitcnt lgkmcnt(6)
v_mfma_f32_16x16x32_bf16 v[192:195], a[224:227], a[56:59], v[192:195]
ds_read_b64_tr_b16 a[252:253], v3 offset:12288
ds_read_b64_tr_b16 a[254:255], v3 offset:14336
v_mfma_f32_16x16x32_bf16 v[200:203], a[224:227], a[60:63], v[200:203]
buffer_load_dword v20, v18, s[20:23], s5 offen
v_mfma_f32_16x16x32_bf16 v[196:199], a[228:231], a[56:59], v[196:199]
s_waitcnt vmcnt(15)
s_barrier
v_mfma_f32_16x16x32_bf16 v[204:207], a[228:231], a[60:63], v[204:207]
ds_read_b128 a[64:67], v22 offset:32768
ds_read_b64_tr_b16 a[224:225], v0 offset:49152
ds_read_b64_tr_b16 a[226:227], v0 offset:51200
v_mfma_f32_16x16x32_bf16 v[208:211], a[232:235], a[56:59], v[208:211]
ds_read_b128 a[68:71], v22 offset:34816
ds_read_b64_tr_b16 a[228:229], v1 offset:49152
v_mfma_f32_16x16x32_bf16 v[216:219], a[232:235], a[60:63], v[216:219]
ds_read_b64_tr_b16 a[230:231], v1 offset:51200
s_add_u32 m0, s4, 32768
v_mfma_f32_16x16x32_bf16 v[212:215], a[236:239], a[56:59], v[212:215]
ds_read_b128 a[72:75], v22 offset:32832
ds_read_b64_tr_b16 a[232:233], v2 offset:49152
v_mfma_f32_16x16x32_bf16 v[220:223], a[236:239], a[60:63], v[220:223]
ds_read_b64_tr_b16 a[234:235], v2 offset:51200
s_waitcnt lgkmcnt(9)
v_mfma_f32_16x16x32_bf16 v[224:227], a[240:243], a[56:59], v[224:227]
ds_read_b128 a[76:79], v22 offset:34880
ds_read_b64_tr_b16 a[236:237], v3 offset:49152
v_mfma_f32_16x16x32_bf16 v[232:235], a[240:243], a[60:63], v[232:235]
ds_read_b64_tr_b16 a[238:239], v3 offset:51200
buffer_load_dwordx4 v6, s[12:15], s35 offen offset:2048 nt lds
v_mfma_f32_16x16x32_bf16 v[228:231], a[244:247], a[56:59], v[228:231]
ds_read_b64_tr_b16 a[240:241], v0 offset:57344
ds_read_b64_tr_b16 a[242:243], v0 offset:59392
s_add_u32 m0, s4, 81920
v_mfma_f32_16x16x32_bf16 v[236:239], a[244:247], a[60:63], v[236:239]
s_add_u32 s5, s57, 256
buffer_load_dwordx4 v16, s[20:23], s5 offen lds
v_mfma_f32_16x16x32_bf16 v[240:243], a[248:251], a[56:59], v[240:243]
ds_read_b64_tr_b16 a[244:245], v1 offset:57344
v_mfma_f32_16x16x32_bf16 v[248:251], a[248:251], a[60:63], v[248:251]
ds_read_b64_tr_b16 a[246:247], v1 offset:59392
s_add_u32 s5, s57, 130304
v_mfma_f32_16x16x32_bf16 v[244:247], a[252:255], a[56:59], v[244:247]
ds_read_b64_tr_b16 a[248:249], v2 offset:57344
v_mfma_f32_16x16x32_bf16 v[252:255], a[252:255], a[60:63], v[252:255]
ds_read_b64_tr_b16 a[250:251], v2 offset:59392
L_step_8:
s_waitcnt lgkmcnt(6)
v_mfma_f32_16x16x32_bf16 v[128:131], a[224:227], a[64:67], v[128:131]
ds_read_b64_tr_b16 a[252:253], v3 offset:57344
ds_read_b64_tr_b16 a[254:255], v3 offset:59392
v_mfma_f32_16x16x32_bf16 v[136:139], a[224:227], a[68:71], v[136:139]
buffer_load_dwordx4 v16, s[20:23], s5 offen offset:1024 lds
v_mfma_f32_16x16x32_bf16 v[132:135], a[228:231], a[64:67], v[132:135]
ds_read_b64_tr_b16 a[224:225], v0 offset:53248
v_mfma_f32_16x16x32_bf16 v[140:143], a[228:231], a[68:71], v[140:143]
ds_read_b64_tr_b16 a[226:227], v0 offset:55296
s_add_u32 m0, s4, 32768
v_mfma_f32_16x16x32_bf16 v[144:147], a[232:235], a[64:67], v[144:147]
ds_read_b64_tr_b16 a[228:229], v1 offset:53248
ds_read_b64_tr_b16 a[230:231], v1 offset:55296
v_mfma_f32_16x16x32_bf16 v[152:155], a[232:235], a[68:71], v[152:155]
buffer_load_dwordx4 v7, s[12:15], s35 offen offset:3072 nt lds
v_mfma_f32_16x16x32_bf16 v[148:151], a[236:239], a[64:67], v[148:151]
ds_read_b64_tr_b16 a[232:233], v2 offset:53248
ds_read_b64_tr_b16 a[234:235], v2 offset:55296
v_mfma_f32_16x16x32_bf16 v[156:159], a[236:239], a[68:71], v[156:159]
s_add_u32 m0, s4, 81920
s_waitcnt lgkmcnt(6)
v_mfma_f32_16x16x32_bf16 v[160:163], a[240:243], a[64:67], v[160:163]
ds_read_b64_tr_b16 a[236:237], v3 offset:53248
ds_read_b64_tr_b16 a[238:239], v3 offset:55296
v_mfma_f32_16x16x32_bf16 v[168:171], a[240:243], a[68:71], v[168:171]
s_add_u32 s5, s57, 30976
buffer_load_dwordx4 v16, s[20:23], s5 offen offset:2048 lds
v_mfma_f32_16x16x32_bf16 v[164:167], a[244:247], a[64:67], v[164:167]
ds_read_b64_tr_b16 a[240:241], v0 offset:61440
v_mfma_f32_16x16x32_bf16 v[172:175], a[244:247], a[68:71], v[172:175]
ds_read_b64_tr_b16 a[242:243], v0 offset:63488
s_add_u32 s5, s57, 161024
v_mfma_f32_16x16x32_bf16 v[176:179], a[248:251], a[64:67], v[176:179]
ds_read_b64_tr_b16 a[244:245], v1 offset:61440
ds_read_b64_tr_b16 a[246:247], v1 offset:63488
v_mfma_f32_16x16x32_bf16 v[184:187], a[248:251], a[68:71], v[184:187]
buffer_load_dwordx4 v16, s[20:23], s5 offen offset:3072 lds
v_mfma_f32_16x16x32_bf16 v[180:183], a[252:255], a[64:67], v[180:183]
ds_read_b64_tr_b16 a[248:249], v2 offset:61440
ds_read_b64_tr_b16 a[250:251], v2 offset:63488
v_mfma_f32_16x16x32_bf16 v[188:191], a[252:255], a[68:71], v[188:191]
s_add_u32 m0, s4, 16384
s_waitcnt lgkmcnt(6)
v_mfma_f32_16x16x32_bf16 v[128:131], a[224:227], a[72:75], v[128:131]
ds_read_b64_tr_b16 a[252:253], v3 offset:61440
v_mfma_f32_16x16x32_bf16 v[136:139], a[224:227], a[76:79], v[136:139]
ds_read_b64_tr_b16 a[254:255], v3 offset:63488
s_mov_b32 s35, 32768
v_mfma_f32_16x16x32_bf16 v[132:135], a[228:231], a[72:75], v[132:135]
s_waitcnt vmcnt(17)
s_barrier
v_mfma_f32_16x16x32_bf16 v[140:143], a[228:231], a[76:79], v[140:143]
ds_read_b64_tr_b16 a[224:225], v0 offset:32768
ds_read_b64_tr_b16 a[226:227], v0 offset:34816
v_mfma_f32_16x16x32_bf16 v[144:147], a[232:235], a[72:75], v[144:147]
ds_read_b64_tr_b16 a[228:229], v1 offset:32768
ds_read_b64_tr_b16 a[230:231], v1 offset:34816
v_mfma_f32_16x16x32_bf16 v[152:155], a[232:235], a[76:79], v[152:155]
buffer_load_dwordx4 v6, s[12:15], s35 offen nt lds
v_mfma_f32_16x16x32_bf16 v[148:151], a[236:239], a[72:75], v[148:151]
ds_read_b64_tr_b16 a[232:233], v2 offset:32768
ds_read_b64_tr_b16 a[234:235], v2 offset:34816
v_mfma_f32_16x16x32_bf16 v[156:159], a[236:239], a[76:79], v[156:159]
s_add_u32 m0, s4, 114688
s_waitcnt lgkmcnt(6)
v_mfma_f32_16x16x32_bf16 v[160:163], a[240:243], a[72:75], v[160:163]
ds_read_b64_tr_b16 a[236:237], v3 offset:32768
v_mfma_f32_16x16x32_bf16 v[168:171], a[240:243], a[76:79], v[168:171]
ds_read_b64_tr_b16 a[238:239], v3 offset:34816
s_add_u32 s5, s58, 0
v_mfma_f32_16x16x32_bf16 v[164:167], a[244:247], a[72:75], v[164:167]
ds_read_b64_tr_b16 a[240:241], v0 offset:40960
ds_read_b64_tr_b16 a[242:243], v0 offset:43008
v_mfma_f32_16x16x32_bf16 v[172:175], a[244:247], a[76:79], v[172:175]
buffer_load_dwordx4 v16, s[20:23], s5 offen lds
v_mfma_f32_16x16x32_bf16 v[176:179], a[248:251], a[72:75], v[176:179]
ds_read_b64_tr_b16 a[244:245], v1 offset:40960
ds_read_b64_tr_b16 a[246:247], v1 offset:43008
v_mfma_f32_16x16x32_bf16 v[184:187], a[248:251], a[76:79], v[184:187]
s_add_u32 s5, s58, 130048
v_add_u32 v22, 0xfffec000, v22
v_mfma_f32_16x16x32_bf16 v[180:183], a[252:255], a[72:75], v[180:183]
ds_read_b64_tr_b16 a[248:249], v2 offset:40960
v_mfma_f32_16x16x32_bf16 v[188:191], a[252:255], a[76:79], v[188:191]
ds_read_b64_tr_b16 a[250:251], v2 offset:43008
L_step_9:
s_waitcnt lgkmcnt(6)
v_mfma_f32_16x16x32_bf16 v[192:195], a[224:227], a[64:67], v[192:195]
ds_read_b64_tr_b16 a[252:253], v3 offset:40960
ds_read_b64_tr_b16 a[254:255], v3 offset:43008
v_mfma_f32_16x16x32_bf16 v[200:203], a[224:227], a[68:71], v[200:203]
buffer_load_dwordx4 v16, s[20:23], s5 offen offset:1024 lds
v_mfma_f32_16x16x32_bf16 v[196:199], a[228:231], a[64:67], v[196:199]
ds_read_b64_tr_b16 a[224:225], v0 offset:36864
ds_read_b64_tr_b16 a[226:227], v0 offset:38912
v_mfma_f32_16x16x32_bf16 v[204:207], a[228:231], a[68:71], v[204:207]
s_add_u32 m0, s4, 16384
s_waitcnt vmcnt(15)
v_mfma_f32_16x16x32_bf16 v[208:211], a[232:235], a[64:67], v[208:211]
ds_read_b64_tr_b16 a[228:229], v1 offset:36864
ds_read_b64_tr_b16 a[230:231], v1 offset:38912
v_mfma_f32_16x16x32_bf16 v[216:219], a[232:235], a[68:71], v[216:219]
buffer_load_dwordx4 v7, s[12:15], s35 offen offset:1024 nt lds
v_mfma_f32_16x16x32_bf16 v[212:215], a[236:239], a[64:67], v[212:215]
ds_read_b64_tr_b16 a[232:233], v2 offset:36864
ds_read_b64_tr_b16 a[234:235], v2 offset:38912
v_mfma_f32_16x16x32_bf16 v[220:223], a[236:239], a[68:71], v[220:223]
s_add_u32 m0, s4, 114688
s_waitcnt lgkmcnt(6)
v_mfma_f32_16x16x32_bf16 v[224:227], a[240:243], a[64:67], v[224:227]
ds_read_b64_tr_b16 a[236:237], v3 offset:36864
ds_read_b64_tr_b16 a[238:239], v3 offset:38912
v_mfma_f32_16x16x32_bf16 v[232:235], a[240:243], a[68:71], v[232:235]
s_add_u32 s5, s58, 30720
buffer_load_dwordx4 v16, s[20:23], s5 offen offset:2048 lds
v_mfma_f32_16x16x32_bf16 v[228:231], a[244:247], a[64:67], v[228:231]
ds_read_b64_tr_b16 a[240:241], v0 offset:45056
ds_read_b64_tr_b16 a[242:243], v0 offset:47104
v_mfma_f32_16x16x32_bf16 v[236:239], a[244:247], a[68:71], v[236:239]
s_add_u32 s5, s58, 160768
v_add_u32 v0, 0xc000, v0
v_mfma_f32_16x16x32_bf16 v[240:243], a[248:251], a[64:67], v[240:243]
ds_read_b64_tr_b16 a[244:245], v1 offset:45056
ds_read_b64_tr_b16 a[246:247], v1 offset:47104
v_mfma_f32_16x16x32_bf16 v[248:251], a[248:251], a[68:71], v[248:251]
buffer_load_dwordx4 v16, s[20:23], s5 offen offset:3072 lds
v_mfma_f32_16x16x32_bf16 v[244:247], a[252:255], a[64:67], v[244:247]
ds_read_b64_tr_b16 a[248:249], v2 offset:45056
ds_read_b64_tr_b16 a[250:251], v2 offset:47104
v_mfma_f32_16x16x32_bf16 v[252:255], a[252:255], a[68:71], v[252:255]
v_add_u32 v1, 0xc000, v1
s_waitcnt lgkmcnt(6)
v_mfma_f32_16x16x32_bf16 v[192:195], a[224:227], a[72:75], v[192:195]
ds_read_b64_tr_b16 a[252:253], v3 offset:45056
ds_read_b64_tr_b16 a[254:255], v3 offset:47104
v_mfma_f32_16x16x32_bf16 v[200:203], a[224:227], a[76:79], v[200:203]
v_add_u32 v2, 0xc000, v2
v_add_u32 v3, 0xc000, v3
v_mfma_f32_16x16x32_bf16 v[196:199], a[228:231], a[72:75], v[196:199]
s_waitcnt vmcnt(13)
s_barrier
ds_read_b128 a[80:83], v22 offset:0
v_mfma_f32_16x16x32_bf16 v[204:207], a[228:231], a[76:79], v[204:207]
ds_read_b64_tr_b16 a[224:225], v0 offset:32768
ds_read_b64_tr_b16 a[226:227], v0 offset:34816
s_add_u32 m0, s4, 16384
v_mfma_f32_16x16x32_bf16 v[208:211], a[232:235], a[72:75], v[208:211]
ds_read_b128 a[84:87], v22 offset:2048
v_mfma_f32_16x16x32_bf16 v[216:219], a[232:235], a[76:79], v[216:219]
ds_read_b64_tr_b16 a[228:229], v1 offset:32768
ds_read_b64_tr_b16 a[230:231], v1 offset:34816
v_mfma_f32_16x16x32_bf16 v[212:215], a[236:239], a[72:75], v[212:215]
ds_read_b128 a[88:91], v22 offset:64
ds_read_b64_tr_b16 a[232:233], v2 offset:32768
ds_read_b64_tr_b16 a[234:235], v2 offset:34816
v_mfma_f32_16x16x32_bf16 v[220:223], a[236:239], a[76:79], v[220:223]
buffer_load_dwordx4 v6, s[12:15], s35 offen offset:2048 nt lds
s_waitcnt lgkmcnt(9)
v_mfma_f32_16x16x32_bf16 v[224:227], a[240:243], a[72:75], v[224:227]
ds_read_b128 a[92:95], v22 offset:2112
ds_read_b64_tr_b16 a[236:237], v3 offset:32768
v_mfma_f32_16x16x32_bf16 v[232:235], a[240:243], a[76:79], v[232:235]
ds_read_b64_tr_b16 a[238:239], v3 offset:34816
s_add_u32 m0, s4, 65536
v_mfma_f32_16x16x32_bf16 v[228:231], a[244:247], a[72:75], v[228:231]
ds_read_b64_tr_b16 a[240:241], v0 offset:40960
ds_read_b64_tr_b16 a[242:243], v0 offset:43008
v_mfma_f32_16x16x32_bf16 v[236:239], a[244:247], a[76:79], v[236:239]
s_add_u32 s5, s58, 256
buffer_load_dwordx4 v16, s[20:23], s5 offen lds
v_mfma_f32_16x16x32_bf16 v[240:243], a[248:251], a[72:75], v[240:243]
ds_read_b64_tr_b16 a[244:245], v1 offset:40960
v_mfma_f32_16x16x32_bf16 v[248:251], a[248:251], a[76:79], v[248:251]
ds_read_b64_tr_b16 a[246:247], v1 offset:43008
s_add_u32 s5, s58, 130304
v_mfma_f32_16x16x32_bf16 v[244:247], a[252:255], a[72:75], v[244:247]
ds_read_b64_tr_b16 a[248:249], v2 offset:40960
v_mfma_f32_16x16x32_bf16 v[252:255], a[252:255], a[76:79], v[252:255]
ds_read_b64_tr_b16 a[250:251], v2 offset:43008
L_step_10:
s_waitcnt lgkmcnt(6)
v_mfma_f32_16x16x32_bf16 v[128:131], a[224:227], a[80:83], v[128:131]
ds_read_b64_tr_b16 a[252:253], v3 offset:40960
ds_read_b64_tr_b16 a[254:255], v3 offset:43008
v_mfma_f32_16x16x32_bf16 v[136:139], a[224:227], a[84:87], v[136:139]
buffer_load_dwordx4 v16, s[20:23], s5 offen offset:1024 lds
v_mfma_f32_16x16x32_bf16 v[132:135], a[228:231], a[80:83], v[132:135]
ds_read_b64_tr_b16 a[224:225], v0 offset:36864
ds_read_b64_tr_b16 a[226:227], v0 offset:38912
v_mfma_f32_16x16x32_bf16 v[140:143], a[228:231], a[84:87], v[140:143]
s_add_u32 m0, s4, 16384
s_waitcnt vmcnt(14)
v_mfma_f32_16x16x32_bf16 v[144:147], a[232:235], a[80:83], v[144:147]
ds_read_b64_tr_b16 a[228:229], v1 offset:36864
ds_read_b64_tr_b16 a[230:231], v1 offset:38912
v_mfma_f32_16x16x32_bf16 v[152:155], a[232:235], a[84:87], v[152:155]
buffer_load_dwordx4 v7, s[12:15], s35 offen offset:3072 nt lds
v_mfma_f32_16x16x32_bf16 v[148:151], a[236:239], a[80:83], v[148:151]
ds_read_b64_tr_b16 a[232:233], v2 offset:36864
ds_read_b64_tr_b16 a[234:235], v2 offset:38912
v_mfma_f32_16x16x32_bf16 v[156:159], a[236:239], a[84:87], v[156:159]
s_add_u32 m0, s4, 65536
s_waitcnt lgkmcnt(6)
v_mfma_f32_16x16x32_bf16 v[160:163], a[240:243], a[80:83], v[160:163]
ds_read_b64_tr_b16 a[236:237], v3 offset:36864
ds_read_b64_tr_b16 a[238:239], v3 offset:38912
v_mfma_f32_16x16x32_bf16 v[168:171], a[240:243], a[84:87], v[168:171]
s_add_u32 s5, s58, 30976
buffer_load_dwordx4 v16, s[20:23], s5 offen offset:2048 lds
v_mfma_f32_16x16x32_bf16 v[164:167], a[244:247], a[80:83], v[164:167]
ds_read_b64_tr_b16 a[240:241], v0 offset:45056
v_mfma_f32_16x16x32_bf16 v[172:175], a[244:247], a[84:87], v[172:175]
ds_read_b64_tr_b16 a[242:243], v0 offset:47104
s_add_u32 s5, s58, 161024
v_mfma_f32_16x16x32_bf16 v[176:179], a[248:251], a[80:83], v[176:179]
ds_read_b64_tr_b16 a[244:245], v1 offset:45056
ds_read_b64_tr_b16 a[246:247], v1 offset:47104
v_mfma_f32_16x16x32_bf16 v[184:187], a[248:251], a[84:87], v[184:187]
buffer_load_dwordx4 v16, s[20:23], s5 offen offset:3072 lds
v_mfma_f32_16x16x32_bf16 v[180:183], a[252:255], a[80:83], v[180:183]
ds_read_b64_tr_b16 a[248:249], v2 offset:45056
ds_read_b64_tr_b16 a[250:251], v2 offset:47104
v_mfma_f32_16x16x32_bf16 v[188:191], a[252:255], a[84:87], v[188:191]
s_add_u32 m0, s4, 0
s_waitcnt lgkmcnt(6)
v_mfma_f32_16x16x32_bf16 v[128:131], a[224:227], a[88:91], v[128:131]
ds_read_b64_tr_b16 a[252:253], v3 offset:45056
v_mfma_f32_16x16x32_bf16 v[136:139], a[224:227], a[92:95], v[136:139]
ds_read_b64_tr_b16 a[254:255], v3 offset:47104
s_mov_b32 s35, 49152
v_mfma_f32_16x16x32_bf16 v[132:135], a[228:231], a[88:91], v[132:135]
s_waitcnt vmcnt(12)
s_barrier
v_mfma_f32_16x16x32_bf16 v[140:143], a[228:231], a[92:95], v[140:143]
ds_read_b64_tr_b16 a[224:225], v0 offset:16384
ds_read_b64_tr_b16 a[226:227], v0 offset:18432
v_mfma_f32_16x16x32_bf16 v[144:147], a[232:235], a[88:91], v[144:147]
ds_read_b64_tr_b16 a[228:229], v1 offset:16384
ds_read_b64_tr_b16 a[230:231], v1 offset:18432
v_mfma_f32_16x16x32_bf16 v[152:155], a[232:235], a[92:95], v[152:155]
buffer_load_dwordx4 v6, s[12:15], s35 offen nt lds
v_mfma_f32_16x16x32_bf16 v[148:151], a[236:239], a[88:91], v[148:151]
ds_read_b64_tr_b16 a[232:233], v2 offset:16384
v_mfma_f32_16x16x32_bf16 v[156:159], a[236:239], a[92:95], v[156:159]
ds_read_b64_tr_b16 a[234:235], v2 offset:18432
s_waitcnt lgkmcnt(6)
v_mfma_f32_16x16x32_bf16 v[160:163], a[240:243], a[88:91], v[160:163]
ds_read_b64_tr_b16 a[236:237], v3 offset:16384
v_mfma_f32_16x16x32_bf16 v[168:171], a[240:243], a[92:95], v[168:171]
ds_read_b64_tr_b16 a[238:239], v3 offset:18432
v_mfma_f32_16x16x32_bf16 v[164:167], a[244:247], a[88:91], v[164:167]
ds_read_b64_tr_b16 a[240:241], v0 offset:24576
v_mfma_f32_16x16x32_bf16 v[172:175], a[244:247], a[92:95], v[172:175]
ds_read_b64_tr_b16 a[242:243], v0 offset:26624
v_add_u32 v22, 0x14000, v22
v_mfma_f32_16x16x32_bf16 v[176:179], a[248:251], a[88:91], v[176:179]
ds_read_b64_tr_b16 a[244:245], v1 offset:24576
v_mfma_f32_16x16x32_bf16 v[184:187], a[248:251], a[92:95], v[184:187]
ds_read_b64_tr_b16 a[246:247], v1 offset:26624
v_mfma_f32_16x16x32_bf16 v[180:183], a[252:255], a[88:91], v[180:183]
ds_read_b64_tr_b16 a[248:249], v2 offset:24576
v_mfma_f32_16x16x32_bf16 v[188:191], a[252:255], a[92:95], v[188:191]
ds_read_b64_tr_b16 a[250:251], v2 offset:26624
L_step_11:
s_waitcnt lgkmcnt(6)
v_mfma_f32_16x16x32_bf16 v[192:195], a[224:227], a[80:83], v[192:195]
ds_read_b64_tr_b16 a[252:253], v3 offset:24576
v_mfma_f32_16x16x32_bf16 v[200:203], a[224:227], a[84:87], v[200:203]
ds_read_b64_tr_b16 a[254:255], v3 offset:26624
s_waitcnt vmcnt(12)
v_mfma_f32_16x16x32_bf16 v[196:199], a[228:231], a[80:83], v[196:199]
ds_read_b64_tr_b16 a[224:225], v0 offset:20480
ds_read_b64_tr_b16 a[226:227], v0 offset:22528
v_mfma_f32_16x16x32_bf16 v[204:207], a[228:231], a[84:87], v[204:207]
buffer_load_dwordx4 v7, s[12:15], s35 offen offset:1024 nt lds
v_mfma_f32_16x16x32_bf16 v[208:211], a[232:235], a[80:83], v[208:211]
ds_read_b64_tr_b16 a[228:229], v1 offset:20480
v_mfma_f32_16x16x32_bf16 v[216:219], a[232:235], a[84:87], v[216:219]
ds_read_b64_tr_b16 a[230:231], v1 offset:22528
v_mfma_f32_16x16x32_bf16 v[212:215], a[236:239], a[80:83], v[212:215]
ds_read_b64_tr_b16 a[232:233], v2 offset:20480
v_mfma_f32_16x16x32_bf16 v[220:223], a[236:239], a[84:87], v[220:223]
ds_read_b64_tr_b16 a[234:235], v2 offset:22528
s_waitcnt lgkmcnt(6)
v_mfma_f32_16x16x32_bf16 v[224:227], a[240:243], a[80:83], v[224:227]
ds_read_b64_tr_b16 a[236:237], v3 offset:20480
v_mfma_f32_16x16x32_bf16 v[232:235], a[240:243], a[84:87], v[232:235]
ds_read_b64_tr_b16 a[238:239], v3 offset:22528
v_mfma_f32_16x16x32_bf16 v[228:231], a[244:247], a[80:83], v[228:231]
ds_read_b64_tr_b16 a[240:241], v0 offset:28672
v_mfma_f32_16x16x32_bf16 v[236:239], a[244:247], a[84:87], v[236:239]
ds_read_b64_tr_b16 a[242:243], v0 offset:30720
v_mfma_f32_16x16x32_bf16 v[240:243], a[248:251], a[80:83], v[240:243]
ds_read_b64_tr_b16 a[244:245], v1 offset:28672
v_mfma_f32_16x16x32_bf16 v[248:251], a[248:251], a[84:87], v[248:251]
L_pg3:
s_cbranch_scc1 L_pg7
ds_read_b64_tr_b16 a[246:247], v1 offset:30720
v_mfma_f32_16x16x32_bf16 v[244:247], a[252:255], a[80:83], v[244:247]
ds_read_b64_tr_b16 a[248:249], v2 offset:28672
ds_read_b64_tr_b16 a[250:251], v2 offset:30720
v_mfma_f32_16x16x32_bf16 v[252:255], a[252:255], a[84:87], v[252:255]
s_waitcnt vmcnt(10)
s_waitcnt lgkmcnt(6)
v_mfma_f32_16x16x32_bf16 v[192:195], a[224:227], a[88:91], v[192:195]
ds_read_b64_tr_b16 a[252:253], v3 offset:28672
ds_read_b64_tr_b16 a[254:255], v3 offset:30720
v_mfma_f32_16x16x32_bf16 v[200:203], a[224:227], a[92:95], v[200:203]
buffer_load_dwordx4 v6, s[12:15], s35 offen offset:2048 nt lds
v_mfma_f32_16x16x32_bf16 v[196:199], a[228:231], a[88:91], v[196:199]
s_waitcnt vmcnt(9)
s_barrier
v_mfma_f32_16x16x32_bf16 v[204:207], a[228:231], a[92:95], v[204:207]
ds_read_b128 a[96:99], v22 offset:49152
ds_read_b64_tr_b16 a[224:225], v0 offset:49152
ds_read_b64_tr_b16 a[226:227], v0 offset:51200
v_mfma_f32_16x16x32_bf16 v[208:211], a[232:235], a[88:91], v[208:211]
ds_read_b128 a[100:103], v22 offset:51200
ds_read_b64_tr_b16 a[228:229], v1 offset:49152
v_mfma_f32_16x16x32_bf16 v[216:219], a[232:235], a[92:95], v[216:219]
ds_read_b64_tr_b16 a[230:231], v1 offset:51200
s_add_u32 m0, s4, 98304
v_mfma_f32_16x16x32_bf16 v[212:215], a[236:239], a[88:91], v[212:215]
ds_read_b128 a[104:107], v22 offset:49216
ds_read_b64_tr_b16 a[232:233], v0 offset:53248
v_mfma_f32_16x16x32_bf16 v[220:223], a[236:239], a[92:95], v[220:223]
ds_read_b64_tr_b16 a[234:235], v0 offset:55296
s_waitcnt lgkmcnt(9)
v_mfma_f32_16x16x32_bf16 v[224:227], a[240:243], a[88:91], v[224:227]
ds_read_b128 a[108:111], v22 offset:51264
ds_read_b64_tr_b16 a[236:237], v1 offset:53248
v_mfma_f32_16x16x32_bf16 v[232:235], a[240:243], a[92:95], v[232:235]
ds_read_b64_tr_b16 a[238:239], v1 offset:55296
s_add_u32 s5, s52, 512
v_mfma_f32_16x16x32_bf16 v[228:231], a[244:247], a[88:91], v[228:231]
ds_read_b64_tr_b16 a[240:241], v2 offset:49152
ds_read_b64_tr_b16 a[242:243], v2 offset:51200
v_mfma_f32_16x16x32_bf16 v[236:239], a[244:247], a[92:95], v[236:239]
buffer_load_dwordx4 v16, s[20:23], s5 offen lds
v_mfma_f32_16x16x32_bf16 v[240:243], a[248:251], a[88:91], v[240:243]
ds_read_b64_tr_b16 a[244:245], v3 offset:49152
v_mfma_f32_16x16x32_bf16 v[248:251], a[248:251], a[92:95], v[248:251]
ds_read_b64_tr_b16 a[246:247], v3 offset:51200
s_add_u32 s5, s52, 130560
v_mfma_f32_16x16x32_bf16 v[244:247], a[252:255], a[88:91], v[244:247]
ds_read_b64_tr_b16 a[248:249], v2 offset:53248
v_mfma_f32_16x16x32_bf16 v[252:255], a[252:255], a[92:95], v[252:255]
ds_read_b64_tr_b16 a[250:251], v2 offset:55296
L_step_12:
s_waitcnt lgkmcnt(6)
v_mfma_f32_16x16x32_bf16 v[128:131], a[224:227], a[96:99], v[128:131]
ds_read_b64_tr_b16 a[252:253], v3 offset:53248
ds_read_b64_tr_b16 a[254:255], v3 offset:55296
v_mfma_f32_16x16x32_bf16 v[136:139], a[224:227], a[100:103], v[136:139]
buffer_load_dwordx4 v16, s[20:23], s5 offen offset:1024 lds
s_add_u32 m0, s4, 0
v_mfma_f32_16x16x32_bf16 v[132:135], a[228:231], a[96:99], v[132:135]
ds_read_b64_tr_b16 a[224:225], v0 offset:57344
ds_read_b64_tr_b16 a[226:227], v0 offset:59392
v_mfma_f32_16x16x32_bf16 v[140:143], a[228:231], a[100:103], v[140:143]
s_waitcnt vmcnt(10)
buffer_load_dwordx4 v7, s[12:15], s35 offen offset:3072 nt lds
v_mfma_f32_16x16x32_bf16 v[128:131], a[232:235], a[104:107], v[128:131]
ds_read_b64_tr_b16 a[228:229], v1 offset:57344
ds_read_b64_tr_b16 a[230:231], v1 offset:59392
v_mfma_f32_16x16x32_bf16 v[136:139], a[232:235], a[108:111], v[136:139]
s_add_u32 m0, s4, 98304
s_add_u32 s5, s52, 31232
v_mfma_f32_16x16x32_bf16 v[132:135], a[236:239], a[104:107], v[132:135]
ds_read_b64_tr_b16 a[232:233], v0 offset:61440
v_mfma_f32_16x16x32_bf16 v[140:143], a[236:239], a[108:111], v[140:143]
ds_read_b64_tr_b16 a[234:235], v0 offset:63488
s_waitcnt lgkmcnt(6)
v_mfma_f32_16x16x32_bf16 v[144:147], a[240:243], a[96:99], v[144:147]
ds_read_b64_tr_b16 a[236:237], v1 offset:61440
ds_read_b64_tr_b16 a[238:239], v1 offset:63488
v_mfma_f32_16x16x32_bf16 v[152:155], a[240:243], a[100:103], v[152:155]
buffer_load_dwordx4 v16, s[20:23], s5 offen offset:2048 lds
v_mfma_f32_16x16x32_bf16 v[148:151], a[244:247], a[96:99], v[148:151]
ds_read_b64_tr_b16 a[240:241], v2 offset:57344
ds_read_b64_tr_b16 a[242:243], v2 offset:59392
v_mfma_f32_16x16x32_bf16 v[156:159], a[244:247], a[100:103], v[156:159]
s_add_u32 s5, s52, 161280
v_cvt_pk_bf16_f32 v64, v128, v129
v_mfma_f32_16x16x32_bf16 v[144:147], a[248:251], a[104:107], v[144:147]
ds_read_b64_tr_b16 a[244:245], v3 offset:57344
ds_read_b64_tr_b16 a[246:247], v3 offset:59392
v_mfma_f32_16x16x32_bf16 v[152:155], a[248:251], a[108:111], v[152:155]
buffer_load_dwordx4 v16, s[20:23], s5 offen offset:3072 lds
s_add_u32 m0, s4, 49152
v_mfma_f32_16x16x32_bf16 v[148:151], a[252:255], a[104:107], v[148:151]
ds_read_b64_tr_b16 a[248:249], v2 offset:61440
ds_read_b64_tr_b16 a[250:251], v2 offset:63488
v_mfma_f32_16x16x32_bf16 v[156:159], a[252:255], a[108:111], v[156:159]
s_mov_b32 s35, 65536
s_waitcnt lgkmcnt(6)
v_mfma_f32_16x16x32_bf16 v[160:163], a[224:227], a[96:99], v[160:163]
ds_read_b64_tr_b16 a[252:253], v3 offset:61440
ds_read_b64_tr_b16 a[254:255], v3 offset:63488
v_mfma_f32_16x16x32_bf16 v[168:171], a[224:227], a[100:103], v[168:171]
s_waitcnt vmcnt(10)
buffer_load_dwordx4 v6, s[12:15], s35 offen nt lds
v_mfma_f32_16x16x32_bf16 v[164:167], a[228:231], a[96:99], v[164:167]
s_waitcnt vmcnt(9)
s_barrier
v_mfma_f32_16x16x32_bf16 v[172:175], a[228:231], a[100:103], v[172:175]
ds_read_b64_tr_b16 a[224:225], v0 offset:0
ds_read_b64_tr_b16 a[226:227], v0 offset:2048
v_mfma_f32_16x16x32_bf16 v[160:163], a[232:235], a[104:107], v[160:163]
ds_read_b64_tr_b16 a[228:229], v1 offset:0
ds_read_b64_tr_b16 a[230:231], v1 offset:2048
v_mfma_f32_16x16x32_bf16 v[168:171], a[232:235], a[108:111], v[168:171]
s_add_u32 m0, s4, 81920
s_add_u32 s5, s53, 512
v_mfma_f32_16x16x32_bf16 v[164:167], a[236:239], a[104:107], v[164:167]
ds_read_b64_tr_b16 a[232:233], v0 offset:4096
ds_read_b64_tr_b16 a[234:235], v0 offset:6144
v_mfma_f32_16x16x32_bf16 v[172:175], a[236:239], a[108:111], v[172:175]
v_cvt_pk_bf16_f32 v65, v130, v131
s_waitcnt lgkmcnt(6)
v_mfma_f32_16x16x32_bf16 v[176:179], a[240:243], a[96:99], v[176:179]
ds_read_b64_tr_b16 a[236:237], v1 offset:4096
ds_read_b64_tr_b16 a[238:239], v1 offset:6144
v_mfma_f32_16x16x32_bf16 v[184:187], a[240:243], a[100:103], v[184:187]
buffer_load_dwordx4 v16, s[20:23], s5 offen lds
v_mfma_f32_16x16x32_bf16 v[180:183], a[244:247], a[96:99], v[180:183]
ds_read_b64_tr_b16 a[240:241], v2 offset:0
ds_read_b64_tr_b16 a[242:243], v2 offset:2048
v_mfma_f32_16x16x32_bf16 v[188:191], a[244:247], a[100:103], v[188:191]
s_add_u32 m0, s4, 49152
s_waitcnt vmcnt(9)
v_mfma_f32_16x16x32_bf16 v[176:179], a[248:251], a[104:107], v[176:179]
ds_read_b64_tr_b16 a[244:245], v3 offset:0
ds_read_b64_tr_b16 a[246:247], v3 offset:2048
v_mfma_f32_16x16x32_bf16 v[184:187], a[248:251], a[108:111], v[184:187]
buffer_load_dwordx4 v7, s[12:15], s35 offen offset:1024 nt lds
v_mfma_f32_16x16x32_bf16 v[180:183], a[252:255], a[104:107], v[180:183]
ds_read_b64_tr_b16 a[248:249], v2 offset:4096
ds_read_b64_tr_b16 a[250:251], v2 offset:6144
v_mfma_f32_16x16x32_bf16 v[188:191], a[252:255], a[108:111], v[188:191]
s_add_u32 m0, s4, 81920
L_step_13:
s_waitcnt lgkmcnt(6)
v_mfma_f32_16x16x32_bf16 v[192:195], a[224:227], a[96:99], v[192:195]
ds_read_b64_tr_b16 a[252:253], v3 offset:4096
ds_read_b64_tr_b16 a[254:255], v3 offset:6144
v_mfma_f32_16x16x32_bf16 v[200:203], a[224:227], a[100:103], v[200:203]
s_add_u32 s5, s53, 130560
buffer_load_dwordx4 v16, s[20:23], s5 offen offset:1024 lds
v_mfma_f32_16x16x32_bf16 v[196:199], a[228:231], a[96:99], v[196:199]
ds_read_b64_tr_b16 a[224:225], v0 offset:8192
ds_read_b64_tr_b16 a[226:227], v0 offset:10240
v_mfma_f32_16x16x32_bf16 v[204:207], a[228:231], a[100:103], v[204:207]
s_add_u32 s5, s53, 31232
buffer_load_dwordx4 v16, s[20:23], s5 offen offset:2048 lds
v_mfma_f32_16x16x32_bf16 v[192:195], a[232:235], a[104:107], v[192:195]
ds_read_b64_tr_b16 a[228:229], v1 offset:8192
ds_read_b64_tr_b16 a[230:231], v1 offset:10240
v_mfma_f32_16x16x32_bf16 v[200:203], a[232:235], a[108:111], v[200:203]
s_add_u32 m0, s4, 49152
v_add_u32 v4, 0x18000, v4
v_add_u32 v5, 0x18000, v5
v_mfma_f32_16x16x32_bf16 v[196:199], a[236:239], a[104:107], v[196:199]
ds_read_b64_tr_b16 a[232:233], v0 offset:12288
ds_read_b64_tr_b16 a[234:235], v0 offset:14336
v_mfma_f32_16x16x32_bf16 v[204:207], a[236:239], a[108:111], v[204:207]
s_waitcnt vmcnt(11)
v_cvt_pk_bf16_f32 v66, v132, v133
s_waitcnt lgkmcnt(6)
v_mfma_f32_16x16x32_bf16 v[208:211], a[240:243], a[96:99], v[208:211]
ds_read_b64_tr_b16 a[236:237], v1 offset:12288
ds_read_b64_tr_b16 a[238:239], v1 offset:14336
v_mfma_f32_16x16x32_bf16 v[216:219], a[240:243], a[100:103], v[216:219]
buffer_load_dwordx4 v6, s[12:15], s35 offen offset:2048 nt lds
s_add_u32 m0, s4, 81920
s_add_u32 s5, s53, 161280
v_mfma_f32_16x16x32_bf16 v[212:215], a[244:247], a[96:99], v[212:215]
ds_read_b64_tr_b16 a[240:241], v2 offset:8192
ds_read_b64_tr_b16 a[242:243], v2 offset:10240
v_mfma_f32_16x16x32_bf16 v[220:223], a[244:247], a[100:103], v[220:223]
buffer_load_dwordx4 v16, s[20:23], s5 offen offset:3072 lds
v_cvt_pk_bf16_f32 v67, v134, v135
v_cvt_pk_bf16_f32 v68, v136, v137
v_mfma_f32_16x16x32_bf16 v[208:211], a[248:251], a[104:107], v[208:211]
ds_read_b64_tr_b16 a[244:245], v3 offset:8192
ds_read_b64_tr_b16 a[246:247], v3 offset:10240
v_cvt_pk_bf16_f32 v69, v138, v139
v_mfma_f32_16x16x32_bf16 v[216:219], a[248:251], a[108:111], v[216:219]
v_cvt_pk_bf16_f32 v70, v140, v141
v_cvt_pk_bf16_f32 v71, v142, v143
v_permlane32_swap_b32 v64, v66
v_mfma_f32_16x16x32_bf16 v[212:215], a[252:255], a[104:107], v[212:215]
ds_read_b64_tr_b16 a[248:249], v2 offset:12288
ds_read_b64_tr_b16 a[250:251], v2 offset:14336
s_add_u32 m0, s4, 49152
v_mfma_f32_16x16x32_bf16 v[220:223], a[252:255], a[108:111], v[220:223]
v_permlane32_swap_b32 v65, v67
v_permlane32_swap_b32 v68, v70
s_waitcnt lgkmcnt(6)
v_mfma_f32_16x16x32_bf16 v[224:227], a[224:227], a[96:99], v[224:227]
ds_read_b64_tr_b16 a[252:253], v3 offset:12288
ds_read_b64_tr_b16 a[254:255], v3 offset:14336
v_permlane32_swap_b32 v69, v71
v_mfma_f32_16x16x32_bf16 v[232:235], a[224:227], a[100:103], v[232:235]
v_permlane16_swap_b32 v64, v66
v_permlane16_swap_b32 v65, v67
v_permlane16_swap_b32 v68, v70
v_mfma_f32_16x16x32_bf16 v[228:231], a[228:231], a[96:99], v[228:231]
s_barrier
ds_read_b128 a[224:227], v4 offset:49152
v_permlane16_swap_b32 v69, v71
v_mfma_f32_16x16x32_bf16 v[236:239], a[228:231], a[100:103], v[236:239]
v_cvt_pk_bf16_f32 v72, v144, v145
v_cvt_pk_bf16_f32 v73, v146, v147
v_cvt_pk_bf16_f32 v74, v148, v149
v_mfma_f32_16x16x32_bf16 v[224:227], a[232:235], a[104:107], v[224:227]
ds_read_b128 a[228:231], v4 offset:51200
s_waitcnt vmcnt(12)
buffer_load_dwordx4 v7, s[12:15], s35 offen offset:3072 nt lds
v_mfma_f32_16x16x32_bf16 v[232:235], a[232:235], a[108:111], v[232:235]
v_cvt_pk_bf16_f32 v75, v150, v151
v_cvt_pk_bf16_f32 v76, v152, v153
v_cvt_pk_bf16_f32 v77, v154, v155
v_mfma_f32_16x16x32_bf16 v[228:231], a[236:239], a[104:107], v[228:231]
ds_read_b128 a[232:235], v5 offset:49152
v_cvt_pk_bf16_f32 v78, v156, v157
v_cvt_pk_bf16_f32 v79, v158, v159
v_mfma_f32_16x16x32_bf16 v[236:239], a[236:239], a[108:111], v[236:239]
v_permlane32_swap_b32 v72, v74
v_permlane32_swap_b32 v73, v75
v_permlane32_swap_b32 v76, v78
s_waitcnt lgkmcnt(3)
v_mfma_f32_16x16x32_bf16 v[240:243], a[240:243], a[96:99], v[240:243]
ds_read_b128 a[236:239], v5 offset:51200
v_permlane32_swap_b32 v77, v79
v_permlane16_swap_b32 v72, v74
v_mfma_f32_16x16x32_bf16 v[248:251], a[240:243], a[100:103], v[248:251]
v_permlane16_swap_b32 v73, v75
v_permlane16_swap_b32 v76, v78
v_permlane16_swap_b32 v77, v79
v_cvt_pk_bf16_f32 v80, v160, v161
v_mfma_f32_16x16x32_bf16 v[244:247], a[244:247], a[96:99], v[244:247]
ds_read_b128 a[240:243], v4 offset:53248
v_cvt_pk_bf16_f32 v81, v162, v163
v_cvt_pk_bf16_f32 v82, v164, v165
v_mfma_f32_16x16x32_bf16 v[252:255], a[244:247], a[100:103], v[252:255]
v_cvt_pk_bf16_f32 v83, v166, v167
v_cvt_pk_bf16_f32 v84, v168, v169
v_cvt_pk_bf16_f32 v85, v170, v171
v_cvt_pk_bf16_f32 v86, v172, v173
v_mfma_f32_16x16x32_bf16 v[240:243], a[248:251], a[104:107], v[240:243]
ds_read_b128 a[244:247], v4 offset:55296
v_cvt_pk_bf16_f32 v87, v174, v175
v_permlane32_swap_b32 v80, v82
v_mfma_f32_16x16x32_bf16 v[248:251], a[248:251], a[108:111], v[248:251]
v_permlane32_swap_b32 v81, v83
v_permlane32_swap_b32 v84, v86
v_permlane32_swap_b32 v85, v87
v_permlane16_swap_b32 v80, v82
v_mfma_f32_16x16x32_bf16 v[244:247], a[252:255], a[104:107], v[244:247]
ds_read_b128 a[248:251], v5 offset:53248
v_permlane16_swap_b32 v81, v83
v_permlane16_swap_b32 v84, v86
v_mfma_f32_16x16x32_bf16 v[252:255], a[252:255], a[108:111], v[252:255]
v_permlane16_swap_b32 v85, v87
s_add_u32 m0, s4, 131072
s_mov_b32 s35, 81920
L_step_14:
s_waitcnt lgkmcnt(3)
v_mfma_f32_16x16x32_bf16 v[32:35], a[224:227], v[64:67], 0
ds_read_b128 a[252:255], v5 offset:55296
s_waitcnt vmcnt(10)
buffer_load_dwordx4 v6, s[12:15], s35 offen nt lds
v_mfma_f32_16x16x32_bf16 v[40:43], a[224:227], v[68:71], 0
v_cvt_pk_bf16_f32 v88, v176, v177
v_cvt_pk_bf16_f32 v89, v178, v179
v_cvt_pk_bf16_f32 v90, v180, v181
v_cvt_pk_bf16_f32 v91, v182, v183
v_mfma_f32_16x16x32_bf16 v[36:39], a[228:231], v[64:67], 0
ds_read_b128 a[224:227], v4 offset:57344
v_cvt_pk_bf16_f32 v92, v184, v185
v_cvt_pk_bf16_f32 v93, v186, v187
v_cvt_pk_bf16_f32 v94, v188, v189
v_mfma_f32_16x16x32_bf16 v[44:47], a[228:231], v[68:71], 0
v_cvt_pk_bf16_f32 v95, v190, v191
v_permlane32_swap_b32 v88, v90
v_permlane32_swap_b32 v89, v91
v_permlane32_swap_b32 v92, v94
v_mfma_f32_16x16x32_bf16 v[32:35], a[232:235], v[72:75], v[32:35]
ds_read_b128 a[228:231], v4 offset:59392
v_permlane32_swap_b32 v93, v95
v_permlane16_swap_b32 v88, v90
v_permlane16_swap_b32 v89, v91
v_mfma_f32_16x16x32_bf16 v[40:43], a[232:235], v[76:79], v[40:43]
v_permlane16_swap_b32 v92, v94
v_permlane16_swap_b32 v93, v95
v_cvt_pk_bf16_f32 v96, v192, v193
v_cvt_pk_bf16_f32 v97, v194, v195
v_mfma_f32_16x16x32_bf16 v[36:39], a[236:239], v[72:75], v[36:39]
ds_read_b128 a[232:235], v5 offset:57344
v_cvt_pk_bf16_f32 v98, v196, v197
v_cvt_pk_bf16_f32 v99, v198, v199
v_cvt_pk_bf16_f32 v100, v200, v201
v_mfma_f32_16x16x32_bf16 v[44:47], a[236:239], v[76:79], v[44:47]
v_cvt_pk_bf16_f32 v101, v202, v203
v_cvt_pk_bf16_f32 v102, v204, v205
v_cvt_pk_bf16_f32 v103, v206, v207
s_waitcnt lgkmcnt(3)
v_mfma_f32_16x16x32_bf16 v[32:35], a[240:243], v[80:83], v[32:35]
ds_read_b128 a[236:239], v5 offset:59392
v_permlane32_swap_b32 v96, v98
v_permlane32_swap_b32 v97, v99
v_permlane32_swap_b32 v100, v102
v_mfma_f32_16x16x32_bf16 v[40:43], a[240:243], v[84:87], v[40:43]
v_permlane32_swap_b32 v101, v103
v_permlane16_swap_b32 v96, v98
v_permlane16_swap_b32 v97, v99
v_permlane16_swap_b32 v100, v102
v_mfma_f32_16x16x32_bf16 v[36:39], a[244:247], v[80:83], v[36:39]
ds_read_b128 a[240:243], v4 offset:61440
v_permlane16_swap_b32 v101, v103
v_cvt_pk_bf16_f32 v104, v208, v209
v_cvt_pk_bf16_f32 v105, v210, v211
v_mfma_f32_16x16x32_bf16 v[44:47], a[244:247], v[84:87], v[44:47]
v_cvt_pk_bf16_f32 v106, v212, v213
v_cvt_pk_bf16_f32 v107, v214, v215
v_cvt_pk_bf16_f32 v108, v216, v217
v_cvt_pk_bf16_f32 v109, v218, v219
v_mfma_f32_16x16x32_bf16 v[32:35], a[248:251], v[88:91], v[32:35]
ds_read_b128 a[244:247], v4 offset:63488
v_cvt_pk_bf16_f32 v110, v220, v221
v_cvt_pk_bf16_f32 v111, v222, v223
v_permlane32_swap_b32 v104, v106
v_mfma_f32_16x16x32_bf16 v[40:43], a[248:251], v[92:95], v[40:43]
v_permlane32_swap_b32 v105, v107
v_permlane32_swap_b32 v108, v110
v_permlane32_swap_b32 v109, v111
v_permlane16_swap_b32 v104, v106
v_mfma_f32_16x16x32_bf16 v[36:39], a[252:255], v[88:91], v[36:39]
ds_read_b128 a[248:251], v5 offset:61440
v_permlane16_swap_b32 v105, v107
v_permlane16_swap_b32 v108, v110
v_permlane16_swap_b32 v109, v111
v_mfma_f32_16x16x32_bf16 v[44:47], a[252:255], v[92:95], v[44:47]
s_waitcnt vmcnt(8)
buffer_load_dwordx4 v7, s[12:15], s35 offen offset:1024 nt lds
s_waitcnt lgkmcnt(3)
v_mfma_f32_16x16x32_bf16 v[32:35], a[224:227], v[96:99], v[32:35]
ds_read_b128 a[252:255], v5 offset:63488
v_cvt_pk_bf16_f32 v112, v224, v225
v_cvt_pk_bf16_f32 v113, v226, v227
v_cvt_pk_bf16_f32 v114, v228, v229
v_mfma_f32_16x16x32_bf16 v[40:43], a[224:227], v[100:103], v[40:43]
v_cvt_pk_bf16_f32 v115, v230, v231
v_cvt_pk_bf16_f32 v116, v232, v233
v_cvt_pk_bf16_f32 v117, v234, v235
v_cvt_pk_bf16_f32 v118, v236, v237
v_cvt_pk_bf16_f32 v119, v238, v239
v_mfma_f32_16x16x32_bf16 v[36:39], a[228:231], v[96:99], v[36:39]
s_barrier
ds_read_b64_tr_b16 a[224:225], v0 offset:32768
ds_read_b64_tr_b16 a[226:227], v0 offset:34816
v_permlane32_swap_b32 v112, v114
v_mfma_f32_16x16x32_bf16 v[44:47], a[228:231], v[100:103], v[44:47]
v_permlane32_swap_b32 v113, v115
v_permlane32_swap_b32 v116, v118
v_permlane32_swap_b32 v117, v119
v_permlane16_swap_b32 v112, v114
v_mfma_f32_16x16x32_bf16 v[32:35], a[232:235], v[104:107], v[32:35]
ds_read_b64_tr_b16 a[228:229], v1 offset:32768
ds_read_b64_tr_b16 a[230:231], v1 offset:34816
v_permlane16_swap_b32 v113, v115
v_permlane16_swap_b32 v116, v118
v_mfma_f32_16x16x32_bf16 v[40:43], a[232:235], v[108:111], v[40:43]
v_permlane16_swap_b32 v117, v119
v_cvt_pk_bf16_f32 v120, v240, v241
v_cvt_pk_bf16_f32 v121, v242, v243
v_cvt_pk_bf16_f32 v122, v244, v245
v_cvt_pk_bf16_f32 v123, v246, v247
v_mfma_f32_16x16x32_bf16 v[36:39], a[236:239], v[104:107], v[36:39]
ds_read_b64_tr_b16 a[232:233], v2 offset:32768
ds_read_b64_tr_b16 a[234:235], v2 offset:34816
v_cvt_pk_bf16_f32 v124, v248, v249
v_cvt_pk_bf16_f32 v125, v250, v251
v_mfma_f32_16x16x32_bf16 v[44:47], a[236:239], v[108:111], v[44:47]
v_cvt_pk_bf16_f32 v126, v252, v253
v_cvt_pk_bf16_f32 v127, v254, v255
v_permlane32_swap_b32 v120, v122
s_waitcnt lgkmcnt(6)
v_mfma_f32_16x16x32_bf16 v[32:35], a[240:243], v[112:115], v[32:35]
ds_read_b64_tr_b16 a[236:237], v3 offset:32768
ds_read_b64_tr_b16 a[238:239], v3 offset:34816
v_permlane32_swap_b32 v121, v123
v_permlane32_swap_b32 v124, v126
v_mfma_f32_16x16x32_bf16 v[40:43], a[240:243], v[116:119], v[40:43]
v_permlane32_swap_b32 v125, v127
v_permlane16_swap_b32 v120, v122
v_permlane16_swap_b32 v121, v123
v_permlane16_swap_b32 v124, v126
v_permlane16_swap_b32 v125, v127
v_mfma_f32_16x16x32_bf16 v[36:39], a[244:247], v[112:115], v[36:39]
ds_read_b64_tr_b16 a[240:241], v0 offset:40960
ds_read_b64_tr_b16 a[242:243], v0 offset:43008
v_mfma_f32_16x16x32_bf16 v[44:47], a[244:247], v[116:119], v[44:47]
s_waitcnt vmcnt(7)
v_add_u32 v4, 0xfffe8000, v4
v_mfma_f32_16x16x32_bf16 v[32:35], a[248:251], v[120:123], v[32:35]
ds_read_b64_tr_b16 a[244:245], v1 offset:40960
ds_read_b64_tr_b16 a[246:247], v1 offset:43008
v_mfma_f32_16x16x32_bf16 v[40:43], a[248:251], v[124:127], v[40:43]
buffer_load_dwordx4 v6, s[12:15], s35 offen offset:2048 nt lds
v_mfma_f32_16x16x32_bf16 v[36:39], a[252:255], v[120:123], v[36:39]
ds_read_b64_tr_b16 a[248:249], v2 offset:40960
ds_read_b64_tr_b16 a[250:251], v2 offset:43008
v_mfma_f32_16x16x32_bf16 v[44:47], a[252:255], v[124:127], v[44:47]
v_add_u32 v5, 0xfffe8000, v5
L_step_15:
s_waitcnt lgkmcnt(6)
v_mfma_f32_16x16x32_bf16 a[112:115], a[224:227], a[0:3], 0
ds_read_b64_tr_b16 a[252:253], v3 offset:40960
v_mfma_f32_16x16x32_bf16 a[120:123], a[224:227], a[4:7], 0
ds_read_b64_tr_b16 a[254:255], v3 offset:43008
v_mfma_f32_16x16x32_bf16 a[116:119], a[228:231], a[0:3], 0
ds_read_b64_tr_b16 a[224:225], v0 offset:36864
ds_read_b64_tr_b16 a[226:227], v0 offset:38912
v_mfma_f32_16x16x32_bf16 a[124:127], a[228:231], a[4:7], 0
v_max3_f32 v12, v32, v33, v34
v_max3_f32 v13, v40, v41, v42
v_mfma_f32_16x16x32_bf16 v[208:211], a[232:235], a[0:3], 0
ds_read_b64_tr_b16 a[228:229], v1 offset:36864
ds_read_b64_tr_b16 a[230:231], v1 offset:38912
v_mfma_f32_16x16x32_bf16 v[216:219], a[232:235], a[4:7], 0
v_max3_f32 v12, v12, v35, v36
v_max3_f32 v13, v13, v43, v44
v_mfma_f32_16x16x32_bf16 v[212:215], a[236:239], a[0:3], 0
ds_read_b64_tr_b16 a[232:233], v2 offset:36864
ds_read_b64_tr_b16 a[234:235], v2 offset:38912
v_mfma_f32_16x16x32_bf16 v[220:223], a[236:239], a[4:7], 0
v_max3_f32 v12, v12, v37, v38
s_waitcnt lgkmcnt(6)
v_mfma_f32_16x16x32_bf16 v[224:227], a[240:243], a[0:3], 0
ds_read_b64_tr_b16 a[236:237], v3 offset:36864
ds_read_b64_tr_b16 a[238:239], v3 offset:38912
v_mfma_f32_16x16x32_bf16 v[232:235], a[240:243], a[4:7], 0
s_waitcnt vmcnt(5)
v_max3_f32 v13, v13, v45, v46
v_mfma_f32_16x16x32_bf16 v[228:231], a[244:247], a[0:3], 0
ds_read_b64_tr_b16 a[240:241], v0 offset:45056
ds_read_b64_tr_b16 a[242:243], v0 offset:47104
v_mfma_f32_16x16x32_bf16 v[236:239], a[244:247], a[4:7], 0
buffer_load_dwordx4 v7, s[12:15], s35 offen offset:3072 nt lds
v_mfma_f32_16x16x32_bf16 v[240:243], a[248:251], a[0:3], 0
ds_read_b64_tr_b16 a[244:245], v1 offset:45056
ds_read_b64_tr_b16 a[246:247], v1 offset:47104
v_mfma_f32_16x16x32_bf16 v[248:251], a[248:251], a[4:7], 0
v_max_f32 v12, v12, v39
v_max_f32 v13, v13, v47
v_mfma_f32_16x16x32_bf16 v[244:247], a[252:255], a[0:3], 0
ds_read_b64_tr_b16 a[248:249], v2 offset:45056
ds_read_b64_tr_b16 a[250:251], v2 offset:47104
v_mfma_f32_16x16x32_bf16 v[252:255], a[252:255], a[4:7], 0
s_add_u32 m0, s4, 65536
s_waitcnt lgkmcnt(6)
v_mfma_f32_16x16x32_bf16 a[112:115], a[224:227], a[8:11], a[112:115]
ds_read_b64_tr_b16 a[252:253], v3 offset:45056
ds_read_b64_tr_b16 a[254:255], v3 offset:47104
v_mfma_f32_16x16x32_bf16 a[120:123], a[224:227], a[12:15], a[120:123]
s_add_u32 s5, s54, 512
v_permlane32_swap_b32 v12, v13
v_mfma_f32_16x16x32_bf16 a[116:119], a[228:231], a[8:11], a[116:119]
s_barrier
ds_read_b128 a[224:227], v4 offset:32768
v_mfma_f32_16x16x32_bf16 a[124:127], a[228:231], a[12:15], a[124:127]
v_max_f32 v12, v12, v13
v_mov_b32 v13, v12
v_mfma_f32_16x16x32_bf16 v[208:211], a[232:235], a[8:11], v[208:211]
ds_read_b128 a[228:231], v4 offset:34816
v_mfma_f32_16x16x32_bf16 v[216:219], a[232:235], a[12:15], v[216:219]
buffer_load_dwordx4 v16, s[20:23], s5 offen lds
s_add_u32 m0, s4, 114688
v_mfma_f32_16x16x32_bf16 v[212:215], a[236:239], a[8:11], v[212:215]
ds_read_b128 a[232:235], v5 offset:32768
s_mov_b32 s35, 98304
v_mfma_f32_16x16x32_bf16 v[220:223], a[236:239], a[12:15], v[220:223]
s_waitcnt vmcnt(5)
s_waitcnt lgkmcnt(3)
v_mfma_f32_16x16x32_bf16 v[224:227], a[240:243], a[8:11], v[224:227]
ds_read_b128 a[236:239], v5 offset:34816
v_mfma_f32_16x16x32_bf16 v[232:235], a[240:243], a[12:15], v[232:235]
buffer_load_dwordx4 v6, s[12:15], s35 offen nt lds
s_add_u32 m0, s4, 65536
v_mfma_f32_16x16x32_bf16 v[228:231], a[244:247], a[8:11], v[228:231]
ds_read_b128 a[240:243], v4 offset:36864
s_add_u32 s5, s54, 130560
v_mfma_f32_16x16x32_bf16 v[236:239], a[244:247], a[12:15], v[236:239]
buffer_load_dwordx4 v16, s[20:23], s5 offen offset:1024 lds
v_mfma_f32_16x16x32_bf16 v[240:243], a[248:251], a[8:11], v[240:243]
ds_read_b128 a[244:247], v4 offset:38912
s_add_u32 m0, s4, 114688
v_mfma_f32_16x16x32_bf16 v[248:251], a[248:251], a[12:15], v[248:251]
v_permlane16_swap_b32 v12, v13
v_max_f32 v12, v12, v13
v_mfma_f32_16x16x32_bf16 v[244:247], a[252:255], a[8:11], v[244:247]
ds_read_b128 a[248:251], v5 offset:36864
v_mov_b32 v13, v12
v_mfma_f32_16x16x32_bf16 v[252:255], a[252:255], a[12:15], v[252:255]
s_nop 0
v_permlane32_swap_b32 v12, v13
L_step_16:
s_waitcnt lgkmcnt(3)
v_mfma_f32_16x16x32_bf16 v[48:51], a[224:227], v[64:67], 0
ds_read_b128 a[252:255], v5 offset:38912
v_mul_f32 v10, s6, v12
v_mfma_f32_16x16x32_bf16 v[56:59], a[224:227], v[68:71], 0
v_mul_f32 v11, s6, v13
v_ceil_f32 v10, v10
v_mfma_f32_16x16x32_bf16 v[52:55], a[228:231], v[64:67], 0
ds_read_b128 a[224:227], v4 offset:40960
s_waitcnt vmcnt(6)
v_mfma_f32_16x16x32_bf16 v[60:63], a[228:231], v[68:71], 0
buffer_load_dwordx4 v7, s[12:15], s35 offen offset:1024 nt lds
v_mfma_f32_16x16x32_bf16 v[48:51], a[232:235], v[72:75], v[48:51]
ds_read_b128 a[228:231], v4 offset:43008
s_add_u32 m0, s4, 65536
v_mfma_f32_16x16x32_bf16 v[56:59], a[232:235], v[76:79], v[56:59]
s_add_u32 s5, s54, 31232
v_ceil_f32 v11, v11
v_mfma_f32_16x16x32_bf16 v[52:55], a[236:239], v[72:75], v[52:55]
ds_read_b128 a[232:235], v5 offset:40960
v_mfma_f32_16x16x32_bf16 v[60:63], a[236:239], v[76:79], v[60:63]
buffer_load_dwordx4 v16, s[20:23], s5 offen offset:2048 lds
s_waitcnt lgkmcnt(3)
v_mfma_f32_16x16x32_bf16 v[48:51], a[240:243], v[80:83], v[48:51]
ds_read_b128 a[236:239], v5 offset:43008
s_add_u32 s5, s54, 161280
v_mfma_f32_16x16x32_bf16 v[56:59], a[240:243], v[84:87], v[56:59]
buffer_load_dwordx4 v16, s[20:23], s5 offen offset:3072 lds
v_mfma_f32_16x16x32_bf16 v[52:55], a[244:247], v[80:83], v[52:55]
ds_read_b128 a[240:243], v4 offset:45056
s_add_u32 m0, s4, 114688
v_mfma_f32_16x16x32_bf16 v[60:63], a[244:247], v[84:87], v[60:63]
v_fma_f32 v32, v32, s6, -v10
v_fma_f32 v33, v33, s6, -v10
v_mfma_f32_16x16x32_bf16 v[48:51], a[248:251], v[88:91], v[48:51]
ds_read_b128 a[244:247], v4 offset:47104
v_fma_f32 v34, v34, s6, -v10
v_mfma_f32_16x16x32_bf16 v[56:59], a[248:251], v[92:95], v[56:59]
v_fma_f32 v35, v35, s6, -v10
v_fma_f32 v36, v36, s6, -v10
v_mfma_f32_16x16x32_bf16 v[52:55], a[252:255], v[88:91], v[52:55]
ds_read_b128 a[248:251], v5 offset:45056
s_waitcnt vmcnt(8)
v_mfma_f32_16x16x32_bf16 v[60:63], a[252:255], v[92:95], v[60:63]
v_fma_f32 v37, v37, s6, -v10
s_waitcnt lgkmcnt(3)
v_mfma_f32_16x16x32_bf16 v[48:51], a[224:227], v[96:99], v[48:51]
ds_read_b128 a[252:255], v5 offset:47104
v_mfma_f32_16x16x32_bf16 v[56:59], a[224:227], v[100:103], v[56:59]
buffer_load_dwordx4 v6, s[12:15], s35 offen offset:2048 nt lds
v_fma_f32 v38, v38, s6, -v10
v_mfma_f32_16x16x32_bf16 v[52:55], a[228:231], v[96:99], v[52:55]
s_barrier
ds_read_b64_tr_b16 a[224:225], v0 offset:16384
v_mfma_f32_16x16x32_bf16 v[60:63], a[228:231], v[100:103], v[60:63]
ds_read_b64_tr_b16 a[226:227], v0 offset:18432
v_fma_f32 v39, v39, s6, -v10
v_mfma_f32_16x16x32_bf16 v[48:51], a[232:235], v[104:107], v[48:51]
ds_read_b64_tr_b16 a[228:229], v1 offset:16384
ds_read_b64_tr_b16 a[230:231], v1 offset:18432
v_mfma_f32_16x16x32_bf16 v[56:59], a[232:235], v[108:111], v[56:59]
v_fma_f32 v40, v40, s6, -v11
v_fma_f32 v41, v41, s6, -v11
v_mfma_f32_16x16x32_bf16 v[52:55], a[236:239], v[104:107], v[52:55]
ds_read_b64_tr_b16 a[232:233], v2 offset:16384
L_pg4:
s_cbranch_scc1 L_pg8
ds_read_b64_tr_b16 a[234:235], v2 offset:18432
v_mfma_f32_16x16x32_bf16 v[60:63], a[236:239], v[108:111], v[60:63]
v_fma_f32 v42, v42, s6, -v11
s_waitcnt lgkmcnt(6)
v_mfma_f32_16x16x32_bf16 v[48:51], a[240:243], v[112:115], v[48:51]
ds_read_b64_tr_b16 a[236:237], v3 offset:16384
ds_read_b64_tr_b16 a[238:239], v3 offset:18432
v_mfma_f32_16x16x32_bf16 v[56:59], a[240:243], v[116:119], v[56:59]
v_fma_f32 v43, v43, s6, -v11
v_fma_f32 v44, v44, s6, -v11
v_mfma_f32_16x16x32_bf16 v[52:55], a[244:247], v[112:115], v[52:55]
ds_read_b64_tr_b16 a[240:241], v0 offset:24576
ds_read_b64_tr_b16 a[242:243], v0 offset:26624
v_mfma_f32_16x16x32_bf16 v[60:63], a[244:247], v[116:119], v[60:63]
v_fma_f32 v45, v45, s6, -v11
v_fma_f32 v46, v46, s6, -v11
v_mfma_f32_16x16x32_bf16 v[48:51], a[248:251], v[120:123], v[48:51]
ds_read_b64_tr_b16 a[244:245], v1 offset:24576
ds_read_b64_tr_b16 a[246:247], v1 offset:26624
v_mfma_f32_16x16x32_bf16 v[56:59], a[248:251], v[124:127], v[56:59]
s_waitcnt vmcnt(8)
v_fma_f32 v47, v47, s6, -v11
v_mfma_f32_16x16x32_bf16 v[52:55], a[252:255], v[120:123], v[52:55]
ds_read_b64_tr_b16 a[248:249], v2 offset:24576
v_mfma_f32_16x16x32_bf16 v[60:63], a[252:255], v[124:127], v[60:63]
ds_read_b64_tr_b16 a[250:251], v2 offset:26624
L_step_17:
s_waitcnt lgkmcnt(6)
v_mfma_f32_16x16x32_bf16 a[112:115], a[224:227], a[16:19], a[112:115]
ds_read_b64_tr_b16 a[252:253], v3 offset:24576
ds_read_b64_tr_b16 a[254:255], v3 offset:26624
v_mfma_f32_16x16x32_bf16 a[120:123], a[224:227], a[20:23], a[120:123]
buffer_load_dwordx4 v7, s[12:15], s35 offen offset:3072 nt lds
v_mfma_f32_16x16x32_bf16 a[116:119], a[228:231], a[16:19], a[116:119]
ds_read_b64_tr_b16 a[224:225], v0 offset:20480
ds_read_b64_tr_b16 a[226:227], v0 offset:22528
v_mfma_f32_16x16x32_bf16 a[124:127], a[228:231], a[20:23], a[124:127]
v_exp_f32 v32, v32
v_mfma_f32_16x16x32_bf16 v[208:211], a[232:235], a[16:19], v[208:211]
ds_read_b64_tr_b16 a[228:229], v1 offset:20480
ds_read_b64_tr_b16 a[230:231], v1 offset:22528
v_mfma_f32_16x16x32_bf16 v[216:219], a[232:235], a[20:23], v[216:219]
s_add_u32 m0, s4, 147456
s_mov_b32 s35, 114688
v_mfma_f32_16x16x32_bf16 v[212:215], a[236:239], a[16:19], v[212:215]
ds_read_b64_tr_b16 a[232:233], v2 offset:20480
ds_read_b64_tr_b16 a[234:235], v2 offset:22528
v_mfma_f32_16x16x32_bf16 v[220:223], a[236:239], a[20:23], v[220:223]
v_exp_f32 v33, v33
s_waitcnt lgkmcnt(6)
v_mfma_f32_16x16x32_bf16 v[224:227], a[240:243], a[16:19], v[224:227]
ds_read_b64_tr_b16 a[236:237], v3 offset:20480
ds_read_b64_tr_b16 a[238:239], v3 offset:22528
v_mfma_f32_16x16x32_bf16 v[232:235], a[240:243], a[20:23], v[232:235]
v_exp_f32 v34, v34
v_mfma_f32_16x16x32_bf16 v[228:231], a[244:247], a[16:19], v[228:231]
ds_read_b64_tr_b16 a[240:241], v0 offset:28672
ds_read_b64_tr_b16 a[242:243], v0 offset:30720
v_mfma_f32_16x16x32_bf16 v[236:239], a[244:247], a[20:23], v[236:239]
s_waitcnt vmcnt(8)
buffer_load_dwordx4 v6, s[12:15], s35 offen nt lds
v_mfma_f32_16x16x32_bf16 v[240:243], a[248:251], a[16:19], v[240:243]
ds_read_b64_tr_b16 a[244:245], v1 offset:28672
ds_read_b64_tr_b16 a[246:247], v1 offset:30720
v_mfma_f32_16x16x32_bf16 v[248:251], a[248:251], a[20:23], v[248:251]
v_exp_f32 v35, v35
v_cvt_pk_bf16_f32 v128, v32, v33
v_mfma_f32_16x16x32_bf16 v[244:247], a[252:255], a[16:19], v[244:247]
ds_read_b64_tr_b16 a[248:249], v2 offset:28672
ds_read_b64_tr_b16 a[250:251], v2 offset:30720
v_mfma_f32_16x16x32_bf16 v[252:255], a[252:255], a[20:23], v[252:255]
s_add_u32 m0, s4, 98304
s_add_u32 s5, s55, 512
s_waitcnt lgkmcnt(6)
v_mfma_f32_16x16x32_bf16 a[112:115], a[224:227], a[24:27], a[112:115]
ds_read_b64_tr_b16 a[252:253], v3 offset:28672
ds_read_b64_tr_b16 a[254:255], v3 offset:30720
v_mfma_f32_16x16x32_bf16 a[120:123], a[224:227], a[28:31], a[120:123]
v_exp_f32 v36, v36
v_mfma_f32_16x16x32_bf16 a[116:119], a[228:231], a[24:27], a[116:119]
s_barrier
ds_read_b128 a[224:227], v4 offset:16384
v_mfma_f32_16x16x32_bf16 a[124:127], a[228:231], a[28:31], a[124:127]
v_exp_f32 v37, v37
v_cvt_pk_bf16_f32 v129, v34, v35
v_mfma_f32_16x16x32_bf16 v[208:211], a[232:235], a[24:27], v[208:211]
ds_read_b128 a[228:231], v4 offset:18432
buffer_load_dwordx4 v16, s[20:23], s5 offen lds
v_mfma_f32_16x16x32_bf16 v[216:219], a[232:235], a[28:31], v[216:219]
s_add_u32 m0, s4, 147456
v_exp_f32 v38, v38
v_mfma_f32_16x16x32_bf16 v[212:215], a[236:239], a[24:27], v[212:215]
ds_read_b128 a[232:235], v5 offset:16384
v_exp_f32 v39, v39
v_mfma_f32_16x16x32_bf16 v[220:223], a[236:239], a[28:31], v[220:223]
v_cvt_pk_bf16_f32 v130, v36, v37
s_waitcnt lgkmcnt(3)
v_mfma_f32_16x16x32_bf16 v[224:227], a[240:243], a[24:27], v[224:227]
ds_read_b128 a[236:239], v5 offset:18432
s_waitcnt vmcnt(8)
buffer_load_dwordx4 v7, s[12:15], s35 offen offset:1024 nt lds
v_mfma_f32_16x16x32_bf16 v[232:235], a[240:243], a[28:31], v[232:235]
v_exp_f32 v40, v40
s_add_u32 m0, s4, 98304
v_mfma_f32_16x16x32_bf16 v[228:231], a[244:247], a[24:27], v[228:231]
ds_read_b128 a[240:243], v4 offset:20480
v_exp_f32 v41, v41
v_cvt_pk_bf16_f32 v131, v38, v39
v_mfma_f32_16x16x32_bf16 v[236:239], a[244:247], a[28:31], v[236:239]
v_exp_f32 v42, v42
v_exp_f32 v43, v43
v_mfma_f32_16x16x32_bf16 v[240:243], a[248:251], a[24:27], v[240:243]
ds_read_b128 a[244:247], v4 offset:22528
v_cvt_pk_bf16_f32 v132, v40, v41
v_exp_f32 v44, v44
v_mfma_f32_16x16x32_bf16 v[248:251], a[248:251], a[28:31], v[248:251]
v_exp_f32 v45, v45
v_cvt_pk_bf16_f32 v133, v42, v43
v_mfma_f32_16x16x32_bf16 v[244:247], a[252:255], a[24:27], v[244:247]
ds_read_b128 a[248:251], v5 offset:20480
v_exp_f32 v46, v46
v_mfma_f32_16x16x32_bf16 v[252:255], a[252:255], a[28:31], v[252:255]
v_exp_f32 v47, v47
v_cvt_pk_bf16_f32 v134, v44, v45
v_cvt_pk_bf16_f32 v135, v46, v47
L_step_18:
s_waitcnt lgkmcnt(3)
v_mfma_f32_16x16x32_bf16 v[32:35], a[224:227], v[64:67], 0
ds_read_b128 a[252:255], v5 offset:22528
s_add_u32 s5, s55, 130560
v_mfma_f32_16x16x32_bf16 v[40:43], a[224:227], v[68:71], 0
buffer_load_dwordx4 v16, s[20:23], s5 offen offset:1024 lds
s_add_u32 s5, s55, 31232
v_fma_f32 v48, v48, s6, -v10
v_mfma_f32_16x16x32_bf16 v[36:39], a[228:231], v[64:67], 0
ds_read_b128 a[224:227], v4 offset:24576
buffer_load_dwordx4 v16, s[20:23], s5 offen offset:2048 lds
v_mfma_f32_16x16x32_bf16 v[44:47], a[228:231], v[68:71], 0
s_add_u32 m0, s4, 147456
v_fma_f32 v49, v49, s6, -v10
v_fma_f32 v50, v50, s6, -v10
v_mfma_f32_16x16x32_bf16 v[32:35], a[232:235], v[72:75], v[32:35]
ds_read_b128 a[228:231], v4 offset:26624
s_waitcnt vmcnt(9)
v_mfma_f32_16x16x32_bf16 v[40:43], a[232:235], v[76:79], v[40:43]
buffer_load_dwordx4 v6, s[12:15], s35 offen offset:2048 nt lds
s_add_u32 m0, s4, 98304
s_add_u32 s5, s55, 161280
v_mfma_f32_16x16x32_bf16 v[36:39], a[236:239], v[72:75], v[36:39]
ds_read_b128 a[232:235], v5 offset:24576
v_fma_f32 v51, v51, s6, -v10
v_max3_f32 v12, v48, v49, v50
v_mfma_f32_16x16x32_bf16 v[44:47], a[236:239], v[76:79], v[44:47]
v_fma_f32 v52, v52, s6, -v10
v_fma_f32 v53, v53, s6, -v10
s_waitcnt lgkmcnt(3)
v_mfma_f32_16x16x32_bf16 v[32:35], a[240:243], v[80:83], v[32:35]
ds_read_b128 a[236:239], v5 offset:26624
buffer_load_dwordx4 v16, s[20:23], s5 offen offset:3072 lds
v_mfma_f32_16x16x32_bf16 v[40:43], a[240:243], v[84:87], v[40:43]
v_fma_f32 v54, v54, s6, -v10
v_max3_f32 v13, v51, v52, v53
v_fma_f32 v55, v55, s6, -v10
v_mfma_f32_16x16x32_bf16 v[36:39], a[244:247], v[80:83], v[36:39]
ds_read_b128 a[240:243], v4 offset:28672
s_add_u32 m0, s4, 147456
v_fma_f32 v56, v56, s6, -v11
v_mfma_f32_16x16x32_bf16 v[44:47], a[244:247], v[84:87], v[44:47]
v_max3_f32 v12, v12, v54, v55
v_fma_f32 v57, v57, s6, -v11
v_fma_f32 v58, v58, s6, -v11
v_max3_f32 v13, v13, v56, v57
v_mfma_f32_16x16x32_bf16 v[32:35], a[248:251], v[88:91], v[32:35]
ds_read_b128 a[244:247], v4 offset:30720
v_fma_f32 v59, v59, s6, -v11
v_fma_f32 v60, v60, s6, -v11
v_mfma_f32_16x16x32_bf16 v[40:43], a[248:251], v[92:95], v[40:43]
v_max3_f32 v12, v12, v58, v59
v_fma_f32 v61, v61, s6, -v11
v_fma_f32 v62, v62, s6, -v11
v_mfma_f32_16x16x32_bf16 v[36:39], a[252:255], v[88:91], v[36:39]
ds_read_b128 a[248:251], v5 offset:28672
v_max3_f32 v13, v13, v60, v61
v_fma_f32 v63, v63, s6, -v11
v_mfma_f32_16x16x32_bf16 v[44:47], a[252:255], v[92:95], v[44:47]
v_max3_f32 v12, v12, v62, v63
v_max_f32 v12, v12, v13
v_cmp_lt_f32 vcc, 0x41000000, v12
s_waitcnt lgkmcnt(3)
v_mfma_f32_16x16x32_bf16 v[32:35], a[224:227], v[96:99], v[32:35]
ds_read_b128 a[252:255], v5 offset:30720
s_waitcnt vmcnt(8)
buffer_load_dwordx4 v7, s[12:15], s35 offen offset:3072 nt lds
v_mfma_f32_16x16x32_bf16 v[40:43], a[224:227], v[100:103], v[40:43]
s_cbranch_vccnz L_stub_0_1
L_back_0_1:
v_exp_f32 v48, v48
v_mfma_f32_16x16x32_bf16 v[36:39], a[228:231], v[96:99], v[36:39]
s_barrier
ds_read_b128 a[224:227], v4 offset:0
v_mfma_f32_16x16x32_bf16 v[44:47], a[228:231], v[100:103], v[44:47]
v_exp_f32 v49, v49
v_exp_f32 v50, v50
v_mfma_f32_16x16x32_bf16 v[32:35], a[232:235], v[104:107], v[32:35]
ds_read_b128 a[228:231], v4 offset:2048
v_exp_f32 v51, v51
v_mfma_f32_16x16x32_bf16 v[40:43], a[232:235], v[108:111], v[40:43]
v_cvt_pk_bf16_f32 v136, v48, v49
v_exp_f32 v52, v52
v_mfma_f32_16x16x32_bf16 v[36:39], a[236:239], v[104:107], v[36:39]
ds_read_b128 a[232:235], v5 offset:0
v_exp_f32 v53, v53
v_mfma_f32_16x16x32_bf16 v[44:47], a[236:239], v[108:111], v[44:47]
v_cvt_pk_bf16_f32 v137, v50, v51
v_exp_f32 v54, v54
s_waitcnt lgkmcnt(3)
v_mfma_f32_16x16x32_bf16 v[32:35], a[240:243], v[112:115], v[32:35]
ds_read_b128 a[236:239], v5 offset:2048
v_exp_f32 v55, v55
v_mfma_f32_16x16x32_bf16 v[40:43], a[240:243], v[116:119], v[40:43]
v_cvt_pk_bf16_f32 v138, v52, v53
v_exp_f32 v56, v56
s_add_u32 m0, s4, 32768
v_mfma_f32_16x16x32_bf16 v[36:39], a[244:247], v[112:115], v[36:39]
ds_read_b128 a[240:243], v4 offset:4096
v_exp_f32 v57, v57
v_cvt_pk_bf16_f32 v139, v54, v55
v_mfma_f32_16x16x32_bf16 v[44:47], a[244:247], v[116:119], v[44:47]
v_exp_f32 v58, v58
v_exp_f32 v59, v59
v_mfma_f32_16x16x32_bf16 v[32:35], a[248:251], v[120:123], v[32:35]
ds_read_b128 a[244:247], v4 offset:6144
v_cvt_pk_bf16_f32 v140, v56, v57
v_exp_f32 v60, v60
v_mfma_f32_16x16x32_bf16 v[40:43], a[248:251], v[124:127], v[40:43]
v_exp_f32 v61, v61
v_cvt_pk_bf16_f32 v141, v58, v59
v_mfma_f32_16x16x32_bf16 v[36:39], a[252:255], v[120:123], v[36:39]
ds_read_b128 a[248:251], v5 offset:4096
v_exp_f32 v62, v62
v_mfma_f32_16x16x32_bf16 v[44:47], a[252:255], v[124:127], v[44:47]
v_exp_f32 v63, v63
v_cvt_pk_bf16_f32 v142, v60, v61
v_cvt_pk_bf16_f32 v143, v62, v63
L_step_19:
s_waitcnt lgkmcnt(3)
v_mfma_f32_16x16x32_bf16 v[48:51], a[224:227], v[64:67], 0
ds_read_b128 a[252:255], v5 offset:6144
v_mfma_f32_16x16x32_bf16 v[56:59], a[224:227], v[68:71], 0
s_mov_b32 s35, 131072
s_waitcnt vmcnt(8)
v_mfma_f32_16x16x32_bf16 v[52:55], a[228:231], v[64:67], 0
ds_read_b128 a[224:227], v4 offset:8192
v_mfma_f32_16x16x32_bf16 v[60:63], a[228:231], v[68:71], 0
buffer_load_dwordx4 v6, s[12:15], s35 offen nt lds
v_fma_f32 v32, v32, s6, -v10
v_mfma_f32_16x16x32_bf16 v[48:51], a[232:235], v[72:75], v[48:51]
ds_read_b128 a[228:231], v4 offset:10240
v_fma_f32 v33, v33, s6, -v10
v_mfma_f32_16x16x32_bf16 v[56:59], a[232:235], v[76:79], v[56:59]
v_fma_f32 v34, v34, s6, -v10
v_fma_f32 v35, v35, s6, -v10
v_mfma_f32_16x16x32_bf16 v[52:55], a[236:239], v[72:75], v[52:55]
ds_read_b128 a[232:235], v5 offset:8192
v_max3_f32 v12, v32, v33, v34
v_mfma_f32_16x16x32_bf16 v[60:63], a[236:239], v[76:79], v[60:63]
v_fma_f32 v36, v36, s6, -v10
s_waitcnt lgkmcnt(3)
v_mfma_f32_16x16x32_bf16 v[48:51], a[240:243], v[80:83], v[48:51]
ds_read_b128 a[236:239], v5 offset:10240
s_waitcnt vmcnt(8)
v_mfma_f32_16x16x32_bf16 v[56:59], a[240:243], v[84:87], v[56:59]
buffer_load_dwordx4 v7, s[12:15], s35 offen offset:1024 nt lds
v_mfma_f32_16x16x32_bf16 v[52:55], a[244:247], v[80:83], v[52:55]
ds_read_b128 a[240:243], v4 offset:12288
v_fma_f32 v37, v37, s6, -v10
v_mfma_f32_16x16x32_bf16 v[60:63], a[244:247], v[84:87], v[60:63]
v_fma_f32 v38, v38, s6, -v10
v_max3_f32 v13, v35, v36, v37
v_mfma_f32_16x16x32_bf16 v[48:51], a[248:251], v[88:91], v[48:51]
ds_read_b128 a[244:247], v4 offset:14336
v_fma_f32 v39, v39, s6, -v10
v_mfma_f32_16x16x32_bf16 v[56:59], a[248:251], v[92:95], v[56:59]
v_fma_f32 v40, v40, s6, -v11
v_max3_f32 v12, v12, v38, v39
v_mfma_f32_16x16x32_bf16 v[52:55], a[252:255], v[88:91], v[52:55]
ds_read_b128 a[248:251], v5 offset:12288
s_mov_b32 s5, 768
v_mfma_f32_16x16x32_bf16 v[60:63], a[252:255], v[92:95], v[60:63]
v_fma_f32 v41, v41, s6, -v11
s_waitcnt lgkmcnt(3)
v_mfma_f32_16x16x32_bf16 v[48:51], a[224:227], v[96:99], v[48:51]
ds_read_b128 a[252:255], v5 offset:14336
v_fma_f32 v42, v42, s6, -v11
v_mfma_f32_16x16x32_bf16 v[56:59], a[224:227], v[100:103], v[56:59]
v_max3_f32 v13, v13, v40, v41
v_fma_f32 v43, v43, s6, -v11
v_mfma_f32_16x16x32_bf16 v[52:55], a[228:231], v[96:99], v[52:55]
s_barrier
ds_read_b64_tr_b16 a[224:225], v0 offset:0
v_mfma_f32_16x16x32_bf16 v[60:63], a[228:231], v[100:103], v[60:63]
ds_read_b64_tr_b16 a[226:227], v0 offset:2048
v_fma_f32 v44, v44, s6, -v11
v_mfma_f32_16x16x32_bf16 v[48:51], a[232:235], v[104:107], v[48:51]
ds_read_b64_tr_b16 a[228:229], v1 offset:0
ds_read_b64_tr_b16 a[230:231], v1 offset:2048
v_mfma_f32_16x16x32_bf16 v[56:59], a[232:235], v[108:111], v[56:59]
buffer_load_dword v20, v18, s[20:23], s5 offen
v_mfma_f32_16x16x32_bf16 v[52:55], a[236:239], v[104:107], v[52:55]
ds_read_b64_tr_b16 a[232:233], v2 offset:0
ds_read_b64_tr_b16 a[234:235], v2 offset:2048
v_mfma_f32_16x16x32_bf16 v[60:63], a[236:239], v[108:111], v[60:63]
s_waitcnt vmcnt(8)
s_waitcnt lgkmcnt(6)
v_mfma_f32_16x16x32_bf16 v[48:51], a[240:243], v[112:115], v[48:51]
ds_read_b64_tr_b16 a[236:237], v3 offset:0
ds_read_b64_tr_b16 a[238:239], v3 offset:2048
v_mfma_f32_16x16x32_bf16 v[56:59], a[240:243], v[116:119], v[56:59]
buffer_load_dwordx4 v6, s[12:15], s35 offen offset:2048 nt lds
v_mfma_f32_16x16x32_bf16 v[52:55], a[244:247], v[112:115], v[52:55]
ds_read_b64_tr_b16 a[240:241], v0 offset:8192
ds_read_b64_tr_b16 a[242:243], v0 offset:10240
v_mfma_f32_16x16x32_bf16 v[60:63], a[244:247], v[116:119], v[60:63]
v_max3_f32 v12, v12, v42, v43
v_fma_f32 v45, v45, s6, -v11
v_fma_f32 v46, v46, s6, -v11
v_mfma_f32_16x16x32_bf16 v[48:51], a[248:251], v[120:123], v[48:51]
ds_read_b64_tr_b16 a[244:245], v1 offset:8192
ds_read_b64_tr_b16 a[246:247], v1 offset:10240
v_mfma_f32_16x16x32_bf16 v[56:59], a[248:251], v[124:127], v[56:59]
v_max3_f32 v13, v13, v44, v45
v_fma_f32 v47, v47, s6, -v11
v_mfma_f32_16x16x32_bf16 v[52:55], a[252:255], v[120:123], v[52:55]
ds_read_b64_tr_b16 a[248:249], v2 offset:8192
ds_read_b64_tr_b16 a[250:251], v2 offset:10240
v_mfma_f32_16x16x32_bf16 v[60:63], a[252:255], v[124:127], v[60:63]
v_max3_f32 v12, v12, v46, v47
v_max_f32 v12, v12, v13
L_step_20:
s_waitcnt lgkmcnt(6)
v_mfma_f32_16x16x32_bf16 a[112:115], a[224:227], a[32:35], a[112:115]
ds_read_b64_tr_b16 a[252:253], v3 offset:8192
ds_read_b64_tr_b16 a[254:255], v3 offset:10240
v_mfma_f32_16x16x32_bf16 a[120:123], a[224:227], a[36:39], a[120:123]
v_cmp_lt_f32 vcc, 0x41000000, v12
s_cbranch_vccnz L_stub_0_2
L_back_0_2:
v_mfma_f32_16x16x32_bf16 a[116:119], a[228:231], a[32:35], a[116:119]
ds_read_b64_tr_b16 a[224:225], v0 offset:4096
ds_read_b64_tr_b16 a[226:227], v0 offset:6144
v_mfma_f32_16x16x32_bf16 a[124:127], a[228:231], a[36:39], a[124:127]
v_exp_f32 v32, v32
v_mfma_f32_16x16x32_bf16 v[208:211], a[232:235], a[32:35], v[208:211]
ds_read_b64_tr_b16 a[228:229], v1 offset:4096
ds_read_b64_tr_b16 a[230:231], v1 offset:6144
v_mfma_f32_16x16x32_bf16 v[216:219], a[232:235], a[36:39], v[216:219]
s_waitcnt vmcnt(6)
buffer_load_dwordx4 v7, s[12:15], s35 offen offset:3072 nt lds
v_mfma_f32_16x16x32_bf16 v[212:215], a[236:239], a[32:35], v[212:215]
ds_read_b64_tr_b16 a[232:233], v2 offset:4096
ds_read_b64_tr_b16 a[234:235], v2 offset:6144
v_mfma_f32_16x16x32_bf16 v[220:223], a[236:239], a[36:39], v[220:223]
v_exp_f32 v33, v33
s_waitcnt lgkmcnt(6)
v_mfma_f32_16x16x32_bf16 v[224:227], a[240:243], a[32:35], v[224:227]
ds_read_b64_tr_b16 a[236:237], v3 offset:4096
ds_read_b64_tr_b16 a[238:239], v3 offset:6144
v_mfma_f32_16x16x32_bf16 v[232:235], a[240:243], a[36:39], v[232:235]
v_exp_f32 v34, v34
v_mfma_f32_16x16x32_bf16 v[228:231], a[244:247], a[32:35], v[228:231]
ds_read_b64_tr_b16 a[240:241], v0 offset:12288
ds_read_b64_tr_b16 a[242:243], v0 offset:14336
v_mfma_f32_16x16x32_bf16 v[236:239], a[244:247], a[36:39], v[236:239]
v_exp_f32 v35, v35
v_cvt_pk_bf16_f32 v144, v32, v33
v_mfma_f32_16x16x32_bf16 v[240:243], a[248:251], a[32:35], v[240:243]
ds_read_b64_tr_b16 a[244:245], v1 offset:12288
ds_read_b64_tr_b16 a[246:247], v1 offset:14336
v_mfma_f32_16x16x32_bf16 v[248:251], a[248:251], a[36:39], v[248:251]
v_exp_f32 v36, v36
v_mfma_f32_16x16x32_bf16 v[244:247], a[252:255], a[32:35], v[244:247]
ds_read_b64_tr_b16 a[248:249], v2 offset:12288
ds_read_b64_tr_b16 a[250:251], v2 offset:14336
v_mfma_f32_16x16x32_bf16 v[252:255], a[252:255], a[36:39], v[252:255]
s_add_u32 m0, s4, 0
s_mov_b32 s35, 147456
s_waitcnt lgkmcnt(6)
v_mfma_f32_16x16x32_bf16 a[112:115], a[224:227], a[40:43], a[112:115]
ds_read_b64_tr_b16 a[252:253], v3 offset:12288
ds_read_b64_tr_b16 a[254:255], v3 offset:14336
v_mfma_f32_16x16x32_bf16 a[120:123], a[224:227], a[44:47], a[120:123]
v_exp_f32 v37, v37
v_cvt_pk_bf16_f32 v145, v34, v35
v_mfma_f32_16x16x32_bf16 a[116:119], a[228:231], a[40:43], a[116:119]
s_barrier
ds_read_b128 a[224:227], v4 offset:49152
v_mfma_f32_16x16x32_bf16 a[124:127], a[228:231], a[44:47], a[124:127]
v_exp_f32 v38, v38
v_mfma_f32_16x16x32_bf16 v[208:211], a[232:235], a[40:43], v[208:211]
ds_read_b128 a[228:231], v4 offset:51200
s_waitcnt vmcnt(5)
v_mfma_f32_16x16x32_bf16 v[216:219], a[232:235], a[44:47], v[216:219]
buffer_load_dwordx4 v6, s[12:15], s35 offen nt lds
s_add_u32 m0, s4, 81920
s_add_u32 s5, s56, 512
v_mfma_f32_16x16x32_bf16 v[212:215], a[236:239], a[40:43], v[212:215]
ds_read_b128 a[232:235], v5 offset:49152
buffer_load_dwordx4 v16, s[20:23], s5 offen lds
v_mfma_f32_16x16x32_bf16 v[220:223], a[236:239], a[44:47], v[220:223]
v_exp_f32 v39, v39
v_cvt_pk_bf16_f32 v146, v36, v37
s_waitcnt lgkmcnt(3)
v_mfma_f32_16x16x32_bf16 v[224:227], a[240:243], a[40:43], v[224:227]
ds_read_b128 a[236:239], v5 offset:51200
v_exp_f32 v40, v40
v_mfma_f32_16x16x32_bf16 v[232:235], a[240:243], a[44:47], v[232:235]
v_exp_f32 v41, v41
v_cvt_pk_bf16_f32 v147, v38, v39
v_mfma_f32_16x16x32_bf16 v[228:231], a[244:247], a[40:43], v[228:231]
ds_read_b128 a[240:243], v4 offset:53248
v_exp_f32 v42, v42
v_mfma_f32_16x16x32_bf16 v[236:239], a[244:247], a[44:47], v[236:239]
v_exp_f32 v43, v43
v_cvt_pk_bf16_f32 v148, v40, v41
s_add_u32 s5, s56, 130560
v_mfma_f32_16x16x32_bf16 v[240:243], a[248:251], a[40:43], v[240:243]
ds_read_b128 a[244:247], v4 offset:55296
v_exp_f32 v44, v44
v_mfma_f32_16x16x32_bf16 v[248:251], a[248:251], a[44:47], v[248:251]
v_exp_f32 v45, v45
v_cvt_pk_bf16_f32 v149, v42, v43
v_mfma_f32_16x16x32_bf16 v[244:247], a[252:255], a[40:43], v[244:247]
ds_read_b128 a[248:251], v5 offset:53248
v_exp_f32 v46, v46
v_mfma_f32_16x16x32_bf16 v[252:255], a[252:255], a[44:47], v[252:255]
v_exp_f32 v47, v47
v_cvt_pk_bf16_f32 v150, v44, v45
v_cvt_pk_bf16_f32 v151, v46, v47
L_step_21:
s_waitcnt lgkmcnt(3)
v_mfma_f32_16x16x32_bf16 v[32:35], a[224:227], v[64:67], 0
ds_read_b128 a[252:255], v5 offset:55296
v_mfma_f32_16x16x32_bf16 v[40:43], a[224:227], v[68:71], 0
buffer_load_dwordx4 v16, s[20:23], s5 offen offset:1024 lds
s_add_u32 m0, s4, 0
v_mfma_f32_16x16x32_bf16 v[36:39], a[228:231], v[64:67], 0
ds_read_b128 a[224:227], v4 offset:57344
s_waitcnt vmcnt(7)
v_mfma_f32_16x16x32_bf16 v[44:47], a[228:231], v[68:71], 0
buffer_load_dwordx4 v7, s[12:15], s35 offen offset:1024 nt lds
v_mfma_f32_16x16x32_bf16 v[32:35], a[232:235], v[72:75], v[32:35]
ds_read_b128 a[228:231], v4 offset:59392
s_add_u32 m0, s4, 81920
v_mfma_f32_16x16x32_bf16 v[40:43], a[232:235], v[76:79], v[40:43]
s_add_u32 s5, s56, 31232
v_fma_f32 v48, v48, s6, -v10
v_mfma_f32_16x16x32_bf16 v[36:39], a[236:239], v[72:75], v[36:39]
ds_read_b128 a[232:235], v5 offset:57344
v_mfma_f32_16x16x32_bf16 v[44:47], a[236:239], v[76:79], v[44:47]
buffer_load_dwordx4 v16, s[20:23], s5 offen offset:2048 lds
s_waitcnt lgkmcnt(3)
v_mfma_f32_16x16x32_bf16 v[32:35], a[240:243], v[80:83], v[32:35]
ds_read_b128 a[236:239], v5 offset:59392
s_add_u32 s5, s56, 161280
v_mfma_f32_16x16x32_bf16 v[40:43], a[240:243], v[84:87], v[40:43]
buffer_load_dwordx4 v16, s[20:23], s5 offen offset:3072 lds
v_mfma_f32_16x16x32_bf16 v[36:39], a[244:247], v[80:83], v[36:39]
ds_read_b128 a[240:243], v4 offset:61440
s_add_u32 m0, s4, 0
v_mfma_f32_16x16x32_bf16 v[44:47], a[244:247], v[84:87], v[44:47]
s_waitcnt vmcnt(9)
v_fma_f32 v49, v49, s6, -v10
v_mfma_f32_16x16x32_bf16 v[32:35], a[248:251], v[88:91], v[32:35]
ds_read_b128 a[244:247], v4 offset:63488
v_mfma_f32_16x16x32_bf16 v[40:43], a[248:251], v[92:95], v[40:43]
buffer_load_dwordx4 v6, s[12:15], s35 offen offset:2048 nt lds
v_fma_f32 v50, v50, s6, -v10
v_mfma_f32_16x16x32_bf16 v[36:39], a[252:255], v[88:91], v[36:39]
ds_read_b128 a[248:251], v5 offset:61440
v_fma_f32 v51, v51, s6, -v10
v_mfma_f32_16x16x32_bf16 v[44:47], a[252:255], v[92:95], v[44:47]
v_max3_f32 v12, v48, v49, v50
s_waitcnt lgkmcnt(3)
v_mfma_f32_16x16x32_bf16 v[32:35], a[224:227], v[96:99], v[32:35]
ds_read_b128 a[252:255], v5 offset:63488
v_fma_f32 v52, v52, s6, -v10
v_mfma_f32_16x16x32_bf16 v[40:43], a[224:227], v[100:103], v[40:43]
v_fma_f32 v53, v53, s6, -v10
v_fma_f32 v54, v54, s6, -v10
v_max3_f32 v13, v51, v52, v53
v_mfma_f32_16x16x32_bf16 v[36:39], a[228:231], v[96:99], v[36:39]
s_barrier
ds_read_b64_tr_b16 a[224:225], v0 offset:32768
v_mfma_f32_16x16x32_bf16 v[44:47], a[228:231], v[100:103], v[44:47]
ds_read_b64_tr_b16 a[226:227], v0 offset:34816
v_fma_f32 v55, v55, s6, -v10
v_mfma_f32_16x16x32_bf16 v[32:35], a[232:235], v[104:107], v[32:35]
ds_read_b64_tr_b16 a[228:229], v1 offset:32768
ds_read_b64_tr_b16 a[230:231], v1 offset:34816
v_mfma_f32_16x16x32_bf16 v[40:43], a[232:235], v[108:111], v[40:43]
v_fma_f32 v56, v56, s6, -v11
v_max3_f32 v12, v12, v54, v55
v_fma_f32 v57, v57, s6, -v11
v_mfma_f32_16x16x32_bf16 v[36:39], a[236:239], v[104:107], v[36:39]
ds_read_b64_tr_b16 a[232:233], v2 offset:32768
ds_read_b64_tr_b16 a[234:235], v2 offset:34816
v_mfma_f32_16x16x32_bf16 v[44:47], a[236:239], v[108:111], v[44:47]
v_fma_f32 v58, v58, s6, -v11
s_waitcnt lgkmcnt(6)
v_mfma_f32_16x16x32_bf16 v[32:35], a[240:243], v[112:115], v[32:35]
ds_read_b64_tr_b16 a[236:237], v3 offset:32768
ds_read_b64_tr_b16 a[238:239], v3 offset:34816
v_mfma_f32_16x16x32_bf16 v[40:43], a[240:243], v[116:119], v[40:43]
s_waitcnt vmcnt(8)
buffer_load_dwordx4 v7, s[12:15], s35 offen offset:3072 nt lds
v_mfma_f32_16x16x32_bf16 v[36:39], a[244:247], v[112:115], v[36:39]
ds_read_b64_tr_b16 a[240:241], v0 offset:40960
ds_read_b64_tr_b16 a[242:243], v0 offset:43008
v_mfma_f32_16x16x32_bf16 v[44:47], a[244:247], v[116:119], v[44:47]
v_add_u32 v4, 0x18000, v4
v_max3_f32 v13, v13, v56, v57
v_fma_f32 v59, v59, s6, -v11
v_mfma_f32_16x16x32_bf16 v[32:35], a[248:251], v[120:123], v[32:35]
ds_read_b64_tr_b16 a[244:245], v1 offset:40960
ds_read_b64_tr_b16 a[246:247], v1 offset:43008
v_mfma_f32_16x16x32_bf16 v[40:43], a[248:251], v[124:127], v[40:43]
v_fma_f32 v60, v60, s6, -v11
v_max3_f32 v12, v12, v58, v59
v_fma_f32 v61, v61, s6, -v11
v_mfma_f32_16x16x32_bf16 v[36:39], a[252:255], v[120:123], v[36:39]
ds_read_b64_tr_b16 a[248:249], v2 offset:40960
ds_read_b64_tr_b16 a[250:251], v2 offset:43008
v_mfma_f32_16x16x32_bf16 v[44:47], a[252:255], v[124:127], v[44:47]
v_add_u32 v5, 0x18000, v5
v_fma_f32 v62, v62, s6, -v11
L_step_22:
s_waitcnt lgkmcnt(6)
v_mfma_f32_16x16x32_bf16 a[112:115], a[224:227], a[48:51], a[112:115]
ds_read_b64_tr_b16 a[252:253], v3 offset:40960
ds_read_b64_tr_b16 a[254:255], v3 offset:43008
v_mfma_f32_16x16x32_bf16 a[120:123], a[224:227], a[52:55], a[120:123]
s_add_u32 m0, s4, 16384
s_mov_b32 s35, 163840
v_max3_f32 v13, v13, v60, v61
v_mfma_f32_16x16x32_bf16 a[116:119], a[228:231], a[48:51], a[116:119]
ds_read_b64_tr_b16 a[224:225], v0 offset:36864
ds_read_b64_tr_b16 a[226:227], v0 offset:38912
v_mfma_f32_16x16x32_bf16 a[124:127], a[228:231], a[52:55], a[124:127]
v_fma_f32 v63, v63, s6, -v11
v_max3_f32 v12, v12, v62, v63
v_max_f32 v12, v12, v13
v_mfma_f32_16x16x32_bf16 v[208:211], a[232:235], a[48:51], v[208:211]
ds_read_b64_tr_b16 a[228:229], v1 offset:36864
ds_read_b64_tr_b16 a[230:231], v1 offset:38912
v_mfma_f32_16x16x32_bf16 v[216:219], a[232:235], a[52:55], v[216:219]
v_cmp_lt_f32 vcc, 0x41000000, v12
s_cbranch_vccnz L_stub_0_3
L_back_0_3:
v_mfma_f32_16x16x32_bf16 v[212:215], a[236:239], a[48:51], v[212:215]
ds_read_b64_tr_b16 a[232:233], v2 offset:36864
ds_read_b64_tr_b16 a[234:235], v2 offset:38912
v_mfma_f32_16x16x32_bf16 v[220:223], a[236:239], a[52:55], v[220:223]
s_waitcnt vmcnt(8)
s_waitcnt lgkmcnt(6)
v_mfma_f32_16x16x32_bf16 v[224:227], a[240:243], a[48:51], v[224:227]
ds_read_b64_tr_b16 a[236:237], v3 offset:36864
ds_read_b64_tr_b16 a[238:239], v3 offset:38912
v_mfma_f32_16x16x32_bf16 v[232:235], a[240:243], a[52:55], v[232:235]
buffer_load_dwordx4 v6, s[12:15], s35 offen nt lds
v_mfma_f32_16x16x32_bf16 v[228:231], a[244:247], a[48:51], v[228:231]
L_pg5:
s_cbranch_scc1 L_pg9
ds_read_b64_tr_b16 a[240:241], v0 offset:45056
ds_read_b64_tr_b16 a[242:243], v0 offset:47104
v_mfma_f32_16x16x32_bf16 v[236:239], a[244:247], a[52:55], v[236:239]
v_exp_f32 v48, v48
v_mfma_f32_16x16x32_bf16 v[240:243], a[248:251], a[48:51], v[240:243]
ds_read_b64_tr_b16 a[244:245], v1 offset:45056
ds_read_b64_tr_b16 a[246:247], v1 offset:47104
v_mfma_f32_16x16x32_bf16 v[248:251], a[248:251], a[52:55], v[248:251]
v_exp_f32 v49, v49
v_mfma_f32_16x16x32_bf16 v[244:247], a[252:255], a[48:51], v[244:247]
ds_read_b64_tr_b16 a[248:249], v2 offset:45056
ds_read_b64_tr_b16 a[250:251], v2 offset:47104
v_mfma_f32_16x16x32_bf16 v[252:255], a[252:255], a[52:55], v[252:255]
v_exp_f32 v50, v50
s_waitcnt lgkmcnt(6)
v_mfma_f32_16x16x32_bf16 a[112:115], a[224:227], a[56:59], a[112:115]
ds_read_b64_tr_b16 a[252:253], v3 offset:45056
ds_read_b64_tr_b16 a[254:255], v3 offset:47104
v_mfma_f32_16x16x32_bf16 a[120:123], a[224:227], a[60:63], a[120:123]
v_exp_f32 v51, v51
v_cvt_pk_bf16_f32 v152, v48, v49
v_mfma_f32_16x16x32_bf16 a[116:119], a[228:231], a[56:59], a[116:119]
s_barrier
ds_read_b128 a[224:227], v4 offset:32768
v_mfma_f32_16x16x32_bf16 a[124:127], a[228:231], a[60:63], a[124:127]
v_exp_f32 v52, v52
v_exp_f32 v53, v53
v_mfma_f32_16x16x32_bf16 v[208:211], a[232:235], a[56:59], v[208:211]
ds_read_b128 a[228:231], v4 offset:34816
s_waitcnt vmcnt(8)
buffer_load_dwordx4 v7, s[12:15], s35 offen offset:1024 nt lds
v_mfma_f32_16x16x32_bf16 v[216:219], a[232:235], a[60:63], v[216:219]
s_add_u32 m0, s4, 65536
s_add_u32 s5, s57, 512
v_cvt_pk_bf16_f32 v153, v50, v51
v_mfma_f32_16x16x32_bf16 v[212:215], a[236:239], a[56:59], v[212:215]
ds_read_b128 a[232:235], v5 offset:32768
buffer_load_dwordx4 v16, s[20:23], s5 offen lds
v_mfma_f32_16x16x32_bf16 v[220:223], a[236:239], a[60:63], v[220:223]
v_exp_f32 v54, v54
s_add_u32 s5, s57, 130560
s_waitcnt lgkmcnt(3)
v_mfma_f32_16x16x32_bf16 v[224:227], a[240:243], a[56:59], v[224:227]
ds_read_b128 a[236:239], v5 offset:34816
v_exp_f32 v55, v55
v_mfma_f32_16x16x32_bf16 v[232:235], a[240:243], a[60:63], v[232:235]
v_cvt_pk_bf16_f32 v154, v52, v53
v_exp_f32 v56, v56
v_mfma_f32_16x16x32_bf16 v[228:231], a[244:247], a[56:59], v[228:231]
ds_read_b128 a[240:243], v4 offset:36864
v_exp_f32 v57, v57
v_cvt_pk_bf16_f32 v155, v54, v55
v_mfma_f32_16x16x32_bf16 v[236:239], a[244:247], a[60:63], v[236:239]
v_exp_f32 v58, v58
v_exp_f32 v59, v59
v_mfma_f32_16x16x32_bf16 v[240:243], a[248:251], a[56:59], v[240:243]
ds_read_b128 a[244:247], v4 offset:38912
v_cvt_pk_bf16_f32 v156, v56, v57
v_exp_f32 v60, v60
v_mfma_f32_16x16x32_bf16 v[248:251], a[248:251], a[60:63], v[248:251]
v_exp_f32 v61, v61
v_cvt_pk_bf16_f32 v157, v58, v59
v_mfma_f32_16x16x32_bf16 v[244:247], a[252:255], a[56:59], v[244:247]
ds_read_b128 a[248:251], v5 offset:36864
v_exp_f32 v62, v62
v_mfma_f32_16x16x32_bf16 v[252:255], a[252:255], a[60:63], v[252:255]
v_exp_f32 v63, v63
v_cvt_pk_bf16_f32 v158, v60, v61
v_cvt_pk_bf16_f32 v159, v62, v63
L_step_23:
s_waitcnt lgkmcnt(3)
v_mfma_f32_16x16x32_bf16 v[48:51], a[224:227], v[64:67], 0
ds_read_b128 a[252:255], v5 offset:38912
buffer_load_dwordx4 v16, s[20:23], s5 offen offset:1024 lds
v_mfma_f32_16x16x32_bf16 v[56:59], a[224:227], v[68:71], 0
s_add_u32 m0, s4, 16384
s_waitcnt vmcnt(8)
v_fma_f32 v32, v32, s6, -v10
v_mfma_f32_16x16x32_bf16 v[52:55], a[228:231], v[64:67], 0
ds_read_b128 a[224:227], v4 offset:40960
buffer_load_dwordx4 v6, s[12:15], s35 offen offset:2048 nt lds
v_mfma_f32_16x16x32_bf16 v[60:63], a[228:231], v[68:71], 0
s_add_u32 m0, s4, 65536
s_add_u32 s5, s57, 31232
v_fma_f32 v33, v33, s6, -v10
v_mfma_f32_16x16x32_bf16 v[48:51], a[232:235], v[72:75], v[48:51]
ds_read_b128 a[228:231], v4 offset:43008
buffer_load_dwordx4 v16, s[20:23], s5 offen offset:2048 lds
v_mfma_f32_16x16x32_bf16 v[56:59], a[232:235], v[76:79], v[56:59]
s_add_u32 s5, s57, 161280
v_fma_f32 v34, v34, s6, -v10
v_fma_f32 v35, v35, s6, -v10
v_mfma_f32_16x16x32_bf16 v[52:55], a[236:239], v[72:75], v[52:55]
ds_read_b128 a[232:235], v5 offset:40960
v_max3_f32 v12, v32, v33, v34
v_fma_f32 v36, v36, s6, -v10
v_mfma_f32_16x16x32_bf16 v[60:63], a[236:239], v[76:79], v[60:63]
v_fma_f32 v37, v37, s6, -v10
v_fma_f32 v38, v38, s6, -v10
s_waitcnt lgkmcnt(3)
v_mfma_f32_16x16x32_bf16 v[48:51], a[240:243], v[80:83], v[48:51]
ds_read_b128 a[236:239], v5 offset:43008
buffer_load_dwordx4 v16, s[20:23], s5 offen offset:3072 lds
v_mfma_f32_16x16x32_bf16 v[56:59], a[240:243], v[84:87], v[56:59]
s_add_u32 m0, s4, 16384
v_max3_f32 v13, v35, v36, v37
v_fma_f32 v39, v39, s6, -v10
v_mfma_f32_16x16x32_bf16 v[52:55], a[244:247], v[80:83], v[52:55]
ds_read_b128 a[240:243], v4 offset:45056
v_fma_f32 v40, v40, s6, -v11
v_max3_f32 v12, v12, v38, v39
v_mfma_f32_16x16x32_bf16 v[60:63], a[244:247], v[84:87], v[60:63]
v_fma_f32 v41, v41, s6, -v11
v_fma_f32 v42, v42, s6, -v11
v_max3_f32 v13, v13, v40, v41
v_mfma_f32_16x16x32_bf16 v[48:51], a[248:251], v[88:91], v[48:51]
ds_read_b128 a[244:247], v4 offset:47104
s_waitcnt vmcnt(8)
buffer_load_dwordx4 v7, s[12:15], s35 offen offset:3072 nt lds
v_mfma_f32_16x16x32_bf16 v[56:59], a[248:251], v[92:95], v[56:59]
v_fma_f32 v43, v43, s6, -v11
v_fma_f32 v44, v44, s6, -v11
v_max3_f32 v12, v12, v42, v43
v_mfma_f32_16x16x32_bf16 v[52:55], a[252:255], v[88:91], v[52:55]
ds_read_b128 a[248:251], v5 offset:45056
v_fma_f32 v45, v45, s6, -v11
v_fma_f32 v46, v46, s6, -v11
v_mfma_f32_16x16x32_bf16 v[60:63], a[252:255], v[92:95], v[60:63]
v_max3_f32 v13, v13, v44, v45
v_fma_f32 v47, v47, s6, -v11
v_max3_f32 v12, v12, v46, v47
s_waitcnt lgkmcnt(3)
v_mfma_f32_16x16x32_bf16 v[48:51], a[224:227], v[96:99], v[48:51]
ds_read_b128 a[252:255], v5 offset:47104
v_max_f32 v12, v12, v13
v_cmp_lt_f32 vcc, 0x41000000, v12
v_mfma_f32_16x16x32_bf16 v[56:59], a[224:227], v[100:103], v[56:59]
s_cbranch_vccnz L_stub_0_4
L_back_0_4:
v_exp_f32 v32, v32
v_mfma_f32_16x16x32_bf16 v[52:55], a[228:231], v[96:99], v[52:55]
s_barrier
ds_read_b128 a[224:227], v4 offset:16384
s_add_u32 m0, s4, 49152
v_mfma_f32_16x16x32_bf16 v[60:63], a[228:231], v[100:103], v[60:63]
s_mov_b32 s35, 180224
v_exp_f32 v33, v33
v_mfma_f32_16x16x32_bf16 v[48:51], a[232:235], v[104:107], v[48:51]
ds_read_b128 a[228:231], v4 offset:18432
v_exp_f32 v34, v34
v_mfma_f32_16x16x32_bf16 v[56:59], a[232:235], v[108:111], v[56:59]
v_exp_f32 v35, v35
v_cvt_pk_bf16_f32 v160, v32, v33
v_mfma_f32_16x16x32_bf16 v[52:55], a[236:239], v[104:107], v[52:55]
ds_read_b128 a[232:235], v5 offset:16384
v_exp_f32 v36, v36
v_mfma_f32_16x16x32_bf16 v[60:63], a[236:239], v[108:111], v[60:63]
v_exp_f32 v37, v37
v_cvt_pk_bf16_f32 v161, v34, v35
s_waitcnt lgkmcnt(3)
v_mfma_f32_16x16x32_bf16 v[48:51], a[240:243], v[112:115], v[48:51]
ds_read_b128 a[236:239], v5 offset:18432
s_waitcnt vmcnt(8)
buffer_load_dwordx4 v6, s[12:15], s35 offen nt lds
v_mfma_f32_16x16x32_bf16 v[56:59], a[240:243], v[116:119], v[56:59]
v_exp_f32 v38, v38
v_exp_f32 v39, v39
v_mfma_f32_16x16x32_bf16 v[52:55], a[244:247], v[112:115], v[52:55]
ds_read_b128 a[240:243], v4 offset:20480
v_cvt_pk_bf16_f32 v162, v36, v37
v_exp_f32 v40, v40
v_mfma_f32_16x16x32_bf16 v[60:63], a[244:247], v[116:119], v[60:63]
v_exp_f32 v41, v41
v_cvt_pk_bf16_f32 v163, v38, v39
v_exp_f32 v42, v42
v_mfma_f32_16x16x32_bf16 v[48:51], a[248:251], v[120:123], v[48:51]
ds_read_b128 a[244:247], v4 offset:22528
v_exp_f32 v43, v43
v_cvt_pk_bf16_f32 v164, v40, v41
v_mfma_f32_16x16x32_bf16 v[56:59], a[248:251], v[124:127], v[56:59]
v_exp_f32 v44, v44
v_exp_f32 v45, v45
v_mfma_f32_16x16x32_bf16 v[52:55], a[252:255], v[120:123], v[52:55]
ds_read_b128 a[248:251], v5 offset:20480
v_cvt_pk_bf16_f32 v165, v42, v43
v_exp_f32 v46, v46
v_mfma_f32_16x16x32_bf16 v[60:63], a[252:255], v[124:127], v[60:63]
v_exp_f32 v47, v47
v_cvt_pk_bf16_f32 v166, v44, v45
v_cvt_pk_bf16_f32 v167, v46, v47
L_step_24:
s_waitcnt lgkmcnt(3)
v_mfma_f32_16x16x32_bf16 v[32:35], a[224:227], v[64:67], 0
v_mfma_f32_16x16x32_bf16 v[40:43], a[224:227], v[68:71], 0
ds_read_b128 a[252:255], v5 offset:22528
v_mfma_f32_16x16x32_bf16 v[36:39], a[228:231], v[64:67], 0
ds_read_b128 a[224:227], v4 offset:24576
v_fma_f32 v48, v48, s6, -v10
v_mfma_f32_16x16x32_bf16 v[44:47], a[228:231], v[68:71], 0
v_fma_f32 v49, v49, s6, -v10
v_fma_f32 v50, v50, s6, -v10
v_mfma_f32_16x16x32_bf16 v[32:35], a[232:235], v[72:75], v[32:35]
ds_read_b128 a[228:231], v4 offset:26624
v_fma_f32 v51, v51, s6, -v10
v_mfma_f32_16x16x32_bf16 v[40:43], a[232:235], v[76:79], v[40:43]
v_max3_f32 v12, v48, v49, v50
v_fma_f32 v52, v52, s6, -v10
v_mfma_f32_16x16x32_bf16 v[36:39], a[236:239], v[72:75], v[36:39]
ds_read_b128 a[232:235], v5 offset:24576
s_waitcnt vmcnt(8)
v_mfma_f32_16x16x32_bf16 v[44:47], a[236:239], v[76:79], v[44:47]
v_fma_f32 v53, v53, s6, -v10
s_waitcnt lgkmcnt(3)
v_mfma_f32_16x16x32_bf16 v[32:35], a[240:243], v[80:83], v[32:35]
ds_read_b128 a[236:239], v5 offset:26624
v_mfma_f32_16x16x32_bf16 v[40:43], a[240:243], v[84:87], v[40:43]
buffer_load_dwordx4 v7, s[12:15], s35 offen offset:1024 nt lds
v_fma_f32 v54, v54, s6, -v10
v_mfma_f32_16x16x32_bf16 v[36:39], a[244:247], v[80:83], v[36:39]
ds_read_b128 a[240:243], v4 offset:28672
v_max3_f32 v13, v51, v52, v53
v_mfma_f32_16x16x32_bf16 v[44:47], a[244:247], v[84:87], v[44:47]
v_fma_f32 v55, v55, s6, -v10
v_fma_f32 v56, v56, s6, -v11
v_mfma_f32_16x16x32_bf16 v[32:35], a[248:251], v[88:91], v[32:35]
ds_read_b128 a[244:247], v4 offset:30720
v_max3_f32 v12, v12, v54, v55
v_mfma_f32_16x16x32_bf16 v[40:43], a[248:251], v[92:95], v[40:43]
v_fma_f32 v57, v57, s6, -v11
v_fma_f32 v58, v58, s6, -v11
v_mfma_f32_16x16x32_bf16 v[36:39], a[252:255], v[88:91], v[36:39]
ds_read_b128 a[248:251], v5 offset:28672
v_max3_f32 v13, v13, v56, v57
v_mfma_f32_16x16x32_bf16 v[44:47], a[252:255], v[92:95], v[44:47]
v_fma_f32 v59, v59, s6, -v11
s_waitcnt lgkmcnt(3)
v_mfma_f32_16x16x32_bf16 v[32:35], a[224:227], v[96:99], v[32:35]
ds_read_b128 a[252:255], v5 offset:30720
v_fma_f32 v60, v60, s6, -v11
v_mfma_f32_16x16x32_bf16 v[40:43], a[224:227], v[100:103], v[40:43]
v_max3_f32 v12, v12, v58, v59
v_fma_f32 v61, v61, s6, -v11
v_mfma_f32_16x16x32_bf16 v[36:39], a[228:231], v[96:99], v[36:39]
s_barrier
ds_read_b64_tr_b16 a[224:225], v0 offset:16384
v_mfma_f32_16x16x32_bf16 v[44:47], a[228:231], v[100:103], v[44:47]
ds_read_b64_tr_b16 a[226:227], v0 offset:18432
s_waitcnt vmcnt(8)
v_mfma_f32_16x16x32_bf16 v[32:35], a[232:235], v[104:107], v[32:35]
ds_read_b64_tr_b16 a[228:229], v1 offset:16384
ds_read_b64_tr_b16 a[230:231], v1 offset:18432
v_mfma_f32_16x16x32_bf16 v[40:43], a[232:235], v[108:111], v[40:43]
buffer_load_dwordx4 v6, s[12:15], s35 offen offset:2048 nt lds
v_mfma_f32_16x16x32_bf16 v[36:39], a[236:239], v[104:107], v[36:39]
ds_read_b64_tr_b16 a[232:233], v2 offset:16384
ds_read_b64_tr_b16 a[234:235], v2 offset:18432
v_mfma_f32_16x16x32_bf16 v[44:47], a[236:239], v[108:111], v[44:47]
v_fma_f32 v62, v62, s6, -v11
s_waitcnt lgkmcnt(6)
v_mfma_f32_16x16x32_bf16 v[32:35], a[240:243], v[112:115], v[32:35]
ds_read_b64_tr_b16 a[236:237], v3 offset:16384
ds_read_b64_tr_b16 a[238:239], v3 offset:18432
v_mfma_f32_16x16x32_bf16 v[40:43], a[240:243], v[116:119], v[40:43]
v_max3_f32 v13, v13, v60, v61
v_fma_f32 v63, v63, s6, -v11
v_mfma_f32_16x16x32_bf16 v[36:39], a[244:247], v[112:115], v[36:39]
ds_read_b64_tr_b16 a[240:241], v0 offset:24576
ds_read_b64_tr_b16 a[242:243], v0 offset:26624
v_mfma_f32_16x16x32_bf16 v[44:47], a[244:247], v[116:119], v[44:47]
v_max3_f32 v12, v12, v62, v63
v_max_f32 v12, v12, v13
v_mfma_f32_16x16x32_bf16 v[32:35], a[248:251], v[120:123], v[32:35]
ds_read_b64_tr_b16 a[244:245], v1 offset:24576
ds_read_b64_tr_b16 a[246:247], v1 offset:26624
v_mfma_f32_16x16x32_bf16 v[40:43], a[248:251], v[124:127], v[40:43]
v_cmp_lt_f32 vcc, 0x41000000, v12
s_cbranch_vccnz L_stub_0_5
L_back_0_5:
v_mfma_f32_16x16x32_bf16 v[36:39], a[252:255], v[120:123], v[36:39]
ds_read_b64_tr_b16 a[248:249], v2 offset:24576
v_mfma_f32_16x16x32_bf16 v[44:47], a[252:255], v[124:127], v[44:47]
ds_read_b64_tr_b16 a[250:251], v2 offset:26624
L_step_25:
s_waitcnt lgkmcnt(6)
v_mfma_f32_16x16x32_bf16 a[112:115], a[224:227], a[64:67], a[112:115]
ds_read_b64_tr_b16 a[252:253], v3 offset:24576
ds_read_b64_tr_b16 a[254:255], v3 offset:26624
v_mfma_f32_16x16x32_bf16 a[120:123], a[224:227], a[68:71], a[120:123]
s_waitcnt vmcnt(6)
buffer_load_dwordx4 v7, s[12:15], s35 offen offset:3072 nt lds
v_mfma_f32_16x16x32_bf16 a[116:119], a[228:231], a[64:67], a[116:119]
ds_read_b64_tr_b16 a[224:225], v0 offset:20480
ds_read_b64_tr_b16 a[226:227], v0 offset:22528
v_mfma_f32_16x16x32_bf16 a[124:127], a[228:231], a[68:71], a[124:127]
v_exp_f32 v48, v48
v_mfma_f32_16x16x32_bf16 v[208:211], a[232:235], a[64:67], v[208:211]
ds_read_b64_tr_b16 a[228:229], v1 offset:20480
ds_read_b64_tr_b16 a[230:231], v1 offset:22528
v_mfma_f32_16x16x32_bf16 v[216:219], a[232:235], a[68:71], v[216:219]
v_exp_f32 v49, v49
v_mfma_f32_16x16x32_bf16 v[212:215], a[236:239], a[64:67], v[212:215]
ds_read_b64_tr_b16 a[232:233], v2 offset:20480
ds_read_b64_tr_b16 a[234:235], v2 offset:22528
v_mfma_f32_16x16x32_bf16 v[220:223], a[236:239], a[68:71], v[220:223]
v_exp_f32 v50, v50
s_waitcnt lgkmcnt(6)
v_mfma_f32_16x16x32_bf16 v[224:227], a[240:243], a[64:67], v[224:227]
ds_read_b64_tr_b16 a[236:237], v3 offset:20480
ds_read_b64_tr_b16 a[238:239], v3 offset:22528
v_mfma_f32_16x16x32_bf16 v[232:235], a[240:243], a[68:71], v[232:235]
s_add_u32 m0, s4, 131072
s_mov_b32 s35, 196608
v_mfma_f32_16x16x32_bf16 v[228:231], a[244:247], a[64:67], v[228:231]
ds_read_b64_tr_b16 a[240:241], v0 offset:28672
ds_read_b64_tr_b16 a[242:243], v0 offset:30720
v_mfma_f32_16x16x32_bf16 v[236:239], a[244:247], a[68:71], v[236:239]
v_exp_f32 v51, v51
v_cvt_pk_bf16_f32 v168, v48, v49
v_mfma_f32_16x16x32_bf16 v[240:243], a[248:251], a[64:67], v[240:243]
ds_read_b64_tr_b16 a[244:245], v1 offset:28672
ds_read_b64_tr_b16 a[246:247], v1 offset:30720
v_mfma_f32_16x16x32_bf16 v[248:251], a[248:251], a[68:71], v[248:251]
v_exp_f32 v52, v52
v_mfma_f32_16x16x32_bf16 v[244:247], a[252:255], a[64:67], v[244:247]
ds_read_b64_tr_b16 a[248:249], v2 offset:28672
ds_read_b64_tr_b16 a[250:251], v2 offset:30720
v_mfma_f32_16x16x32_bf16 v[252:255], a[252:255], a[68:71], v[252:255]
s_waitcnt vmcnt(3)
s_waitcnt lgkmcnt(6)
v_mfma_f32_16x16x32_bf16 a[112:115], a[224:227], a[72:75], a[112:115]
ds_read_b64_tr_b16 a[252:253], v3 offset:28672
ds_read_b64_tr_b16 a[254:255], v3 offset:30720
v_mfma_f32_16x16x32_bf16 a[120:123], a[224:227], a[76:79], a[120:123]
buffer_load_dwordx4 v6, s[12:15], s35 offen nt lds
s_add_u32 m0, s4, 98304
s_add_u32 s5, s58, 512
v_mfma_f32_16x16x32_bf16 a[116:119], a[228:231], a[72:75], a[116:119]
s_barrier
ds_read_b128 a[224:227], v4 offset:49152
v_mfma_f32_16x16x32_bf16 a[124:127], a[228:231], a[76:79], a[124:127]
v_exp_f32 v53, v53
v_cvt_pk_bf16_f32 v169, v50, v51
v_mfma_f32_16x16x32_bf16 v[208:211], a[232:235], a[72:75], v[208:211]
ds_read_b128 a[228:231], v4 offset:51200
buffer_load_dwordx4 v16, s[20:23], s5 offen lds
v_mfma_f32_16x16x32_bf16 v[216:219], a[232:235], a[76:79], v[216:219]
v_exp_f32 v54, v54
s_add_u32 m0, s4, 131072
v_mfma_f32_16x16x32_bf16 v[212:215], a[236:239], a[72:75], v[212:215]
ds_read_b128 a[232:235], v5 offset:49152
v_exp_f32 v55, v55
v_mfma_f32_16x16x32_bf16 v[220:223], a[236:239], a[76:79], v[220:223]
v_cvt_pk_bf16_f32 v170, v52, v53
s_waitcnt lgkmcnt(3)
v_mfma_f32_16x16x32_bf16 v[224:227], a[240:243], a[72:75], v[224:227]
ds_read_b128 a[236:239], v5 offset:51200
v_exp_f32 v56, v56
v_mfma_f32_16x16x32_bf16 v[232:235], a[240:243], a[76:79], v[232:235]
v_exp_f32 v57, v57
v_cvt_pk_bf16_f32 v171, v54, v55
v_mfma_f32_16x16x32_bf16 v[228:231], a[244:247], a[72:75], v[228:231]
ds_read_b128 a[240:243], v4 offset:53248
v_exp_f32 v58, v58
v_mfma_f32_16x16x32_bf16 v[236:239], a[244:247], a[76:79], v[236:239]
v_exp_f32 v59, v59
v_cvt_pk_bf16_f32 v172, v56, v57
v_mfma_f32_16x16x32_bf16 v[240:243], a[248:251], a[72:75], v[240:243]
ds_read_b128 a[244:247], v4 offset:55296
v_exp_f32 v60, v60
v_mfma_f32_16x16x32_bf16 v[248:251], a[248:251], a[76:79], v[248:251]
v_exp_f32 v61, v61
v_cvt_pk_bf16_f32 v173, v58, v59
v_mfma_f32_16x16x32_bf16 v[244:247], a[252:255], a[72:75], v[244:247]
ds_read_b128 a[248:251], v5 offset:53248
v_exp_f32 v62, v62
v_mfma_f32_16x16x32_bf16 v[252:255], a[252:255], a[76:79], v[252:255]
v_exp_f32 v63, v63
v_cvt_pk_bf16_f32 v174, v60, v61
v_cvt_pk_bf16_f32 v175, v62, v63
L_step_26:
s_waitcnt lgkmcnt(3)
v_mfma_f32_16x16x32_bf16 v[48:51], a[224:227], v[64:67], 0
ds_read_b128 a[252:255], v5 offset:55296
buffer_load_dwordx4 v7, s[12:15], s35 offen offset:1024 nt lds
v_mfma_f32_16x16x32_bf16 v[56:59], a[224:227], v[68:71], 0
s_add_u32 m0, s4, 98304
s_add_u32 s5, s58, 130560
buffer_load_dwordx4 v16, s[20:23], s5 offen offset:1024 lds
v_mfma_f32_16x16x32_bf16 v[52:55], a[228:231], v[64:67], 0
ds_read_b128 a[224:227], v4 offset:57344
s_add_u32 s5, s58, 31232
v_mfma_f32_16x16x32_bf16 v[60:63], a[228:231], v[68:71], 0
buffer_load_dwordx4 v16, s[20:23], s5 offen offset:2048 lds
v_mfma_f32_16x16x32_bf16 v[48:51], a[232:235], v[72:75], v[48:51]
ds_read_b128 a[228:231], v4 offset:59392
s_add_u32 m0, s4, 131072
v_mfma_f32_16x16x32_bf16 v[56:59], a[232:235], v[76:79], v[56:59]
v_fma_f32 v32, v32, s6, -v10
v_fma_f32 v33, v33, s6, -v10
v_mfma_f32_16x16x32_bf16 v[52:55], a[236:239], v[72:75], v[52:55]
ds_read_b128 a[232:235], v5 offset:57344
v_fma_f32 v34, v34, s6, -v10
v_mfma_f32_16x16x32_bf16 v[60:63], a[236:239], v[76:79], v[60:63]
v_fma_f32 v35, v35, s6, -v10
s_waitcnt lgkmcnt(3)
v_mfma_f32_16x16x32_bf16 v[48:51], a[240:243], v[80:83], v[48:51]
ds_read_b128 a[236:239], v5 offset:59392
s_waitcnt vmcnt(6)
v_mfma_f32_16x16x32_bf16 v[56:59], a[240:243], v[84:87], v[56:59]
buffer_load_dwordx4 v6, s[12:15], s35 offen offset:2048 nt lds
v_mfma_f32_16x16x32_bf16 v[52:55], a[244:247], v[80:83], v[52:55]
ds_read_b128 a[240:243], v4 offset:61440
s_add_u32 m0, s4, 98304
v_mfma_f32_16x16x32_bf16 v[60:63], a[244:247], v[84:87], v[60:63]
s_add_u32 s5, s58, 161280
v_max3_f32 v12, v32, v33, v34
v_mfma_f32_16x16x32_bf16 v[48:51], a[248:251], v[88:91], v[48:51]
ds_read_b128 a[244:247], v4 offset:63488
v_mfma_f32_16x16x32_bf16 v[56:59], a[248:251], v[92:95], v[56:59]
buffer_load_dwordx4 v16, s[20:23], s5 offen offset:3072 lds
v_fma_f32 v36, v36, s6, -v10
v_mfma_f32_16x16x32_bf16 v[52:55], a[252:255], v[88:91], v[52:55]
ds_read_b128 a[248:251], v5 offset:61440
s_add_u32 m0, s4, 131072
v_mfma_f32_16x16x32_bf16 v[60:63], a[252:255], v[92:95], v[60:63]
v_fma_f32 v37, v37, s6, -v10
s_waitcnt lgkmcnt(3)
v_mfma_f32_16x16x32_bf16 v[48:51], a[224:227], v[96:99], v[48:51]
ds_read_b128 a[252:255], v5 offset:63488
v_fma_f32 v38, v38, s6, -v10
v_mfma_f32_16x16x32_bf16 v[56:59], a[224:227], v[100:103], v[56:59]
v_max3_f32 v13, v35, v36, v37
v_fma_f32 v39, v39, s6, -v10
v_mfma_f32_16x16x32_bf16 v[52:55], a[228:231], v[96:99], v[52:55]
s_barrier
ds_read_b64_tr_b16 a[224:225], v0 offset:0
v_mfma_f32_16x16x32_bf16 v[60:63], a[228:231], v[100:103], v[60:63]
ds_read_b64_tr_b16 a[226:227], v0 offset:2048
v_fma_f32 v40, v40, s6, -v11
v_mfma_f32_16x16x32_bf16 v[48:51], a[232:235], v[104:107], v[48:51]
ds_read_b64_tr_b16 a[228:229], v1 offset:0
ds_read_b64_tr_b16 a[230:231], v1 offset:2048
v_mfma_f32_16x16x32_bf16 v[56:59], a[232:235], v[108:111], v[56:59]
buffer_load_dwordx4 v7, s[12:15], s35 offen offset:3072 nt lds
v_max3_f32 v12, v12, v38, v39
v_mfma_f32_16x16x32_bf16 v[52:55], a[236:239], v[104:107], v[52:55]
ds_read_b64_tr_b16 a[232:233], v2 offset:0
ds_read_b64_tr_b16 a[234:235], v2 offset:2048
v_mfma_f32_16x16x32_bf16 v[60:63], a[236:239], v[108:111], v[60:63]
v_fma_f32 v41, v41, s6, -v11
v_fma_f32 v42, v42, s6, -v11
s_waitcnt lgkmcnt(6)
v_mfma_f32_16x16x32_bf16 v[48:51], a[240:243], v[112:115], v[48:51]
ds_read_b64_tr_b16 a[236:237], v3 offset:0
ds_read_b64_tr_b16 a[238:239], v3 offset:2048
v_mfma_f32_16x16x32_bf16 v[56:59], a[240:243], v[116:119], v[56:59]
v_max3_f32 v13, v13, v40, v41
v_fma_f32 v43, v43, s6, -v11
v_fma_f32 v44, v44, s6, -v11
v_mfma_f32_16x16x32_bf16 v[52:55], a[244:247], v[112:115], v[52:55]
ds_read_b64_tr_b16 a[240:241], v0 offset:8192
ds_read_b64_tr_b16 a[242:243], v0 offset:10240
v_mfma_f32_16x16x32_bf16 v[60:63], a[244:247], v[116:119], v[60:63]
v_add_u32 v4, 0xfffe8000, v4
v_max3_f32 v12, v12, v42, v43
v_fma_f32 v45, v45, s6, -v11
v_mfma_f32_16x16x32_bf16 v[48:51], a[248:251], v[120:123], v[48:51]
ds_read_b64_tr_b16 a[244:245], v1 offset:8192
ds_read_b64_tr_b16 a[246:247], v1 offset:10240
v_mfma_f32_16x16x32_bf16 v[56:59], a[248:251], v[124:127], v[56:59]
s_add_u32 m0, s4, 114688
s_mov_b32 s35, 212992
v_fma_f32 v46, v46, s6, -v11
v_mfma_f32_16x16x32_bf16 v[52:55], a[252:255], v[120:123], v[52:55]
ds_read_b64_tr_b16 a[248:249], v2 offset:8192
ds_read_b64_tr_b16 a[250:251], v2 offset:10240
v_mfma_f32_16x16x32_bf16 v[60:63], a[252:255], v[124:127], v[60:63]
v_add_u32 v5, 0xfffe8000, v5
v_max3_f32 v13, v13, v44, v45
L_step_27:
s_waitcnt lgkmcnt(6)
v_mfma_f32_16x16x32_bf16 a[112:115], a[224:227], a[80:83], a[112:115]
ds_read_b64_tr_b16 a[252:253], v3 offset:8192
ds_read_b64_tr_b16 a[254:255], v3 offset:10240
v_mfma_f32_16x16x32_bf16 a[120:123], a[224:227], a[84:87], a[120:123]
v_fma_f32 v47, v47, s6, -v11
v_max3_f32 v12, v12, v46, v47
v_max_f32 v12, v12, v13
v_mfma_f32_16x16x32_bf16 a[116:119], a[228:231], a[80:83], a[116:119]
ds_read_b64_tr_b16 a[224:225], v0 offset:4096
ds_read_b64_tr_b16 a[226:227], v0 offset:6144
v_mfma_f32_16x16x32_bf16 a[124:127], a[228:231], a[84:87], a[124:127]
s_waitcnt vmcnt(7)
buffer_load_dwordx4 v6, s[12:15], s35 offen nt lds
v_mfma_f32_16x16x32_bf16 v[208:211], a[232:235], a[80:83], v[208:211]
ds_read_b64_tr_b16 a[228:229], v1 offset:4096
ds_read_b64_tr_b16 a[230:231], v1 offset:6144
v_mfma_f32_16x16x32_bf16 v[216:219], a[232:235], a[84:87], v[216:219]
v_cmp_lt_f32 vcc, 0x41000000, v12
s_cbranch_vccnz L_stub_0_6
L_back_0_6:
v_mfma_f32_16x16x32_bf16 v[212:215], a[236:239], a[80:83], v[212:215]
ds_read_b64_tr_b16 a[232:233], v2 offset:4096
ds_read_b64_tr_b16 a[234:235], v2 offset:6144
v_mfma_f32_16x16x32_bf16 v[220:223], a[236:239], a[84:87], v[220:223]
v_exp_f32 v32, v32
s_waitcnt lgkmcnt(6)
v_mfma_f32_16x16x32_bf16 v[224:227], a[240:243], a[80:83], v[224:227]
ds_read_b64_tr_b16 a[236:237], v3 offset:4096
ds_read_b64_tr_b16 a[238:239], v3 offset:6144
v_mfma_f32_16x16x32_bf16 v[232:235], a[240:243], a[84:87], v[232:235]
v_exp_f32 v33, v33
v_mfma_f32_16x16x32_bf16 v[228:231], a[244:247], a[80:83], v[228:231]
ds_read_b64_tr_b16 a[240:241], v0 offset:12288
ds_read_b64_tr_b16 a[242:243], v0 offset:14336
v_mfma_f32_16x16x32_bf16 v[236:239], a[244:247], a[84:87], v[236:239]
v_exp_f32 v34, v34
v_mfma_f32_16x16x32_bf16 v[240:243], a[248:251], a[80:83], v[240:243]
ds_read_b64_tr_b16 a[244:245], v1 offset:12288
ds_read_b64_tr_b16 a[246:247], v1 offset:14336
v_mfma_f32_16x16x32_bf16 v[248:251], a[248:251], a[84:87], v[248:251]
v_exp_f32 v35, v35
v_cvt_pk_bf16_f32 v176, v32, v33
v_mfma_f32_16x16x32_bf16 v[244:247], a[252:255], a[80:83], v[244:247]
ds_read_b64_tr_b16 a[248:249], v2 offset:12288
ds_read_b64_tr_b16 a[250:251], v2 offset:14336
v_mfma_f32_16x16x32_bf16 v[252:255], a[252:255], a[84:87], v[252:255]
v_exp_f32 v36, v36
s_waitcnt lgkmcnt(6)
v_mfma_f32_16x16x32_bf16 a[112:115], a[224:227], a[88:91], a[112:115]
ds_read_b64_tr_b16 a[252:253], v3 offset:12288
ds_read_b64_tr_b16 a[254:255], v3 offset:14336
v_mfma_f32_16x16x32_bf16 a[120:123], a[224:227], a[92:95], a[120:123]
buffer_load_dwordx4 v7, s[12:15], s35 offen offset:1024 nt lds
s_add_u32 m0, s4, 81920
s_add_u32 s5, s52, 768
v_mfma_f32_16x16x32_bf16 a[116:119], a[228:231], a[88:91], a[116:119]
s_barrier
ds_read_b128 a[224:227], v4 offset:32768
v_mfma_f32_16x16x32_bf16 a[124:127], a[228:231], a[92:95], a[124:127]
v_exp_f32 v37, v37
v_cvt_pk_bf16_f32 v177, v34, v35
v_mfma_f32_16x16x32_bf16 v[208:211], a[232:235], a[88:91], v[208:211]
ds_read_b128 a[228:231], v4 offset:34816
buffer_load_dwordx4 v16, s[20:23], s5 offen lds
v_mfma_f32_16x16x32_bf16 v[216:219], a[232:235], a[92:95], v[216:219]
v_exp_f32 v38, v38
s_add_u32 s5, s52, 130816
v_mfma_f32_16x16x32_bf16 v[212:215], a[236:239], a[88:91], v[212:215]
ds_read_b128 a[232:235], v5 offset:32768
v_exp_f32 v39, v39
v_mfma_f32_16x16x32_bf16 v[220:223], a[236:239], a[92:95], v[220:223]
v_cvt_pk_bf16_f32 v178, v36, v37
s_waitcnt lgkmcnt(3)
v_mfma_f32_16x16x32_bf16 v[224:227], a[240:243], a[88:91], v[224:227]
ds_read_b128 a[236:239], v5 offset:34816
v_exp_f32 v40, v40
v_mfma_f32_16x16x32_bf16 v[232:235], a[240:243], a[92:95], v[232:235]
v_exp_f32 v41, v41
v_cvt_pk_bf16_f32 v179, v38, v39
v_mfma_f32_16x16x32_bf16 v[228:231], a[244:247], a[88:91], v[228:231]
ds_read_b128 a[240:243], v4 offset:36864
v_exp_f32 v42, v42
v_mfma_f32_16x16x32_bf16 v[236:239], a[244:247], a[92:95], v[236:239]
v_exp_f32 v43, v43
v_cvt_pk_bf16_f32 v180, v40, v41
v_mfma_f32_16x16x32_bf16 v[240:243], a[248:251], a[88:91], v[240:243]
ds_read_b128 a[244:247], v4 offset:38912
v_exp_f32 v44, v44
v_mfma_f32_16x16x32_bf16 v[248:251], a[248:251], a[92:95], v[248:251]
v_exp_f32 v45, v45
v_cvt_pk_bf16_f32 v181, v42, v43
L_pg6:
s_cbranch_scc1 L_pg10
v_mfma_f32_16x16x32_bf16 v[244:247], a[252:255], a[88:91], v[244:247]
ds_read_b128 a[248:251], v5 offset:36864
v_exp_f32 v46, v46
v_mfma_f32_16x16x32_bf16 v[252:255], a[252:255], a[92:95], v[252:255]
v_exp_f32 v47, v47
v_cvt_pk_bf16_f32 v182, v44, v45
v_cvt_pk_bf16_f32 v183, v46, v47
L_step_28:
s_waitcnt lgkmcnt(3)
v_mfma_f32_16x16x32_bf16 v[32:35], a[224:227], v[64:67], 0
ds_read_b128 a[252:255], v5 offset:38912
v_mfma_f32_16x16x32_bf16 v[40:43], a[224:227], v[68:71], 0
buffer_load_dwordx4 v16, s[20:23], s5 offen offset:1024 lds
s_add_u32 m0, s4, 114688
v_mfma_f32_16x16x32_bf16 v[36:39], a[228:231], v[64:67], 0
ds_read_b128 a[224:227], v4 offset:40960
s_waitcnt vmcnt(6)
v_mfma_f32_16x16x32_bf16 v[44:47], a[228:231], v[68:71], 0
buffer_load_dwordx4 v6, s[12:15], s35 offen offset:2048 nt lds
v_mfma_f32_16x16x32_bf16 v[32:35], a[232:235], v[72:75], v[32:35]
ds_read_b128 a[228:231], v4 offset:43008
s_add_u32 m0, s4, 81920
v_mfma_f32_16x16x32_bf16 v[40:43], a[232:235], v[76:79], v[40:43]
s_add_u32 s5, s52, 31488
v_fma_f32 v48, v48, s6, -v10
v_mfma_f32_16x16x32_bf16 v[36:39], a[236:239], v[72:75], v[36:39]
ds_read_b128 a[232:235], v5 offset:40960
v_mfma_f32_16x16x32_bf16 v[44:47], a[236:239], v[76:79], v[44:47]
buffer_load_dwordx4 v16, s[20:23], s5 offen offset:2048 lds
s_waitcnt lgkmcnt(3)
v_mfma_f32_16x16x32_bf16 v[32:35], a[240:243], v[80:83], v[32:35]
ds_read_b128 a[236:239], v5 offset:43008
s_add_u32 s5, s52, 161536
v_mfma_f32_16x16x32_bf16 v[40:43], a[240:243], v[84:87], v[40:43]
buffer_load_dwordx4 v16, s[20:23], s5 offen offset:3072 lds
v_mfma_f32_16x16x32_bf16 v[36:39], a[244:247], v[80:83], v[36:39]
ds_read_b128 a[240:243], v4 offset:45056
s_add_u32 m0, s4, 114688
v_mfma_f32_16x16x32_bf16 v[44:47], a[244:247], v[84:87], v[44:47]
buffer_load_dwordx4 v7, s[12:15], s35 offen offset:3072 nt lds
v_mfma_f32_16x16x32_bf16 v[32:35], a[248:251], v[88:91], v[32:35]
ds_read_b128 a[244:247], v4 offset:47104
v_fma_f32 v49, v49, s6, -v10
v_mfma_f32_16x16x32_bf16 v[40:43], a[248:251], v[92:95], v[40:43]
v_fma_f32 v50, v50, s6, -v10
v_fma_f32 v51, v51, s6, -v10
v_mfma_f32_16x16x32_bf16 v[36:39], a[252:255], v[88:91], v[36:39]
ds_read_b128 a[248:251], v5 offset:45056
v_max3_f32 v12, v48, v49, v50
v_mfma_f32_16x16x32_bf16 v[44:47], a[252:255], v[92:95], v[44:47]
v_fma_f32 v52, v52, s6, -v10
s_waitcnt lgkmcnt(3)
v_mfma_f32_16x16x32_bf16 v[32:35], a[224:227], v[96:99], v[32:35]
ds_read_b128 a[252:255], v5 offset:47104
s_add_u32 m0, s4, 65536
v_mfma_f32_16x16x32_bf16 v[40:43], a[224:227], v[100:103], v[40:43]
s_mov_b32 s35, 229376
v_fma_f32 v53, v53, s6, -v10
v_fma_f32 v54, v54, s6, -v10
v_mfma_f32_16x16x32_bf16 v[36:39], a[228:231], v[96:99], v[36:39]
s_waitcnt vmcnt(9)
s_barrier
v_mfma_f32_16x16x32_bf16 v[44:47], a[228:231], v[100:103], v[44:47]
ds_read_b64_tr_b16 a[224:225], v2 offset:32768
ds_read_b64_tr_b16 a[226:227], v2 offset:34816
v_max3_f32 v13, v51, v52, v53
v_mfma_f32_16x16x32_bf16 v[32:35], a[232:235], v[104:107], v[32:35]
ds_read_b64_tr_b16 a[228:229], v3 offset:32768
ds_read_b64_tr_b16 a[230:231], v3 offset:34816
v_mfma_f32_16x16x32_bf16 v[40:43], a[232:235], v[108:111], v[40:43]
v_fma_f32 v55, v55, s6, -v10
v_fma_f32 v56, v56, s6, -v11
v_max3_f32 v12, v12, v54, v55
v_mfma_f32_16x16x32_bf16 v[36:39], a[236:239], v[104:107], v[36:39]
ds_read_b64_tr_b16 a[232:233], v2 offset:36864
ds_read_b64_tr_b16 a[234:235], v2 offset:38912
v_mfma_f32_16x16x32_bf16 v[44:47], a[236:239], v[108:111], v[44:47]
s_waitcnt vmcnt(7)
v_fma_f32 v57, v57, s6, -v11
s_waitcnt lgkmcnt(6)
v_mfma_f32_16x16x32_bf16 v[32:35], a[240:243], v[112:115], v[32:35]
ds_read_b64_tr_b16 a[236:237], v3 offset:36864
ds_read_b64_tr_b16 a[238:239], v3 offset:38912
v_mfma_f32_16x16x32_bf16 v[40:43], a[240:243], v[116:119], v[40:43]
buffer_load_dwordx4 v6, s[12:15], s35 offen nt lds
v_fma_f32 v58, v58, s6, -v11
v_mfma_f32_16x16x32_bf16 v[36:39], a[244:247], v[112:115], v[36:39]
ds_read_b64_tr_b16 a[240:241], v0 offset:40960
ds_read_b64_tr_b16 a[242:243], v0 offset:43008
v_mfma_f32_16x16x32_bf16 v[44:47], a[244:247], v[116:119], v[44:47]
v_max3_f32 v13, v13, v56, v57
v_fma_f32 v59, v59, s6, -v11
v_fma_f32 v60, v60, s6, -v11
v_mfma_f32_16x16x32_bf16 v[32:35], a[248:251], v[120:123], v[32:35]
ds_read_b64_tr_b16 a[244:245], v1 offset:40960
ds_read_b64_tr_b16 a[246:247], v1 offset:43008
v_mfma_f32_16x16x32_bf16 v[40:43], a[248:251], v[124:127], v[40:43]
v_max3_f32 v12, v12, v58, v59
v_fma_f32 v61, v61, s6, -v11
v_fma_f32 v62, v62, s6, -v11
v_mfma_f32_16x16x32_bf16 v[36:39], a[252:255], v[120:123], v[36:39]
ds_read_b64_tr_b16 a[248:249], v0 offset:45056
ds_read_b64_tr_b16 a[250:251], v0 offset:47104
v_mfma_f32_16x16x32_bf16 v[44:47], a[252:255], v[124:127], v[44:47]
v_max3_f32 v13, v13, v60, v61
v_fma_f32 v63, v63, s6, -v11
L_step_29:
s_waitcnt lgkmcnt(6)
v_mfma_f32_16x16x32_bf16 v[208:211], a[224:227], a[96:99], v[208:211]
ds_read_b64_tr_b16 a[252:253], v1 offset:45056
ds_read_b64_tr_b16 a[254:255], v1 offset:47104
v_mfma_f32_16x16x32_bf16 v[216:219], a[224:227], a[100:103], v[216:219]
v_max3_f32 v12, v12, v62, v63
v_max_f32 v12, v12, v13
v_cmp_lt_f32 vcc, 0x41000000, v12
v_mfma_f32_16x16x32_bf16 v[212:215], a[228:231], a[96:99], v[212:215]
ds_read_b64_tr_b16 a[224:225], v2 offset:40960
ds_read_b64_tr_b16 a[226:227], v2 offset:43008
v_mfma_f32_16x16x32_bf16 v[220:223], a[228:231], a[100:103], v[220:223]
s_cbranch_vccnz L_stub_0_7
L_back_0_7:
v_exp_f32 v48, v48
v_mfma_f32_16x16x32_bf16 v[208:211], a[232:235], a[104:107], v[208:211]
ds_read_b64_tr_b16 a[228:229], v3 offset:40960
ds_read_b64_tr_b16 a[230:231], v3 offset:43008
v_mfma_f32_16x16x32_bf16 v[216:219], a[232:235], a[108:111], v[216:219]
buffer_load_dwordx4 v7, s[12:15], s35 offen offset:1024 nt lds
v_mfma_f32_16x16x32_bf16 v[212:215], a[236:239], a[104:107], v[212:215]
ds_read_b64_tr_b16 a[232:233], v2 offset:45056
ds_read_b64_tr_b16 a[234:235], v2 offset:47104
v_mfma_f32_16x16x32_bf16 v[220:223], a[236:239], a[108:111], v[220:223]
v_exp_f32 v49, v49
s_waitcnt lgkmcnt(6)
v_mfma_f32_16x16x32_bf16 v[224:227], a[240:243], a[96:99], v[224:227]
ds_read_b64_tr_b16 a[236:237], v3 offset:45056
ds_read_b64_tr_b16 a[238:239], v3 offset:47104
v_mfma_f32_16x16x32_bf16 v[232:235], a[240:243], a[100:103], v[232:235]
v_exp_f32 v50, v50
v_mfma_f32_16x16x32_bf16 v[228:231], a[244:247], a[96:99], v[228:231]
ds_read_b64_tr_b16 a[240:241], v0 offset:32768
ds_read_b64_tr_b16 a[242:243], v0 offset:34816
v_mfma_f32_16x16x32_bf16 v[236:239], a[244:247], a[100:103], v[236:239]
v_exp_f32 v51, v51
v_cvt_pk_bf16_f32 v184, v48, v49
v_mfma_f32_16x16x32_bf16 v[224:227], a[248:251], a[104:107], v[224:227]
ds_read_b64_tr_b16 a[244:245], v1 offset:32768
ds_read_b64_tr_b16 a[246:247], v1 offset:34816
v_mfma_f32_16x16x32_bf16 v[232:235], a[248:251], a[108:111], v[232:235]
v_exp_f32 v52, v52
v_cvt_pk_bf16_f32 v208, v208, v209
v_mfma_f32_16x16x32_bf16 v[228:231], a[252:255], a[104:107], v[228:231]
ds_read_b64_tr_b16 a[248:249], v0 offset:36864
ds_read_b64_tr_b16 a[250:251], v0 offset:38912
v_mfma_f32_16x16x32_bf16 v[236:239], a[252:255], a[108:111], v[236:239]
v_exp_f32 v53, v53
s_waitcnt lgkmcnt(6)
v_mfma_f32_16x16x32_bf16 v[240:243], a[224:227], a[96:99], v[240:243]
ds_read_b64_tr_b16 a[252:253], v1 offset:36864
ds_read_b64_tr_b16 a[254:255], v1 offset:38912
v_mfma_f32_16x16x32_bf16 v[248:251], a[224:227], a[100:103], v[248:251]
v_cvt_pk_bf16_f32 v185, v50, v51
v_exp_f32 v54, v54
v_mfma_f32_16x16x32_bf16 v[244:247], a[228:231], a[96:99], v[244:247]
s_barrier
ds_read_b128 a[224:227], v4 offset:0
v_mfma_f32_16x16x32_bf16 v[252:255], a[228:231], a[100:103], v[252:255]
s_waitcnt vmcnt(5)
buffer_load_dwordx4 v6, s[12:15], s35 offen offset:2048 nt lds
v_mfma_f32_16x16x32_bf16 v[240:243], a[232:235], a[104:107], v[240:243]
ds_read_b128 a[228:231], v4 offset:2048
s_sub_u32 s5, s0, 229376
v_mfma_f32_16x16x32_bf16 v[248:251], a[232:235], a[108:111], v[248:251]
buffer_load_dword v20, v29, s[24:27], s5 offen
v_exp_f32 v55, v55
v_mfma_f32_16x16x32_bf16 v[244:247], a[236:239], a[104:107], v[244:247]
ds_read_b128 a[232:235], v5 offset:0
v_cvt_pk_bf16_f32 v186, v52, v53
v_mfma_f32_16x16x32_bf16 v[252:255], a[236:239], a[108:111], v[252:255]
v_exp_f32 v56, v56
v_cvt_pk_bf16_f32 v209, v210, v211
s_waitcnt lgkmcnt(3)
v_mfma_f32_16x16x32_bf16 a[112:115], a[240:243], a[96:99], a[112:115]
ds_read_b128 a[236:239], v5 offset:2048
v_exp_f32 v57, v57
v_mfma_f32_16x16x32_bf16 a[120:123], a[240:243], a[100:103], a[120:123]
v_cvt_pk_bf16_f32 v187, v54, v55
v_exp_f32 v58, v58
v_mfma_f32_16x16x32_bf16 a[116:119], a[244:247], a[96:99], a[116:119]
ds_read_b128 a[240:243], v4 offset:4096
v_exp_f32 v59, v59
v_mfma_f32_16x16x32_bf16 a[124:127], a[244:247], a[100:103], a[124:127]
v_cvt_pk_bf16_f32 v188, v56, v57
v_exp_f32 v60, v60
v_mfma_f32_16x16x32_bf16 a[112:115], a[248:251], a[104:107], a[112:115]
ds_read_b128 a[244:247], v4 offset:6144
v_exp_f32 v61, v61
v_mfma_f32_16x16x32_bf16 a[120:123], a[248:251], a[108:111], a[120:123]
v_cvt_pk_bf16_f32 v189, v58, v59
v_exp_f32 v62, v62
v_mfma_f32_16x16x32_bf16 a[116:119], a[252:255], a[104:107], a[116:119]
ds_read_b128 a[248:251], v5 offset:4096
v_exp_f32 v63, v63
v_mfma_f32_16x16x32_bf16 a[124:127], a[252:255], a[108:111], a[124:127]
v_cvt_pk_bf16_f32 v190, v60, v61
v_cvt_pk_bf16_f32 v191, v62, v63
L_step_30:
s_waitcnt lgkmcnt(3)
v_mfma_f32_16x16x32_bf16 v[48:51], a[224:227], v[64:67], 0
ds_read_b128 a[252:255], v5 offset:6144
buffer_load_dwordx4 v7, s[12:15], s35 offen offset:3072 nt lds
v_mfma_f32_16x16x32_bf16 v[56:59], a[224:227], v[68:71], 0
v_fma_f32 v32, v32, s6, -v10
v_fma_f32 v33, v33, s6, -v10
v_fma_f32 v34, v34, s6, -v10
v_mfma_f32_16x16x32_bf16 v[52:55], a[228:231], v[64:67], 0
ds_read_b128 a[224:227], v4 offset:8192
v_fma_f32 v35, v35, s6, -v10
v_max3_f32 v12, v32, v33, v34
v_mfma_f32_16x16x32_bf16 v[60:63], a[228:231], v[68:71], 0
v_fma_f32 v36, v36, s6, -v10
v_fma_f32 v37, v37, s6, -v10
v_fma_f32 v38, v38, s6, -v10
v_mfma_f32_16x16x32_bf16 v[48:51], a[232:235], v[72:75], v[48:51]
ds_read_b128 a[228:231], v4 offset:10240
s_add_u32 m0, s4, 147456
s_mov_b32 s35, 245760
v_mfma_f32_16x16x32_bf16 v[56:59], a[232:235], v[76:79], v[56:59]
v_max3_f32 v13, v35, v36, v37
v_fma_f32 v39, v39, s6, -v10
v_fma_f32 v40, v40, s6, -v11
v_mfma_f32_16x16x32_bf16 v[52:55], a[236:239], v[72:75], v[52:55]
ds_read_b128 a[232:235], v5 offset:8192
v_max3_f32 v12, v12, v38, v39
v_fma_f32 v41, v41, s6, -v11
v_mfma_f32_16x16x32_bf16 v[60:63], a[236:239], v[76:79], v[60:63]
v_fma_f32 v42, v42, s6, -v11
v_max3_f32 v13, v13, v40, v41
s_waitcnt lgkmcnt(3)
v_mfma_f32_16x16x32_bf16 v[48:51], a[240:243], v[80:83], v[48:51]
ds_read_b128 a[236:239], v5 offset:10240
v_fma_f32 v43, v43, s6, -v11
v_fma_f32 v44, v44, s6, -v11
v_mfma_f32_16x16x32_bf16 v[56:59], a[240:243], v[84:87], v[56:59]
v_max3_f32 v12, v12, v42, v43
v_fma_f32 v45, v45, s6, -v11
v_fma_f32 v46, v46, s6, -v11
v_mfma_f32_16x16x32_bf16 v[52:55], a[244:247], v[80:83], v[52:55]
ds_read_b128 a[240:243], v4 offset:12288
s_waitcnt vmcnt(4)
v_mfma_f32_16x16x32_bf16 v[60:63], a[244:247], v[84:87], v[60:63]
buffer_load_dwordx4 v6, s[12:15], s35 offen nt lds
v_max3_f32 v13, v13, v44, v45
v_fma_f32 v47, v47, s6, -v11
v_mfma_f32_16x16x32_bf16 v[48:51], a[248:251], v[88:91], v[48:51]
ds_read_b128 a[244:247], v4 offset:14336
v_max3_f32 v12, v12, v46, v47
v_max_f32 v12, v12, v13
v_mfma_f32_16x16x32_bf16 v[56:59], a[248:251], v[92:95], v[56:59]
v_cmp_lt_f32 vcc, 0x41000000, v12
s_cbranch_vccnz L_stub_0_8
L_back_0_8:
v_cvt_pk_bf16_f32 v210, v212, v213
v_mfma_f32_16x16x32_bf16 v[52:55], a[252:255], v[88:91], v[52:55]
ds_read_b128 a[248:251], v5 offset:12288
s_add_u32 m0, s4, 98304
s_add_u32 s5, s53, 768
v_mfma_f32_16x16x32_bf16 v[60:63], a[252:255], v[92:95], v[60:63]
v_exp_f32 v32, v32
s_waitcnt lgkmcnt(3)
v_mfma_f32_16x16x32_bf16 v[48:51], a[224:227], v[96:99], v[48:51]
ds_read_b128 a[252:255], v5 offset:14336
v_exp_f32 v33, v33
v_mfma_f32_16x16x32_bf16 v[56:59], a[224:227], v[100:103], v[56:59]
v_exp_f32 v34, v34
v_cvt_pk_bf16_f32 v211, v214, v215
v_mfma_f32_16x16x32_bf16 v[52:55], a[228:231], v[96:99], v[52:55]
s_barrier
ds_read_b128 a[224:227], v4 offset:16384
v_mfma_f32_16x16x32_bf16 v[60:63], a[228:231], v[100:103], v[60:63]
v_exp_f32 v35, v35
v_cvt_pk_bf16_f32 v192, v32, v33
v_cvt_pk_bf16_f32 v212, v216, v217
v_mfma_f32_16x16x32_bf16 v[48:51], a[232:235], v[104:107], v[48:51]
ds_read_b128 a[228:231], v4 offset:18432
buffer_load_dwordx4 v16, s[20:23], s5 offen lds
v_mfma_f32_16x16x32_bf16 v[56:59], a[232:235], v[108:111], v[56:59]
s_add_u32 m0, s4, 147456
v_exp_f32 v36, v36
v_cvt_pk_bf16_f32 v213, v218, v219
v_mfma_f32_16x16x32_bf16 v[52:55], a[236:239], v[104:107], v[52:55]
ds_read_b128 a[232:235], v5 offset:16384
v_exp_f32 v37, v37
v_mfma_f32_16x16x32_bf16 v[60:63], a[236:239], v[108:111], v[60:63]
v_cvt_pk_bf16_f32 v193, v34, v35
v_exp_f32 v38, v38
s_waitcnt lgkmcnt(3)
v_mfma_f32_16x16x32_bf16 v[48:51], a[240:243], v[112:115], v[48:51]
ds_read_b128 a[236:239], v5 offset:18432
buffer_load_dwordx4 v7, s[12:15], s35 offen offset:1024 nt lds
v_mfma_f32_16x16x32_bf16 v[56:59], a[240:243], v[116:119], v[56:59]
v_exp_f32 v39, v39
v_cvt_pk_bf16_f32 v194, v36, v37
v_exp_f32 v40, v40
v_mfma_f32_16x16x32_bf16 v[52:55], a[244:247], v[112:115], v[52:55]
ds_read_b128 a[240:243], v4 offset:20480
v_exp_f32 v41, v41
v_cvt_pk_bf16_f32 v195, v38, v39
v_mfma_f32_16x16x32_bf16 v[60:63], a[244:247], v[116:119], v[60:63]
v_exp_f32 v42, v42
v_exp_f32 v43, v43
v_mfma_f32_16x16x32_bf16 v[48:51], a[248:251], v[120:123], v[48:51]
ds_read_b128 a[244:247], v4 offset:22528
v_cvt_pk_bf16_f32 v196, v40, v41
v_exp_f32 v44, v44
v_mfma_f32_16x16x32_bf16 v[56:59], a[248:251], v[124:127], v[56:59]
v_exp_f32 v45, v45
v_cvt_pk_bf16_f32 v197, v42, v43
v_mfma_f32_16x16x32_bf16 v[52:55], a[252:255], v[120:123], v[52:55]
ds_read_b128 a[248:251], v5 offset:20480
v_exp_f32 v46, v46
v_mfma_f32_16x16x32_bf16 v[60:63], a[252:255], v[124:127], v[60:63]
v_exp_f32 v47, v47
v_cvt_pk_bf16_f32 v198, v44, v45
v_cvt_pk_bf16_f32 v199, v46, v47
L_step_31:
s_waitcnt lgkmcnt(3)
v_mfma_f32_16x16x32_bf16 v[32:35], a[224:227], v[64:67], 0
ds_read_b128 a[252:255], v5 offset:22528
s_add_u32 m0, s4, 98304
v_mfma_f32_16x16x32_bf16 v[40:43], a[224:227], v[68:71], 0
s_add_u32 s5, s53, 130816
buffer_load_dwordx4 v16, s[20:23], s5 offen offset:1024 lds
v_mfma_f32_16x16x32_bf16 v[36:39], a[228:231], v[64:67], 0
ds_read_b128 a[224:227], v4 offset:24576
s_add_u32 s5, s53, 31488
v_mfma_f32_16x16x32_bf16 v[44:47], a[228:231], v[68:71], 0
buffer_load_dwordx4 v16, s[20:23], s5 offen offset:2048 lds
s_add_u32 m0, s4, 147456
v_mfma_f32_16x16x32_bf16 v[32:35], a[232:235], v[72:75], v[32:35]
ds_read_b128 a[228:231], v4 offset:26624
s_waitcnt vmcnt(7)
v_mfma_f32_16x16x32_bf16 v[40:43], a[232:235], v[76:79], v[40:43]
buffer_load_dwordx4 v6, s[12:15], s35 offen offset:2048 nt lds
s_add_u32 m0, s4, 98304
s_add_u32 s5, s53, 161536
v_mfma_f32_16x16x32_bf16 v[36:39], a[236:239], v[72:75], v[36:39]
ds_read_b128 a[232:235], v5 offset:24576
v_cvt_pk_bf16_f32 v214, v220, v221
v_cvt_pk_bf16_f32 v215, v222, v223
v_mfma_f32_16x16x32_bf16 v[44:47], a[236:239], v[76:79], v[44:47]
v_accvgpr_write_b32 a200, v208
v_accvgpr_write_b32 a201, v209
s_waitcnt lgkmcnt(3)
v_mfma_f32_16x16x32_bf16 v[32:35], a[240:243], v[80:83], v[32:35]
ds_read_b128 a[236:239], v5 offset:26624
buffer_load_dwordx4 v16, s[20:23], s5 offen offset:3072 lds
v_mfma_f32_16x16x32_bf16 v[40:43], a[240:243], v[84:87], v[40:43]
v_accvgpr_write_b32 a202, v210
v_accvgpr_write_b32 a203, v211
v_accvgpr_write_b32 a204, v212
v_mfma_f32_16x16x32_bf16 v[36:39], a[244:247], v[80:83], v[36:39]
ds_read_b128 a[240:243], v4 offset:28672
s_add_u32 m0, s4, 147456
v_accvgpr_write_b32 a205, v213
v_mfma_f32_16x16x32_bf16 v[44:47], a[244:247], v[84:87], v[44:47]
v_accvgpr_write_b32 a206, v214
v_accvgpr_write_b32 a207, v215
v_cvt_pk_bf16_f32 v224, v224, v225
v_mfma_f32_16x16x32_bf16 v[32:35], a[248:251], v[88:91], v[32:35]
ds_read_b128 a[244:247], v4 offset:30720
v_cvt_pk_bf16_f32 v225, v226, v227
v_cvt_pk_bf16_f32 v226, v228, v229
v_mfma_f32_16x16x32_bf16 v[40:43], a[248:251], v[92:95], v[40:43]
v_cvt_pk_bf16_f32 v227, v230, v231
v_cvt_pk_bf16_f32 v228, v232, v233
v_cvt_pk_bf16_f32 v229, v234, v235
v_mfma_f32_16x16x32_bf16 v[36:39], a[252:255], v[88:91], v[36:39]
ds_read_b128 a[248:251], v5 offset:28672
v_cvt_pk_bf16_f32 v230, v236, v237
v_cvt_pk_bf16_f32 v231, v238, v239
v_mfma_f32_16x16x32_bf16 v[44:47], a[252:255], v[92:95], v[44:47]
v_accvgpr_write_b32 a208, v224
v_accvgpr_write_b32 a209, v225
s_waitcnt lgkmcnt(3)
v_mfma_f32_16x16x32_bf16 v[32:35], a[224:227], v[96:99], v[32:35]
ds_read_b128 a[252:255], v5 offset:30720
buffer_load_dwordx4 v7, s[12:15], s35 offen offset:3072 nt lds
v_mfma_f32_16x16x32_bf16 v[40:43], a[224:227], v[100:103], v[40:43]
v_accvgpr_write_b32 a210, v226
v_accvgpr_write_b32 a211, v227
v_accvgpr_write_b32 a212, v228
v_mfma_f32_16x16x32_bf16 v[36:39], a[228:231], v[96:99], v[36:39]
s_barrier
ds_read_b64_tr_b16 a[224:225], v0 offset:16384
ds_read_b64_tr_b16 a[226:227], v0 offset:18432
v_mfma_f32_16x16x32_bf16 v[44:47], a[228:231], v[100:103], v[44:47]
v_accvgpr_write_b32 a213, v229
v_accvgpr_write_b32 a214, v230
v_accvgpr_write_b32 a215, v231
v_mfma_f32_16x16x32_bf16 v[32:35], a[232:235], v[104:107], v[32:35]
ds_read_b64_tr_b16 a[228:229], v1 offset:16384
ds_read_b64_tr_b16 a[230:231], v1 offset:18432
v_cvt_pk_bf16_f32 v240, v240, v241
v_mfma_f32_16x16x32_bf16 v[40:43], a[232:235], v[108:111], v[40:43]
v_cvt_pk_bf16_f32 v241, v242, v243
v_cvt_pk_bf16_f32 v242, v244, v245
v_cvt_pk_bf16_f32 v243, v246, v247
v_mfma_f32_16x16x32_bf16 v[36:39], a[236:239], v[104:107], v[36:39]
ds_read_b64_tr_b16 a[232:233], v2 offset:16384
ds_read_b64_tr_b16 a[234:235], v2 offset:18432
v_cvt_pk_bf16_f32 v244, v248, v249
v_mfma_f32_16x16x32_bf16 v[44:47], a[236:239], v[108:111], v[44:47]
v_cvt_pk_bf16_f32 v245, v250, v251
v_cvt_pk_bf16_f32 v246, v252, v253
s_waitcnt lgkmcnt(6)
v_mfma_f32_16x16x32_bf16 v[32:35], a[240:243], v[112:115], v[32:35]
ds_read_b64_tr_b16 a[236:237], v3 offset:16384
ds_read_b64_tr_b16 a[238:239], v3 offset:18432
v_cvt_pk_bf16_f32 v247, v254, v255
v_mfma_f32_16x16x32_bf16 v[40:43], a[240:243], v[116:119], v[40:43]
v_accvgpr_write_b32 a216, v240
v_accvgpr_write_b32 a217, v241
v_accvgpr_write_b32 a218, v242
v_mfma_f32_16x16x32_bf16 v[36:39], a[244:247], v[112:115], v[36:39]
ds_read_b64_tr_b16 a[240:241], v0 offset:24576
ds_read_b64_tr_b16 a[242:243], v0 offset:26624
v_accvgpr_write_b32 a219, v243
v_mfma_f32_16x16x32_bf16 v[44:47], a[244:247], v[116:119], v[44:47]
v_accvgpr_write_b32 a220, v244
v_accvgpr_write_b32 a221, v245
v_accvgpr_write_b32 a222, v246
v_mfma_f32_16x16x32_bf16 v[32:35], a[248:251], v[120:123], v[32:35]
ds_read_b64_tr_b16 a[244:245], v1 offset:24576
ds_read_b64_tr_b16 a[246:247], v1 offset:26624
v_accvgpr_write_b32 a223, v247
v_mfma_f32_16x16x32_bf16 v[40:43], a[248:251], v[124:127], v[40:43]
s_add_u32 m0, s4, 32768
s_mov_b32 s35, 0
v_fma_f32 v48, v48, s6, -v10
v_mfma_f32_16x16x32_bf16 v[36:39], a[252:255], v[120:123], v[36:39]
ds_read_b64_tr_b16 a[248:249], v2 offset:24576
ds_read_b64_tr_b16 a[250:251], v2 offset:26624
s_waitcnt vmcnt(7)
v_mfma_f32_16x16x32_bf16 v[44:47], a[252:255], v[124:127], v[44:47]
buffer_load_dwordx4 v8, s[16:19], s35 offen nt lds
L_step_32:
s_waitcnt lgkmcnt(6)
v_mfma_f32_16x16x32_bf16 a[128:131], a[224:227], a[0:3], 0
ds_read_b64_tr_b16 a[252:253], v3 offset:24576
ds_read_b64_tr_b16 a[254:255], v3 offset:26624
v_fma_f32 v49, v49, s6, -v10
v_mfma_f32_16x16x32_bf16 a[136:139], a[224:227], a[4:7], 0
v_fma_f32 v50, v50, s6, -v10
v_fma_f32 v51, v51, s6, -v10
v_max3_f32 v12, v48, v49, v50
v_mfma_f32_16x16x32_bf16 a[132:135], a[228:231], a[0:3], 0
ds_read_b64_tr_b16 a[224:225], v0 offset:20480
ds_read_b64_tr_b16 a[226:227], v0 offset:22528
v_fma_f32 v52, v52, s6, -v10
v_mfma_f32_16x16x32_bf16 a[140:143], a[228:231], a[4:7], 0
v_fma_f32 v53, v53, s6, -v10
v_fma_f32 v54, v54, s6, -v10
v_max3_f32 v13, v51, v52, v53
v_mfma_f32_16x16x32_bf16 a[144:147], a[232:235], a[0:3], 0
ds_read_b64_tr_b16 a[228:229], v1 offset:20480
ds_read_b64_tr_b16 a[230:231], v1 offset:22528
v_fma_f32 v55, v55, s6, -v10
v_mfma_f32_16x16x32_bf16 a[152:155], a[232:235], a[4:7], 0
v_fma_f32 v56, v56, s6, -v11
v_max3_f32 v12, v12, v54, v55
v_fma_f32 v57, v57, s6, -v11
v_mfma_f32_16x16x32_bf16 a[148:151], a[236:239], a[0:3], 0
ds_read_b64_tr_b16 a[232:233], v2 offset:20480
ds_read_b64_tr_b16 a[234:235], v2 offset:22528
v_fma_f32 v58, v58, s6, -v11
v_mfma_f32_16x16x32_bf16 a[156:159], a[236:239], a[4:7], 0
v_max3_f32 v13, v13, v56, v57
v_fma_f32 v59, v59, s6, -v11
s_waitcnt lgkmcnt(6)
v_mfma_f32_16x16x32_bf16 a[160:163], a[240:243], a[0:3], 0
ds_read_b64_tr_b16 a[236:237], v3 offset:20480
ds_read_b64_tr_b16 a[238:239], v3 offset:22528
v_fma_f32 v60, v60, s6, -v11
v_mfma_f32_16x16x32_bf16 a[168:171], a[240:243], a[4:7], 0
v_max3_f32 v12, v12, v58, v59
v_fma_f32 v61, v61, s6, -v11
v_fma_f32 v62, v62, s6, -v11
v_mfma_f32_16x16x32_bf16 a[164:167], a[244:247], a[0:3], 0
ds_read_b64_tr_b16 a[240:241], v0 offset:28672
ds_read_b64_tr_b16 a[242:243], v0 offset:30720
v_max3_f32 v13, v13, v60, v61
v_mfma_f32_16x16x32_bf16 a[172:175], a[244:247], a[4:7], 0
v_fma_f32 v63, v63, s6, -v11
v_max3_f32 v12, v12, v62, v63
v_max_f32 v12, v12, v13
v_mfma_f32_16x16x32_bf16 a[176:179], a[248:251], a[0:3], 0
ds_read_b64_tr_b16 a[244:245], v1 offset:28672
ds_read_b64_tr_b16 a[246:247], v1 offset:30720
v_mfma_f32_16x16x32_bf16 a[184:187], a[248:251], a[4:7], 0
buffer_load_dwordx4 v8, s[16:19], s35 offen offset:1024 nt lds
v_cmp_lt_f32 vcc, 0x41000000, v12
s_cbranch_vccnz L_stub_0_9
L_back_0_9:
v_mfma_f32_16x16x32_bf16 a[180:183], a[252:255], a[0:3], 0
ds_read_b64_tr_b16 a[248:249], v2 offset:28672
ds_read_b64_tr_b16 a[250:251], v2 offset:30720
v_mfma_f32_16x16x32_bf16 a[188:191], a[252:255], a[4:7], 0
s_add_u32 m0, s4, 16384
s_add_u32 s5, s54, 768
s_waitcnt lgkmcnt(6)
v_mfma_f32_16x16x32_bf16 a[128:131], a[224:227], a[8:11], a[128:131]
ds_read_b64_tr_b16 a[252:253], v3 offset:28672
ds_read_b64_tr_b16 a[254:255], v3 offset:30720
v_mfma_f32_16x16x32_bf16 a[136:139], a[224:227], a[12:15], a[136:139]
v_exp_f32 v48, v48
v_exp_f32 v49, v49
v_mfma_f32_16x16x32_bf16 a[132:135], a[228:231], a[8:11], a[132:135]
s_barrier
ds_read_b128 a[224:227], v4 offset:49152
v_exp_f32 v50, v50
v_mfma_f32_16x16x32_bf16 a[140:143], a[228:231], a[12:15], a[140:143]
v_exp_f32 v51, v51
v_cvt_pk_bf16_f32 v200, v48, v49
v_mfma_f32_16x16x32_bf16 a[144:147], a[232:235], a[8:11], a[144:147]
ds_read_b128 a[228:231], v4 offset:51200
buffer_load_dwordx4 v16, s[20:23], s5 offen lds
v_mfma_f32_16x16x32_bf16 a[152:155], a[232:235], a[12:15], a[152:155]
v_exp_f32 v52, v52
v_exp_f32 v53, v53
v_mfma_f32_16x16x32_bf16 a[148:151], a[236:239], a[8:11], a[148:151]
ds_read_b128 a[232:235], v5 offset:49152
v_cvt_pk_bf16_f32 v201, v50, v51
v_exp_f32 v54, v54
v_mfma_f32_16x16x32_bf16 a[156:159], a[236:239], a[12:15], a[156:159]
v_exp_f32 v55, v55
s_waitcnt lgkmcnt(3)
v_mfma_f32_16x16x32_bf16 a[160:163], a[240:243], a[8:11], a[160:163]
ds_read_b128 a[236:239], v5 offset:51200
v_cvt_pk_bf16_f32 v202, v52, v53
v_exp_f32 v56, v56
v_mfma_f32_16x16x32_bf16 a[168:171], a[240:243], a[12:15], a[168:171]
v_exp_f32 v57, v57
v_cvt_pk_bf16_f32 v203, v54, v55
v_mfma_f32_16x16x32_bf16 a[164:167], a[244:247], a[8:11], a[164:167]
ds_read_b128 a[240:243], v4 offset:53248
v_exp_f32 v58, v58
v_mfma_f32_16x16x32_bf16 a[172:175], a[244:247], a[12:15], a[172:175]
v_exp_f32 v59, v59
v_cvt_pk_bf16_f32 v204, v56, v57
s_add_u32 m0, s4, 32768
v_mfma_f32_16x16x32_bf16 a[176:179], a[248:251], a[8:11], a[176:179]
ds_read_b128 a[244:247], v4 offset:55296
v_exp_f32 v60, v60
v_mfma_f32_16x16x32_bf16 a[184:187], a[248:251], a[12:15], a[184:187]
v_exp_f32 v61, v61
v_cvt_pk_bf16_f32 v205, v58, v59
s_waitcnt vmcnt(5)
v_mfma_f32_16x16x32_bf16 a[180:183], a[252:255], a[8:11], a[180:183]
ds_read_b128 a[248:251], v5 offset:53248
v_exp_f32 v62, v62
v_mfma_f32_16x16x32_bf16 a[188:191], a[252:255], a[12:15], a[188:191]
v_exp_f32 v63, v63
v_cvt_pk_bf16_f32 v206, v60, v61
v_cvt_pk_bf16_f32 v207, v62, v63
L_step_33:
s_waitcnt lgkmcnt(3)
L_pg7:
s_cbranch_scc1 L_pg11
v_mfma_f32_16x16x32_bf16 v[48:51], a[224:227], v[64:67], 0
ds_read_b128 a[252:255], v5 offset:55296
buffer_load_dwordx4 v8, s[16:19], s35 offen offset:2048 nt lds
v_mfma_f32_16x16x32_bf16 v[56:59], a[224:227], v[68:71], 0
s_add_u32 m0, s4, 16384
s_add_u32 s5, s54, 130816
buffer_load_dwordx4 v16, s[20:23], s5 offen offset:1024 lds
v_mfma_f32_16x16x32_bf16 v[52:55], a[228:231], v[64:67], 0
ds_read_b128 a[224:227], v4 offset:57344
s_add_u32 s5, s54, 31488
v_mfma_f32_16x16x32_bf16 v[60:63], a[228:231], v[68:71], 0
buffer_load_dwordx4 v16, s[20:23], s5 offen offset:2048 lds
s_add_u32 m0, s4, 32768
v_fma_f32 v32, v32, s6, -v10
v_mfma_f32_16x16x32_bf16 v[48:51], a[232:235], v[72:75], v[48:51]
ds_read_b128 a[228:231], v4 offset:59392
v_fma_f32 v33, v33, s6, -v10
v_fma_f32 v34, v34, s6, -v10
v_mfma_f32_16x16x32_bf16 v[56:59], a[232:235], v[76:79], v[56:59]
v_fma_f32 v35, v35, s6, -v10
v_max3_f32 v12, v32, v33, v34
v_fma_f32 v36, v36, s6, -v10
v_mfma_f32_16x16x32_bf16 v[52:55], a[236:239], v[72:75], v[52:55]
ds_read_b128 a[232:235], v5 offset:57344
buffer_load_dwordx4 v8, s[16:19], s35 offen offset:3072 nt lds
v_mfma_f32_16x16x32_bf16 v[60:63], a[236:239], v[76:79], v[60:63]
s_add_u32 m0, s4, 16384
s_add_u32 s5, s54, 161536
s_waitcnt lgkmcnt(3)
v_mfma_f32_16x16x32_bf16 v[48:51], a[240:243], v[80:83], v[48:51]
ds_read_b128 a[236:239], v5 offset:59392
buffer_load_dwordx4 v16, s[20:23], s5 offen offset:3072 lds
v_mfma_f32_16x16x32_bf16 v[56:59], a[240:243], v[84:87], v[56:59]
v_fma_f32 v37, v37, s6, -v10
v_fma_f32 v38, v38, s6, -v10
v_max3_f32 v13, v35, v36, v37
v_mfma_f32_16x16x32_bf16 v[52:55], a[244:247], v[80:83], v[52:55]
ds_read_b128 a[240:243], v4 offset:61440
v_fma_f32 v39, v39, s6, -v10
v_fma_f32 v40, v40, s6, -v11
v_mfma_f32_16x16x32_bf16 v[60:63], a[244:247], v[84:87], v[60:63]
v_max3_f32 v12, v12, v38, v39
v_fma_f32 v41, v41, s6, -v11
v_fma_f32 v42, v42, s6, -v11
v_max3_f32 v13, v13, v40, v41
v_mfma_f32_16x16x32_bf16 v[48:51], a[248:251], v[88:91], v[48:51]
ds_read_b128 a[244:247], v4 offset:63488
v_add_u32 v4, 0x14000, v4
v_fma_f32 v43, v43, s6, -v11
v_mfma_f32_16x16x32_bf16 v[56:59], a[248:251], v[92:95], v[56:59]
v_fma_f32 v44, v44, s6, -v11
v_max3_f32 v12, v12, v42, v43
v_fma_f32 v45, v45, s6, -v11
v_fma_f32 v46, v46, s6, -v11
v_mfma_f32_16x16x32_bf16 v[52:55], a[252:255], v[88:91], v[52:55]
ds_read_b128 a[248:251], v5 offset:61440
s_add_u32 m0, s4, 0
s_mov_b32 s35, 65536
v_mfma_f32_16x16x32_bf16 v[60:63], a[252:255], v[92:95], v[60:63]
v_max3_f32 v13, v13, v44, v45
v_fma_f32 v47, v47, s6, -v11
v_max3_f32 v12, v12, v46, v47
s_waitcnt lgkmcnt(3)
v_mfma_f32_16x16x32_bf16 v[48:51], a[224:227], v[96:99], v[48:51]
ds_read_b128 a[252:255], v5 offset:63488
v_add_u32 v5, 0x14000, v5
v_max_f32 v12, v12, v13
v_mfma_f32_16x16x32_bf16 v[56:59], a[224:227], v[100:103], v[56:59]
v_cmp_lt_f32 vcc, 0x41000000, v12
s_cbranch_vccnz L_stub_0_10
L_back_0_10:
v_exp_f32 v32, v32
v_mfma_f32_16x16x32_bf16 v[52:55], a[228:231], v[96:99], v[52:55]
s_barrier
ds_read_b128 a[224:227], v4 offset:49152
v_mfma_f32_16x16x32_bf16 v[60:63], a[228:231], v[100:103], v[60:63]
v_exp_f32 v33, v33
v_exp_f32 v34, v34
v_mfma_f32_16x16x32_bf16 v[48:51], a[232:235], v[104:107], v[48:51]
ds_read_b128 a[228:231], v4 offset:51200
s_waitcnt vmcnt(7)
buffer_load_dwordx4 v8, s[16:19], s35 offen nt lds
v_mfma_f32_16x16x32_bf16 v[56:59], a[232:235], v[108:111], v[56:59]
v_exp_f32 v35, v35
v_cvt_pk_bf16_f32 v208, v32, v33
v_mfma_f32_16x16x32_bf16 v[52:55], a[236:239], v[104:107], v[52:55]
ds_read_b128 a[232:235], v5 offset:49152
v_exp_f32 v36, v36
v_mfma_f32_16x16x32_bf16 v[60:63], a[236:239], v[108:111], v[60:63]
v_exp_f32 v37, v37
v_cvt_pk_bf16_f32 v209, v34, v35
s_waitcnt lgkmcnt(3)
v_mfma_f32_16x16x32_bf16 v[48:51], a[240:243], v[112:115], v[48:51]
ds_read_b128 a[236:239], v5 offset:51200
v_exp_f32 v38, v38
v_mfma_f32_16x16x32_bf16 v[56:59], a[240:243], v[116:119], v[56:59]
v_exp_f32 v39, v39
v_cvt_pk_bf16_f32 v210, v36, v37
v_exp_f32 v40, v40
v_mfma_f32_16x16x32_bf16 v[52:55], a[244:247], v[112:115], v[52:55]
ds_read_b128 a[240:243], v4 offset:53248
v_exp_f32 v41, v41
v_cvt_pk_bf16_f32 v211, v38, v39
v_mfma_f32_16x16x32_bf16 v[60:63], a[244:247], v[116:119], v[60:63]
v_exp_f32 v42, v42
v_exp_f32 v43, v43
v_mfma_f32_16x16x32_bf16 v[48:51], a[248:251], v[120:123], v[48:51]
ds_read_b128 a[244:247], v4 offset:55296
v_cvt_pk_bf16_f32 v212, v40, v41
v_exp_f32 v44, v44
v_mfma_f32_16x16x32_bf16 v[56:59], a[248:251], v[124:127], v[56:59]
v_exp_f32 v45, v45
v_cvt_pk_bf16_f32 v213, v42, v43
v_mfma_f32_16x16x32_bf16 v[52:55], a[252:255], v[120:123], v[52:55]
ds_read_b128 a[248:251], v5 offset:53248
v_exp_f32 v46, v46
v_mfma_f32_16x16x32_bf16 v[60:63], a[252:255], v[124:127], v[60:63]
v_exp_f32 v47, v47
v_cvt_pk_bf16_f32 v214, v44, v45
v_cvt_pk_bf16_f32 v215, v46, v47
L_step_34:
s_waitcnt lgkmcnt(3)
v_mfma_f32_16x16x32_bf16 v[32:35], a[224:227], v[64:67], 0
ds_read_b128 a[252:255], v5 offset:55296
v_mfma_f32_16x16x32_bf16 v[40:43], a[224:227], v[68:71], 0
buffer_load_dwordx4 v8, s[16:19], s35 offen offset:1024 nt lds
v_mfma_f32_16x16x32_bf16 v[36:39], a[228:231], v[64:67], 0
ds_read_b128 a[224:227], v4 offset:57344
v_fma_f32 v48, v48, s6, -v10
v_mfma_f32_16x16x32_bf16 v[44:47], a[228:231], v[68:71], 0
v_fma_f32 v49, v49, s6, -v10
v_fma_f32 v50, v50, s6, -v10
v_mfma_f32_16x16x32_bf16 v[32:35], a[232:235], v[72:75], v[32:35]
ds_read_b128 a[228:231], v4 offset:59392
v_fma_f32 v51, v51, s6, -v10
v_mfma_f32_16x16x32_bf16 v[40:43], a[232:235], v[76:79], v[40:43]
v_max3_f32 v12, v48, v49, v50
v_fma_f32 v52, v52, s6, -v10
v_mfma_f32_16x16x32_bf16 v[36:39], a[236:239], v[72:75], v[36:39]
ds_read_b128 a[232:235], v5 offset:57344
v_fma_f32 v53, v53, s6, -v10
v_mfma_f32_16x16x32_bf16 v[44:47], a[236:239], v[76:79], v[44:47]
v_fma_f32 v54, v54, s6, -v10
s_waitcnt lgkmcnt(3)
v_mfma_f32_16x16x32_bf16 v[32:35], a[240:243], v[80:83], v[32:35]
ds_read_b128 a[236:239], v5 offset:59392
v_max3_f32 v13, v51, v52, v53
v_mfma_f32_16x16x32_bf16 v[40:43], a[240:243], v[84:87], v[40:43]
v_fma_f32 v55, v55, s6, -v10
v_fma_f32 v56, v56, s6, -v11
v_mfma_f32_16x16x32_bf16 v[36:39], a[244:247], v[80:83], v[36:39]
ds_read_b128 a[240:243], v4 offset:61440
s_waitcnt vmcnt(6)
v_mfma_f32_16x16x32_bf16 v[44:47], a[244:247], v[84:87], v[44:47]
buffer_load_dwordx4 v8, s[16:19], s35 offen offset:2048 nt lds
v_mfma_f32_16x16x32_bf16 v[32:35], a[248:251], v[88:91], v[32:35]
ds_read_b128 a[244:247], v4 offset:63488
v_max3_f32 v12, v12, v54, v55
v_mfma_f32_16x16x32_bf16 v[40:43], a[248:251], v[92:95], v[40:43]
v_fma_f32 v57, v57, s6, -v11
v_fma_f32 v58, v58, s6, -v11
v_mfma_f32_16x16x32_bf16 v[36:39], a[252:255], v[88:91], v[36:39]
ds_read_b128 a[248:251], v5 offset:61440
v_max3_f32 v13, v13, v56, v57
v_mfma_f32_16x16x32_bf16 v[44:47], a[252:255], v[92:95], v[44:47]
v_fma_f32 v59, v59, s6, -v11
s_waitcnt lgkmcnt(3)
v_mfma_f32_16x16x32_bf16 v[32:35], a[224:227], v[96:99], v[32:35]
ds_read_b128 a[252:255], v5 offset:63488
v_fma_f32 v60, v60, s6, -v11
v_mfma_f32_16x16x32_bf16 v[40:43], a[224:227], v[100:103], v[40:43]
v_max3_f32 v12, v12, v58, v59
v_fma_f32 v61, v61, s6, -v11
v_mfma_f32_16x16x32_bf16 v[36:39], a[228:231], v[96:99], v[36:39]
s_barrier
ds_read_b64_tr_b16 a[224:225], v0 offset:32768
v_mfma_f32_16x16x32_bf16 v[44:47], a[228:231], v[100:103], v[44:47]
ds_read_b64_tr_b16 a[226:227], v0 offset:34816
v_fma_f32 v62, v62, s6, -v11
v_mfma_f32_16x16x32_bf16 v[32:35], a[232:235], v[104:107], v[32:35]
ds_read_b64_tr_b16 a[228:229], v1 offset:32768
ds_read_b64_tr_b16 a[230:231], v1 offset:34816
v_mfma_f32_16x16x32_bf16 v[40:43], a[232:235], v[108:111], v[40:43]
v_max3_f32 v13, v13, v60, v61
v_fma_f32 v63, v63, s6, -v11
v_mfma_f32_16x16x32_bf16 v[36:39], a[236:239], v[104:107], v[36:39]
ds_read_b64_tr_b16 a[232:233], v2 offset:32768
ds_read_b64_tr_b16 a[234:235], v2 offset:34816
v_mfma_f32_16x16x32_bf16 v[44:47], a[236:239], v[108:111], v[44:47]
v_max3_f32 v12, v12, v62, v63
s_waitcnt lgkmcnt(6)
v_mfma_f32_16x16x32_bf16 v[32:35], a[240:243], v[112:115], v[32:35]
ds_read_b64_tr_b16 a[236:237], v3 offset:32768
ds_read_b64_tr_b16 a[238:239], v3 offset:34816
v_mfma_f32_16x16x32_bf16 v[40:43], a[240:243], v[116:119], v[40:43]
buffer_load_dwordx4 v8, s[16:19], s35 offen offset:3072 nt lds
v_mfma_f32_16x16x32_bf16 v[36:39], a[244:247], v[112:115], v[36:39]
ds_read_b64_tr_b16 a[240:241], v0 offset:40960
ds_read_b64_tr_b16 a[242:243], v0 offset:43008
v_mfma_f32_16x16x32_bf16 v[44:47], a[244:247], v[116:119], v[44:47]
v_max_f32 v12, v12, v13
v_cmp_lt_f32 vcc, 0x41000000, v12
v_mfma_f32_16x16x32_bf16 v[32:35], a[248:251], v[120:123], v[32:35]
ds_read_b64_tr_b16 a[244:245], v1 offset:40960
v_mfma_f32_16x16x32_bf16 v[40:43], a[248:251], v[124:127], v[40:43]
ds_read_b64_tr_b16 a[246:247], v1 offset:43008
s_cbranch_vccnz L_stub_0_11
L_back_0_11:
v_mfma_f32_16x16x32_bf16 v[36:39], a[252:255], v[120:123], v[36:39]
ds_read_b64_tr_b16 a[248:249], v2 offset:40960
v_mfma_f32_16x16x32_bf16 v[44:47], a[252:255], v[124:127], v[44:47]
ds_read_b64_tr_b16 a[250:251], v2 offset:43008
L_step_35:
s_waitcnt lgkmcnt(6)
v_mfma_f32_16x16x32_bf16 a[128:131], a[224:227], a[16:19], a[128:131]
ds_read_b64_tr_b16 a[252:253], v3 offset:40960
ds_read_b64_tr_b16 a[254:255], v3 offset:43008
v_mfma_f32_16x16x32_bf16 a[136:139], a[224:227], a[20:23], a[136:139]
s_add_u32 m0, s4, 81920
s_mov_b32 s35, 131072
v_mfma_f32_16x16x32_bf16 a[132:135], a[228:231], a[16:19], a[132:135]
ds_read_b64_tr_b16 a[224:225], v0 offset:36864
ds_read_b64_tr_b16 a[226:227], v0 offset:38912
v_mfma_f32_16x16x32_bf16 a[140:143], a[228:231], a[20:23], a[140:143]
v_exp_f32 v48, v48
v_mfma_f32_16x16x32_bf16 a[144:147], a[232:235], a[16:19], a[144:147]
ds_read_b64_tr_b16 a[228:229], v1 offset:36864
ds_read_b64_tr_b16 a[230:231], v1 offset:38912
v_mfma_f32_16x16x32_bf16 a[152:155], a[232:235], a[20:23], a[152:155]
v_exp_f32 v49, v49
v_mfma_f32_16x16x32_bf16 a[148:151], a[236:239], a[16:19], a[148:151]
ds_read_b64_tr_b16 a[232:233], v2 offset:36864
ds_read_b64_tr_b16 a[234:235], v2 offset:38912
v_mfma_f32_16x16x32_bf16 a[156:159], a[236:239], a[20:23], a[156:159]
s_waitcnt vmcnt(3)
s_waitcnt lgkmcnt(6)
v_mfma_f32_16x16x32_bf16 a[160:163], a[240:243], a[16:19], a[160:163]
ds_read_b64_tr_b16 a[236:237], v3 offset:36864
ds_read_b64_tr_b16 a[238:239], v3 offset:38912
v_mfma_f32_16x16x32_bf16 a[168:171], a[240:243], a[20:23], a[168:171]
buffer_load_dwordx4 v8, s[16:19], s35 offen nt lds
v_mfma_f32_16x16x32_bf16 a[164:167], a[244:247], a[16:19], a[164:167]
ds_read_b64_tr_b16 a[240:241], v0 offset:45056
ds_read_b64_tr_b16 a[242:243], v0 offset:47104
v_mfma_f32_16x16x32_bf16 a[172:175], a[244:247], a[20:23], a[172:175]
v_exp_f32 v50, v50
v_mfma_f32_16x16x32_bf16 a[176:179], a[248:251], a[16:19], a[176:179]
ds_read_b64_tr_b16 a[244:245], v1 offset:45056
ds_read_b64_tr_b16 a[246:247], v1 offset:47104
v_mfma_f32_16x16x32_bf16 a[184:187], a[248:251], a[20:23], a[184:187]
v_exp_f32 v51, v51
v_cvt_pk_bf16_f32 v216, v48, v49
v_mfma_f32_16x16x32_bf16 a[180:183], a[252:255], a[16:19], a[180:183]
ds_read_b64_tr_b16 a[248:249], v2 offset:45056
ds_read_b64_tr_b16 a[250:251], v2 offset:47104
v_mfma_f32_16x16x32_bf16 a[188:191], a[252:255], a[20:23], a[188:191]
v_exp_f32 v52, v52
s_waitcnt lgkmcnt(6)
v_mfma_f32_16x16x32_bf16 a[128:131], a[224:227], a[24:27], a[128:131]
ds_read_b64_tr_b16 a[252:253], v3 offset:45056
ds_read_b64_tr_b16 a[254:255], v3 offset:47104
v_mfma_f32_16x16x32_bf16 a[136:139], a[224:227], a[28:31], a[136:139]
v_exp_f32 v53, v53
v_cvt_pk_bf16_f32 v217, v50, v51
v_mfma_f32_16x16x32_bf16 a[132:135], a[228:231], a[24:27], a[132:135]
s_barrier
ds_read_b128 a[224:227], v4 offset:32768
v_mfma_f32_16x16x32_bf16 a[140:143], a[228:231], a[28:31], a[140:143]
v_exp_f32 v54, v54
v_mfma_f32_16x16x32_bf16 a[144:147], a[232:235], a[24:27], a[144:147]
ds_read_b128 a[228:231], v4 offset:34816
buffer_load_dwordx4 v8, s[16:19], s35 offen offset:1024 nt lds
v_mfma_f32_16x16x32_bf16 a[152:155], a[232:235], a[28:31], a[152:155]
s_add_u32 m0, s4, 49152
s_add_u32 s5, s55, 768
v_mfma_f32_16x16x32_bf16 a[148:151], a[236:239], a[24:27], a[148:151]
ds_read_b128 a[232:235], v5 offset:32768
buffer_load_dwordx4 v16, s[20:23], s5 offen lds
v_mfma_f32_16x16x32_bf16 a[156:159], a[236:239], a[28:31], a[156:159]
s_add_u32 s5, s55, 130816
v_exp_f32 v55, v55
s_waitcnt lgkmcnt(3)
v_mfma_f32_16x16x32_bf16 a[160:163], a[240:243], a[24:27], a[160:163]
ds_read_b128 a[236:239], v5 offset:34816
buffer_load_dwordx4 v16, s[20:23], s5 offen offset:1024 lds
v_mfma_f32_16x16x32_bf16 a[168:171], a[240:243], a[28:31], a[168:171]
v_cvt_pk_bf16_f32 v218, v52, v53
v_exp_f32 v56, v56
s_add_u32 s5, s55, 31488
v_mfma_f32_16x16x32_bf16 a[164:167], a[244:247], a[24:27], a[164:167]
ds_read_b128 a[240:243], v4 offset:36864
v_exp_f32 v57, v57
v_cvt_pk_bf16_f32 v219, v54, v55
v_mfma_f32_16x16x32_bf16 a[172:175], a[244:247], a[28:31], a[172:175]
v_exp_f32 v58, v58
v_exp_f32 v59, v59
v_mfma_f32_16x16x32_bf16 a[176:179], a[248:251], a[24:27], a[176:179]
ds_read_b128 a[244:247], v4 offset:38912
v_cvt_pk_bf16_f32 v220, v56, v57
v_exp_f32 v60, v60
v_mfma_f32_16x16x32_bf16 a[184:187], a[248:251], a[28:31], a[184:187]
v_exp_f32 v61, v61
v_cvt_pk_bf16_f32 v221, v58, v59
v_mfma_f32_16x16x32_bf16 a[180:183], a[252:255], a[24:27], a[180:183]
ds_read_b128 a[248:251], v5 offset:36864
v_exp_f32 v62, v62
v_mfma_f32_16x16x32_bf16 a[188:191], a[252:255], a[28:31], a[188:191]
v_exp_f32 v63, v63
v_cvt_pk_bf16_f32 v222, v60, v61
v_cvt_pk_bf16_f32 v223, v62, v63
L_step_36:
s_waitcnt lgkmcnt(3)
v_mfma_f32_16x16x32_bf16 v[48:51], a[224:227], v[64:67], 0
ds_read_b128 a[252:255], v5 offset:38912
v_mfma_f32_16x16x32_bf16 v[56:59], a[224:227], v[68:71], 0
buffer_load_dwordx4 v16, s[20:23], s5 offen offset:2048 lds
s_add_u32 m0, s4, 81920
v_mfma_f32_16x16x32_bf16 v[52:55], a[228:231], v[64:67], 0
ds_read_b128 a[224:227], v4 offset:40960
s_waitcnt vmcnt(6)
v_mfma_f32_16x16x32_bf16 v[60:63], a[228:231], v[68:71], 0
buffer_load_dwordx4 v8, s[16:19], s35 offen offset:2048 nt lds
v_mfma_f32_16x16x32_bf16 v[48:51], a[232:235], v[72:75], v[48:51]
ds_read_b128 a[228:231], v4 offset:43008
s_add_u32 m0, s4, 49152
v_mfma_f32_16x16x32_bf16 v[56:59], a[232:235], v[76:79], v[56:59]
s_add_u32 s5, s55, 161536
v_add_u32 v0, 0xffff0000, v0
v_mfma_f32_16x16x32_bf16 v[52:55], a[236:239], v[72:75], v[52:55]
ds_read_b128 a[232:235], v5 offset:40960
v_mfma_f32_16x16x32_bf16 v[60:63], a[236:239], v[76:79], v[60:63]
buffer_load_dwordx4 v16, s[20:23], s5 offen offset:3072 lds
s_waitcnt lgkmcnt(3)
v_mfma_f32_16x16x32_bf16 v[48:51], a[240:243], v[80:83], v[48:51]
ds_read_b128 a[236:239], v5 offset:43008
v_add_u32 v1, 0xffff0000, v1
v_mfma_f32_16x16x32_bf16 v[56:59], a[240:243], v[84:87], v[56:59]
v_add_u32 v2, 0xffff0000, v2
v_add_u32 v3, 0xffff0000, v3
v_mfma_f32_16x16x32_bf16 v[52:55], a[244:247], v[80:83], v[52:55]
ds_read_b128 a[240:243], v4 offset:45056
v_mfma_f32_16x16x32_bf16 v[60:63], a[244:247], v[84:87], v[60:63]
buffer_load_dword v20, v29, s[24:27], s0 offen
s_add_u32 m0, s4, 81920
v_mfma_f32_16x16x32_bf16 v[48:51], a[248:251], v[88:91], v[48:51]
ds_read_b128 a[244:247], v4 offset:47104
buffer_load_dwordx4 v8, s[16:19], s35 offen offset:3072 nt lds
v_mfma_f32_16x16x32_bf16 v[56:59], a[248:251], v[92:95], v[56:59]
v_fma_f32 v32, v32, s6, -v10
v_fma_f32 v33, v33, s6, -v10
v_mfma_f32_16x16x32_bf16 v[52:55], a[252:255], v[88:91], v[52:55]
ds_read_b128 a[248:251], v5 offset:45056
v_fma_f32 v34, v34, s6, -v10
v_mfma_f32_16x16x32_bf16 v[60:63], a[252:255], v[92:95], v[60:63]
v_fma_f32 v35, v35, s6, -v10
v_max3_f32 v12, v32, v33, v34
s_waitcnt lgkmcnt(3)
v_mfma_f32_16x16x32_bf16 v[48:51], a[224:227], v[96:99], v[48:51]
ds_read_b128 a[252:255], v5 offset:47104
v_fma_f32 v36, v36, s6, -v10
v_mfma_f32_16x16x32_bf16 v[56:59], a[224:227], v[100:103], v[56:59]
v_fma_f32 v37, v37, s6, -v10
v_fma_f32 v38, v38, s6, -v10
v_max3_f32 v13, v35, v36, v37
v_mfma_f32_16x16x32_bf16 v[52:55], a[228:231], v[96:99], v[52:55]
s_barrier
ds_read_b64_tr_b16 a[224:225], v0 offset:16384
v_mfma_f32_16x16x32_bf16 v[60:63], a[228:231], v[100:103], v[60:63]
ds_read_b64_tr_b16 a[226:227], v0 offset:18432
v_fma_f32 v39, v39, s6, -v10
v_mfma_f32_16x16x32_bf16 v[48:51], a[232:235], v[104:107], v[48:51]
ds_read_b64_tr_b16 a[228:229], v1 offset:16384
ds_read_b64_tr_b16 a[230:231], v1 offset:18432
v_mfma_f32_16x16x32_bf16 v[56:59], a[232:235], v[108:111], v[56:59]
s_add_u32 m0, s4, 131072
s_mov_b32 s35, 196608
v_fma_f32 v40, v40, s6, -v11
v_mfma_f32_16x16x32_bf16 v[52:55], a[236:239], v[104:107], v[52:55]
ds_read_b64_tr_b16 a[232:233], v2 offset:16384
ds_read_b64_tr_b16 a[234:235], v2 offset:18432
v_mfma_f32_16x16x32_bf16 v[60:63], a[236:239], v[108:111], v[60:63]
v_max3_f32 v12, v12, v38, v39
v_fma_f32 v41, v41, s6, -v11
s_waitcnt lgkmcnt(6)
v_mfma_f32_16x16x32_bf16 v[48:51], a[240:243], v[112:115], v[48:51]
ds_read_b64_tr_b16 a[236:237], v3 offset:16384
ds_read_b64_tr_b16 a[238:239], v3 offset:18432
v_mfma_f32_16x16x32_bf16 v[56:59], a[240:243], v[116:119], v[56:59]
v_fma_f32 v42, v42, s6, -v11
v_max3_f32 v13, v13, v40, v41
v_fma_f32 v43, v43, s6, -v11
v_mfma_f32_16x16x32_bf16 v[52:55], a[244:247], v[112:115], v[52:55]
ds_read_b64_tr_b16 a[240:241], v0 offset:24576
ds_read_b64_tr_b16 a[242:243], v0 offset:26624
v_mfma_f32_16x16x32_bf16 v[60:63], a[244:247], v[116:119], v[60:63]
s_waitcnt vmcnt(8)
buffer_load_dwordx4 v8, s[16:19], s35 offen nt lds
v_mfma_f32_16x16x32_bf16 v[48:51], a[248:251], v[120:123], v[48:51]
ds_read_b64_tr_b16 a[244:245], v1 offset:24576
ds_read_b64_tr_b16 a[246:247], v1 offset:26624
v_mfma_f32_16x16x32_bf16 v[56:59], a[248:251], v[124:127], v[56:59]
v_add_u32 v4, 0xffff0000, v4
v_fma_f32 v44, v44, s6, -v11
v_max3_f32 v12, v12, v42, v43
v_mfma_f32_16x16x32_bf16 v[52:55], a[252:255], v[120:123], v[52:55]
ds_read_b64_tr_b16 a[248:249], v2 offset:24576
ds_read_b64_tr_b16 a[250:251], v2 offset:26624
v_mfma_f32_16x16x32_bf16 v[60:63], a[252:255], v[124:127], v[60:63]
v_add_u32 v5, 0xffff0000, v5
v_fma_f32 v45, v45, s6, -v11
L_step_37:
s_waitcnt lgkmcnt(6)
v_mfma_f32_16x16x32_bf16 a[128:131], a[224:227], a[32:35], a[128:131]
ds_read_b64_tr_b16 a[252:253], v3 offset:24576
ds_read_b64_tr_b16 a[254:255], v3 offset:26624
v_mfma_f32_16x16x32_bf16 a[136:139], a[224:227], a[36:39], a[136:139]
v_fma_f32 v46, v46, s6, -v11
v_max3_f32 v13, v13, v44, v45
v_fma_f32 v47, v47, s6, -v11
v_mfma_f32_16x16x32_bf16 a[132:135], a[228:231], a[32:35], a[132:135]
ds_read_b64_tr_b16 a[224:225], v0 offset:20480
ds_read_b64_tr_b16 a[226:227], v0 offset:22528
v_mfma_f32_16x16x32_bf16 a[140:143], a[228:231], a[36:39], a[140:143]
v_max3_f32 v12, v12, v46, v47
v_max_f32 v12, v12, v13
v_cmp_lt_f32 vcc, 0x41000000, v12
v_mfma_f32_16x16x32_bf16 a[144:147], a[232:235], a[32:35], a[144:147]
ds_read_b64_tr_b16 a[228:229], v1 offset:20480
ds_read_b64_tr_b16 a[230:231], v1 offset:22528
v_mfma_f32_16x16x32_bf16 a[152:155], a[232:235], a[36:39], a[152:155]
s_cbranch_vccnz L_stub_0_12
L_back_0_12:
v_exp_f32 v32, v32
v_mfma_f32_16x16x32_bf16 a[148:151], a[236:239], a[32:35], a[148:151]
ds_read_b64_tr_b16 a[232:233], v2 offset:20480
ds_read_b64_tr_b16 a[234:235], v2 offset:22528
v_mfma_f32_16x16x32_bf16 a[156:159], a[236:239], a[36:39], a[156:159]
v_exp_f32 v33, v33
s_waitcnt lgkmcnt(6)
v_mfma_f32_16x16x32_bf16 a[160:163], a[240:243], a[32:35], a[160:163]
ds_read_b64_tr_b16 a[236:237], v3 offset:20480
ds_read_b64_tr_b16 a[238:239], v3 offset:22528
v_mfma_f32_16x16x32_bf16 a[168:171], a[240:243], a[36:39], a[168:171]
buffer_load_dwordx4 v8, s[16:19], s35 offen offset:1024 nt lds
v_mfma_f32_16x16x32_bf16 a[164:167], a[244:247], a[32:35], a[164:167]
ds_read_b64_tr_b16 a[240:241], v0 offset:28672
ds_read_b64_tr_b16 a[242:243], v0 offset:30720
v_mfma_f32_16x16x32_bf16 a[172:175], a[244:247], a[36:39], a[172:175]
v_exp_f32 v34, v34
v_mfma_f32_16x16x32_bf16 a[176:179], a[248:251], a[32:35], a[176:179]
ds_read_b64_tr_b16 a[244:245], v1 offset:28672
ds_read_b64_tr_b16 a[246:247], v1 offset:30720
v_mfma_f32_16x16x32_bf16 a[184:187], a[248:251], a[36:39], a[184:187]
v_exp_f32 v35, v35
v_cvt_pk_bf16_f32 v224, v32, v33
v_mfma_f32_16x16x32_bf16 a[180:183], a[252:255], a[32:35], a[180:183]
ds_read_b64_tr_b16 a[248:249], v2 offset:28672
ds_read_b64_tr_b16 a[250:251], v2 offset:30720
v_mfma_f32_16x16x32_bf16 a[188:191], a[252:255], a[36:39], a[188:191]
v_exp_f32 v36, v36
s_waitcnt lgkmcnt(6)
v_mfma_f32_16x16x32_bf16 a[128:131], a[224:227], a[40:43], a[128:131]
ds_read_b64_tr_b16 a[252:253], v3 offset:28672
ds_read_b64_tr_b16 a[254:255], v3 offset:30720
v_mfma_f32_16x16x32_bf16 a[136:139], a[224:227], a[44:47], a[136:139]
v_exp_f32 v37, v37
v_cvt_pk_bf16_f32 v225, v34, v35
v_mfma_f32_16x16x32_bf16 a[132:135], a[228:231], a[40:43], a[132:135]
s_barrier
ds_read_b128 a[224:227], v4 offset:49152
v_mfma_f32_16x16x32_bf16 a[140:143], a[228:231], a[44:47], a[140:143]
v_exp_f32 v38, v38
v_mfma_f32_16x16x32_bf16 a[144:147], a[232:235], a[40:43], a[144:147]
ds_read_b128 a[228:231], v4 offset:51200
v_mfma_f32_16x16x32_bf16 a[152:155], a[232:235], a[44:47], a[152:155]
v_exp_f32 v39, v39
v_cvt_pk_bf16_f32 v226, v36, v37
v_mfma_f32_16x16x32_bf16 a[148:151], a[236:239], a[40:43], a[148:151]
ds_read_b128 a[232:235], v5 offset:49152
s_waitcnt vmcnt(5)
v_mfma_f32_16x16x32_bf16 a[156:159], a[236:239], a[44:47], a[156:159]
buffer_load_dwordx4 v8, s[16:19], s35 offen offset:2048 nt lds
s_waitcnt lgkmcnt(3)
v_mfma_f32_16x16x32_bf16 a[160:163], a[240:243], a[40:43], a[160:163]
ds_read_b128 a[236:239], v5 offset:51200
v_exp_f32 v40, v40
v_mfma_f32_16x16x32_bf16 a[168:171], a[240:243], a[44:47], a[168:171]
v_exp_f32 v41, v41
v_cvt_pk_bf16_f32 v227, v38, v39
v_mfma_f32_16x16x32_bf16 a[164:167], a[244:247], a[40:43], a[164:167]
ds_read_b128 a[240:243], v4 offset:53248
v_exp_f32 v42, v42
v_mfma_f32_16x16x32_bf16 a[172:175], a[244:247], a[44:47], a[172:175]
v_exp_f32 v43, v43
v_cvt_pk_bf16_f32 v228, v40, v41
v_mfma_f32_16x16x32_bf16 a[176:179], a[248:251], a[40:43], a[176:179]
ds_read_b128 a[244:247], v4 offset:55296
v_exp_f32 v44, v44
v_mfma_f32_16x16x32_bf16 a[184:187], a[248:251], a[44:47], a[184:187]
v_exp_f32 v45, v45
v_cvt_pk_bf16_f32 v229, v42, v43
v_mfma_f32_16x16x32_bf16 a[180:183], a[252:255], a[40:43], a[180:183]
ds_read_b128 a[248:251], v5 offset:53248
v_exp_f32 v46, v46
v_mfma_f32_16x16x32_bf16 a[188:191], a[252:255], a[44:47], a[188:191]
v_exp_f32 v47, v47
v_cvt_pk_bf16_f32 v230, v44, v45
v_cvt_pk_bf16_f32 v231, v46, v47
L_step_38:
s_waitcnt lgkmcnt(3)
v_mfma_f32_16x16x32_bf16 v[32:35], a[224:227], v[64:67], 0
ds_read_b128 a[252:255], v5 offset:55296
v_fma_f32 v48, v48, s6, -v10
v_mfma_f32_16x16x32_bf16 v[40:43], a[224:227], v[68:71], 0
v_fma_f32 v49, v49, s6, -v10
v_fma_f32 v50, v50, s6, -v10
v_fma_f32 v51, v51, s6, -v10
v_mfma_f32_16x16x32_bf16 v[36:39], a[228:231], v[64:67], 0
ds_read_b128 a[224:227], v4 offset:57344
buffer_load_dwordx4 v8, s[16:19], s35 offen offset:3072 nt lds
v_mfma_f32_16x16x32_bf16 v[44:47], a[228:231], v[68:71], 0
v_max3_f32 v12, v48, v49, v50
v_fma_f32 v52, v52, s6, -v10
v_fma_f32 v53, v53, s6, -v10
v_mfma_f32_16x16x32_bf16 v[32:35], a[232:235], v[72:75], v[32:35]
ds_read_b128 a[228:231], v4 offset:59392
v_fma_f32 v54, v54, s6, -v10
v_max3_f32 v13, v51, v52, v53
v_mfma_f32_16x16x32_bf16 v[40:43], a[232:235], v[76:79], v[40:43]
v_fma_f32 v55, v55, s6, -v10
v_fma_f32 v56, v56, s6, -v11
v_max3_f32 v12, v12, v54, v55
v_mfma_f32_16x16x32_bf16 v[36:39], a[236:239], v[72:75], v[36:39]
ds_read_b128 a[232:235], v5 offset:57344
v_fma_f32 v57, v57, s6, -v11
v_fma_f32 v58, v58, s6, -v11
v_mfma_f32_16x16x32_bf16 v[44:47], a[236:239], v[76:79], v[44:47]
v_max3_f32 v13, v13, v56, v57
v_fma_f32 v59, v59, s6, -v11
s_waitcnt lgkmcnt(3)
v_mfma_f32_16x16x32_bf16 v[32:35], a[240:243], v[80:83], v[32:35]
ds_read_b128 a[236:239], v5 offset:59392
s_add_u32 m0, s4, 114688
s_mov_b32 s35, 128
v_mfma_f32_16x16x32_bf16 v[40:43], a[240:243], v[84:87], v[40:43]
v_fma_f32 v60, v60, s6, -v11
v_max3_f32 v12, v12, v58, v59
v_fma_f32 v61, v61, s6, -v11
v_mfma_f32_16x16x32_bf16 v[36:39], a[244:247], v[80:83], v[36:39]
ds_read_b128 a[240:243], v4 offset:61440
v_fma_f32 v62, v62, s6, -v11
v_max3_f32 v13, v13, v60, v61
v_mfma_f32_16x16x32_bf16 v[44:47], a[244:247], v[84:87], v[44:47]
v_fma_f32 v63, v63, s6, -v11
v_max3_f32 v12, v12, v62, v63
v_max_f32 v12, v12, v13
v_mfma_f32_16x16x32_bf16 v[32:35], a[248:251], v[88:91], v[32:35]
ds_read_b128 a[244:247], v4 offset:63488
v_add_u32 v4, 0x14000, v4
v_cmp_lt_f32 vcc, 0x41000000, v12
v_mfma_f32_16x16x32_bf16 v[40:43], a[248:251], v[92:95], v[40:43]
s_cbranch_vccnz L_stub_0_13
L_back_0_13:
v_exp_f32 v48, v48
v_mfma_f32_16x16x32_bf16 v[36:39], a[252:255], v[88:91], v[36:39]
ds_read_b128 a[248:251], v5 offset:61440
L_pg8:
s_cbranch_scc1 L_pg12
s_waitcnt vmcnt(3)
v_mfma_f32_16x16x32_bf16 v[44:47], a[252:255], v[92:95], v[44:47]
buffer_load_dwordx4 v8, s[16:19], s35 offen nt lds
s_add_u32 m0, s4, 16384
s_waitcnt lgkmcnt(3)
v_mfma_f32_16x16x32_bf16 v[32:35], a[224:227], v[96:99], v[32:35]
ds_read_b128 a[252:255], v5 offset:63488
v_add_u32 v5, 0x14000, v5
v_mfma_f32_16x16x32_bf16 v[40:43], a[224:227], v[100:103], v[40:43]
s_add_u32 s5, s56, 768
v_exp_f32 v49, v49
v_mfma_f32_16x16x32_bf16 v[36:39], a[228:231], v[96:99], v[36:39]
s_barrier
ds_read_b128 a[224:227], v4 offset:49152
v_exp_f32 v50, v50
v_mfma_f32_16x16x32_bf16 v[44:47], a[228:231], v[100:103], v[44:47]
v_exp_f32 v51, v51
v_cvt_pk_bf16_f32 v232, v48, v49
v_mfma_f32_16x16x32_bf16 v[32:35], a[232:235], v[104:107], v[32:35]
ds_read_b128 a[228:231], v4 offset:51200
buffer_load_dwordx4 v16, s[20:23], s5 offen lds
v_mfma_f32_16x16x32_bf16 v[40:43], a[232:235], v[108:111], v[40:43]
v_exp_f32 v52, v52
v_exp_f32 v53, v53
v_mfma_f32_16x16x32_bf16 v[36:39], a[236:239], v[104:107], v[36:39]
ds_read_b128 a[232:235], v5 offset:49152
v_cvt_pk_bf16_f32 v233, v50, v51
v_exp_f32 v54, v54
v_mfma_f32_16x16x32_bf16 v[44:47], a[236:239], v[108:111], v[44:47]
v_exp_f32 v55, v55
s_waitcnt lgkmcnt(3)
v_mfma_f32_16x16x32_bf16 v[32:35], a[240:243], v[112:115], v[32:35]
ds_read_b128 a[236:239], v5 offset:51200
v_cvt_pk_bf16_f32 v234, v52, v53
v_exp_f32 v56, v56
v_mfma_f32_16x16x32_bf16 v[40:43], a[240:243], v[116:119], v[40:43]
v_exp_f32 v57, v57
v_cvt_pk_bf16_f32 v235, v54, v55
v_mfma_f32_16x16x32_bf16 v[36:39], a[244:247], v[112:115], v[36:39]
ds_read_b128 a[240:243], v4 offset:53248
v_exp_f32 v58, v58
v_mfma_f32_16x16x32_bf16 v[44:47], a[244:247], v[116:119], v[44:47]
v_exp_f32 v59, v59
v_cvt_pk_bf16_f32 v236, v56, v57
s_add_u32 s5, s56, 130816
v_mfma_f32_16x16x32_bf16 v[32:35], a[248:251], v[120:123], v[32:35]
ds_read_b128 a[244:247], v4 offset:55296
v_exp_f32 v60, v60
v_mfma_f32_16x16x32_bf16 v[40:43], a[248:251], v[124:127], v[40:43]
v_exp_f32 v61, v61
v_cvt_pk_bf16_f32 v237, v58, v59
v_mfma_f32_16x16x32_bf16 v[36:39], a[252:255], v[120:123], v[36:39]
ds_read_b128 a[248:251], v5 offset:53248
v_exp_f32 v62, v62
v_mfma_f32_16x16x32_bf16 v[44:47], a[252:255], v[124:127], v[44:47]
v_exp_f32 v63, v63
v_cvt_pk_bf16_f32 v238, v60, v61
v_cvt_pk_bf16_f32 v239, v62, v63
L_step_39:
s_waitcnt lgkmcnt(3)
v_mfma_f32_16x16x32_bf16 v[48:51], a[224:227], v[64:67], 0
ds_read_b128 a[252:255], v5 offset:55296
v_mfma_f32_16x16x32_bf16 v[56:59], a[224:227], v[68:71], 0
buffer_load_dwordx4 v16, s[20:23], s5 offen offset:1024 lds
s_add_u32 m0, s4, 114688
v_mfma_f32_16x16x32_bf16 v[52:55], a[228:231], v[64:67], 0
ds_read_b128 a[224:227], v4 offset:57344
buffer_load_dwordx4 v8, s[16:19], s35 offen offset:1024 nt lds
v_mfma_f32_16x16x32_bf16 v[60:63], a[228:231], v[68:71], 0
s_add_u32 m0, s4, 16384
s_add_u32 s5, s56, 31488
v_mfma_f32_16x16x32_bf16 v[48:51], a[232:235], v[72:75], v[48:51]
ds_read_b128 a[228:231], v4 offset:59392
buffer_load_dwordx4 v16, s[20:23], s5 offen offset:2048 lds
v_mfma_f32_16x16x32_bf16 v[56:59], a[232:235], v[76:79], v[56:59]
s_add_u32 m0, s4, 114688
v_fma_f32 v32, v32, s6, -v10
v_mfma_f32_16x16x32_bf16 v[52:55], a[236:239], v[72:75], v[52:55]
ds_read_b128 a[232:235], v5 offset:57344
v_fma_f32 v33, v33, s6, -v10
v_mfma_f32_16x16x32_bf16 v[60:63], a[236:239], v[76:79], v[60:63]
v_fma_f32 v34, v34, s6, -v10
v_fma_f32 v35, v35, s6, -v10
s_waitcnt lgkmcnt(3)
v_mfma_f32_16x16x32_bf16 v[48:51], a[240:243], v[80:83], v[48:51]
ds_read_b128 a[236:239], v5 offset:59392
s_waitcnt vmcnt(6)
v_mfma_f32_16x16x32_bf16 v[56:59], a[240:243], v[84:87], v[56:59]
buffer_load_dwordx4 v8, s[16:19], s35 offen offset:2048 nt lds
s_add_u32 m0, s4, 16384
s_add_u32 s5, s56, 161536
v_mfma_f32_16x16x32_bf16 v[52:55], a[244:247], v[80:83], v[52:55]
ds_read_b128 a[240:243], v4 offset:61440
buffer_load_dwordx4 v16, s[20:23], s5 offen offset:3072 lds
v_mfma_f32_16x16x32_bf16 v[60:63], a[244:247], v[84:87], v[60:63]
v_max3_f32 v12, v32, v33, v34
v_fma_f32 v36, v36, s6, -v10
v_fma_f32 v37, v37, s6, -v10
v_mfma_f32_16x16x32_bf16 v[48:51], a[248:251], v[88:91], v[48:51]
ds_read_b128 a[244:247], v4 offset:63488
v_fma_f32 v38, v38, s6, -v10
v_max3_f32 v13, v35, v36, v37
v_mfma_f32_16x16x32_bf16 v[56:59], a[248:251], v[92:95], v[56:59]
v_fma_f32 v39, v39, s6, -v10
v_fma_f32 v40, v40, s6, -v11
v_max3_f32 v12, v12, v38, v39
v_mfma_f32_16x16x32_bf16 v[52:55], a[252:255], v[88:91], v[52:55]
ds_read_b128 a[248:251], v5 offset:61440
s_add_u32 m0, s4, 114688
v_fma_f32 v41, v41, s6, -v11
v_mfma_f32_16x16x32_bf16 v[60:63], a[252:255], v[92:95], v[60:63]
v_fma_f32 v42, v42, s6, -v11
v_max3_f32 v13, v13, v40, v41
s_waitcnt lgkmcnt(3)
v_mfma_f32_16x16x32_bf16 v[48:51], a[224:227], v[96:99], v[48:51]
ds_read_b128 a[252:255], v5 offset:63488
v_fma_f32 v43, v43, s6, -v11
v_fma_f32 v44, v44, s6, -v11
v_mfma_f32_16x16x32_bf16 v[56:59], a[224:227], v[100:103], v[56:59]
v_max3_f32 v12, v12, v42, v43
v_fma_f32 v45, v45, s6, -v11
v_fma_f32 v46, v46, s6, -v11
v_mfma_f32_16x16x32_bf16 v[52:55], a[228:231], v[96:99], v[52:55]
s_barrier
ds_read_b64_tr_b16 a[224:225], v0 offset:49152
ds_read_b64_tr_b16 a[226:227], v0 offset:51200
v_mfma_f32_16x16x32_bf16 v[60:63], a[228:231], v[100:103], v[60:63]
v_max3_f32 v13, v13, v44, v45
v_fma_f32 v47, v47, s6, -v11
v_max3_f32 v12, v12, v46, v47
v_mfma_f32_16x16x32_bf16 v[48:51], a[232:235], v[104:107], v[48:51]
ds_read_b64_tr_b16 a[228:229], v1 offset:49152
ds_read_b64_tr_b16 a[230:231], v1 offset:51200
v_mfma_f32_16x16x32_bf16 v[56:59], a[232:235], v[108:111], v[56:59]
buffer_load_dwordx4 v8, s[16:19], s35 offen offset:3072 nt lds
v_max_f32 v12, v12, v13
v_cmp_lt_f32 vcc, 0x41000000, v12
v_mfma_f32_16x16x32_bf16 v[52:55], a[236:239], v[104:107], v[52:55]
ds_read_b64_tr_b16 a[232:233], v2 offset:49152
ds_read_b64_tr_b16 a[234:235], v2 offset:51200
s_cbranch_vccnz L_stub_0_14
L_back_0_14:
v_mfma_f32_16x16x32_bf16 v[60:63], a[236:239], v[108:111], v[60:63]
v_exp_f32 v32, v32
s_waitcnt lgkmcnt(6)
v_mfma_f32_16x16x32_bf16 v[48:51], a[240:243], v[112:115], v[48:51]
ds_read_b64_tr_b16 a[236:237], v3 offset:49152
ds_read_b64_tr_b16 a[238:239], v3 offset:51200
v_mfma_f32_16x16x32_bf16 v[56:59], a[240:243], v[116:119], v[56:59]
v_exp_f32 v33, v33
v_exp_f32 v34, v34
v_mfma_f32_16x16x32_bf16 v[52:55], a[244:247], v[112:115], v[52:55]
ds_read_b64_tr_b16 a[240:241], v0 offset:57344
ds_read_b64_tr_b16 a[242:243], v0 offset:59392
v_mfma_f32_16x16x32_bf16 v[60:63], a[244:247], v[116:119], v[60:63]
v_exp_f32 v35, v35
v_cvt_pk_bf16_f32 v240, v32, v33
v_mfma_f32_16x16x32_bf16 v[48:51], a[248:251], v[120:123], v[48:51]
ds_read_b64_tr_b16 a[244:245], v1 offset:57344
ds_read_b64_tr_b16 a[246:247], v1 offset:59392
s_add_u32 m0, s4, 65536
v_mfma_f32_16x16x32_bf16 v[56:59], a[248:251], v[124:127], v[56:59]
s_mov_b32 s35, 65664
v_exp_f32 v36, v36
v_mfma_f32_16x16x32_bf16 v[52:55], a[252:255], v[120:123], v[52:55]
ds_read_b64_tr_b16 a[248:249], v2 offset:57344
ds_read_b64_tr_b16 a[250:251], v2 offset:59392
v_mfma_f32_16x16x32_bf16 v[60:63], a[252:255], v[124:127], v[60:63]
v_exp_f32 v37, v37
v_cvt_pk_bf16_f32 v241, v34, v35
L_step_40:
s_waitcnt lgkmcnt(6)
v_mfma_f32_16x16x32_bf16 a[128:131], a[224:227], a[48:51], a[128:131]
ds_read_b64_tr_b16 a[252:253], v3 offset:57344
ds_read_b64_tr_b16 a[254:255], v3 offset:59392
v_mfma_f32_16x16x32_bf16 a[136:139], a[224:227], a[52:55], a[136:139]
v_exp_f32 v38, v38
v_exp_f32 v39, v39
v_mfma_f32_16x16x32_bf16 a[132:135], a[228:231], a[48:51], a[132:135]
ds_read_b64_tr_b16 a[224:225], v0 offset:53248
ds_read_b64_tr_b16 a[226:227], v0 offset:55296
s_waitcnt vmcnt(7)
v_mfma_f32_16x16x32_bf16 a[140:143], a[228:231], a[52:55], a[140:143]
buffer_load_dwordx4 v8, s[16:19], s35 offen nt lds
v_cvt_pk_bf16_f32 v242, v36, v37
v_mfma_f32_16x16x32_bf16 a[144:147], a[232:235], a[48:51], a[144:147]
ds_read_b64_tr_b16 a[228:229], v1 offset:53248
ds_read_b64_tr_b16 a[230:231], v1 offset:55296
v_mfma_f32_16x16x32_bf16 a[152:155], a[232:235], a[52:55], a[152:155]
v_exp_f32 v40, v40
v_exp_f32 v41, v41
v_mfma_f32_16x16x32_bf16 a[148:151], a[236:239], a[48:51], a[148:151]
ds_read_b64_tr_b16 a[232:233], v2 offset:53248
ds_read_b64_tr_b16 a[234:235], v2 offset:55296
v_cvt_pk_bf16_f32 v243, v38, v39
v_mfma_f32_16x16x32_bf16 a[156:159], a[236:239], a[52:55], a[156:159]
v_exp_f32 v42, v42
s_waitcnt lgkmcnt(6)
v_mfma_f32_16x16x32_bf16 a[160:163], a[240:243], a[48:51], a[160:163]
ds_read_b64_tr_b16 a[236:237], v3 offset:53248
ds_read_b64_tr_b16 a[238:239], v3 offset:55296
v_exp_f32 v43, v43
v_mfma_f32_16x16x32_bf16 a[168:171], a[240:243], a[52:55], a[168:171]
v_cvt_pk_bf16_f32 v244, v40, v41
v_exp_f32 v44, v44
v_mfma_f32_16x16x32_bf16 a[164:167], a[244:247], a[48:51], a[164:167]
ds_read_b64_tr_b16 a[240:241], v0 offset:61440
ds_read_b64_tr_b16 a[242:243], v0 offset:63488
v_mfma_f32_16x16x32_bf16 a[172:175], a[244:247], a[52:55], a[172:175]
v_exp_f32 v45, v45
v_cvt_pk_bf16_f32 v245, v42, v43
v_accvgpr_read_b32 v24, a112
v_mfma_f32_16x16x32_bf16 a[176:179], a[248:251], a[48:51], a[176:179]
ds_read_b64_tr_b16 a[244:245], v1 offset:61440
ds_read_b64_tr_b16 a[246:247], v1 offset:63488
v_exp_f32 v46, v46
v_mfma_f32_16x16x32_bf16 a[184:187], a[248:251], a[52:55], a[184:187]
v_exp_f32 v47, v47
v_cvt_pk_bf16_f32 v246, v44, v45
v_cvt_pk_bf16_f32 v247, v46, v47
v_mfma_f32_16x16x32_bf16 a[180:183], a[252:255], a[48:51], a[180:183]
ds_read_b64_tr_b16 a[248:249], v2 offset:61440
ds_read_b64_tr_b16 a[250:251], v2 offset:63488
v_mfma_f32_16x16x32_bf16 a[188:191], a[252:255], a[52:55], a[188:191]
v_fma_f32 v48, v48, s6, -v10
s_waitcnt lgkmcnt(6)
v_mfma_f32_16x16x32_bf16 a[128:131], a[224:227], a[56:59], a[128:131]
ds_read_b64_tr_b16 a[252:253], v3 offset:61440
ds_read_b64_tr_b16 a[254:255], v3 offset:63488
v_mfma_f32_16x16x32_bf16 a[136:139], a[224:227], a[60:63], a[136:139]
v_fma_f32 v49, v49, s6, -v10
v_fma_f32 v50, v50, s6, -v10
v_fma_f32 v51, v51, s6, -v10
v_mfma_f32_16x16x32_bf16 a[132:135], a[228:231], a[56:59], a[132:135]
buffer_load_dwordx4 v8, s[16:19], s35 offen offset:1024 nt lds
v_mfma_f32_16x16x32_bf16 a[140:143], a[228:231], a[60:63], a[140:143]
v_max3_f32 v12, v48, v49, v50
v_fma_f32 v52, v52, s6, -v10
v_fma_f32 v53, v53, s6, -v10
v_mfma_f32_16x16x32_bf16 a[144:147], a[232:235], a[56:59], a[144:147]
v_fma_f32 v54, v54, s6, -v10
v_max3_f32 v13, v51, v52, v53
v_mfma_f32_16x16x32_bf16 a[152:155], a[232:235], a[60:63], a[152:155]
v_fma_f32 v55, v55, s6, -v10
v_fma_f32 v56, v56, s6, -v11
v_max3_f32 v12, v12, v54, v55
v_mfma_f32_16x16x32_bf16 a[148:151], a[236:239], a[56:59], a[148:151]
v_fma_f32 v57, v57, s6, -v11
v_fma_f32 v58, v58, s6, -v11
v_mfma_f32_16x16x32_bf16 a[156:159], a[236:239], a[60:63], a[156:159]
v_max3_f32 v13, v13, v56, v57
v_fma_f32 v59, v59, s6, -v11
s_waitcnt lgkmcnt(0)
v_mfma_f32_16x16x32_bf16 a[160:163], a[240:243], a[56:59], a[160:163]
v_fma_f32 v60, v60, s6, -v11
v_max3_f32 v12, v12, v58, v59
v_mfma_f32_16x16x32_bf16 a[168:171], a[240:243], a[60:63], a[168:171]
v_fma_f32 v61, v61, s6, -v11
v_fma_f32 v62, v62, s6, -v11
v_max3_f32 v13, v13, v60, v61
v_mfma_f32_16x16x32_bf16 a[164:167], a[244:247], a[56:59], a[164:167]
v_fma_f32 v63, v63, s6, -v11
v_max3_f32 v12, v12, v62, v63
v_mfma_f32_16x16x32_bf16 a[172:175], a[244:247], a[60:63], a[172:175]
v_max_f32 v12, v12, v13
v_cmp_lt_f32 vcc, 0x41000000, v12
v_mfma_f32_16x16x32_bf16 a[176:179], a[248:251], a[56:59], a[176:179]
s_cbranch_vccnz L_stub_0_15
L_back_0_15:
v_mov_b32 v10, 0x3f803f80
v_mfma_f32_16x16x32_bf16 a[184:187], a[248:251], a[60:63], a[184:187]
v_mov_b32 v11, 0x3f803f80
v_mov_b32 v12, 0x3f803f80
v_mov_b32 v13, 0x3f803f80
v_mfma_f32_16x16x32_bf16 a[180:183], a[252:255], a[56:59], a[180:183]
v_exp_f32 v48, v48
v_mfma_f32_16x16x32_bf16 a[188:191], a[252:255], a[60:63], a[188:191]
v_exp_f32 v49, v49
v_mfma_f32_16x16x32_bf16 v[112:115], v[10:13], v[128:131], 0
s_waitcnt vmcnt(4)
v_mfma_f32_16x16x32_bf16 v[120:123], v[10:13], v[132:135], 0
buffer_load_dwordx4 v8, s[16:19], s35 offen offset:2048 nt lds
v_accvgpr_read_b32 v25, a113
v_mfma_f32_16x16x32_bf16 v[112:115], v[10:13], v[136:139], v[112:115]
v_exp_f32 v50, v50
v_mfma_f32_16x16x32_bf16 v[120:123], v[10:13], v[140:143], v[120:123]
v_exp_f32 v51, v51
v_mfma_f32_16x16x32_bf16 v[112:115], v[10:13], v[144:147], v[112:115]
v_cvt_pk_bf16_f32 v248, v48, v49
v_mfma_f32_16x16x32_bf16 v[120:123], v[10:13], v[148:151], v[120:123]
v_exp_f32 v52, v52
v_accvgpr_read_b32 v26, a114
v_mfma_f32_16x16x32_bf16 v[112:115], v[10:13], v[152:155], v[112:115]
v_exp_f32 v53, v53
v_mfma_f32_16x16x32_bf16 v[120:123], v[10:13], v[156:159], v[120:123]
v_cvt_pk_bf16_f32 v249, v50, v51
v_accvgpr_read_b32 v27, a115
v_mfma_f32_16x16x32_bf16 v[112:115], v[10:13], v[160:163], v[112:115]
v_exp_f32 v54, v54
v_mfma_f32_16x16x32_bf16 v[120:123], v[10:13], v[164:167], v[120:123]
v_exp_f32 v55, v55
v_mfma_f32_16x16x32_bf16 v[112:115], v[10:13], v[168:171], v[112:115]
v_cvt_pk_bf16_f32 v250, v52, v53
v_mfma_f32_16x16x32_bf16 v[120:123], v[10:13], v[172:175], v[120:123]
v_exp_f32 v56, v56
v_cvt_pk_bf16_f32 v64, v24, v25
v_mfma_f32_16x16x32_bf16 v[112:115], v[10:13], v[176:179], v[112:115]
v_exp_f32 v57, v57
v_mfma_f32_16x16x32_bf16 v[120:123], v[10:13], v[180:183], v[120:123]
v_cvt_pk_bf16_f32 v251, v54, v55
v_cvt_pk_bf16_f32 v65, v26, v27
v_mfma_f32_16x16x32_bf16 v[112:115], v[10:13], v[184:187], v[112:115]
buffer_load_dwordx4 v8, s[16:19], s35 offen offset:3072 nt lds
v_mfma_f32_16x16x32_bf16 v[120:123], v[10:13], v[188:191], v[120:123]
s_add_u32 m0, s4, 98304
s_add_u32 s5, s57, 768
v_mfma_f32_16x16x32_bf16 v[112:115], v[10:13], v[192:195], v[112:115]
s_barrier
ds_read_b64_tr_b16 a[252:253], v0 offset:32768
v_mfma_f32_16x16x32_bf16 v[120:123], v[10:13], v[196:199], v[120:123]
ds_read_b64_tr_b16 a[254:255], v0 offset:34816
v_exp_f32 v58, v58
v_mfma_f32_16x16x32_bf16 v[112:115], v[10:13], v[200:203], v[112:115]
ds_read_b64_tr_b16 a[224:225], v1 offset:32768
ds_read_b64_tr_b16 a[226:227], v1 offset:34816
v_mfma_f32_16x16x32_bf16 v[120:123], v[10:13], v[204:207], v[120:123]
buffer_load_dwordx4 v16, s[20:23], s5 offen lds
s_add_u32 s5, s57, 130816
v_mfma_f32_16x16x32_bf16 v[112:115], v[10:13], v[208:211], v[112:115]
ds_read_b64_tr_b16 a[228:229], v2 offset:32768
ds_read_b64_tr_b16 a[230:231], v2 offset:34816
v_mfma_f32_16x16x32_bf16 v[120:123], v[10:13], v[212:215], v[120:123]
v_exp_f32 v59, v59
v_cvt_pk_bf16_f32 v252, v56, v57
v_mfma_f32_16x16x32_bf16 v[112:115], v[10:13], v[216:219], v[112:115]
ds_read_b64_tr_b16 a[232:233], v3 offset:32768
ds_read_b64_tr_b16 a[234:235], v3 offset:34816
v_mfma_f32_16x16x32_bf16 v[120:123], v[10:13], v[220:223], v[120:123]
v_exp_f32 v60, v60
v_accvgpr_read_b32 v24, a116
v_mfma_f32_16x16x32_bf16 v[112:115], v[10:13], v[224:227], v[112:115]
ds_read_b64_tr_b16 a[236:237], v0 offset:36864
ds_read_b64_tr_b16 a[238:239], v0 offset:38912
v_mfma_f32_16x16x32_bf16 v[120:123], v[10:13], v[228:231], v[120:123]
v_exp_f32 v61, v61
v_cvt_pk_bf16_f32 v253, v58, v59
v_mfma_f32_16x16x32_bf16 v[112:115], v[10:13], v[232:235], v[112:115]
ds_read_b64_tr_b16 a[240:241], v1 offset:36864
ds_read_b64_tr_b16 a[242:243], v1 offset:38912
v_mfma_f32_16x16x32_bf16 v[120:123], v[10:13], v[236:239], v[120:123]
v_exp_f32 v62, v62
v_accvgpr_read_b32 v25, a117
v_mfma_f32_16x16x32_bf16 v[112:115], v[10:13], v[240:243], v[112:115]
ds_read_b64_tr_b16 a[244:245], v2 offset:36864
ds_read_b64_tr_b16 a[246:247], v2 offset:38912
v_exp_f32 v63, v63
v_mfma_f32_16x16x32_bf16 v[120:123], v[10:13], v[244:247], v[120:123]
v_cvt_pk_bf16_f32 v254, v60, v61
v_cvt_pk_bf16_f32 v255, v62, v63
L_step_41:
s_waitcnt lgkmcnt(12)
v_mfma_f32_16x16x32_bf16 v[32:35], a[252:255], v[128:131], 0
ds_read_b64_tr_b16 a[248:249], v3 offset:36864
ds_read_b64_tr_b16 a[250:251], v3 offset:38912
v_mfma_f32_16x16x32_bf16 v[40:43], a[252:255], v[132:135], 0
buffer_load_dwordx4 v16, s[20:23], s5 offen offset:1024 lds
s_waitcnt lgkmcnt(6)
v_mfma_f32_16x16x32_bf16 v[36:39], a[224:227], v[128:131], 0
ds_read_b64_tr_b16 a[252:253], v0 offset:40960
ds_read_b64_tr_b16 a[254:255], v0 offset:43008
v_mfma_f32_16x16x32_bf16 v[44:47], a[224:227], v[132:135], 0
s_add_u32 m0, s4, 147456
s_mov_b32 s35, 131200
v_mfma_f32_16x16x32_bf16 v[48:51], a[228:231], v[128:131], 0
ds_read_b64_tr_b16 a[224:225], v1 offset:40960
ds_read_b64_tr_b16 a[226:227], v1 offset:43008
v_mfma_f32_16x16x32_bf16 v[56:59], a[228:231], v[132:135], 0
s_waitcnt vmcnt(5)
buffer_load_dwordx4 v8, s[16:19], s35 offen nt lds
v_mfma_f32_16x16x32_bf16 v[52:55], a[232:235], v[128:131], 0
ds_read_b64_tr_b16 a[228:229], v2 offset:40960
ds_read_b64_tr_b16 a[230:231], v2 offset:43008
v_mfma_f32_16x16x32_bf16 v[60:63], a[232:235], v[132:135], 0
s_add_u32 m0, s4, 98304
s_add_u32 s5, s57, 31488
v_mfma_f32_16x16x32_bf16 v[32:35], a[236:239], v[136:139], v[32:35]
ds_read_b64_tr_b16 a[232:233], v3 offset:40960
ds_read_b64_tr_b16 a[234:235], v3 offset:43008
v_mfma_f32_16x16x32_bf16 v[40:43], a[236:239], v[140:143], v[40:43]
buffer_load_dwordx4 v16, s[20:23], s5 offen offset:2048 lds
s_waitcnt lgkmcnt(6)
v_mfma_f32_16x16x32_bf16 v[36:39], a[240:243], v[136:139], v[36:39]
ds_read_b64_tr_b16 a[236:237], v0 offset:45056
ds_read_b64_tr_b16 a[238:239], v0 offset:47104
v_mfma_f32_16x16x32_bf16 v[44:47], a[240:243], v[140:143], v[44:47]
s_add_u32 s5, s57, 161536
v_accvgpr_read_b32 v26, a118
v_mfma_f32_16x16x32_bf16 v[48:51], a[244:247], v[136:139], v[48:51]
ds_read_b64_tr_b16 a[240:241], v1 offset:45056
ds_read_b64_tr_b16 a[242:243], v1 offset:47104
v_mfma_f32_16x16x32_bf16 v[56:59], a[244:247], v[140:143], v[56:59]
buffer_load_dwordx4 v16, s[20:23], s5 offen offset:3072 lds
v_mfma_f32_16x16x32_bf16 v[52:55], a[248:251], v[136:139], v[52:55]
ds_read_b64_tr_b16 a[244:245], v2 offset:45056
ds_read_b64_tr_b16 a[246:247], v2 offset:47104
v_mfma_f32_16x16x32_bf16 v[60:63], a[248:251], v[140:143], v[60:63]
s_add_u32 m0, s4, 147456
s_waitcnt vmcnt(7)
v_mfma_f32_16x16x32_bf16 v[32:35], a[252:255], v[144:147], v[32:35]
ds_read_b64_tr_b16 a[248:249], v3 offset:45056
ds_read_b64_tr_b16 a[250:251], v3 offset:47104
v_mfma_f32_16x16x32_bf16 v[40:43], a[252:255], v[148:151], v[40:43]
v_accvgpr_read_b32 v27, a119
s_waitcnt lgkmcnt(6)
v_mfma_f32_16x16x32_bf16 v[36:39], a[224:227], v[144:147], v[36:39]
s_barrier
ds_read_b64_tr_b16 a[252:253], v0 offset:16384
v_mfma_f32_16x16x32_bf16 v[44:47], a[224:227], v[148:151], v[44:47]
ds_read_b64_tr_b16 a[254:255], v0 offset:18432
v_cvt_pk_bf16_f32 v66, v24, v25
v_mfma_f32_16x16x32_bf16 v[48:51], a[228:231], v[144:147], v[48:51]
ds_read_b64_tr_b16 a[224:225], v1 offset:16384
ds_read_b64_tr_b16 a[226:227], v1 offset:18432
v_mfma_f32_16x16x32_bf16 v[56:59], a[228:231], v[148:151], v[56:59]
buffer_load_dwordx4 v8, s[16:19], s35 offen offset:1024 nt lds
v_mfma_f32_16x16x32_bf16 v[52:55], a[232:235], v[144:147], v[52:55]
ds_read_b64_tr_b16 a[228:229], v2 offset:16384
ds_read_b64_tr_b16 a[230:231], v2 offset:18432
v_mfma_f32_16x16x32_bf16 v[60:63], a[232:235], v[148:151], v[60:63]
v_cvt_pk_bf16_f32 v67, v26, v27
v_accvgpr_read_b32 v24, a120
v_mfma_f32_16x16x32_bf16 v[32:35], a[236:239], v[152:155], v[32:35]
ds_read_b64_tr_b16 a[232:233], v3 offset:16384
ds_read_b64_tr_b16 a[234:235], v3 offset:18432
v_mfma_f32_16x16x32_bf16 v[40:43], a[236:239], v[156:159], v[40:43]
v_accvgpr_read_b32 v25, a121
s_waitcnt lgkmcnt(6)
v_mfma_f32_16x16x32_bf16 v[36:39], a[240:243], v[152:155], v[36:39]
ds_read_b64_tr_b16 a[236:237], v0 offset:24576
ds_read_b64_tr_b16 a[238:239], v0 offset:26624
v_mfma_f32_16x16x32_bf16 v[44:47], a[240:243], v[156:159], v[44:47]
v_accvgpr_read_b32 v26, a122
v_accvgpr_read_b32 v27, a123
v_mfma_f32_16x16x32_bf16 v[48:51], a[244:247], v[152:155], v[48:51]
ds_read_b64_tr_b16 a[240:241], v1 offset:24576
ds_read_b64_tr_b16 a[242:243], v1 offset:26624
v_mfma_f32_16x16x32_bf16 v[56:59], a[244:247], v[156:159], v[56:59]
s_waitcnt vmcnt(7)
v_cvt_pk_bf16_f32 v68, v24, v25
v_mfma_f32_16x16x32_bf16 v[52:55], a[248:251], v[152:155], v[52:55]
ds_read_b64_tr_b16 a[244:245], v2 offset:24576
ds_read_b64_tr_b16 a[246:247], v2 offset:26624
v_mfma_f32_16x16x32_bf16 v[60:63], a[248:251], v[156:159], v[60:63]
buffer_load_dwordx4 v8, s[16:19], s35 offen offset:2048 nt lds
L_step_42:
v_mfma_f32_16x16x32_bf16 a[128:131], a[252:255], a[64:67], a[128:131]
ds_read_b64_tr_b16 a[248:249], v3 offset:24576
ds_read_b64_tr_b16 a[250:251], v3 offset:26624
v_mfma_f32_16x16x32_bf16 a[136:139], a[252:255], a[68:71], a[136:139]
v_cvt_pk_bf16_f32 v69, v26, v27
s_waitcnt lgkmcnt(6)
v_mfma_f32_16x16x32_bf16 a[132:135], a[224:227], a[64:67], a[132:135]
ds_read_b64_tr_b16 a[252:253], v0 offset:20480
ds_read_b64_tr_b16 a[254:255], v0 offset:22528
v_mfma_f32_16x16x32_bf16 a[140:143], a[224:227], a[68:71], a[140:143]
v_accvgpr_read_b32 v24, a124
v_accvgpr_read_b32 v25, a125
v_mfma_f32_16x16x32_bf16 a[144:147], a[228:231], a[64:67], a[144:147]
ds_read_b64_tr_b16 a[224:225], v1 offset:20480
ds_read_b64_tr_b16 a[226:227], v1 offset:22528
v_mfma_f32_16x16x32_bf16 a[152:155], a[228:231], a[68:71], a[152:155]
v_accvgpr_read_b32 v26, a126
v_accvgpr_read_b32 v27, a127
v_mfma_f32_16x16x32_bf16 a[148:151], a[232:235], a[64:67], a[148:151]
ds_read_b64_tr_b16 a[228:229], v2 offset:20480
ds_read_b64_tr_b16 a[230:231], v2 offset:22528
v_mfma_f32_16x16x32_bf16 a[156:159], a[232:235], a[68:71], a[156:159]
v_cvt_pk_bf16_f32 v70, v24, v25
v_cvt_pk_bf16_f32 v71, v26, v27
v_mfma_f32_16x16x32_bf16 a[160:163], a[236:239], a[64:67], a[160:163]
ds_read_b64_tr_b16 a[232:233], v3 offset:20480
ds_read_b64_tr_b16 a[234:235], v3 offset:22528
v_mfma_f32_16x16x32_bf16 a[168:171], a[236:239], a[68:71], a[168:171]
v_accvgpr_read_b32 v72, a200
s_waitcnt lgkmcnt(6)
v_mfma_f32_16x16x32_bf16 a[164:167], a[240:243], a[64:67], a[164:167]
ds_read_b64_tr_b16 a[236:237], v0 offset:28672
ds_read_b64_tr_b16 a[238:239], v0 offset:30720
v_mfma_f32_16x16x32_bf16 a[172:175], a[240:243], a[68:71], a[172:175]
s_waitcnt vmcnt(7)
v_accvgpr_read_b32 v73, a201
v_mfma_f32_16x16x32_bf16 a[176:179], a[244:247], a[64:67], a[176:179]
ds_read_b64_tr_b16 a[240:241], v1 offset:28672
ds_read_b64_tr_b16 a[242:243], v1 offset:30720
v_mfma_f32_16x16x32_bf16 a[184:187], a[244:247], a[68:71], a[184:187]
buffer_load_dwordx4 v8, s[16:19], s35 offen offset:3072 nt lds
v_mfma_f32_16x16x32_bf16 a[180:183], a[248:251], a[64:67], a[180:183]
ds_read_b64_tr_b16 a[244:245], v2 offset:28672
ds_read_b64_tr_b16 a[246:247], v2 offset:30720
v_mfma_f32_16x16x32_bf16 a[188:191], a[248:251], a[68:71], a[188:191]
s_add_u32 m0, s4, 49152
s_add_u32 s5, s58, 768
v_mfma_f32_16x16x32_bf16 a[128:131], a[252:255], a[72:75], a[128:131]
ds_read_b64_tr_b16 a[248:249], v3 offset:28672
ds_read_b64_tr_b16 a[250:251], v3 offset:30720
v_mfma_f32_16x16x32_bf16 a[136:139], a[252:255], a[76:79], a[136:139]
v_accvgpr_read_b32 v74, a202
s_waitcnt lgkmcnt(6)
v_mfma_f32_16x16x32_bf16 a[132:135], a[224:227], a[72:75], a[132:135]
s_barrier
ds_read_b64_tr_b16 a[252:253], v0 offset:0
v_mfma_f32_16x16x32_bf16 a[140:143], a[224:227], a[76:79], a[140:143]
ds_read_b64_tr_b16 a[254:255], v0 offset:2048
v_accvgpr_read_b32 v75, a203
v_mfma_f32_16x16x32_bf16 a[144:147], a[228:231], a[72:75], a[144:147]
ds_read_b64_tr_b16 a[224:225], v1 offset:0
ds_read_b64_tr_b16 a[226:227], v1 offset:2048
v_mfma_f32_16x16x32_bf16 a[152:155], a[228:231], a[76:79], a[152:155]
buffer_load_dwordx4 v16, s[20:23], s5 offen lds
v_mfma_f32_16x16x32_bf16 a[148:151], a[232:235], a[72:75], a[148:151]
ds_read_b64_tr_b16 a[228:229], v2 offset:0
ds_read_b64_tr_b16 a[230:231], v2 offset:2048
v_mfma_f32_16x16x32_bf16 a[156:159], a[232:235], a[76:79], a[156:159]
s_add_u32 m0, s4, 32768
s_mov_b32 s35, 196736
v_mfma_f32_16x16x32_bf16 a[160:163], a[236:239], a[72:75], a[160:163]
ds_read_b64_tr_b16 a[232:233], v3 offset:0
ds_read_b64_tr_b16 a[234:235], v3 offset:2048
v_mfma_f32_16x16x32_bf16 a[168:171], a[236:239], a[76:79], a[168:171]
s_waitcnt vmcnt(6)
s_waitcnt lgkmcnt(6)
v_mfma_f32_16x16x32_bf16 a[164:167], a[240:243], a[72:75], a[164:167]
ds_read_b64_tr_b16 a[236:237], v0 offset:4096
ds_read_b64_tr_b16 a[238:239], v0 offset:6144
v_mfma_f32_16x16x32_bf16 a[172:175], a[240:243], a[76:79], a[172:175]
buffer_load_dwordx4 v8, s[16:19], s35 offen nt lds
v_mfma_f32_16x16x32_bf16 a[176:179], a[244:247], a[72:75], a[176:179]
ds_read_b64_tr_b16 a[240:241], v1 offset:4096
ds_read_b64_tr_b16 a[242:243], v1 offset:6144
v_mfma_f32_16x16x32_bf16 a[184:187], a[244:247], a[76:79], a[184:187]
s_add_u32 m0, s4, 49152
s_add_u32 s5, s58, 130816
v_mfma_f32_16x16x32_bf16 a[180:183], a[248:251], a[72:75], a[180:183]
ds_read_b64_tr_b16 a[244:245], v2 offset:4096
ds_read_b64_tr_b16 a[246:247], v2 offset:6144
v_mfma_f32_16x16x32_bf16 a[188:191], a[248:251], a[76:79], a[188:191]
buffer_load_dwordx4 v16, s[20:23], s5 offen offset:1024 lds
L_step_43:
v_mfma_f32_16x16x32_bf16 v[32:35], a[252:255], v[160:163], v[32:35]
ds_read_b64_tr_b16 a[248:249], v3 offset:4096
ds_read_b64_tr_b16 a[250:251], v3 offset:6144
v_mfma_f32_16x16x32_bf16 v[40:43], a[252:255], v[164:167], v[40:43]
s_add_u32 s5, s58, 31488
s_waitcnt lgkmcnt(6)
v_mfma_f32_16x16x32_bf16 v[36:39], a[224:227], v[160:163], v[36:39]
ds_read_b64_tr_b16 a[252:253], v0 offset:8192
ds_read_b64_tr_b16 a[254:255], v0 offset:10240
v_mfma_f32_16x16x32_bf16 v[44:47], a[224:227], v[164:167], v[44:47]
buffer_load_dwordx4 v16, s[20:23], s5 offen offset:2048 lds
v_mfma_f32_16x16x32_bf16 v[48:51], a[228:231], v[160:163], v[48:51]
ds_read_b64_tr_b16 a[224:225], v1 offset:8192
L_pg9:
s_cbranch_scc1 L_pg13
ds_read_b64_tr_b16 a[226:227], v1 offset:10240
v_mfma_f32_16x16x32_bf16 v[56:59], a[228:231], v[164:167], v[56:59]
s_add_u32 m0, s4, 32768
v_accvgpr_read_b32 v76, a204
v_mfma_f32_16x16x32_bf16 v[52:55], a[232:235], v[160:163], v[52:55]
ds_read_b64_tr_b16 a[228:229], v2 offset:8192
ds_read_b64_tr_b16 a[230:231], v2 offset:10240
v_mfma_f32_16x16x32_bf16 v[60:63], a[232:235], v[164:167], v[60:63]
v_accvgpr_read_b32 v77, a205
v_accvgpr_read_b32 v78, a206
v_mfma_f32_16x16x32_bf16 v[32:35], a[236:239], v[168:171], v[32:35]
ds_read_b64_tr_b16 a[232:233], v3 offset:8192
ds_read_b64_tr_b16 a[234:235], v3 offset:10240
v_mfma_f32_16x16x32_bf16 v[40:43], a[236:239], v[172:175], v[40:43]
s_waitcnt vmcnt(6)
s_waitcnt lgkmcnt(6)
v_mfma_f32_16x16x32_bf16 v[36:39], a[240:243], v[168:171], v[36:39]
ds_read_b64_tr_b16 a[236:237], v0 offset:12288
ds_read_b64_tr_b16 a[238:239], v0 offset:14336
v_mfma_f32_16x16x32_bf16 v[44:47], a[240:243], v[172:175], v[44:47]
buffer_load_dwordx4 v8, s[16:19], s35 offen offset:1024 nt lds
v_mfma_f32_16x16x32_bf16 v[48:51], a[244:247], v[168:171], v[48:51]
ds_read_b64_tr_b16 a[240:241], v1 offset:12288
ds_read_b64_tr_b16 a[242:243], v1 offset:14336
v_mfma_f32_16x16x32_bf16 v[56:59], a[244:247], v[172:175], v[56:59]
s_add_u32 m0, s4, 49152
s_add_u32 s5, s58, 161536
v_mfma_f32_16x16x32_bf16 v[52:55], a[248:251], v[168:171], v[52:55]
ds_read_b64_tr_b16 a[244:245], v2 offset:12288
ds_read_b64_tr_b16 a[246:247], v2 offset:14336
v_mfma_f32_16x16x32_bf16 v[60:63], a[248:251], v[172:175], v[60:63]
buffer_load_dwordx4 v16, s[20:23], s5 offen offset:3072 lds
v_mfma_f32_16x16x32_bf16 v[32:35], a[252:255], v[176:179], v[32:35]
ds_read_b64_tr_b16 a[248:249], v3 offset:12288
ds_read_b64_tr_b16 a[250:251], v3 offset:14336
v_mfma_f32_16x16x32_bf16 v[40:43], a[252:255], v[180:183], v[40:43]
v_add_u32 v0, 0xc000, v0
s_waitcnt lgkmcnt(6)
v_mfma_f32_16x16x32_bf16 v[36:39], a[224:227], v[176:179], v[36:39]
s_barrier
ds_read_b64_tr_b16 a[252:253], v0 offset:49152
v_mfma_f32_16x16x32_bf16 v[44:47], a[224:227], v[180:183], v[44:47]
ds_read_b64_tr_b16 a[254:255], v0 offset:51200
v_add_u32 v1, 0xc000, v1
v_mfma_f32_16x16x32_bf16 v[48:51], a[228:231], v[176:179], v[48:51]
ds_read_b64_tr_b16 a[224:225], v1 offset:49152
ds_read_b64_tr_b16 a[226:227], v1 offset:51200
v_mfma_f32_16x16x32_bf16 v[56:59], a[228:231], v[180:183], v[56:59]
v_add_u32 v2, 0xc000, v2
v_add_u32 v3, 0xc000, v3
v_mfma_f32_16x16x32_bf16 v[52:55], a[232:235], v[176:179], v[52:55]
ds_read_b64_tr_b16 a[228:229], v2 offset:49152
ds_read_b64_tr_b16 a[230:231], v2 offset:51200
v_mfma_f32_16x16x32_bf16 v[60:63], a[232:235], v[180:183], v[60:63]
s_add_u32 m0, s4, 32768
s_waitcnt vmcnt(7)
v_mfma_f32_16x16x32_bf16 v[32:35], a[236:239], v[184:187], v[32:35]
ds_read_b64_tr_b16 a[232:233], v3 offset:49152
ds_read_b64_tr_b16 a[234:235], v3 offset:51200
v_mfma_f32_16x16x32_bf16 v[40:43], a[236:239], v[188:191], v[40:43]
v_accvgpr_read_b32 v79, a207
s_waitcnt lgkmcnt(6)
v_mfma_f32_16x16x32_bf16 v[36:39], a[240:243], v[184:187], v[36:39]
ds_read_b64_tr_b16 a[236:237], v0 offset:57344
ds_read_b64_tr_b16 a[238:239], v0 offset:59392
v_mfma_f32_16x16x32_bf16 v[44:47], a[240:243], v[188:191], v[44:47]
buffer_load_dwordx4 v8, s[16:19], s35 offen offset:2048 nt lds
v_mfma_f32_16x16x32_bf16 v[48:51], a[244:247], v[184:187], v[48:51]
ds_read_b64_tr_b16 a[240:241], v1 offset:57344
ds_read_b64_tr_b16 a[242:243], v1 offset:59392
v_mfma_f32_16x16x32_bf16 v[56:59], a[244:247], v[188:191], v[56:59]
v_accvgpr_read_b32 v80, a208
v_accvgpr_read_b32 v81, a209
v_mfma_f32_16x16x32_bf16 v[52:55], a[248:251], v[184:187], v[52:55]
ds_read_b64_tr_b16 a[244:245], v2 offset:57344
ds_read_b64_tr_b16 a[246:247], v2 offset:59392
v_mfma_f32_16x16x32_bf16 v[60:63], a[248:251], v[188:191], v[60:63]
v_accvgpr_read_b32 v82, a210
v_accvgpr_read_b32 v83, a211
L_step_44:
v_mfma_f32_16x16x32_bf16 a[128:131], a[252:255], a[80:83], a[128:131]
ds_read_b64_tr_b16 a[248:249], v3 offset:57344
ds_read_b64_tr_b16 a[250:251], v3 offset:59392
v_mfma_f32_16x16x32_bf16 a[136:139], a[252:255], a[84:87], a[136:139]
v_accvgpr_read_b32 v84, a212
s_waitcnt lgkmcnt(6)
v_mfma_f32_16x16x32_bf16 a[132:135], a[224:227], a[80:83], a[132:135]
ds_read_b64_tr_b16 a[252:253], v0 offset:53248
ds_read_b64_tr_b16 a[254:255], v0 offset:55296
v_mfma_f32_16x16x32_bf16 a[140:143], a[224:227], a[84:87], a[140:143]
v_accvgpr_read_b32 v85, a213
v_accvgpr_read_b32 v86, a214
v_mfma_f32_16x16x32_bf16 a[144:147], a[228:231], a[80:83], a[144:147]
ds_read_b64_tr_b16 a[224:225], v1 offset:53248
ds_read_b64_tr_b16 a[226:227], v1 offset:55296
v_mfma_f32_16x16x32_bf16 a[152:155], a[228:231], a[84:87], a[152:155]
s_waitcnt vmcnt(7)
v_accvgpr_read_b32 v87, a215
v_mfma_f32_16x16x32_bf16 a[148:151], a[232:235], a[80:83], a[148:151]
ds_read_b64_tr_b16 a[228:229], v2 offset:53248
ds_read_b64_tr_b16 a[230:231], v2 offset:55296
v_mfma_f32_16x16x32_bf16 a[156:159], a[232:235], a[84:87], a[156:159]
buffer_load_dwordx4 v8, s[16:19], s35 offen offset:3072 nt lds
v_mfma_f32_16x16x32_bf16 a[160:163], a[236:239], a[80:83], a[160:163]
ds_read_b64_tr_b16 a[232:233], v3 offset:53248
ds_read_b64_tr_b16 a[234:235], v3 offset:55296
v_mfma_f32_16x16x32_bf16 a[168:171], a[236:239], a[84:87], a[168:171]
v_accvgpr_read_b32 v88, a216
s_waitcnt lgkmcnt(6)
v_mfma_f32_16x16x32_bf16 a[164:167], a[240:243], a[80:83], a[164:167]
ds_read_b64_tr_b16 a[236:237], v0 offset:61440
ds_read_b64_tr_b16 a[238:239], v0 offset:63488
v_mfma_f32_16x16x32_bf16 a[172:175], a[240:243], a[84:87], a[172:175]
v_accvgpr_read_b32 v89, a217
v_accvgpr_read_b32 v90, a218
v_mfma_f32_16x16x32_bf16 a[176:179], a[244:247], a[80:83], a[176:179]
ds_read_b64_tr_b16 a[240:241], v1 offset:61440
ds_read_b64_tr_b16 a[242:243], v1 offset:63488
v_mfma_f32_16x16x32_bf16 a[184:187], a[244:247], a[84:87], a[184:187]
v_accvgpr_read_b32 v91, a219
v_accvgpr_read_b32 v92, a220
v_mfma_f32_16x16x32_bf16 a[180:183], a[248:251], a[80:83], a[180:183]
ds_read_b64_tr_b16 a[244:245], v2 offset:61440
ds_read_b64_tr_b16 a[246:247], v2 offset:63488
v_mfma_f32_16x16x32_bf16 a[188:191], a[248:251], a[84:87], a[188:191]
s_add_u32 m0, s4, 16384
s_mov_b32 s35, 256
v_mfma_f32_16x16x32_bf16 a[128:131], a[252:255], a[88:91], a[128:131]
ds_read_b64_tr_b16 a[248:249], v3 offset:61440
ds_read_b64_tr_b16 a[250:251], v3 offset:63488
v_mfma_f32_16x16x32_bf16 a[136:139], a[252:255], a[92:95], a[136:139]
v_accvgpr_read_b32 v93, a221
s_waitcnt lgkmcnt(6)
v_mfma_f32_16x16x32_bf16 a[132:135], a[224:227], a[88:91], a[132:135]
s_barrier
ds_read_b64_tr_b16 a[252:253], v0 offset:32768
v_mfma_f32_16x16x32_bf16 a[140:143], a[224:227], a[92:95], a[140:143]
ds_read_b64_tr_b16 a[254:255], v0 offset:34816
v_accvgpr_read_b32 v94, a222
v_mfma_f32_16x16x32_bf16 a[144:147], a[228:231], a[88:91], a[144:147]
ds_read_b64_tr_b16 a[224:225], v1 offset:32768
ds_read_b64_tr_b16 a[226:227], v1 offset:34816
v_mfma_f32_16x16x32_bf16 a[152:155], a[228:231], a[92:95], a[152:155]
s_waitcnt vmcnt(6)
v_accvgpr_read_b32 v95, a223
v_mfma_f32_16x16x32_bf16 a[148:151], a[232:235], a[88:91], a[148:151]
ds_read_b64_tr_b16 a[228:229], v2 offset:32768
ds_read_b64_tr_b16 a[230:231], v2 offset:34816
v_mfma_f32_16x16x32_bf16 a[156:159], a[232:235], a[92:95], a[156:159]
buffer_load_dwordx4 v8, s[16:19], s35 offen nt lds
v_mfma_f32_16x16x32_bf16 a[160:163], a[236:239], a[88:91], a[160:163]
ds_read_b64_tr_b16 a[232:233], v3 offset:32768
ds_read_b64_tr_b16 a[234:235], v3 offset:34816
v_mfma_f32_16x16x32_bf16 a[168:171], a[236:239], a[92:95], a[168:171]
s_add_u32 m0, s4, 0
s_waitcnt lgkmcnt(6)
v_mfma_f32_16x16x32_bf16 a[164:167], a[240:243], a[88:91], a[164:167]
ds_read_b64_tr_b16 a[236:237], v0 offset:36864
ds_read_b64_tr_b16 a[238:239], v0 offset:38912
v_mfma_f32_16x16x32_bf16 a[172:175], a[240:243], a[92:95], a[172:175]
s_mov_b32 s5, 0
buffer_load_dwordx4 v9, s[24:27], s5 offen lds
v_mfma_f32_16x16x32_bf16 a[176:179], a[244:247], a[88:91], a[176:179]
ds_read_b64_tr_b16 a[240:241], v1 offset:36864
v_mfma_f32_16x16x32_bf16 a[184:187], a[244:247], a[92:95], a[184:187]
ds_read_b64_tr_b16 a[242:243], v1 offset:38912
s_mov_b32 s5, 6144
v_mfma_f32_16x16x32_bf16 a[180:183], a[248:251], a[88:91], a[180:183]
ds_read_b64_tr_b16 a[244:245], v2 offset:36864
ds_read_b64_tr_b16 a[246:247], v2 offset:38912
v_mfma_f32_16x16x32_bf16 a[188:191], a[248:251], a[92:95], a[188:191]
buffer_load_dwordx4 v9, s[24:27], s5 offen offset:1024 lds
L_step_45:
v_mfma_f32_16x16x32_bf16 v[32:35], a[252:255], v[192:195], v[32:35]
ds_read_b64_tr_b16 a[248:249], v3 offset:36864
ds_read_b64_tr_b16 a[250:251], v3 offset:38912
v_mfma_f32_16x16x32_bf16 v[40:43], a[252:255], v[196:199], v[40:43]
s_add_u32 m0, s4, 16384
s_waitcnt lgkmcnt(6)
v_mfma_f32_16x16x32_bf16 v[36:39], a[224:227], v[192:195], v[36:39]
ds_read_b64_tr_b16 a[252:253], v0 offset:40960
v_mfma_f32_16x16x32_bf16 v[44:47], a[224:227], v[196:199], v[44:47]
ds_read_b64_tr_b16 a[254:255], v0 offset:43008
s_waitcnt vmcnt(6)
v_mfma_f32_16x16x32_bf16 v[48:51], a[228:231], v[192:195], v[48:51]
ds_read_b64_tr_b16 a[224:225], v1 offset:40960
ds_read_b64_tr_b16 a[226:227], v1 offset:43008
v_mfma_f32_16x16x32_bf16 v[56:59], a[228:231], v[196:199], v[56:59]
buffer_load_dwordx4 v8, s[16:19], s35 offen offset:1024 nt lds
v_mfma_f32_16x16x32_bf16 v[52:55], a[232:235], v[192:195], v[52:55]
ds_read_b64_tr_b16 a[228:229], v2 offset:40960
ds_read_b64_tr_b16 a[230:231], v2 offset:43008
v_mfma_f32_16x16x32_bf16 v[60:63], a[232:235], v[196:199], v[60:63]
s_add_u32 m0, s4, 0
s_mov_b32 s5, 12288
v_mfma_f32_16x16x32_bf16 v[32:35], a[236:239], v[200:203], v[32:35]
ds_read_b64_tr_b16 a[232:233], v3 offset:40960
ds_read_b64_tr_b16 a[234:235], v3 offset:43008
v_mfma_f32_16x16x32_bf16 v[40:43], a[236:239], v[204:207], v[40:43]
buffer_load_dwordx4 v9, s[24:27], s5 offen offset:2048 lds
s_waitcnt lgkmcnt(6)
v_mfma_f32_16x16x32_bf16 v[36:39], a[240:243], v[200:203], v[36:39]
ds_read_b64_tr_b16 a[236:237], v0 offset:45056
v_mfma_f32_16x16x32_bf16 v[44:47], a[240:243], v[204:207], v[44:47]
ds_read_b64_tr_b16 a[238:239], v0 offset:47104
s_mov_b32 s5, 18432
v_mfma_f32_16x16x32_bf16 v[48:51], a[244:247], v[200:203], v[48:51]
ds_read_b64_tr_b16 a[240:241], v1 offset:45056
ds_read_b64_tr_b16 a[242:243], v1 offset:47104
v_mfma_f32_16x16x32_bf16 v[56:59], a[244:247], v[204:207], v[56:59]
buffer_load_dwordx4 v9, s[24:27], s5 offen offset:3072 lds
v_mfma_f32_16x16x32_bf16 v[52:55], a[248:251], v[200:203], v[52:55]
ds_read_b64_tr_b16 a[244:245], v2 offset:45056
v_mfma_f32_16x16x32_bf16 v[60:63], a[248:251], v[204:207], v[60:63]
ds_read_b64_tr_b16 a[246:247], v2 offset:47104
s_add_u32 m0, s4, 16384
v_mfma_f32_16x16x32_bf16 v[32:35], a[252:255], v[208:211], v[32:35]
ds_read_b64_tr_b16 a[248:249], v3 offset:45056
v_mfma_f32_16x16x32_bf16 v[40:43], a[252:255], v[212:215], v[40:43]
ds_read_b64_tr_b16 a[250:251], v3 offset:47104
s_waitcnt lgkmcnt(6)
v_mfma_f32_16x16x32_bf16 v[36:39], a[224:227], v[208:211], v[36:39]
s_waitcnt vmcnt(7)
v_mfma_f32_16x16x32_bf16 v[44:47], a[224:227], v[212:215], v[44:47]
buffer_load_dwordx4 v8, s[16:19], s35 offen offset:2048 nt lds
v_mfma_f32_16x16x32_bf16 v[48:51], a[228:231], v[208:211], v[48:51]
s_barrier
v_mfma_f32_16x16x32_bf16 v[56:59], a[228:231], v[212:215], v[56:59]
ds_read_b64_tr_b16 a[224:225], v0 offset:0
ds_read_b64_tr_b16 a[226:227], v0 offset:2048
v_mfma_f32_16x16x32_bf16 v[52:55], a[232:235], v[208:211], v[52:55]
ds_read_b64_tr_b16 a[228:229], v1 offset:0
v_mfma_f32_16x16x32_bf16 v[60:63], a[232:235], v[212:215], v[60:63]
ds_read_b64_tr_b16 a[230:231], v1 offset:2048
v_mfma_f32_16x16x32_bf16 v[32:35], a[236:239], v[216:219], v[32:35]
ds_read_b64_tr_b16 a[232:233], v0 offset:4096
v_mfma_f32_16x16x32_bf16 v[40:43], a[236:239], v[220:223], v[40:43]
ds_read_b64_tr_b16 a[234:235], v0 offset:6144
s_waitcnt lgkmcnt(6)
v_mfma_f32_16x16x32_bf16 v[36:39], a[240:243], v[216:219], v[36:39]
ds_read_b64_tr_b16 a[236:237], v1 offset:4096
v_mfma_f32_16x16x32_bf16 v[44:47], a[240:243], v[220:223], v[44:47]
ds_read_b64_tr_b16 a[238:239], v1 offset:6144
v_mfma_f32_16x16x32_bf16 v[48:51], a[244:247], v[216:219], v[48:51]
ds_read_b64_tr_b16 a[240:241], v2 offset:0
v_mfma_f32_16x16x32_bf16 v[56:59], a[244:247], v[220:223], v[56:59]
ds_read_b64_tr_b16 a[242:243], v2 offset:2048
v_mfma_f32_16x16x32_bf16 v[52:55], a[248:251], v[216:219], v[52:55]
ds_read_b64_tr_b16 a[244:245], v3 offset:0
v_mfma_f32_16x16x32_bf16 v[60:63], a[248:251], v[220:223], v[60:63]
ds_read_b64_tr_b16 a[246:247], v3 offset:2048
v_mfma_f32_16x16x32_bf16 v[112:115], v[10:13], v[248:251], v[112:115]
ds_read_b64_tr_b16 a[248:249], v2 offset:4096
ds_read_b64_tr_b16 a[250:251], v2 offset:6144
v_mfma_f32_16x16x32_bf16 v[120:123], v[10:13], v[252:255], v[120:123]
s_waitcnt vmcnt(7)
L_step_46:
s_waitcnt lgkmcnt(6)
v_mfma_f32_16x16x32_bf16 a[128:131], a[224:227], a[96:99], a[128:131]
ds_read_b64_tr_b16 a[252:253], v3 offset:4096
ds_read_b64_tr_b16 a[254:255], v3 offset:6144
v_mfma_f32_16x16x32_bf16 a[136:139], a[224:227], a[100:103], a[136:139]
buffer_load_dwordx4 v8, s[16:19], s35 offen offset:3072 nt lds
v_mfma_f32_16x16x32_bf16 a[132:135], a[228:231], a[96:99], a[132:135]
ds_read_b64_tr_b16 a[224:225], v0 offset:8192
ds_read_b64_tr_b16 a[226:227], v0 offset:10240
v_mfma_f32_16x16x32_bf16 a[140:143], a[228:231], a[100:103], a[140:143]
v_rcp_f32 v14, v112
v_mfma_f32_16x16x32_bf16 a[128:131], a[232:235], a[104:107], a[128:131]
ds_read_b64_tr_b16 a[228:229], v1 offset:8192
ds_read_b64_tr_b16 a[230:231], v1 offset:10240
v_mfma_f32_16x16x32_bf16 a[136:139], a[232:235], a[108:111], a[136:139]
v_rcp_f32 v15, v120
v_mfma_f32_16x16x32_bf16 a[132:135], a[236:239], a[104:107], a[132:135]
ds_read_b64_tr_b16 a[232:233], v0 offset:12288
ds_read_b64_tr_b16 a[234:235], v0 offset:14336
v_mfma_f32_16x16x32_bf16 a[140:143], a[236:239], a[108:111], a[140:143]
v_add_u32 v0, 0x8000, v0
s_waitcnt lgkmcnt(6)
v_mfma_f32_16x16x32_bf16 a[144:147], a[240:243], a[96:99], a[144:147]
ds_read_b64_tr_b16 a[236:237], v1 offset:12288
ds_read_b64_tr_b16 a[238:239], v1 offset:14336
v_mfma_f32_16x16x32_bf16 a[152:155], a[240:243], a[100:103], a[152:155]
v_add_u32 v1, 0x8000, v1
s_add_u32 m0, s4, 98304
v_mfma_f32_16x16x32_bf16 a[148:151], a[244:247], a[96:99], a[148:151]
ds_read_b64_tr_b16 a[240:241], v2 offset:8192
ds_read_b64_tr_b16 a[242:243], v2 offset:10240
v_mfma_f32_16x16x32_bf16 a[156:159], a[244:247], a[100:103], a[156:159]
s_mov_b32 s35, 65792
v_accvgpr_read_b32 v10, a128
v_mfma_f32_16x16x32_bf16 a[144:147], a[248:251], a[104:107], a[144:147]
ds_read_b64_tr_b16 a[244:245], v3 offset:8192
ds_read_b64_tr_b16 a[246:247], v3 offset:10240
v_mfma_f32_16x16x32_bf16 a[152:155], a[248:251], a[108:111], a[152:155]
s_waitcnt vmcnt(7)
v_accvgpr_read_b32 v11, a129
v_mfma_f32_16x16x32_bf16 a[148:151], a[252:255], a[104:107], a[148:151]
ds_read_b64_tr_b16 a[248:249], v2 offset:12288
ds_read_b64_tr_b16 a[250:251], v2 offset:14336
v_mfma_f32_16x16x32_bf16 a[156:159], a[252:255], a[108:111], a[156:159]
v_add_u32 v2, 0x8000, v2
s_waitcnt lgkmcnt(6)
v_mfma_f32_16x16x32_bf16 a[160:163], a[224:227], a[96:99], a[160:163]
ds_read_b64_tr_b16 a[252:253], v3 offset:12288
ds_read_b64_tr_b16 a[254:255], v3 offset:14336
v_mfma_f32_16x16x32_bf16 a[168:171], a[224:227], a[100:103], a[168:171]
buffer_load_dwordx4 v8, s[16:19], s35 offen nt lds
v_mfma_f32_16x16x32_bf16 a[164:167], a[228:231], a[96:99], a[164:167]
s_barrier
ds_read_b64_tr_b16 a[224:225], v0 offset:49152
v_mfma_f32_16x16x32_bf16 a[172:175], a[228:231], a[100:103], a[172:175]
ds_read_b64_tr_b16 a[226:227], v0 offset:51200
s_add_u32 m0, s4, 81920
v_mfma_f32_16x16x32_bf16 a[160:163], a[232:235], a[104:107], a[160:163]
ds_read_b64_tr_b16 a[228:229], v1 offset:49152
ds_read_b64_tr_b16 a[230:231], v1 offset:51200
v_mfma_f32_16x16x32_bf16 a[168:171], a[232:235], a[108:111], a[168:171]
s_mov_b32 s5, 256
v_add_u32 v3, 0x8000, v3
v_mfma_f32_16x16x32_bf16 a[164:167], a[236:239], a[104:107], a[164:167]
ds_read_b64_tr_b16 a[232:233], v0 offset:53248
ds_read_b64_tr_b16 a[234:235], v0 offset:55296
v_mfma_f32_16x16x32_bf16 a[172:175], a[236:239], a[108:111], a[172:175]
v_accvgpr_read_b32 v12, a130
s_waitcnt lgkmcnt(6)
v_mfma_f32_16x16x32_bf16 a[176:179], a[240:243], a[96:99], a[176:179]
ds_read_b64_tr_b16 a[236:237], v1 offset:53248
ds_read_b64_tr_b16 a[238:239], v1 offset:55296
v_mfma_f32_16x16x32_bf16 a[184:187], a[240:243], a[100:103], a[184:187]
buffer_load_dwordx4 v9, s[24:27], s5 offen lds
v_mfma_f32_16x16x32_bf16 a[180:183], a[244:247], a[96:99], a[180:183]
ds_read_b64_tr_b16 a[240:241], v0 offset:57344
ds_read_b64_tr_b16 a[242:243], v0 offset:59392
v_mfma_f32_16x16x32_bf16 a[188:191], a[244:247], a[100:103], a[188:191]
s_add_u32 m0, s4, 98304
s_waitcnt vmcnt(6)
v_mfma_f32_16x16x32_bf16 a[176:179], a[248:251], a[104:107], a[176:179]
ds_read_b64_tr_b16 a[244:245], v1 offset:57344
ds_read_b64_tr_b16 a[246:247], v1 offset:59392
v_mfma_f32_16x16x32_bf16 a[184:187], a[248:251], a[108:111], a[184:187]
buffer_load_dwordx4 v8, s[16:19], s35 offen offset:1024 nt lds
v_mfma_f32_16x16x32_bf16 a[180:183], a[252:255], a[104:107], a[180:183]
ds_read_b64_tr_b16 a[248:249], v0 offset:61440
ds_read_b64_tr_b16 a[250:251], v0 offset:63488
v_mfma_f32_16x16x32_bf16 a[188:191], a[252:255], a[108:111], a[188:191]
s_add_u32 m0, s4, 81920
L_step_47:
s_waitcnt lgkmcnt(6)
v_mfma_f32_16x16x32_bf16 v[32:35], a[224:227], v[224:227], v[32:35]
ds_read_b64_tr_b16 a[252:253], v1 offset:61440
ds_read_b64_tr_b16 a[254:255], v1 offset:63488
v_mfma_f32_16x16x32_bf16 v[40:43], a[224:227], v[228:231], v[40:43]
s_mov_b32 s5, 6400
buffer_load_dwordx4 v9, s[24:27], s5 offen offset:1024 lds
v_mfma_f32_16x16x32_bf16 v[36:39], a[228:231], v[224:227], v[36:39]
ds_read_b64_tr_b16 a[224:225], v2 offset:49152
ds_read_b64_tr_b16 a[226:227], v2 offset:51200
v_mfma_f32_16x16x32_bf16 v[44:47], a[228:231], v[228:231], v[44:47]
s_mov_b32 s5, 12544
v_add_u32 v0, 0xfffec000, v0
v_mfma_f32_16x16x32_bf16 v[32:35], a[232:235], v[232:235], v[32:35]
ds_read_b64_tr_b16 a[228:229], v3 offset:49152
ds_read_b64_tr_b16 a[230:231], v3 offset:51200
v_mfma_f32_16x16x32_bf16 v[40:43], a[232:235], v[236:239], v[40:43]
buffer_load_dwordx4 v9, s[24:27], s5 offen offset:2048 lds
v_mfma_f32_16x16x32_bf16 v[36:39], a[236:239], v[232:235], v[36:39]
ds_read_b64_tr_b16 a[232:233], v2 offset:53248
ds_read_b64_tr_b16 a[234:235], v2 offset:55296
v_mfma_f32_16x16x32_bf16 v[44:47], a[236:239], v[236:239], v[44:47]
s_mov_b32 s5, 18688
s_waitcnt lgkmcnt(6)
v_mfma_f32_16x16x32_bf16 v[32:35], a[240:243], v[240:243], v[32:35]
ds_read_b64_tr_b16 a[236:237], v3 offset:53248
ds_read_b64_tr_b16 a[238:239], v3 offset:55296
v_mfma_f32_16x16x32_bf16 v[40:43], a[240:243], v[244:247], v[40:43]
buffer_load_dwordx4 v9, s[24:27], s5 offen offset:3072 lds
v_mfma_f32_16x16x32_bf16 v[36:39], a[244:247], v[240:243], v[36:39]
ds_read_b64_tr_b16 a[240:241], v2 offset:57344
ds_read_b64_tr_b16 a[242:243], v2 offset:59392
v_mfma_f32_16x16x32_bf16 v[44:47], a[244:247], v[244:247], v[44:47]
s_add_u32 m0, s4, 98304
s_waitcnt vmcnt(7)
v_mfma_f32_16x16x32_bf16 v[32:35], a[248:251], v[248:251], v[32:35]
ds_read_b64_tr_b16 a[244:245], v3 offset:57344
ds_read_b64_tr_b16 a[246:247], v3 offset:59392
v_mfma_f32_16x16x32_bf16 v[40:43], a[248:251], v[252:255], v[40:43]
buffer_load_dwordx4 v8, s[16:19], s35 offen offset:2048 nt lds
v_mfma_f32_16x16x32_bf16 v[36:39], a[252:255], v[248:251], v[36:39]
ds_read_b64_tr_b16 a[248:249], v2 offset:61440
ds_read_b64_tr_b16 a[250:251], v2 offset:63488
v_mfma_f32_16x16x32_bf16 v[44:47], a[252:255], v[252:255], v[44:47]
v_add_u32 v1, 0xfffec000, v1
s_waitcnt lgkmcnt(6)
v_mfma_f32_16x16x32_bf16 v[48:51], a[224:227], v[224:227], v[48:51]
ds_read_b64_tr_b16 a[252:253], v3 offset:61440
ds_read_b64_tr_b16 a[254:255], v3 offset:63488
v_mfma_f32_16x16x32_bf16 v[56:59], a[224:227], v[228:231], v[56:59]
v_add_u32 v2, 0xfffec000, v2
v_add_u32 v3, 0xfffec000, v3
v_mfma_f32_16x16x32_bf16 v[52:55], a[228:231], v[224:227], v[52:55]
s_barrier
ds_read_b64_tr_b16 a[224:225], v0 offset:0
ds_read_b64_tr_b16 a[226:227], v0 offset:2048
v_mfma_f32_16x16x32_bf16 v[60:63], a[228:231], v[228:231], v[60:63]
v_mul_f32 v32, v32, v14
v_mul_f32 v33, v33, v14
v_mul_f32 v34, v34, v14
v_mfma_f32_16x16x32_bf16 v[48:51], a[232:235], v[232:235], v[48:51]
ds_read_b64_tr_b16 a[228:229], v1 offset:0
ds_read_b64_tr_b16 a[230:231], v1 offset:2048
v_mul_f32 v35, v35, v14
v_mfma_f32_16x16x32_bf16 v[56:59], a[232:235], v[236:239], v[56:59]
v_cvt_pk_bf16_f32 v16, v32, v33
v_mul_f32 v36, v36, v14
v_mul_f32 v37, v37, v14
v_mfma_f32_16x16x32_bf16 v[52:55], a[236:239], v[232:235], v[52:55]
ds_read_b64_tr_b16 a[232:233], v2 offset:0
ds_read_b64_tr_b16 a[234:235], v2 offset:2048
v_cvt_pk_bf16_f32 v17, v34, v35
v_mfma_f32_16x16x32_bf16 v[60:63], a[236:239], v[236:239], v[60:63]
v_mul_f32 v38, v38, v14
v_mul_f32 v39, v39, v14
s_waitcnt lgkmcnt(6)
v_mfma_f32_16x16x32_bf16 v[48:51], a[240:243], v[240:243], v[48:51]
ds_read_b64_tr_b16 a[236:237], v3 offset:0
ds_read_b64_tr_b16 a[238:239], v3 offset:2048
s_waitcnt vmcnt(7)
v_mfma_f32_16x16x32_bf16 v[56:59], a[240:243], v[244:247], v[56:59]
buffer_load_dwordx4 v8, s[16:19], s35 offen offset:3072 nt lds
v_cvt_pk_bf16_f32 v18, v36, v37
v_mfma_f32_16x16x32_bf16 v[52:55], a[244:247], v[240:243], v[52:55]
ds_read_b64_tr_b16 a[240:241], v0 offset:8192
ds_read_b64_tr_b16 a[242:243], v0 offset:10240
v_cvt_pk_bf16_f32 v19, v38, v39
v_mfma_f32_16x16x32_bf16 v[60:63], a[244:247], v[244:247], v[60:63]
v_mul_f32 v40, v40, v15
v_mul_f32 v41, v41, v15
v_mul_f32 v42, v42, v15
v_mul_f32 v43, v43, v15
v_mfma_f32_16x16x32_bf16 v[48:51], a[248:251], v[248:251], v[48:51]
ds_read_b64_tr_b16 a[244:245], v1 offset:8192
ds_read_b64_tr_b16 a[246:247], v1 offset:10240
v_cvt_pk_bf16_f32 v20, v40, v41
v_mfma_f32_16x16x32_bf16 v[56:59], a[248:251], v[252:255], v[56:59]
v_mul_f32 v44, v44, v15
v_mul_f32 v45, v45, v15
v_cvt_pk_bf16_f32 v21, v42, v43
v_mfma_f32_16x16x32_bf16 v[52:55], a[252:255], v[248:251], v[52:55]
ds_read_b64_tr_b16 a[248:249], v2 offset:8192
ds_read_b64_tr_b16 a[250:251], v2 offset:10240
v_mul_f32 v46, v46, v15
v_mfma_f32_16x16x32_bf16 v[60:63], a[252:255], v[252:255], v[60:63]
v_mul_f32 v47, v47, v15
v_cvt_pk_bf16_f32 v22, v44, v45
v_cvt_pk_bf16_f32 v23, v46, v47
L_step_48:
s_waitcnt lgkmcnt(6)
v_mfma_f32_16x16x32_bf16 a[0:3], a[224:227], v[16:19], 0
ds_read_b64_tr_b16 a[252:253], v3 offset:8192
ds_read_b64_tr_b16 a[254:255], v3 offset:10240
v_mfma_f32_16x16x32_bf16 a[8:11], a[224:227], v[20:23], 0
s_add_u32 m0, s4, 49152
s_mov_b32 s35, 131328
v_mfma_f32_16x16x32_bf16 a[4:7], a[228:231], v[16:19], 0
ds_read_b64_tr_b16 a[224:225], v0 offset:4096
ds_read_b64_tr_b16 a[226:227], v0 offset:6144
v_mul_f32 v48, v48, v14
v_mfma_f32_16x16x32_bf16 a[12:15], a[228:231], v[20:23], 0
v_mul_f32 v49, v49, v14
v_mul_f32 v50, v50, v14
v_mul_f32 v51, v51, v14
v_mfma_f32_16x16x32_bf16 a[16:19], a[232:235], v[16:19], 0
ds_read_b64_tr_b16 a[228:229], v1 offset:4096
ds_read_b64_tr_b16 a[230:231], v1 offset:6144
v_cvt_pk_bf16_f32 v24, v48, v49
v_mfma_f32_16x16x32_bf16 a[24:27], a[232:235], v[20:23], 0
v_mul_f32 v52, v52, v14
v_mul_f32 v53, v53, v14
v_cvt_pk_bf16_f32 v25, v50, v51
v_mfma_f32_16x16x32_bf16 a[20:23], a[236:239], v[16:19], 0
ds_read_b64_tr_b16 a[232:233], v2 offset:4096
ds_read_b64_tr_b16 a[234:235], v2 offset:6144
s_waitcnt vmcnt(7)
v_mfma_f32_16x16x32_bf16 a[28:31], a[236:239], v[20:23], 0
buffer_load_dwordx4 v8, s[16:19], s35 offen nt lds
s_waitcnt lgkmcnt(6)
v_mfma_f32_16x16x32_bf16 a[32:35], a[240:243], v[16:19], 0
ds_read_b64_tr_b16 a[236:237], v3 offset:4096
ds_read_b64_tr_b16 a[238:239], v3 offset:6144
v_mul_f32 v54, v54, v14
v_mfma_f32_16x16x32_bf16 a[40:43], a[240:243], v[20:23], 0
v_mul_f32 v55, v55, v14
v_cvt_pk_bf16_f32 v26, v52, v53
v_cvt_pk_bf16_f32 v27, v54, v55
v_mfma_f32_16x16x32_bf16 a[36:39], a[244:247], v[16:19], 0
ds_read_b64_tr_b16 a[240:241], v0 offset:12288
ds_read_b64_tr_b16 a[242:243], v0 offset:14336
v_mul_f32 v56, v56, v15
v_mfma_f32_16x16x32_bf16 a[44:47], a[244:247], v[20:23], 0
v_mul_f32 v57, v57, v15
v_mul_f32 v58, v58, v15
v_mul_f32 v59, v59, v15
v_mfma_f32_16x16x32_bf16 a[48:51], a[248:251], v[16:19], 0
ds_read_b64_tr_b16 a[244:245], v1 offset:12288
ds_read_b64_tr_b16 a[246:247], v1 offset:14336
v_cvt_pk_bf16_f32 v28, v56, v57
v_mfma_f32_16x16x32_bf16 a[56:59], a[248:251], v[20:23], 0
v_mul_f32 v60, v60, v15
v_mul_f32 v61, v61, v15
v_cvt_pk_bf16_f32 v29, v58, v59
v_mfma_f32_16x16x32_bf16 a[52:55], a[252:255], v[16:19], 0
ds_read_b64_tr_b16 a[248:249], v2 offset:12288
ds_read_b64_tr_b16 a[250:251], v2 offset:14336
v_mul_f32 v62, v62, v15
v_mfma_f32_16x16x32_bf16 a[60:63], a[252:255], v[20:23], 0
v_mul_f32 v63, v63, v15
v_cvt_pk_bf16_f32 v30, v60, v61
v_cvt_pk_bf16_f32 v31, v62, v63
s_waitcnt lgkmcnt(6)
v_mfma_f32_16x16x32_bf16 a[0:3], a[224:227], v[24:27], a[0:3]
ds_read_b64_tr_b16 a[252:253], v3 offset:12288
ds_read_b64_tr_b16 a[254:255], v3 offset:14336
v_mfma_f32_16x16x32_bf16 a[8:11], a[224:227], v[28:31], a[8:11]
v_add_u32 v0, 0x10000, v0
v_add_u32 v1, 0x10000, v1
v_mfma_f32_16x16x32_bf16 a[4:7], a[228:231], v[24:27], a[4:7]
s_barrier
ds_read_b64_tr_b16 a[224:225], v0 offset:49152
v_mfma_f32_16x16x32_bf16 a[12:15], a[228:231], v[28:31], a[12:15]
ds_read_b64_tr_b16 a[226:227], v0 offset:51200
v_add_u32 v2, 0x10000, v2
v_mfma_f32_16x16x32_bf16 a[16:19], a[232:235], v[24:27], a[16:19]
ds_read_b64_tr_b16 a[228:229], v1 offset:49152
ds_read_b64_tr_b16 a[230:231], v1 offset:51200
v_mfma_f32_16x16x32_bf16 a[24:27], a[232:235], v[28:31], a[24:27]
v_add_u32 v3, 0x10000, v3
s_add_u32 m0, s4, 131072
v_mfma_f32_16x16x32_bf16 a[20:23], a[236:239], v[24:27], a[20:23]
ds_read_b64_tr_b16 a[232:233], v2 offset:49152
ds_read_b64_tr_b16 a[234:235], v2 offset:51200
v_mfma_f32_16x16x32_bf16 a[28:31], a[236:239], v[28:31], a[28:31]
s_mov_b32 s5, 512
s_waitcnt lgkmcnt(6)
v_mfma_f32_16x16x32_bf16 a[32:35], a[240:243], v[24:27], a[32:35]
ds_read_b64_tr_b16 a[236:237], v3 offset:49152
ds_read_b64_tr_b16 a[238:239], v3 offset:51200
v_mfma_f32_16x16x32_bf16 a[40:43], a[240:243], v[28:31], a[40:43]
buffer_load_dwordx4 v9, s[24:27], s5 offen lds
v_mfma_f32_16x16x32_bf16 a[36:39], a[244:247], v[24:27], a[36:39]
ds_read_b64_tr_b16 a[240:241], v0 offset:53248
ds_read_b64_tr_b16 a[242:243], v0 offset:55296
v_mfma_f32_16x16x32_bf16 a[44:47], a[244:247], v[28:31], a[44:47]
s_add_u32 m0, s4, 49152
s_waitcnt vmcnt(7)
v_mfma_f32_16x16x32_bf16 a[48:51], a[248:251], v[24:27], a[48:51]
L_pg10:
s_cbranch_scc1 L_pg14
ds_read_b64_tr_b16 a[244:245], v1 offset:53248
ds_read_b64_tr_b16 a[246:247], v1 offset:55296
v_mfma_f32_16x16x32_bf16 a[56:59], a[248:251], v[28:31], a[56:59]
buffer_load_dwordx4 v8, s[16:19], s35 offen offset:1024 nt lds
v_mfma_f32_16x16x32_bf16 a[52:55], a[252:255], v[24:27], a[52:55]
ds_read_b64_tr_b16 a[248:249], v2 offset:53248
ds_read_b64_tr_b16 a[250:251], v2 offset:55296
v_mfma_f32_16x16x32_bf16 a[60:63], a[252:255], v[28:31], a[60:63]
s_add_u32 m0, s4, 131072
L_step_49:
s_waitcnt lgkmcnt(6)
v_mfma_f32_16x16x32_bf16 v[32:35], a[224:227], v[128:131], 0
ds_read_b64_tr_b16 a[252:253], v3 offset:53248
ds_read_b64_tr_b16 a[254:255], v3 offset:55296
v_mfma_f32_16x16x32_bf16 v[40:43], a[224:227], v[132:135], 0
s_mov_b32 s5, 6656
buffer_load_dwordx4 v9, s[24:27], s5 offen offset:1024 lds
v_mfma_f32_16x16x32_bf16 v[36:39], a[228:231], v[128:131], 0
ds_read_b64_tr_b16 a[224:225], v0 offset:57344
ds_read_b64_tr_b16 a[226:227], v0 offset:59392
v_mfma_f32_16x16x32_bf16 v[44:47], a[228:231], v[132:135], 0
s_mov_b32 s5, 12800
v_accvgpr_read_b32 v13, a131
v_mfma_f32_16x16x32_bf16 v[48:51], a[232:235], v[128:131], 0
ds_read_b64_tr_b16 a[228:229], v1 offset:57344
ds_read_b64_tr_b16 a[230:231], v1 offset:59392
v_mfma_f32_16x16x32_bf16 v[56:59], a[232:235], v[132:135], 0
buffer_load_dwordx4 v9, s[24:27], s5 offen offset:2048 lds
s_add_u32 m0, s4, 49152
v_mfma_f32_16x16x32_bf16 v[52:55], a[236:239], v[128:131], 0
ds_read_b64_tr_b16 a[232:233], v2 offset:57344
ds_read_b64_tr_b16 a[234:235], v2 offset:59392
v_mfma_f32_16x16x32_bf16 v[60:63], a[236:239], v[132:135], 0
s_waitcnt vmcnt(6)
s_waitcnt lgkmcnt(6)
v_mfma_f32_16x16x32_bf16 v[32:35], a[240:243], v[136:139], v[32:35]
ds_read_b64_tr_b16 a[236:237], v3 offset:57344
ds_read_b64_tr_b16 a[238:239], v3 offset:59392
v_mfma_f32_16x16x32_bf16 v[40:43], a[240:243], v[140:143], v[40:43]
buffer_load_dwordx4 v8, s[16:19], s35 offen offset:2048 nt lds
s_add_u32 m0, s4, 131072
v_mfma_f32_16x16x32_bf16 v[36:39], a[244:247], v[136:139], v[36:39]
ds_read_b64_tr_b16 a[240:241], v0 offset:61440
ds_read_b64_tr_b16 a[242:243], v0 offset:63488
v_mfma_f32_16x16x32_bf16 v[44:47], a[244:247], v[140:143], v[44:47]
s_mov_b32 s5, 18944
buffer_load_dwordx4 v9, s[24:27], s5 offen offset:3072 lds
v_mfma_f32_16x16x32_bf16 v[48:51], a[248:251], v[136:139], v[48:51]
ds_read_b64_tr_b16 a[244:245], v1 offset:61440
ds_read_b64_tr_b16 a[246:247], v1 offset:63488
v_mfma_f32_16x16x32_bf16 v[56:59], a[248:251], v[140:143], v[56:59]
v_cvt_pk_bf16_f32 v96, v10, v11
v_cvt_pk_bf16_f32 v97, v12, v13
v_accvgpr_read_b32 v10, a132
v_mfma_f32_16x16x32_bf16 v[52:55], a[252:255], v[136:139], v[52:55]
ds_read_b64_tr_b16 a[248:249], v2 offset:61440
ds_read_b64_tr_b16 a[250:251], v2 offset:63488
v_mfma_f32_16x16x32_bf16 v[60:63], a[252:255], v[140:143], v[60:63]
s_add_u32 m0, s4, 49152
v_accvgpr_read_b32 v11, a133
s_waitcnt lgkmcnt(6)
v_mfma_f32_16x16x32_bf16 v[32:35], a[224:227], v[144:147], v[32:35]
ds_read_b64_tr_b16 a[252:253], v3 offset:61440
ds_read_b64_tr_b16 a[254:255], v3 offset:63488
v_mfma_f32_16x16x32_bf16 v[40:43], a[224:227], v[148:151], v[40:43]
v_accvgpr_read_b32 v12, a134
v_accvgpr_read_b32 v13, a135
v_cvt_pk_bf16_f32 v98, v10, v11
v_mfma_f32_16x16x32_bf16 v[36:39], a[228:231], v[144:147], v[36:39]
s_barrier
ds_read_b64_tr_b16 a[224:225], v0 offset:16384
v_mfma_f32_16x16x32_bf16 v[44:47], a[228:231], v[148:151], v[44:47]
ds_read_b64_tr_b16 a[226:227], v0 offset:18432
v_cvt_pk_bf16_f32 v99, v12, v13
v_accvgpr_read_b32 v10, a136
v_mfma_f32_16x16x32_bf16 v[48:51], a[232:235], v[144:147], v[48:51]
ds_read_b64_tr_b16 a[228:229], v1 offset:16384
ds_read_b64_tr_b16 a[230:231], v1 offset:18432
v_mfma_f32_16x16x32_bf16 v[56:59], a[232:235], v[148:151], v[56:59]
s_waitcnt vmcnt(7)
buffer_load_dwordx4 v8, s[16:19], s35 offen offset:3072 nt lds
v_mfma_f32_16x16x32_bf16 v[52:55], a[236:239], v[144:147], v[52:55]
ds_read_b64_tr_b16 a[232:233], v2 offset:16384
ds_read_b64_tr_b16 a[234:235], v2 offset:18432
v_mfma_f32_16x16x32_bf16 v[60:63], a[236:239], v[148:151], v[60:63]
v_accvgpr_read_b32 v11, a137
v_accvgpr_read_b32 v12, a138
s_waitcnt lgkmcnt(6)
v_mfma_f32_16x16x32_bf16 v[32:35], a[240:243], v[152:155], v[32:35]
ds_read_b64_tr_b16 a[236:237], v3 offset:16384
ds_read_b64_tr_b16 a[238:239], v3 offset:18432
v_mfma_f32_16x16x32_bf16 v[40:43], a[240:243], v[156:159], v[40:43]
v_accvgpr_read_b32 v13, a139
v_cvt_pk_bf16_f32 v100, v10, v11
v_cvt_pk_bf16_f32 v101, v12, v13
v_mfma_f32_16x16x32_bf16 v[36:39], a[244:247], v[152:155], v[36:39]
ds_read_b64_tr_b16 a[240:241], v0 offset:24576
ds_read_b64_tr_b16 a[242:243], v0 offset:26624
v_mfma_f32_16x16x32_bf16 v[44:47], a[244:247], v[156:159], v[44:47]
v_accvgpr_read_b32 v10, a140
v_accvgpr_read_b32 v11, a141
v_accvgpr_read_b32 v12, a142
v_mfma_f32_16x16x32_bf16 v[48:51], a[248:251], v[152:155], v[48:51]
ds_read_b64_tr_b16 a[244:245], v1 offset:24576
ds_read_b64_tr_b16 a[246:247], v1 offset:26624
v_mfma_f32_16x16x32_bf16 v[56:59], a[248:251], v[156:159], v[56:59]
s_add_u32 m0, s4, 0
s_mov_b32 s35, 196864
v_accvgpr_read_b32 v13, a143
v_mfma_f32_16x16x32_bf16 v[52:55], a[252:255], v[152:155], v[52:55]
ds_read_b64_tr_b16 a[248:249], v2 offset:24576
ds_read_b64_tr_b16 a[250:251], v2 offset:26624
v_mfma_f32_16x16x32_bf16 v[60:63], a[252:255], v[156:159], v[60:63]
v_cvt_pk_bf16_f32 v102, v10, v11
v_cvt_pk_bf16_f32 v103, v12, v13
L_step_50:
s_waitcnt lgkmcnt(6)
v_mfma_f32_16x16x32_bf16 a[64:67], a[224:227], v[16:19], 0
ds_read_b64_tr_b16 a[252:253], v3 offset:24576
ds_read_b64_tr_b16 a[254:255], v3 offset:26624
v_mfma_f32_16x16x32_bf16 a[72:75], a[224:227], v[20:23], 0
v_accvgpr_read_b32 v10, a144
v_accvgpr_read_b32 v11, a145
v_accvgpr_read_b32 v12, a146
v_mfma_f32_16x16x32_bf16 a[68:71], a[228:231], v[16:19], 0
ds_read_b64_tr_b16 a[224:225], v0 offset:20480
ds_read_b64_tr_b16 a[226:227], v0 offset:22528
v_mfma_f32_16x16x32_bf16 a[76:79], a[228:231], v[20:23], 0
s_waitcnt vmcnt(7)
buffer_load_dwordx4 v8, s[16:19], s35 offen nt lds
v_mfma_f32_16x16x32_bf16 a[80:83], a[232:235], v[16:19], 0
ds_read_b64_tr_b16 a[228:229], v1 offset:20480
ds_read_b64_tr_b16 a[230:231], v1 offset:22528
v_mfma_f32_16x16x32_bf16 a[88:91], a[232:235], v[20:23], 0
v_accvgpr_read_b32 v13, a147
v_cvt_pk_bf16_f32 v104, v10, v11
v_cvt_pk_bf16_f32 v105, v12, v13
v_mfma_f32_16x16x32_bf16 a[84:87], a[236:239], v[16:19], 0
ds_read_b64_tr_b16 a[232:233], v2 offset:20480
ds_read_b64_tr_b16 a[234:235], v2 offset:22528
v_mfma_f32_16x16x32_bf16 a[92:95], a[236:239], v[20:23], 0
v_accvgpr_read_b32 v10, a148
v_accvgpr_read_b32 v11, a149
s_waitcnt lgkmcnt(6)
v_mfma_f32_16x16x32_bf16 a[96:99], a[240:243], v[16:19], 0
ds_read_b64_tr_b16 a[236:237], v3 offset:20480
ds_read_b64_tr_b16 a[238:239], v3 offset:22528
v_mfma_f32_16x16x32_bf16 a[104:107], a[240:243], v[20:23], 0
v_accvgpr_read_b32 v12, a150
v_accvgpr_read_b32 v13, a151
v_cvt_pk_bf16_f32 v106, v10, v11
v_mfma_f32_16x16x32_bf16 a[100:103], a[244:247], v[16:19], 0
ds_read_b64_tr_b16 a[240:241], v0 offset:28672
ds_read_b64_tr_b16 a[242:243], v0 offset:30720
v_mfma_f32_16x16x32_bf16 a[108:111], a[244:247], v[20:23], 0
v_cvt_pk_bf16_f32 v107, v12, v13
v_accvgpr_read_b32 v10, a152
v_accvgpr_read_b32 v11, a153
v_mfma_f32_16x16x32_bf16 a[112:115], a[248:251], v[16:19], 0
ds_read_b64_tr_b16 a[244:245], v1 offset:28672
ds_read_b64_tr_b16 a[246:247], v1 offset:30720
v_mfma_f32_16x16x32_bf16 a[120:123], a[248:251], v[20:23], 0
v_accvgpr_read_b32 v12, a154
v_accvgpr_read_b32 v13, a155
v_cvt_pk_bf16_f32 v108, v10, v11
v_mfma_f32_16x16x32_bf16 a[116:119], a[252:255], v[16:19], 0
ds_read_b64_tr_b16 a[248:249], v2 offset:28672
ds_read_b64_tr_b16 a[250:251], v2 offset:30720
v_mfma_f32_16x16x32_bf16 a[124:127], a[252:255], v[20:23], 0
v_cvt_pk_bf16_f32 v109, v12, v13
v_accvgpr_read_b32 v10, a156
s_waitcnt lgkmcnt(6)
v_mfma_f32_16x16x32_bf16 a[64:67], a[224:227], v[24:27], a[64:67]
ds_read_b64_tr_b16 a[252:253], v3 offset:28672
ds_read_b64_tr_b16 a[254:255], v3 offset:30720
v_mfma_f32_16x16x32_bf16 a[72:75], a[224:227], v[28:31], a[72:75]
s_waitcnt vmcnt(6)
buffer_load_dwordx4 v8, s[16:19], s35 offen offset:1024 nt lds
v_mfma_f32_16x16x32_bf16 a[68:71], a[228:231], v[24:27], a[68:71]
s_barrier
ds_read_b64_tr_b16 a[224:225], v0 offset:0
v_mfma_f32_16x16x32_bf16 a[76:79], a[228:231], v[28:31], a[76:79]
ds_read_b64_tr_b16 a[226:227], v0 offset:2048
s_add_u32 m0, s4, 114688
s_add_u32 s5, s88, 768
v_mfma_f32_16x16x32_bf16 a[80:83], a[232:235], v[24:27], a[80:83]
ds_read_b64_tr_b16 a[228:229], v1 offset:0
ds_read_b64_tr_b16 a[230:231], v1 offset:2048
v_mfma_f32_16x16x32_bf16 a[88:91], a[232:235], v[28:31], a[88:91]
buffer_load_dwordx4 v9, s[24:27], s5 offen lds
s_add_u32 s5, s88, 6912
v_mfma_f32_16x16x32_bf16 a[84:87], a[236:239], v[24:27], a[84:87]
ds_read_b64_tr_b16 a[232:233], v2 offset:0
ds_read_b64_tr_b16 a[234:235], v2 offset:2048
v_mfma_f32_16x16x32_bf16 a[92:95], a[236:239], v[28:31], a[92:95]
v_accvgpr_read_b32 v11, a157
v_accvgpr_read_b32 v12, a158
s_waitcnt lgkmcnt(6)
v_mfma_f32_16x16x32_bf16 a[96:99], a[240:243], v[24:27], a[96:99]
ds_read_b64_tr_b16 a[236:237], v3 offset:0
ds_read_b64_tr_b16 a[238:239], v3 offset:2048
v_mfma_f32_16x16x32_bf16 a[104:107], a[240:243], v[28:31], a[104:107]
v_accvgpr_read_b32 v13, a159
v_cvt_pk_bf16_f32 v110, v10, v11
v_cvt_pk_bf16_f32 v111, v12, v13
v_mfma_f32_16x16x32_bf16 a[100:103], a[244:247], v[24:27], a[100:103]
ds_read_b64_tr_b16 a[240:241], v0 offset:4096
ds_read_b64_tr_b16 a[242:243], v0 offset:6144
v_mfma_f32_16x16x32_bf16 a[108:111], a[244:247], v[28:31], a[108:111]
buffer_load_dwordx4 v9, s[24:27], s5 offen offset:1024 lds
s_add_u32 m0, s4, 0
v_mfma_f32_16x16x32_bf16 a[112:115], a[248:251], v[24:27], a[112:115]
ds_read_b64_tr_b16 a[244:245], v1 offset:4096
ds_read_b64_tr_b16 a[246:247], v1 offset:6144
v_mfma_f32_16x16x32_bf16 a[120:123], a[248:251], v[28:31], a[120:123]
v_accvgpr_read_b32 v10, a160
v_accvgpr_read_b32 v11, a161
v_accvgpr_read_b32 v12, a162
v_mfma_f32_16x16x32_bf16 a[116:119], a[252:255], v[24:27], a[116:119]
ds_read_b64_tr_b16 a[248:249], v2 offset:4096
ds_read_b64_tr_b16 a[250:251], v2 offset:6144
v_mfma_f32_16x16x32_bf16 a[124:127], a[252:255], v[28:31], a[124:127]
v_accvgpr_read_b32 v13, a163
v_cvt_pk_bf16_f32 v112, v10, v11
L_step_51:
s_waitcnt lgkmcnt(6)
v_mfma_f32_16x16x32_bf16 v[32:35], a[224:227], v[160:163], v[32:35]
ds_read_b64_tr_b16 a[252:253], v3 offset:4096
ds_read_b64_tr_b16 a[254:255], v3 offset:6144
v_mfma_f32_16x16x32_bf16 v[40:43], a[224:227], v[164:167], v[40:43]
s_waitcnt vmcnt(6)
buffer_load_dwordx4 v8, s[16:19], s35 offen offset:2048 nt lds
v_mfma_f32_16x16x32_bf16 v[36:39], a[228:231], v[160:163], v[36:39]
ds_read_b64_tr_b16 a[224:225], v0 offset:8192
ds_read_b64_tr_b16 a[226:227], v0 offset:10240
s_add_u32 m0, s4, 114688
v_mfma_f32_16x16x32_bf16 v[44:47], a[228:231], v[164:167], v[44:47]
s_add_u32 s5, s88, 13056
buffer_load_dwordx4 v9, s[24:27], s5 offen offset:2048 lds
v_mfma_f32_16x16x32_bf16 v[48:51], a[232:235], v[160:163], v[48:51]
ds_read_b64_tr_b16 a[228:229], v1 offset:8192
ds_read_b64_tr_b16 a[230:231], v1 offset:10240
s_add_u32 s5, s88, 19200
v_mfma_f32_16x16x32_bf16 v[56:59], a[232:235], v[164:167], v[56:59]
v_cvt_pk_bf16_f32 v113, v12, v13
v_accvgpr_read_b32 v10, a164
v_accvgpr_read_b32 v11, a165
v_mfma_f32_16x16x32_bf16 v[52:55], a[236:239], v[160:163], v[52:55]
ds_read_b64_tr_b16 a[232:233], v2 offset:8192
ds_read_b64_tr_b16 a[234:235], v2 offset:10240
v_accvgpr_read_b32 v12, a166
v_mfma_f32_16x16x32_bf16 v[60:63], a[236:239], v[164:167], v[60:63]
v_accvgpr_read_b32 v13, a167
v_cvt_pk_bf16_f32 v114, v10, v11
s_waitcnt lgkmcnt(6)
v_mfma_f32_16x16x32_bf16 v[32:35], a[240:243], v[168:171], v[32:35]
ds_read_b64_tr_b16 a[236:237], v3 offset:8192
ds_read_b64_tr_b16 a[238:239], v3 offset:10240
v_mfma_f32_16x16x32_bf16 v[40:43], a[240:243], v[172:175], v[40:43]
buffer_load_dwordx4 v9, s[24:27], s5 offen offset:3072 lds
s_add_u32 m0, s4, 0
v_cvt_pk_bf16_f32 v115, v12, v13
v_mfma_f32_16x16x32_bf16 v[36:39], a[244:247], v[168:171], v[36:39]
ds_read_b64_tr_b16 a[240:241], v0 offset:12288
ds_read_b64_tr_b16 a[242:243], v0 offset:14336
v_add_u32 v0, 0x8000, v0
v_mfma_f32_16x16x32_bf16 v[44:47], a[244:247], v[172:175], v[44:47]
v_accvgpr_read_b32 v10, a168
v_accvgpr_read_b32 v11, a169
v_accvgpr_read_b32 v12, a170
v_mfma_f32_16x16x32_bf16 v[48:51], a[248:251], v[168:171], v[48:51]
ds_read_b64_tr_b16 a[244:245], v1 offset:12288
ds_read_b64_tr_b16 a[246:247], v1 offset:14336
v_add_u32 v1, 0x8000, v1
v_mfma_f32_16x16x32_bf16 v[56:59], a[248:251], v[172:175], v[56:59]
v_accvgpr_read_b32 v13, a171
v_cvt_pk_bf16_f32 v116, v10, v11
v_cvt_pk_bf16_f32 v117, v12, v13
v_mfma_f32_16x16x32_bf16 v[52:55], a[252:255], v[168:171], v[52:55]
ds_read_b64_tr_b16 a[248:249], v2 offset:12288
ds_read_b64_tr_b16 a[250:251], v2 offset:14336
v_add_u32 v2, 0x8000, v2
v_mfma_f32_16x16x32_bf16 v[60:63], a[252:255], v[172:175], v[60:63]
s_waitcnt vmcnt(7)
buffer_load_dwordx4 v8, s[16:19], s35 offen offset:3072 nt lds
s_waitcnt lgkmcnt(6)
v_mfma_f32_16x16x32_bf16 v[32:35], a[224:227], v[176:179], v[32:35]
ds_read_b64_tr_b16 a[252:253], v3 offset:12288
ds_read_b64_tr_b16 a[254:255], v3 offset:14336
v_add_u32 v3, 0x8000, v3
v_mfma_f32_16x16x32_bf16 v[40:43], a[224:227], v[180:183], v[40:43]
v_accvgpr_read_b32 v10, a172
v_accvgpr_read_b32 v11, a173
v_accvgpr_read_b32 v12, a174
v_accvgpr_read_b32 v13, a175
v_mfma_f32_16x16x32_bf16 v[36:39], a[228:231], v[176:179], v[36:39]
s_barrier
ds_read_b64_tr_b16 a[224:225], v0 offset:32768
ds_read_b64_tr_b16 a[226:227], v0 offset:34816
v_mfma_f32_16x16x32_bf16 v[44:47], a[228:231], v[180:183], v[44:47]
v_cvt_pk_bf16_f32 v118, v10, v11
v_cvt_pk_bf16_f32 v119, v12, v13
v_accvgpr_read_b32 v10, a176
v_accvgpr_read_b32 v11, a177
v_mfma_f32_16x16x32_bf16 v[48:51], a[232:235], v[176:179], v[48:51]
ds_read_b64_tr_b16 a[228:229], v1 offset:32768
ds_read_b64_tr_b16 a[230:231], v1 offset:34816
v_accvgpr_read_b32 v12, a178
v_mfma_f32_16x16x32_bf16 v[56:59], a[232:235], v[180:183], v[56:59]
v_accvgpr_read_b32 v13, a179
v_cvt_pk_bf16_f32 v120, v10, v11
v_cvt_pk_bf16_f32 v121, v12, v13
v_accvgpr_read_b32 v10, a180
v_mfma_f32_16x16x32_bf16 v[52:55], a[236:239], v[176:179], v[52:55]
ds_read_b64_tr_b16 a[232:233], v2 offset:32768
ds_read_b64_tr_b16 a[234:235], v2 offset:34816
v_accvgpr_read_b32 v11, a181
v_mfma_f32_16x16x32_bf16 v[60:63], a[236:239], v[180:183], v[60:63]
v_accvgpr_read_b32 v12, a182
v_accvgpr_read_b32 v13, a183
s_waitcnt lgkmcnt(6)
v_mfma_f32_16x16x32_bf16 v[32:35], a[240:243], v[184:187], v[32:35]
ds_read_b64_tr_b16 a[236:237], v3 offset:32768
ds_read_b64_tr_b16 a[238:239], v3 offset:34816
v_cvt_pk_bf16_f32 v122, v10, v11
v_mfma_f32_16x16x32_bf16 v[40:43], a[240:243], v[188:191], v[40:43]
v_cvt_pk_bf16_f32 v123, v12, v13
v_accvgpr_read_b32 v10, a184
v_accvgpr_read_b32 v11, a185
v_accvgpr_read_b32 v12, a186
v_mfma_f32_16x16x32_bf16 v[36:39], a[244:247], v[184:187], v[36:39]
ds_read_b64_tr_b16 a[240:241], v0 offset:40960
ds_read_b64_tr_b16 a[242:243], v0 offset:43008
v_accvgpr_read_b32 v13, a187
v_mfma_f32_16x16x32_bf16 v[44:47], a[244:247], v[188:191], v[44:47]
v_cvt_pk_bf16_f32 v124, v10, v11
v_cvt_pk_bf16_f32 v125, v12, v13
v_accvgpr_read_b32 v10, a188
v_mfma_f32_16x16x32_bf16 v[48:51], a[248:251], v[184:187], v[48:51]
ds_read_b64_tr_b16 a[244:245], v1 offset:40960
ds_read_b64_tr_b16 a[246:247], v1 offset:43008
v_accvgpr_read_b32 v11, a189
v_mfma_f32_16x16x32_bf16 v[56:59], a[248:251], v[188:191], v[56:59]
v_accvgpr_read_b32 v12, a190
v_accvgpr_read_b32 v13, a191
v_cvt_pk_bf16_f32 v126, v10, v11
v_cvt_pk_bf16_f32 v127, v12, v13
v_mfma_f32_16x16x32_bf16 v[52:55], a[252:255], v[184:187], v[52:55]
ds_read_b64_tr_b16 a[248:249], v2 offset:40960
ds_read_b64_tr_b16 a[250:251], v2 offset:43008
v_mfma_f32_16x16x32_bf16 v[60:63], a[252:255], v[188:191], v[60:63]
s_add_u32 m0, s4, 81920
L_step_52:
s_waitcnt lgkmcnt(6)
v_mfma_f32_16x16x32_bf16 a[128:131], a[224:227], v[16:19], 0
ds_read_b64_tr_b16 a[252:253], v3 offset:40960
ds_read_b64_tr_b16 a[254:255], v3 offset:43008
v_mfma_f32_16x16x32_bf16 a[136:139], a[224:227], v[20:23], 0
s_mov_b32 s35, 384
s_waitcnt vmcnt(7)
v_mfma_f32_16x16x32_bf16 a[132:135], a[228:231], v[16:19], 0
ds_read_b64_tr_b16 a[224:225], v0 offset:36864
ds_read_b64_tr_b16 a[226:227], v0 offset:38912
v_mfma_f32_16x16x32_bf16 a[140:143], a[228:231], v[20:23], 0
buffer_load_dwordx4 v8, s[16:19], s35 offen nt lds
v_mfma_f32_16x16x32_bf16 a[144:147], a[232:235], v[16:19], 0
ds_read_b64_tr_b16 a[228:229], v1 offset:36864
ds_read_b64_tr_b16 a[230:231], v1 offset:38912
v_mfma_f32_16x16x32_bf16 a[152:155], a[232:235], v[20:23], 0
v_permlane32_swap_b32 v64, v66
v_permlane32_swap_b32 v65, v67
v_mfma_f32_16x16x32_bf16 a[148:151], a[236:239], v[16:19], 0
ds_read_b64_tr_b16 a[232:233], v2 offset:36864
ds_read_b64_tr_b16 a[234:235], v2 offset:38912
v_mfma_f32_16x16x32_bf16 a[156:159], a[236:239], v[20:23], 0
v_permlane32_swap_b32 v68, v70
s_waitcnt lgkmcnt(6)
v_mfma_f32_16x16x32_bf16 a[160:163], a[240:243], v[16:19], 0
ds_read_b64_tr_b16 a[236:237], v3 offset:36864
ds_read_b64_tr_b16 a[238:239], v3 offset:38912
v_mfma_f32_16x16x32_bf16 a[168:171], a[240:243], v[20:23], 0
v_permlane32_swap_b32 v69, v71
v_permlane16_swap_b32 v64, v66
v_mfma_f32_16x16x32_bf16 a[164:167], a[244:247], v[16:19], 0
ds_read_b64_tr_b16 a[240:241], v0 offset:45056
ds_read_b64_tr_b16 a[242:243], v0 offset:47104
v_mfma_f32_16x16x32_bf16 a[172:175], a[244:247], v[20:23], 0
s_waitcnt vmcnt(7)
v_permlane16_swap_b32 v65, v67
v_mfma_f32_16x16x32_bf16 a[176:179], a[248:251], v[16:19], 0
ds_read_b64_tr_b16 a[244:245], v1 offset:45056
ds_read_b64_tr_b16 a[246:247], v1 offset:47104
v_mfma_f32_16x16x32_bf16 a[184:187], a[248:251], v[20:23], 0
buffer_load_dwordx4 v8, s[16:19], s35 offen offset:1024 nt lds
v_mfma_f32_16x16x32_bf16 a[180:183], a[252:255], v[16:19], 0
ds_read_b64_tr_b16 a[248:249], v2 offset:45056
ds_read_b64_tr_b16 a[250:251], v2 offset:47104
v_mfma_f32_16x16x32_bf16 a[188:191], a[252:255], v[20:23], 0
s_add_u32 m0, s4, 65536
s_waitcnt lgkmcnt(6)
v_mfma_f32_16x16x32_bf16 a[128:131], a[224:227], v[24:27], a[128:131]
ds_read_b64_tr_b16 a[252:253], v3 offset:45056
ds_read_b64_tr_b16 a[254:255], v3 offset:47104
v_mfma_f32_16x16x32_bf16 a[136:139], a[224:227], v[28:31], a[136:139]
s_mov_b32 s5, 57344
v_permlane16_swap_b32 v68, v70
v_mfma_f32_16x16x32_bf16 a[132:135], a[228:231], v[24:27], a[132:135]
s_barrier
ds_read_b64_tr_b16 a[224:225], v0 offset:49152
v_mfma_f32_16x16x32_bf16 a[140:143], a[228:231], v[28:31], a[140:143]
ds_read_b64_tr_b16 a[226:227], v0 offset:51200
v_permlane16_swap_b32 v69, v71
v_mfma_f32_16x16x32_bf16 a[144:147], a[232:235], v[24:27], a[144:147]
ds_read_b64_tr_b16 a[228:229], v1 offset:49152
ds_read_b64_tr_b16 a[230:231], v1 offset:51200
v_mfma_f32_16x16x32_bf16 a[152:155], a[232:235], v[28:31], a[152:155]
buffer_load_dwordx4 v9, s[24:27], s5 offen lds
v_mfma_f32_16x16x32_bf16 a[148:151], a[236:239], v[24:27], a[148:151]
ds_read_b64_tr_b16 a[232:233], v2 offset:49152
ds_read_b64_tr_b16 a[234:235], v2 offset:51200
v_mfma_f32_16x16x32_bf16 a[156:159], a[236:239], v[28:31], a[156:159]
s_mov_b32 s5, 63488
s_waitcnt lgkmcnt(6)
v_mfma_f32_16x16x32_bf16 a[160:163], a[240:243], v[24:27], a[160:163]
ds_read_b64_tr_b16 a[236:237], v3 offset:49152
ds_read_b64_tr_b16 a[238:239], v3 offset:51200
v_mfma_f32_16x16x32_bf16 a[168:171], a[240:243], v[28:31], a[168:171]
buffer_load_dwordx4 v9, s[24:27], s5 offen offset:1024 lds
v_mfma_f32_16x16x32_bf16 a[164:167], a[244:247], v[24:27], a[164:167]
ds_read_b64_tr_b16 a[240:241], v0 offset:53248
ds_read_b64_tr_b16 a[242:243], v0 offset:55296
v_mfma_f32_16x16x32_bf16 a[172:175], a[244:247], v[28:31], a[172:175]
s_mov_b32 s5, 69632
buffer_load_dwordx4 v9, s[24:27], s5 offen offset:2048 lds
v_mfma_f32_16x16x32_bf16 a[176:179], a[248:251], v[24:27], a[176:179]
ds_read_b64_tr_b16 a[244:245], v1 offset:53248
ds_read_b64_tr_b16 a[246:247], v1 offset:55296
v_mfma_f32_16x16x32_bf16 a[184:187], a[248:251], v[28:31], a[184:187]
s_add_u32 m0, s4, 81920
s_waitcnt vmcnt(8)
v_permlane32_swap_b32 v72, v74
v_mfma_f32_16x16x32_bf16 a[180:183], a[252:255], v[24:27], a[180:183]
ds_read_b64_tr_b16 a[248:249], v2 offset:53248
ds_read_b64_tr_b16 a[250:251], v2 offset:55296
v_mfma_f32_16x16x32_bf16 a[188:191], a[252:255], v[28:31], a[188:191]
buffer_load_dwordx4 v8, s[16:19], s35 offen offset:2048 nt lds
L_step_53:
s_waitcnt lgkmcnt(6)
v_mfma_f32_16x16x32_bf16 v[32:35], a[224:227], v[192:195], v[32:35]
ds_read_b64_tr_b16 a[252:253], v3 offset:53248
ds_read_b64_tr_b16 a[254:255], v3 offset:55296
s_add_u32 m0, s4, 65536
v_mfma_f32_16x16x32_bf16 v[40:43], a[224:227], v[196:199], v[40:43]
s_mov_b32 s5, 75776
buffer_load_dwordx4 v9, s[24:27], s5 offen offset:3072 lds
v_mfma_f32_16x16x32_bf16 v[36:39], a[228:231], v[192:195], v[36:39]
ds_read_b64_tr_b16 a[224:225], v0 offset:57344
ds_read_b64_tr_b16 a[226:227], v0 offset:59392
v_mfma_f32_16x16x32_bf16 v[44:47], a[228:231], v[196:199], v[44:47]
s_add_u32 m0, s4, 81920
v_permlane32_swap_b32 v73, v75
v_mfma_f32_16x16x32_bf16 v[48:51], a[232:235], v[192:195], v[48:51]
ds_read_b64_tr_b16 a[228:229], v1 offset:57344
ds_read_b64_tr_b16 a[230:231], v1 offset:59392
v_mfma_f32_16x16x32_bf16 v[56:59], a[232:235], v[196:199], v[56:59]
v_permlane32_swap_b32 v76, v78
v_permlane32_swap_b32 v77, v79
v_mfma_f32_16x16x32_bf16 v[52:55], a[236:239], v[192:195], v[52:55]
ds_read_b64_tr_b16 a[232:233], v2 offset:57344
ds_read_b64_tr_b16 a[234:235], v2 offset:59392
v_mfma_f32_16x16x32_bf16 v[60:63], a[236:239], v[196:199], v[60:63]
v_permlane16_swap_b32 v72, v74
s_waitcnt lgkmcnt(6)
v_mfma_f32_16x16x32_bf16 v[32:35], a[240:243], v[200:203], v[32:35]
ds_read_b64_tr_b16 a[236:237], v3 offset:57344
ds_read_b64_tr_b16 a[238:239], v3 offset:59392
v_mfma_f32_16x16x32_bf16 v[40:43], a[240:243], v[204:207], v[40:43]
s_waitcnt vmcnt(7)
v_permlane16_swap_b32 v73, v75
v_mfma_f32_16x16x32_bf16 v[36:39], a[244:247], v[200:203], v[36:39]
ds_read_b64_tr_b16 a[240:241], v0 offset:61440
ds_read_b64_tr_b16 a[242:243], v0 offset:63488
v_mfma_f32_16x16x32_bf16 v[44:47], a[244:247], v[204:207], v[44:47]
buffer_load_dwordx4 v8, s[16:19], s35 offen offset:3072 nt lds
v_mfma_f32_16x16x32_bf16 v[48:51], a[248:251], v[200:203], v[48:51]
ds_read_b64_tr_b16 a[244:245], v1 offset:61440
ds_read_b64_tr_b16 a[246:247], v1 offset:63488
v_mfma_f32_16x16x32_bf16 v[56:59], a[248:251], v[204:207], v[56:59]
v_permlane16_swap_b32 v76, v78
v_permlane16_swap_b32 v77, v79
v_mfma_f32_16x16x32_bf16 v[52:55], a[252:255], v[200:203], v[52:55]
ds_read_b64_tr_b16 a[248:249], v2 offset:61440
ds_read_b64_tr_b16 a[250:251], v2 offset:63488
v_mfma_f32_16x16x32_bf16 v[60:63], a[252:255], v[204:207], v[60:63]
v_permlane32_swap_b32 v80, v82
s_waitcnt lgkmcnt(6)
v_mfma_f32_16x16x32_bf16 v[32:35], a[224:227], v[208:211], v[32:35]
ds_read_b64_tr_b16 a[252:253], v3 offset:61440
ds_read_b64_tr_b16 a[254:255], v3 offset:63488
v_mfma_f32_16x16x32_bf16 v[40:43], a[224:227], v[212:215], v[40:43]
s_add_u32 m0, s4, 131072
s_mov_b32 s35, 65920
v_mfma_f32_16x16x32_bf16 v[36:39], a[228:231], v[208:211], v[36:39]
s_barrier
ds_read_b64_tr_b16 a[224:225], v0 offset:16384
v_mfma_f32_16x16x32_bf16 v[44:47], a[228:231], v[212:215], v[44:47]
ds_read_b64_tr_b16 a[226:227], v0 offset:18432
v_permlane32_swap_b32 v81, v83
v_mfma_f32_16x16x32_bf16 v[48:51], a[232:235], v[208:211], v[48:51]
ds_read_b64_tr_b16 a[228:229], v1 offset:16384
ds_read_b64_tr_b16 a[230:231], v1 offset:18432
v_mfma_f32_16x16x32_bf16 v[56:59], a[232:235], v[212:215], v[56:59]
v_permlane32_swap_b32 v84, v86
v_permlane32_swap_b32 v85, v87
v_mfma_f32_16x16x32_bf16 v[52:55], a[236:239], v[208:211], v[52:55]
ds_read_b64_tr_b16 a[232:233], v2 offset:16384
ds_read_b64_tr_b16 a[234:235], v2 offset:18432
v_mfma_f32_16x16x32_bf16 v[60:63], a[236:239], v[212:215], v[60:63]
s_waitcnt vmcnt(7)
s_waitcnt lgkmcnt(6)
v_mfma_f32_16x16x32_bf16 v[32:35], a[240:243], v[216:219], v[32:35]
ds_read_b64_tr_b16 a[236:237], v3 offset:16384
ds_read_b64_tr_b16 a[238:239], v3 offset:18432
v_mfma_f32_16x16x32_bf16 v[40:43], a[240:243], v[220:223], v[40:43]
buffer_load_dwordx4 v8, s[16:19], s35 offen nt lds
v_mfma_f32_16x16x32_bf16 v[36:39], a[244:247], v[216:219], v[36:39]
ds_read_b64_tr_b16 a[240:241], v0 offset:20480
ds_read_b64_tr_b16 a[242:243], v0 offset:22528
v_mfma_f32_16x16x32_bf16 v[44:47], a[244:247], v[220:223], v[44:47]
v_add_u32 v0, 0xfffec000, v0
v_permlane16_swap_b32 v80, v82
v_mfma_f32_16x16x32_bf16 v[48:51], a[248:251], v[216:219], v[48:51]
ds_read_b64_tr_b16 a[244:245], v1 offset:20480
ds_read_b64_tr_b16 a[246:247], v1 offset:22528
v_mfma_f32_16x16x32_bf16 v[56:59], a[248:251], v[220:223], v[56:59]
v_add_u32 v1, 0xfffec000, v1
v_permlane16_swap_b32 v81, v83
v_mfma_f32_16x16x32_bf16 v[52:55], a[252:255], v[216:219], v[52:55]
ds_read_b64_tr_b16 a[248:249], v2 offset:20480
ds_read_b64_tr_b16 a[250:251], v2 offset:22528
v_mfma_f32_16x16x32_bf16 v[60:63], a[252:255], v[220:223], v[60:63]
v_add_u32 v2, 0xfffec000, v2
L_step_54:
s_waitcnt lgkmcnt(6)
v_mfma_f32_16x16x32_bf16 a[192:195], a[224:227], v[16:19], 0
ds_read_b64_tr_b16 a[252:253], v3 offset:20480
ds_read_b64_tr_b16 a[254:255], v3 offset:22528
v_mfma_f32_16x16x32_bf16 a[200:203], a[224:227], v[20:23], 0
L_pg11:
s_cbranch_scc1 L_pg15
v_add_u32 v3, 0xfffec000, v3
v_permlane16_swap_b32 v84, v86
v_mfma_f32_16x16x32_bf16 a[196:199], a[228:231], v[16:19], 0
s_barrier
ds_read_b64_tr_b16 a[224:225], v0 offset:16384
v_mfma_f32_16x16x32_bf16 a[204:207], a[228:231], v[20:23], 0
ds_read_b64_tr_b16 a[226:227], v0 offset:18432
v_permlane16_swap_b32 v85, v87
v_mfma_f32_16x16x32_bf16 a[208:211], a[232:235], v[16:19], 0
ds_read_b64_tr_b16 a[228:229], v1 offset:16384
ds_read_b64_tr_b16 a[230:231], v1 offset:18432
v_mfma_f32_16x16x32_bf16 a[216:219], a[232:235], v[20:23], 0
s_waitcnt vmcnt(7)
v_permlane32_swap_b32 v88, v90
v_mfma_f32_16x16x32_bf16 a[212:215], a[236:239], v[16:19], 0
ds_read_b64_tr_b16 a[232:233], v0 offset:20480
ds_read_b64_tr_b16 a[234:235], v0 offset:22528
v_mfma_f32_16x16x32_bf16 a[220:223], a[236:239], v[20:23], 0
v_permlane32_swap_b32 v89, v91
s_waitcnt lgkmcnt(6)
v_mfma_f32_16x16x32_bf16 a[192:195], a[240:243], v[24:27], a[192:195]
ds_read_b64_tr_b16 a[236:237], v1 offset:20480
ds_read_b64_tr_b16 a[238:239], v1 offset:22528
v_mfma_f32_16x16x32_bf16 a[200:203], a[240:243], v[28:31], a[200:203]
buffer_load_dwordx4 v8, s[16:19], s35 offen offset:1024 nt lds
s_add_u32 m0, s4, 147456
v_mfma_f32_16x16x32_bf16 a[196:199], a[244:247], v[24:27], a[196:199]
ds_read_b64_tr_b16 a[240:241], v0 offset:24576
ds_read_b64_tr_b16 a[242:243], v0 offset:26624
v_mfma_f32_16x16x32_bf16 a[204:207], a[244:247], v[28:31], a[204:207]
s_mov_b32 s5, 57600
buffer_load_dwordx4 v9, s[24:27], s5 offen lds
v_mfma_f32_16x16x32_bf16 a[208:211], a[248:251], v[24:27], a[208:211]
ds_read_b64_tr_b16 a[244:245], v1 offset:24576
ds_read_b64_tr_b16 a[246:247], v1 offset:26624
v_mfma_f32_16x16x32_bf16 a[216:219], a[248:251], v[28:31], a[216:219]
s_mov_b32 s5, 63744
v_permlane32_swap_b32 v92, v94
v_mfma_f32_16x16x32_bf16 a[212:215], a[252:255], v[24:27], a[212:215]
ds_read_b64_tr_b16 a[248:249], v0 offset:28672
ds_read_b64_tr_b16 a[250:251], v0 offset:30720
v_mfma_f32_16x16x32_bf16 a[220:223], a[252:255], v[28:31], a[220:223]
v_permlane32_swap_b32 v93, v95
L_step_55:
s_waitcnt lgkmcnt(6)
v_mfma_f32_16x16x32_bf16 v[32:35], a[224:227], v[224:227], v[32:35]
ds_read_b64_tr_b16 a[252:253], v1 offset:28672
ds_read_b64_tr_b16 a[254:255], v1 offset:30720
v_mfma_f32_16x16x32_bf16 v[40:43], a[224:227], v[228:231], v[40:43]
buffer_load_dwordx4 v9, s[24:27], s5 offen offset:1024 lds
v_mfma_f32_16x16x32_bf16 v[36:39], a[228:231], v[224:227], v[36:39]
ds_read_b64_tr_b16 a[224:225], v2 offset:16384
ds_read_b64_tr_b16 a[226:227], v2 offset:18432
v_mfma_f32_16x16x32_bf16 v[44:47], a[228:231], v[228:231], v[44:47]
s_mov_b32 s5, 69888
v_permlane16_swap_b32 v88, v90
v_mfma_f32_16x16x32_bf16 v[32:35], a[232:235], v[232:235], v[32:35]
ds_read_b64_tr_b16 a[228:229], v3 offset:16384
ds_read_b64_tr_b16 a[230:231], v3 offset:18432
v_mfma_f32_16x16x32_bf16 v[40:43], a[232:235], v[236:239], v[40:43]
buffer_load_dwordx4 v9, s[24:27], s5 offen offset:2048 lds
v_mfma_f32_16x16x32_bf16 v[36:39], a[236:239], v[232:235], v[36:39]
ds_read_b64_tr_b16 a[232:233], v2 offset:20480
ds_read_b64_tr_b16 a[234:235], v2 offset:22528
v_mfma_f32_16x16x32_bf16 v[44:47], a[236:239], v[236:239], v[44:47]
s_add_u32 m0, s4, 131072
s_waitcnt lgkmcnt(6)
v_mfma_f32_16x16x32_bf16 v[32:35], a[240:243], v[240:243], v[32:35]
ds_read_b64_tr_b16 a[236:237], v3 offset:20480
ds_read_b64_tr_b16 a[238:239], v3 offset:22528
v_mfma_f32_16x16x32_bf16 v[40:43], a[240:243], v[244:247], v[40:43]
s_waitcnt vmcnt(7)
v_permlane16_swap_b32 v89, v91
v_mfma_f32_16x16x32_bf16 v[36:39], a[244:247], v[240:243], v[36:39]
ds_read_b64_tr_b16 a[240:241], v2 offset:24576
ds_read_b64_tr_b16 a[242:243], v2 offset:26624
v_mfma_f32_16x16x32_bf16 v[44:47], a[244:247], v[244:247], v[44:47]
buffer_load_dwordx4 v8, s[16:19], s35 offen offset:2048 nt lds
v_mfma_f32_16x16x32_bf16 v[32:35], a[248:251], v[248:251], v[32:35]
ds_read_b64_tr_b16 a[244:245], v3 offset:24576
ds_read_b64_tr_b16 a[246:247], v3 offset:26624
v_mfma_f32_16x16x32_bf16 v[40:43], a[248:251], v[252:255], v[40:43]
s_add_u32 m0, s4, 147456
s_mov_b32 s5, 76032
v_mfma_f32_16x16x32_bf16 v[36:39], a[252:255], v[248:251], v[36:39]
ds_read_b64_tr_b16 a[248:249], v2 offset:28672
ds_read_b64_tr_b16 a[250:251], v2 offset:30720
v_mfma_f32_16x16x32_bf16 v[44:47], a[252:255], v[252:255], v[44:47]
buffer_load_dwordx4 v9, s[24:27], s5 offen offset:3072 lds
s_waitcnt lgkmcnt(6)
v_mfma_f32_16x16x32_bf16 v[48:51], a[224:227], v[224:227], v[48:51]
ds_read_b64_tr_b16 a[252:253], v3 offset:28672
ds_read_b64_tr_b16 a[254:255], v3 offset:30720
v_mfma_f32_16x16x32_bf16 v[56:59], a[224:227], v[228:231], v[56:59]
s_add_u32 m0, s4, 131072
v_permlane16_swap_b32 v92, v94
v_mfma_f32_16x16x32_bf16 v[52:55], a[228:231], v[224:227], v[52:55]
s_waitcnt vmcnt(8)
s_barrier
ds_read_b64_tr_b16 a[224:225], v0 offset:49152
v_mfma_f32_16x16x32_bf16 v[60:63], a[228:231], v[228:231], v[60:63]
ds_read_b64_tr_b16 a[226:227], v0 offset:51200
s_waitcnt vmcnt(7)
buffer_load_dwordx4 v8, s[16:19], s35 offen offset:3072 nt lds
v_mfma_f32_16x16x32_bf16 v[48:51], a[232:235], v[232:235], v[48:51]
ds_read_b64_tr_b16 a[228:229], v1 offset:49152
ds_read_b64_tr_b16 a[230:231], v1 offset:51200
v_mov_b32 v13, 1
v_mfma_f32_16x16x32_bf16 v[56:59], a[232:235], v[236:239], v[56:59]
s_xor_b32 s32, s33, 0
s_cmp_eq_u32 s3, 77
buffer_atomic_add v13, v8, s[64:67], s32 offen sc1
v_mfma_f32_16x16x32_bf16 v[52:55], a[236:239], v[232:235], v[52:55]
ds_read_b64_tr_b16 a[232:233], v2 offset:49152
ds_read_b64_tr_b16 a[234:235], v2 offset:51200
v_mul_f32 v32, v32, v14
v_mfma_f32_16x16x32_bf16 v[60:63], a[236:239], v[236:239], v[60:63]
v_mul_f32 v33, v33, v14
v_mul_f32 v34, v34, v14
v_mul_f32 v35, v35, v14
s_waitcnt lgkmcnt(6)
v_mfma_f32_16x16x32_bf16 v[48:51], a[240:243], v[240:243], v[48:51]
ds_read_b64_tr_b16 a[236:237], v3 offset:49152
ds_read_b64_tr_b16 a[238:239], v3 offset:51200
v_cvt_pk_bf16_f32 v16, v32, v33
v_mfma_f32_16x16x32_bf16 v[56:59], a[240:243], v[244:247], v[56:59]
v_mul_f32 v36, v36, v14
v_mul_f32 v37, v37, v14
v_cvt_pk_bf16_f32 v17, v34, v35
v_mul_f32 v38, v38, v14
v_mfma_f32_16x16x32_bf16 v[52:55], a[244:247], v[240:243], v[52:55]
ds_read_b64_tr_b16 a[240:241], v0 offset:57344
ds_read_b64_tr_b16 a[242:243], v0 offset:59392
v_mul_f32 v39, v39, v14
v_mfma_f32_16x16x32_bf16 v[60:63], a[244:247], v[244:247], v[60:63]
v_cvt_pk_bf16_f32 v18, v36, v37
v_cvt_pk_bf16_f32 v19, v38, v39
v_mul_f32 v40, v40, v15
v_mul_f32 v41, v41, v15
v_mfma_f32_16x16x32_bf16 v[48:51], a[248:251], v[248:251], v[48:51]
ds_read_b64_tr_b16 a[244:245], v1 offset:57344
ds_read_b64_tr_b16 a[246:247], v1 offset:59392
v_mul_f32 v42, v42, v15
v_mfma_f32_16x16x32_bf16 v[56:59], a[248:251], v[252:255], v[56:59]
v_mul_f32 v43, v43, v15
v_cvt_pk_bf16_f32 v20, v40, v41
v_mul_f32 v44, v44, v15
v_mul_f32 v45, v45, v15
v_mfma_f32_16x16x32_bf16 v[52:55], a[252:255], v[248:251], v[52:55]
ds_read_b64_tr_b16 a[248:249], v2 offset:57344
ds_read_b64_tr_b16 a[250:251], v2 offset:59392
v_cvt_pk_bf16_f32 v21, v42, v43
v_mul_f32 v46, v46, v15
v_mfma_f32_16x16x32_bf16 v[60:63], a[252:255], v[252:255], v[60:63]
v_mul_f32 v47, v47, v15
v_cvt_pk_bf16_f32 v22, v44, v45
v_cvt_pk_bf16_f32 v23, v46, v47
L_step_56:
s_waitcnt lgkmcnt(6)
v_mfma_f32_16x16x32_bf16 a[0:3], a[224:227], v[16:19], a[0:3]
ds_read_b64_tr_b16 a[252:253], v3 offset:57344
ds_read_b64_tr_b16 a[254:255], v3 offset:59392
v_mfma_f32_16x16x32_bf16 a[8:11], a[224:227], v[20:23], a[8:11]
s_add_u32 m0, s4, 114688
s_mov_b32 s35, 131456
v_mfma_f32_16x16x32_bf16 a[4:7], a[228:231], v[16:19], a[4:7]
ds_read_b64_tr_b16 a[224:225], v0 offset:53248
ds_read_b64_tr_b16 a[226:227], v0 offset:55296
s_waitcnt vmcnt(8)
v_mfma_f32_16x16x32_bf16 a[12:15], a[228:231], v[20:23], a[12:15]
buffer_load_dwordx4 v8, s[16:19], s35 offen nt lds
v_mul_f32 v48, v48, v14
v_mfma_f32_16x16x32_bf16 a[16:19], a[232:235], v[16:19], a[16:19]
ds_read_b64_tr_b16 a[228:229], v1 offset:53248
ds_read_b64_tr_b16 a[230:231], v1 offset:55296
v_mul_f32 v49, v49, v14
v_mfma_f32_16x16x32_bf16 a[24:27], a[232:235], v[20:23], a[24:27]
v_mul_f32 v50, v50, v14
v_mul_f32 v51, v51, v14
v_cvt_pk_bf16_f32 v24, v48, v49
v_mfma_f32_16x16x32_bf16 a[20:23], a[236:239], v[16:19], a[20:23]
ds_read_b64_tr_b16 a[232:233], v2 offset:53248
ds_read_b64_tr_b16 a[234:235], v2 offset:55296
v_mul_f32 v52, v52, v14
v_mfma_f32_16x16x32_bf16 a[28:31], a[236:239], v[20:23], a[28:31]
v_mul_f32 v53, v53, v14
v_cvt_pk_bf16_f32 v25, v50, v51
s_waitcnt lgkmcnt(6)
v_mfma_f32_16x16x32_bf16 a[32:35], a[240:243], v[16:19], a[32:35]
ds_read_b64_tr_b16 a[236:237], v3 offset:53248
ds_read_b64_tr_b16 a[238:239], v3 offset:55296
v_mul_f32 v54, v54, v14
v_mfma_f32_16x16x32_bf16 a[40:43], a[240:243], v[20:23], a[40:43]
v_mul_f32 v55, v55, v14
v_cvt_pk_bf16_f32 v26, v52, v53
v_cvt_pk_bf16_f32 v27, v54, v55
v_mfma_f32_16x16x32_bf16 a[36:39], a[244:247], v[16:19], a[36:39]
ds_read_b64_tr_b16 a[240:241], v0 offset:61440
ds_read_b64_tr_b16 a[242:243], v0 offset:63488
v_mul_f32 v56, v56, v15
v_mfma_f32_16x16x32_bf16 a[44:47], a[244:247], v[20:23], a[44:47]
v_mul_f32 v57, v57, v15
v_mul_f32 v58, v58, v15
v_mul_f32 v59, v59, v15
v_mfma_f32_16x16x32_bf16 a[48:51], a[248:251], v[16:19], a[48:51]
ds_read_b64_tr_b16 a[244:245], v1 offset:61440
ds_read_b64_tr_b16 a[246:247], v1 offset:63488
v_cvt_pk_bf16_f32 v28, v56, v57
v_mfma_f32_16x16x32_bf16 a[56:59], a[248:251], v[20:23], a[56:59]
v_mul_f32 v60, v60, v15
v_mul_f32 v61, v61, v15
v_cvt_pk_bf16_f32 v29, v58, v59
v_mfma_f32_16x16x32_bf16 a[52:55], a[252:255], v[16:19], a[52:55]
ds_read_b64_tr_b16 a[248:249], v2 offset:61440
ds_read_b64_tr_b16 a[250:251], v2 offset:63488
v_mul_f32 v62, v62, v15
v_mfma_f32_16x16x32_bf16 a[60:63], a[252:255], v[20:23], a[60:63]
v_mul_f32 v63, v63, v15
v_cvt_pk_bf16_f32 v30, v60, v61
v_cvt_pk_bf16_f32 v31, v62, v63
s_waitcnt lgkmcnt(6)
v_mfma_f32_16x16x32_bf16 a[0:3], a[224:227], v[24:27], a[0:3]
ds_read_b64_tr_b16 a[252:253], v3 offset:61440
ds_read_b64_tr_b16 a[254:255], v3 offset:63488
v_mfma_f32_16x16x32_bf16 a[8:11], a[224:227], v[28:31], a[8:11]
s_waitcnt vmcnt(8)
v_permlane16_swap_b32 v93, v95
v_mfma_f32_16x16x32_bf16 a[4:7], a[228:231], v[24:27], a[4:7]
s_barrier
ds_read_b64_tr_b16 a[224:225], v0 offset:0
v_mfma_f32_16x16x32_bf16 a[12:15], a[228:231], v[28:31], a[12:15]
ds_read_b64_tr_b16 a[226:227], v0 offset:2048
v_permlane32_swap_b32 v96, v98
v_mfma_f32_16x16x32_bf16 a[16:19], a[232:235], v[24:27], a[16:19]
ds_read_b64_tr_b16 a[228:229], v1 offset:0
ds_read_b64_tr_b16 a[230:231], v1 offset:2048
v_mfma_f32_16x16x32_bf16 a[24:27], a[232:235], v[28:31], a[24:27]
buffer_load_dwordx4 v8, s[16:19], s35 offen offset:1024 nt lds
v_mfma_f32_16x16x32_bf16 a[20:23], a[236:239], v[24:27], a[20:23]
ds_read_b64_tr_b16 a[232:233], v2 offset:0
ds_read_b64_tr_b16 a[234:235], v2 offset:2048
v_mfma_f32_16x16x32_bf16 a[28:31], a[236:239], v[28:31], a[28:31]
v_permlane32_swap_b32 v97, v99
s_waitcnt lgkmcnt(6)
v_mfma_f32_16x16x32_bf16 a[32:35], a[240:243], v[24:27], a[32:35]
ds_read_b64_tr_b16 a[236:237], v3 offset:0
ds_read_b64_tr_b16 a[238:239], v3 offset:2048
v_mfma_f32_16x16x32_bf16 a[40:43], a[240:243], v[28:31], a[40:43]
s_xor_b32 s32, s33, 8
s_cmp_eq_u32 s3, 77
v_mfma_f32_16x16x32_bf16 a[36:39], a[244:247], v[24:27], a[36:39]
ds_read_b64_tr_b16 a[240:241], v0 offset:4096
ds_read_b64_tr_b16 a[242:243], v0 offset:6144
v_mfma_f32_16x16x32_bf16 a[44:47], a[244:247], v[28:31], a[44:47]
buffer_atomic_add v13, v8, s[64:67], s32 offen sc1
v_mfma_f32_16x16x32_bf16 a[48:51], a[248:251], v[24:27], a[48:51]
ds_read_b64_tr_b16 a[244:245], v1 offset:4096
ds_read_b64_tr_b16 a[246:247], v1 offset:6144
v_mfma_f32_16x16x32_bf16 a[56:59], a[248:251], v[28:31], a[56:59]
s_add_u32 m0, s4, 32768
s_mov_b32 s5, 57856
v_mfma_f32_16x16x32_bf16 a[52:55], a[252:255], v[24:27], a[52:55]
ds_read_b64_tr_b16 a[248:249], v2 offset:4096
ds_read_b64_tr_b16 a[250:251], v2 offset:6144
v_mfma_f32_16x16x32_bf16 a[60:63], a[252:255], v[28:31], a[60:63]
buffer_load_dwordx4 v9, s[24:27], s5 offen lds
L_step_57:
s_waitcnt lgkmcnt(6)
v_mfma_f32_16x16x32_bf16 v[32:35], a[224:227], v[128:131], 0
ds_read_b64_tr_b16 a[252:253], v3 offset:4096
ds_read_b64_tr_b16 a[254:255], v3 offset:6144
v_mfma_f32_16x16x32_bf16 v[40:43], a[224:227], v[132:135], 0
s_add_u32 m0, s4, 114688
s_waitcnt vmcnt(7)
v_permlane32_swap_b32 v100, v102
v_mfma_f32_16x16x32_bf16 v[36:39], a[228:231], v[128:131], 0
ds_read_b64_tr_b16 a[224:225], v0 offset:8192
ds_read_b64_tr_b16 a[226:227], v0 offset:10240
v_mfma_f32_16x16x32_bf16 v[44:47], a[228:231], v[132:135], 0
buffer_load_dwordx4 v8, s[16:19], s35 offen offset:2048 nt lds
s_add_u32 m0, s4, 32768
v_mfma_f32_16x16x32_bf16 v[48:51], a[232:235], v[128:131], 0
ds_read_b64_tr_b16 a[228:229], v1 offset:8192
ds_read_b64_tr_b16 a[230:231], v1 offset:10240
v_mfma_f32_16x16x32_bf16 v[56:59], a[232:235], v[132:135], 0
s_mov_b32 s5, 64000
buffer_load_dwordx4 v9, s[24:27], s5 offen offset:1024 lds
v_mfma_f32_16x16x32_bf16 v[52:55], a[236:239], v[128:131], 0
ds_read_b64_tr_b16 a[232:233], v2 offset:8192
ds_read_b64_tr_b16 a[234:235], v2 offset:10240
v_mfma_f32_16x16x32_bf16 v[60:63], a[236:239], v[132:135], 0
s_mov_b32 s5, 70144
s_waitcnt lgkmcnt(6)
v_mfma_f32_16x16x32_bf16 v[32:35], a[240:243], v[136:139], v[32:35]
ds_read_b64_tr_b16 a[236:237], v3 offset:8192
ds_read_b64_tr_b16 a[238:239], v3 offset:10240
v_mfma_f32_16x16x32_bf16 v[40:43], a[240:243], v[140:143], v[40:43]
buffer_load_dwordx4 v9, s[24:27], s5 offen offset:2048 lds
v_mfma_f32_16x16x32_bf16 v[36:39], a[244:247], v[136:139], v[36:39]
ds_read_b64_tr_b16 a[240:241], v0 offset:12288
ds_read_b64_tr_b16 a[242:243], v0 offset:14336
v_mfma_f32_16x16x32_bf16 v[44:47], a[244:247], v[140:143], v[44:47]
v_add_u32 v0, 0x14000, v0
s_mov_b32 s5, 76288
v_mfma_f32_16x16x32_bf16 v[48:51], a[248:251], v[136:139], v[48:51]
ds_read_b64_tr_b16 a[244:245], v1 offset:12288
ds_read_b64_tr_b16 a[246:247], v1 offset:14336
v_mfma_f32_16x16x32_bf16 v[56:59], a[248:251], v[140:143], v[56:59]
buffer_load_dwordx4 v9, s[24:27], s5 offen offset:3072 lds
v_mfma_f32_16x16x32_bf16 v[52:55], a[252:255], v[136:139], v[52:55]
ds_read_b64_tr_b16 a[248:249], v2 offset:12288
ds_read_b64_tr_b16 a[250:251], v2 offset:14336
v_mfma_f32_16x16x32_bf16 v[60:63], a[252:255], v[140:143], v[60:63]
v_add_u32 v1, 0x14000, v1
s_waitcnt lgkmcnt(6)
v_mfma_f32_16x16x32_bf16 v[32:35], a[224:227], v[144:147], v[32:35]
ds_read_b64_tr_b16 a[252:253], v3 offset:12288
ds_read_b64_tr_b16 a[254:255], v3 offset:14336
v_mfma_f32_16x16x32_bf16 v[40:43], a[224:227], v[148:151], v[40:43]
s_add_u32 m0, s4, 114688
s_waitcnt vmcnt(9)
v_mfma_f32_16x16x32_bf16 v[36:39], a[228:231], v[144:147], v[36:39]
s_barrier
ds_read_b64_tr_b16 a[224:225], v0 offset:49152
v_mfma_f32_16x16x32_bf16 v[44:47], a[228:231], v[148:151], v[44:47]
ds_read_b64_tr_b16 a[226:227], v0 offset:51200
buffer_load_dwordx4 v8, s[16:19], s35 offen offset:3072 nt lds
v_mfma_f32_16x16x32_bf16 v[48:51], a[232:235], v[144:147], v[48:51]
ds_read_b64_tr_b16 a[228:229], v1 offset:49152
ds_read_b64_tr_b16 a[230:231], v1 offset:51200
v_mfma_f32_16x16x32_bf16 v[56:59], a[232:235], v[148:151], v[56:59]
v_add_u32 v2, 0x14000, v2
v_add_u32 v3, 0x14000, v3
v_mfma_f32_16x16x32_bf16 v[52:55], a[236:239], v[144:147], v[52:55]
ds_read_b64_tr_b16 a[232:233], v2 offset:49152
ds_read_b64_tr_b16 a[234:235], v2 offset:51200
v_mfma_f32_16x16x32_bf16 v[60:63], a[236:239], v[148:151], v[60:63]
v_permlane32_swap_b32 v101, v103
s_waitcnt lgkmcnt(6)
v_mfma_f32_16x16x32_bf16 v[32:35], a[240:243], v[152:155], v[32:35]
ds_read_b64_tr_b16 a[236:237], v3 offset:49152
ds_read_b64_tr_b16 a[238:239], v3 offset:51200
v_mfma_f32_16x16x32_bf16 v[40:43], a[240:243], v[156:159], v[40:43]
s_xor_b32 s32, s33, 16
s_cmp_eq_u32 s3, 77
v_mfma_f32_16x16x32_bf16 v[36:39], a[244:247], v[152:155], v[36:39]
ds_read_b64_tr_b16 a[240:241], v0 offset:57344
ds_read_b64_tr_b16 a[242:243], v0 offset:59392
v_mfma_f32_16x16x32_bf16 v[44:47], a[244:247], v[156:159], v[44:47]
buffer_atomic_add v13, v8, s[64:67], s32 offen sc1
v_mfma_f32_16x16x32_bf16 v[48:51], a[248:251], v[152:155], v[48:51]
ds_read_b64_tr_b16 a[244:245], v1 offset:57344
ds_read_b64_tr_b16 a[246:247], v1 offset:59392
v_mfma_f32_16x16x32_bf16 v[56:59], a[248:251], v[156:159], v[56:59]
s_add_u32 m0, s4, 65536
s_mov_b32 s35, 196992
v_mfma_f32_16x16x32_bf16 v[52:55], a[252:255], v[152:155], v[52:55]
ds_read_b64_tr_b16 a[248:249], v2 offset:57344
ds_read_b64_tr_b16 a[250:251], v2 offset:59392
v_mfma_f32_16x16x32_bf16 v[60:63], a[252:255], v[156:159], v[60:63]
s_waitcnt vmcnt(9)
L_step_58:
s_waitcnt lgkmcnt(6)
v_mfma_f32_16x16x32_bf16 a[64:67], a[224:227], v[16:19], a[64:67]
ds_read_b64_tr_b16 a[252:253], v3 offset:57344
ds_read_b64_tr_b16 a[254:255], v3 offset:59392
v_mfma_f32_16x16x32_bf16 a[72:75], a[224:227], v[20:23], a[72:75]
buffer_load_dwordx4 v8, s[16:19], s35 offen nt lds
v_mfma_f32_16x16x32_bf16 a[68:71], a[228:231], v[16:19], a[68:71]
ds_read_b64_tr_b16 a[224:225], v0 offset:53248
ds_read_b64_tr_b16 a[226:227], v0 offset:55296
v_mfma_f32_16x16x32_bf16 a[76:79], a[228:231], v[20:23], a[76:79]
v_permlane16_swap_b32 v96, v98
v_permlane16_swap_b32 v97, v99
v_mfma_f32_16x16x32_bf16 a[80:83], a[232:235], v[16:19], a[80:83]
ds_read_b64_tr_b16 a[228:229], v1 offset:53248
ds_read_b64_tr_b16 a[230:231], v1 offset:55296
v_mfma_f32_16x16x32_bf16 a[88:91], a[232:235], v[20:23], a[88:91]
v_permlane16_swap_b32 v100, v102
v_permlane16_swap_b32 v101, v103
v_mfma_f32_16x16x32_bf16 a[84:87], a[236:239], v[16:19], a[84:87]
ds_read_b64_tr_b16 a[232:233], v2 offset:53248
ds_read_b64_tr_b16 a[234:235], v2 offset:55296
v_mfma_f32_16x16x32_bf16 a[92:95], a[236:239], v[20:23], a[92:95]
v_permlane32_swap_b32 v104, v106
s_waitcnt lgkmcnt(6)
v_mfma_f32_16x16x32_bf16 a[96:99], a[240:243], v[16:19], a[96:99]
ds_read_b64_tr_b16 a[236:237], v3 offset:53248
ds_read_b64_tr_b16 a[238:239], v3 offset:55296
v_mfma_f32_16x16x32_bf16 a[104:107], a[240:243], v[20:23], a[104:107]
v_permlane32_swap_b32 v105, v107
v_permlane32_swap_b32 v108, v110
v_mfma_f32_16x16x32_bf16 a[100:103], a[244:247], v[16:19], a[100:103]
ds_read_b64_tr_b16 a[240:241], v0 offset:61440
ds_read_b64_tr_b16 a[242:243], v0 offset:63488
v_mfma_f32_16x16x32_bf16 a[108:111], a[244:247], v[20:23], a[108:111]
s_waitcnt vmcnt(9)
v_permlane32_swap_b32 v109, v111
v_mfma_f32_16x16x32_bf16 a[112:115], a[248:251], v[16:19], a[112:115]
ds_read_b64_tr_b16 a[244:245], v1 offset:61440
ds_read_b64_tr_b16 a[246:247], v1 offset:63488
v_mfma_f32_16x16x32_bf16 a[120:123], a[248:251], v[20:23], a[120:123]
buffer_load_dwordx4 v8, s[16:19], s35 offen offset:1024 nt lds
v_mfma_f32_16x16x32_bf16 a[116:119], a[252:255], v[16:19], a[116:119]
ds_read_b64_tr_b16 a[248:249], v2 offset:61440
ds_read_b64_tr_b16 a[250:251], v2 offset:63488
v_mfma_f32_16x16x32_bf16 a[124:127], a[252:255], v[20:23], a[124:127]
v_permlane16_swap_b32 v104, v106
s_waitcnt lgkmcnt(6)
v_mfma_f32_16x16x32_bf16 a[64:67], a[224:227], v[24:27], a[64:67]
ds_read_b64_tr_b16 a[252:253], v3 offset:61440
ds_read_b64_tr_b16 a[254:255], v3 offset:63488
v_mfma_f32_16x16x32_bf16 a[72:75], a[224:227], v[28:31], a[72:75]
s_xor_b32 s32, s33, 24
s_cmp_eq_u32 s3, 77
v_mfma_f32_16x16x32_bf16 a[68:71], a[228:231], v[24:27], a[68:71]
s_barrier
ds_read_b64_tr_b16 a[224:225], v0 offset:0
v_mfma_f32_16x16x32_bf16 a[76:79], a[228:231], v[28:31], a[76:79]
ds_read_b64_tr_b16 a[226:227], v0 offset:2048
v_permlane16_swap_b32 v105, v107
v_mfma_f32_16x16x32_bf16 a[80:83], a[232:235], v[24:27], a[80:83]
ds_read_b64_tr_b16 a[228:229], v1 offset:0
ds_read_b64_tr_b16 a[230:231], v1 offset:2048
v_mfma_f32_16x16x32_bf16 a[88:91], a[232:235], v[28:31], a[88:91]
buffer_atomic_add v13, v8, s[64:67], s32 offen sc1
v_mfma_f32_16x16x32_bf16 a[84:87], a[236:239], v[24:27], a[84:87]
ds_read_b64_tr_b16 a[232:233], v2 offset:0
ds_read_b64_tr_b16 a[234:235], v2 offset:2048
v_mfma_f32_16x16x32_bf16 a[92:95], a[236:239], v[28:31], a[92:95]
v_permlane16_swap_b32 v108, v110
s_waitcnt lgkmcnt(6)
v_mfma_f32_16x16x32_bf16 a[96:99], a[240:243], v[24:27], a[96:99]
ds_read_b64_tr_b16 a[236:237], v3 offset:0
ds_read_b64_tr_b16 a[238:239], v3 offset:2048
v_mfma_f32_16x16x32_bf16 a[104:107], a[240:243], v[28:31], a[104:107]
s_waitcnt vmcnt(8)
v_permlane16_swap_b32 v109, v111
v_mfma_f32_16x16x32_bf16 a[100:103], a[244:247], v[24:27], a[100:103]
ds_read_b64_tr_b16 a[240:241], v0 offset:4096
ds_read_b64_tr_b16 a[242:243], v0 offset:6144
v_mfma_f32_16x16x32_bf16 a[108:111], a[244:247], v[28:31], a[108:111]
buffer_load_dwordx4 v8, s[16:19], s35 offen offset:2048 nt lds
v_mfma_f32_16x16x32_bf16 a[112:115], a[248:251], v[24:27], a[112:115]
ds_read_b64_tr_b16 a[244:245], v1 offset:4096
ds_read_b64_tr_b16 a[246:247], v1 offset:6144
v_mfma_f32_16x16x32_bf16 a[120:123], a[248:251], v[28:31], a[120:123]
s_add_u32 m0, s4, 16384
s_add_u32 s5, s88, 58112
v_mfma_f32_16x16x32_bf16 a[116:119], a[252:255], v[24:27], a[116:119]
ds_read_b64_tr_b16 a[248:249], v2 offset:4096
ds_read_b64_tr_b16 a[250:251], v2 offset:6144
v_mfma_f32_16x16x32_bf16 a[124:127], a[252:255], v[28:31], a[124:127]
buffer_load_dwordx4 v9, s[24:27], s5 offen lds
L_step_59:
s_waitcnt lgkmcnt(6)
v_mfma_f32_16x16x32_bf16 v[32:35], a[224:227], v[160:163], v[32:35]
ds_read_b64_tr_b16 a[252:253], v3 offset:4096
ds_read_b64_tr_b16 a[254:255], v3 offset:6144
v_mfma_f32_16x16x32_bf16 v[40:43], a[224:227], v[164:167], v[40:43]
s_add_u32 s5, s88, 64256
v_permlane32_swap_b32 v112, v114
v_mfma_f32_16x16x32_bf16 v[36:39], a[228:231], v[160:163], v[36:39]
ds_read_b64_tr_b16 a[224:225], v0 offset:8192
ds_read_b64_tr_b16 a[226:227], v0 offset:10240
v_mfma_f32_16x16x32_bf16 v[44:47], a[228:231], v[164:167], v[44:47]
buffer_load_dwordx4 v9, s[24:27], s5 offen offset:1024 lds
v_mfma_f32_16x16x32_bf16 v[48:51], a[232:235], v[160:163], v[48:51]
ds_read_b64_tr_b16 a[228:229], v1 offset:8192
ds_read_b64_tr_b16 a[230:231], v1 offset:10240
v_mfma_f32_16x16x32_bf16 v[56:59], a[232:235], v[164:167], v[56:59]
s_add_u32 s5, s88, 70400
v_permlane32_swap_b32 v113, v115
v_mfma_f32_16x16x32_bf16 v[52:55], a[236:239], v[160:163], v[52:55]
ds_read_b64_tr_b16 a[232:233], v2 offset:8192
ds_read_b64_tr_b16 a[234:235], v2 offset:10240
v_mfma_f32_16x16x32_bf16 v[60:63], a[236:239], v[164:167], v[60:63]
v_permlane32_swap_b32 v116, v118
s_waitcnt lgkmcnt(6)
v_mfma_f32_16x16x32_bf16 v[32:35], a[240:243], v[168:171], v[32:35]
ds_read_b64_tr_b16 a[236:237], v3 offset:8192
ds_read_b64_tr_b16 a[238:239], v3 offset:10240
v_mfma_f32_16x16x32_bf16 v[40:43], a[240:243], v[172:175], v[40:43]
buffer_load_dwordx4 v9, s[24:27], s5 offen offset:2048 lds
v_mfma_f32_16x16x32_bf16 v[36:39], a[244:247], v[168:171], v[36:39]
ds_read_b64_tr_b16 a[240:241], v0 offset:12288
ds_read_b64_tr_b16 a[242:243], v0 offset:14336
v_mfma_f32_16x16x32_bf16 v[44:47], a[244:247], v[172:175], v[44:47]
s_add_u32 m0, s4, 65536
s_waitcnt vmcnt(8)
v_mfma_f32_16x16x32_bf16 v[48:51], a[248:251], v[168:171], v[48:51]
ds_read_b64_tr_b16 a[244:245], v1 offset:12288
ds_read_b64_tr_b16 a[246:247], v1 offset:14336
v_mfma_f32_16x16x32_bf16 v[56:59], a[248:251], v[172:175], v[56:59]
buffer_load_dwordx4 v8, s[16:19], s35 offen offset:3072 nt lds
v_add_u32 v0, 0xfffe8000, v0
v_mfma_f32_16x16x32_bf16 v[52:55], a[252:255], v[168:171], v[52:55]
ds_read_b64_tr_b16 a[248:249], v2 offset:12288
ds_read_b64_tr_b16 a[250:251], v2 offset:14336
v_mfma_f32_16x16x32_bf16 v[60:63], a[252:255], v[172:175], v[60:63]
s_add_u32 m0, s4, 16384
s_waitcnt lgkmcnt(6)
v_mfma_f32_16x16x32_bf16 v[32:35], a[224:227], v[176:179], v[32:35]
ds_read_b64_tr_b16 a[252:253], v3 offset:12288
ds_read_b64_tr_b16 a[254:255], v3 offset:14336
v_mfma_f32_16x16x32_bf16 v[40:43], a[224:227], v[180:183], v[40:43]
s_add_u32 s5, s88, 76544
buffer_load_dwordx4 v9, s[24:27], s5 offen offset:3072 lds
v_mfma_f32_16x16x32_bf16 v[36:39], a[228:231], v[176:179], v[36:39]
s_barrier
ds_read_b64_tr_b16 a[224:225], v0 offset:32768
v_mfma_f32_16x16x32_bf16 v[44:47], a[228:231], v[180:183], v[44:47]
ds_read_b64_tr_b16 a[226:227], v0 offset:34816
v_add_u32 v1, 0xfffe8000, v1
v_mfma_f32_16x16x32_bf16 v[48:51], a[232:235], v[176:179], v[48:51]
ds_read_b64_tr_b16 a[228:229], v1 offset:32768
ds_read_b64_tr_b16 a[230:231], v1 offset:34816
v_mfma_f32_16x16x32_bf16 v[56:59], a[232:235], v[180:183], v[56:59]
v_add_u32 v2, 0xfffe8000, v2
v_add_u32 v3, 0xfffe8000, v3
v_mfma_f32_16x16x32_bf16 v[52:55], a[236:239], v[176:179], v[52:55]
ds_read_b64_tr_b16 a[232:233], v2 offset:32768
ds_read_b64_tr_b16 a[234:235], v2 offset:34816
v_mfma_f32_16x16x32_bf16 v[60:63], a[236:239], v[180:183], v[60:63]
v_permlane32_swap_b32 v117, v119
s_waitcnt lgkmcnt(6)
v_mfma_f32_16x16x32_bf16 v[32:35], a[240:243], v[184:187], v[32:35]
ds_read_b64_tr_b16 a[236:237], v3 offset:32768
ds_read_b64_tr_b16 a[238:239], v3 offset:34816
v_mfma_f32_16x16x32_bf16 v[40:43], a[240:243], v[188:191], v[40:43]
s_xor_b32 s32, s33, 32
s_cmp_eq_u32 s3, 77
v_permlane16_swap_b32 v112, v114
v_mfma_f32_16x16x32_bf16 v[36:39], a[244:247], v[184:187], v[36:39]
ds_read_b64_tr_b16 a[240:241], v0 offset:40960
ds_read_b64_tr_b16 a[242:243], v0 offset:43008
v_mfma_f32_16x16x32_bf16 v[44:47], a[244:247], v[188:191], v[44:47]
buffer_atomic_add v13, v8, s[64:67], s32 offen sc1
s_add_u32 m0, s4, 147456
v_mfma_f32_16x16x32_bf16 v[48:51], a[248:251], v[184:187], v[48:51]
ds_read_b64_tr_b16 a[244:245], v1 offset:40960
ds_read_b64_tr_b16 a[246:247], v1 offset:43008
s_mov_b32 s35, 262144
v_mfma_f32_16x16x32_bf16 v[56:59], a[248:251], v[188:191], v[56:59]
s_waitcnt vmcnt(9)
buffer_load_dwordx4 v6, s[12:15], s35 offen nt lds
v_mfma_f32_16x16x32_bf16 v[52:55], a[252:255], v[184:187], v[52:55]
ds_read_b64_tr_b16 a[248:249], v2 offset:40960
ds_read_b64_tr_b16 a[250:251], v2 offset:43008
v_mfma_f32_16x16x32_bf16 v[60:63], a[252:255], v[188:191], v[60:63]
v_permlane16_swap_b32 v113, v115
L_step_60:
s_waitcnt lgkmcnt(6)
v_mfma_f32_16x16x32_bf16 a[128:131], a[224:227], v[16:19], a[128:131]
ds_read_b64_tr_b16 a[252:253], v3 offset:40960
ds_read_b64_tr_b16 a[254:255], v3 offset:43008
v_mfma_f32_16x16x32_bf16 a[136:139], a[224:227], v[20:23], a[136:139]
v_permlane16_swap_b32 v116, v118
v_permlane16_swap_b32 v117, v119
v_mfma_f32_16x16x32_bf16 a[132:135], a[228:231], v[16:19], a[132:135]
ds_read_b64_tr_b16 a[224:225], v0 offset:36864
ds_read_b64_tr_b16 a[226:227], v0 offset:38912
v_mfma_f32_16x16x32_bf16 a[140:143], a[228:231], v[20:23], a[140:143]
v_permlane32_swap_b32 v120, v122
v_permlane32_swap_b32 v121, v123
v_mfma_f32_16x16x32_bf16 a[144:147], a[232:235], v[16:19], a[144:147]
ds_read_b64_tr_b16 a[228:229], v1 offset:36864
ds_read_b64_tr_b16 a[230:231], v1 offset:38912
v_mfma_f32_16x16x32_bf16 a[152:155], a[232:235], v[20:23], a[152:155]
s_waitcnt vmcnt(9)
v_permlane32_swap_b32 v124, v126
v_mfma_f32_16x16x32_bf16 a[148:151], a[236:239], v[16:19], a[148:151]
ds_read_b64_tr_b16 a[232:233], v2 offset:36864
ds_read_b64_tr_b16 a[234:235], v2 offset:38912
v_mfma_f32_16x16x32_bf16 a[156:159], a[236:239], v[20:23], a[156:159]
v_permlane32_swap_b32 v125, v127
s_waitcnt lgkmcnt(6)
L_pg12:
s_cbranch_scc1 L_pg16
v_mfma_f32_16x16x32_bf16 a[160:163], a[240:243], v[16:19], a[160:163]
ds_read_b64_tr_b16 a[236:237], v3 offset:36864
ds_read_b64_tr_b16 a[238:239], v3 offset:38912
v_mfma_f32_16x16x32_bf16 a[168:171], a[240:243], v[20:23], a[168:171]
buffer_load_dwordx4 v7, s[12:15], s35 offen offset:1024 nt lds
v_mfma_f32_16x16x32_bf16 a[164:167], a[244:247], v[16:19], a[164:167]
ds_read_b64_tr_b16 a[240:241], v0 offset:45056
ds_read_b64_tr_b16 a[242:243], v0 offset:47104
v_mfma_f32_16x16x32_bf16 a[172:175], a[244:247], v[20:23], a[172:175]
v_permlane16_swap_b32 v120, v122
v_permlane16_swap_b32 v121, v123
v_mfma_f32_16x16x32_bf16 a[176:179], a[248:251], v[16:19], a[176:179]
ds_read_b64_tr_b16 a[244:245], v1 offset:45056
ds_read_b64_tr_b16 a[246:247], v1 offset:47104
v_mfma_f32_16x16x32_bf16 a[184:187], a[248:251], v[20:23], a[184:187]
v_permlane16_swap_b32 v124, v126
v_permlane16_swap_b32 v125, v127
v_mfma_f32_16x16x32_bf16 a[180:183], a[252:255], v[16:19], a[180:183]
ds_read_b64_tr_b16 a[248:249], v2 offset:45056
v_mfma_f32_16x16x32_bf16 a[188:191], a[252:255], v[20:23], a[188:191]
ds_read_b64_tr_b16 a[250:251], v2 offset:47104
s_waitcnt lgkmcnt(6)
v_mfma_f32_16x16x32_bf16 a[128:131], a[224:227], v[24:27], a[128:131]
ds_read_b64_tr_b16 a[252:253], v3 offset:45056
v_mfma_f32_16x16x32_bf16 a[136:139], a[224:227], v[28:31], a[136:139]
ds_read_b64_tr_b16 a[254:255], v3 offset:47104
v_mfma_f32_16x16x32_bf16 a[132:135], a[228:231], v[24:27], a[132:135]
s_barrier
v_mfma_f32_16x16x32_bf16 a[140:143], a[228:231], v[28:31], a[140:143]
ds_read_b64_tr_b16 a[224:225], v0 offset:49152
ds_read_b64_tr_b16 a[226:227], v0 offset:51200
v_mfma_f32_16x16x32_bf16 a[144:147], a[232:235], v[24:27], a[144:147]
ds_read_b64_tr_b16 a[228:229], v1 offset:49152
ds_read_b64_tr_b16 a[230:231], v1 offset:51200
v_mfma_f32_16x16x32_bf16 a[152:155], a[232:235], v[28:31], a[152:155]
s_waitcnt vmcnt(8)
buffer_load_dwordx4 v6, s[12:15], s35 offen offset:2048 nt lds
v_mfma_f32_16x16x32_bf16 a[148:151], a[236:239], v[24:27], a[148:151]
ds_read_b64_tr_b16 a[232:233], v2 offset:49152
ds_read_b64_tr_b16 a[234:235], v2 offset:51200
v_mfma_f32_16x16x32_bf16 a[156:159], a[236:239], v[28:31], a[156:159]
s_xor_b32 s32, s33, 40
s_cmp_eq_u32 s3, 77
s_waitcnt lgkmcnt(6)
v_mfma_f32_16x16x32_bf16 a[160:163], a[240:243], v[24:27], a[160:163]
ds_read_b64_tr_b16 a[236:237], v3 offset:49152
ds_read_b64_tr_b16 a[238:239], v3 offset:51200
v_mfma_f32_16x16x32_bf16 a[168:171], a[240:243], v[28:31], a[168:171]
buffer_atomic_add v13, v8, s[64:67], s32 offen sc1
s_add_u32 m0, s4, 98304
v_mfma_f32_16x16x32_bf16 a[164:167], a[244:247], v[24:27], a[164:167]
ds_read_b64_tr_b16 a[240:241], v0 offset:53248
ds_read_b64_tr_b16 a[242:243], v0 offset:55296
v_mfma_f32_16x16x32_bf16 a[172:175], a[244:247], v[28:31], a[172:175]
s_mov_b32 s5, 114688
buffer_load_dwordx4 v9, s[24:27], s5 offen lds
v_mfma_f32_16x16x32_bf16 a[176:179], a[248:251], v[24:27], a[176:179]
ds_read_b64_tr_b16 a[244:245], v1 offset:53248
ds_read_b64_tr_b16 a[246:247], v1 offset:55296
v_mfma_f32_16x16x32_bf16 a[184:187], a[248:251], v[28:31], a[184:187]
s_mov_b32 s5, 120832
buffer_load_dwordx4 v9, s[24:27], s5 offen offset:1024 lds
v_mfma_f32_16x16x32_bf16 a[180:183], a[252:255], v[24:27], a[180:183]
ds_read_b64_tr_b16 a[248:249], v2 offset:53248
ds_read_b64_tr_b16 a[250:251], v2 offset:55296
s_mov_b32 s5, 126976
v_mfma_f32_16x16x32_bf16 a[188:191], a[252:255], v[28:31], a[188:191]
buffer_load_dwordx4 v9, s[24:27], s5 offen offset:2048 lds
L_step_61:
s_waitcnt lgkmcnt(6)
v_mfma_f32_16x16x32_bf16 v[32:35], a[224:227], v[192:195], v[32:35]
ds_read_b64_tr_b16 a[252:253], v3 offset:53248
ds_read_b64_tr_b16 a[254:255], v3 offset:55296
v_mfma_f32_16x16x32_bf16 v[40:43], a[224:227], v[196:199], v[40:43]
s_mov_b32 s5, 133120
buffer_load_dwordx4 v9, s[24:27], s5 offen offset:3072 lds
v_mfma_f32_16x16x32_bf16 v[36:39], a[228:231], v[192:195], v[36:39]
ds_read_b64_tr_b16 a[224:225], v0 offset:57344
ds_read_b64_tr_b16 a[226:227], v0 offset:59392
v_mfma_f32_16x16x32_bf16 v[44:47], a[228:231], v[196:199], v[44:47]
s_add_u32 m0, s4, 147456
s_waitcnt vmcnt(10)
v_mfma_f32_16x16x32_bf16 v[48:51], a[232:235], v[192:195], v[48:51]
ds_read_b64_tr_b16 a[228:229], v1 offset:57344
ds_read_b64_tr_b16 a[230:231], v1 offset:59392
v_mfma_f32_16x16x32_bf16 v[56:59], a[232:235], v[196:199], v[56:59]
buffer_load_dwordx4 v7, s[12:15], s35 offen offset:3072 nt lds
v_mfma_f32_16x16x32_bf16 v[52:55], a[236:239], v[192:195], v[52:55]
ds_read_b64_tr_b16 a[232:233], v2 offset:57344
v_mfma_f32_16x16x32_bf16 v[60:63], a[236:239], v[196:199], v[60:63]
ds_read_b64_tr_b16 a[234:235], v2 offset:59392
s_waitcnt lgkmcnt(6)
v_mfma_f32_16x16x32_bf16 v[32:35], a[240:243], v[200:203], v[32:35]
ds_read_b64_tr_b16 a[236:237], v3 offset:57344
v_mfma_f32_16x16x32_bf16 v[40:43], a[240:243], v[204:207], v[40:43]
ds_read_b64_tr_b16 a[238:239], v3 offset:59392
v_mfma_f32_16x16x32_bf16 v[36:39], a[244:247], v[200:203], v[36:39]
ds_read_b64_tr_b16 a[240:241], v0 offset:61440
v_mfma_f32_16x16x32_bf16 v[44:47], a[244:247], v[204:207], v[44:47]
ds_read_b64_tr_b16 a[242:243], v0 offset:63488
v_mfma_f32_16x16x32_bf16 v[48:51], a[248:251], v[200:203], v[48:51]
ds_read_b64_tr_b16 a[244:245], v1 offset:61440
v_mfma_f32_16x16x32_bf16 v[56:59], a[248:251], v[204:207], v[56:59]
ds_read_b64_tr_b16 a[246:247], v1 offset:63488
v_mfma_f32_16x16x32_bf16 v[52:55], a[252:255], v[200:203], v[52:55]
ds_read_b64_tr_b16 a[248:249], v2 offset:61440
ds_read_b64_tr_b16 a[250:251], v2 offset:63488
v_mfma_f32_16x16x32_bf16 v[60:63], a[252:255], v[204:207], v[60:63]
s_add_u32 m0, s4, 32768
s_waitcnt lgkmcnt(6)
v_mfma_f32_16x16x32_bf16 v[32:35], a[224:227], v[208:211], v[32:35]
ds_read_b64_tr_b16 a[252:253], v3 offset:61440
v_mfma_f32_16x16x32_bf16 v[40:43], a[224:227], v[212:215], v[40:43]
ds_read_b64_tr_b16 a[254:255], v3 offset:63488
s_mov_b32 s35, 278528
v_mfma_f32_16x16x32_bf16 v[36:39], a[228:231], v[208:211], v[36:39]
s_waitcnt vmcnt(10)
s_barrier
v_mfma_f32_16x16x32_bf16 v[44:47], a[228:231], v[212:215], v[44:47]
ds_read_b64_tr_b16 a[224:225], v0 offset:16384
ds_read_b64_tr_b16 a[226:227], v0 offset:18432
v_mfma_f32_16x16x32_bf16 v[48:51], a[232:235], v[208:211], v[48:51]
ds_read_b64_tr_b16 a[228:229], v1 offset:16384
v_mfma_f32_16x16x32_bf16 v[56:59], a[232:235], v[212:215], v[56:59]
ds_read_b64_tr_b16 a[230:231], v1 offset:18432
s_waitcnt vmcnt(8)
v_mfma_f32_16x16x32_bf16 v[52:55], a[236:239], v[208:211], v[52:55]
ds_read_b64_tr_b16 a[232:233], v2 offset:16384
v_mfma_f32_16x16x32_bf16 v[60:63], a[236:239], v[212:215], v[60:63]
ds_read_b64_tr_b16 a[234:235], v2 offset:18432
s_waitcnt lgkmcnt(6)
v_mfma_f32_16x16x32_bf16 v[32:35], a[240:243], v[216:219], v[32:35]
ds_read_b64_tr_b16 a[236:237], v3 offset:16384
ds_read_b64_tr_b16 a[238:239], v3 offset:18432
v_mfma_f32_16x16x32_bf16 v[40:43], a[240:243], v[220:223], v[40:43]
buffer_load_dwordx4 v6, s[12:15], s35 offen nt lds
v_mfma_f32_16x16x32_bf16 v[36:39], a[244:247], v[216:219], v[36:39]
ds_read_b64_tr_b16 a[240:241], v0 offset:20480
ds_read_b64_tr_b16 a[242:243], v0 offset:22528
v_mfma_f32_16x16x32_bf16 v[44:47], a[244:247], v[220:223], v[44:47]
s_xor_b32 s32, s33, 48
s_cmp_eq_u32 s3, 77
buffer_atomic_add v13, v8, s[64:67], s32 offen sc1
v_mfma_f32_16x16x32_bf16 v[48:51], a[248:251], v[216:219], v[48:51]
ds_read_b64_tr_b16 a[244:245], v1 offset:20480
v_mfma_f32_16x16x32_bf16 v[56:59], a[248:251], v[220:223], v[56:59]
ds_read_b64_tr_b16 a[246:247], v1 offset:22528
v_mfma_f32_16x16x32_bf16 v[52:55], a[252:255], v[216:219], v[52:55]
ds_read_b64_tr_b16 a[248:249], v2 offset:20480
ds_read_b64_tr_b16 a[250:251], v2 offset:22528
v_mfma_f32_16x16x32_bf16 v[60:63], a[252:255], v[220:223], v[60:63]
s_waitcnt vmcnt(9)
L_step_62:
s_waitcnt lgkmcnt(6)
v_mfma_f32_16x16x32_bf16 a[192:195], a[224:227], v[16:19], a[192:195]
ds_read_b64_tr_b16 a[252:253], v3 offset:20480
ds_read_b64_tr_b16 a[254:255], v3 offset:22528
v_mfma_f32_16x16x32_bf16 a[200:203], a[224:227], v[20:23], a[200:203]
buffer_load_dwordx4 v7, s[12:15], s35 offen offset:1024 nt lds
v_mfma_f32_16x16x32_bf16 a[196:199], a[228:231], v[16:19], a[196:199]
s_barrier
v_mfma_f32_16x16x32_bf16 a[204:207], a[228:231], v[20:23], a[204:207]
ds_read_b64_tr_b16 a[224:225], v0 offset:0
ds_read_b64_tr_b16 a[226:227], v0 offset:2048
v_mfma_f32_16x16x32_bf16 a[208:211], a[232:235], v[16:19], a[208:211]
ds_read_b64_tr_b16 a[228:229], v1 offset:0
ds_read_b64_tr_b16 a[230:231], v1 offset:2048
v_mfma_f32_16x16x32_bf16 a[216:219], a[232:235], v[20:23], a[216:219]
s_xor_b32 s32, s33, 56
s_cmp_eq_u32 s3, 77
v_mfma_f32_16x16x32_bf16 a[212:215], a[236:239], v[16:19], a[212:215]
ds_read_b64_tr_b16 a[232:233], v0 offset:4096
v_mfma_f32_16x16x32_bf16 a[220:223], a[236:239], v[20:23], a[220:223]
ds_read_b64_tr_b16 a[234:235], v0 offset:6144
s_waitcnt lgkmcnt(6)
v_mfma_f32_16x16x32_bf16 a[192:195], a[240:243], v[24:27], a[192:195]
ds_read_b64_tr_b16 a[236:237], v1 offset:4096
ds_read_b64_tr_b16 a[238:239], v1 offset:6144
v_mfma_f32_16x16x32_bf16 a[200:203], a[240:243], v[28:31], a[200:203]
buffer_atomic_add v13, v8, s[64:67], s32 offen sc1
v_mfma_f32_16x16x32_bf16 a[196:199], a[244:247], v[24:27], a[196:199]
ds_read_b64_tr_b16 a[240:241], v0 offset:8192
v_mfma_f32_16x16x32_bf16 a[204:207], a[244:247], v[28:31], a[204:207]
ds_read_b64_tr_b16 a[242:243], v0 offset:10240
s_waitcnt vmcnt(10)
v_mfma_f32_16x16x32_bf16 a[208:211], a[248:251], v[24:27], a[208:211]
ds_read_b64_tr_b16 a[244:245], v1 offset:8192
ds_read_b64_tr_b16 a[246:247], v1 offset:10240
v_mfma_f32_16x16x32_bf16 a[216:219], a[248:251], v[28:31], a[216:219]
buffer_load_dwordx4 v6, s[12:15], s35 offen offset:2048 nt lds
v_mfma_f32_16x16x32_bf16 a[212:215], a[252:255], v[24:27], a[212:215]
ds_read_b64_tr_b16 a[248:249], v0 offset:12288
ds_read_b64_tr_b16 a[250:251], v0 offset:14336
v_mfma_f32_16x16x32_bf16 a[220:223], a[252:255], v[28:31], a[220:223]
v_add_u32 v0, 0x14000, v0
L_step_63:
s_waitcnt lgkmcnt(6)
v_mfma_f32_16x16x32_bf16 v[32:35], a[224:227], v[224:227], v[32:35]
ds_read_b64_tr_b16 a[252:253], v1 offset:12288
v_mfma_f32_16x16x32_bf16 v[40:43], a[224:227], v[228:231], v[40:43]
ds_read_b64_tr_b16 a[254:255], v1 offset:14336
v_add_u32 v1, 0x14000, v1
v_mfma_f32_16x16x32_bf16 v[36:39], a[228:231], v[224:227], v[36:39]
ds_read_b64_tr_b16 a[224:225], v2 offset:0
v_mfma_f32_16x16x32_bf16 v[44:47], a[228:231], v[228:231], v[44:47]
ds_read_b64_tr_b16 a[226:227], v2 offset:2048
v_mfma_f32_16x16x32_bf16 v[32:35], a[232:235], v[232:235], v[32:35]
ds_read_b64_tr_b16 a[228:229], v3 offset:0
v_mfma_f32_16x16x32_bf16 v[40:43], a[232:235], v[236:239], v[40:43]
ds_read_b64_tr_b16 a[230:231], v3 offset:2048
v_mfma_f32_16x16x32_bf16 v[36:39], a[236:239], v[232:235], v[36:39]
ds_read_b64_tr_b16 a[232:233], v2 offset:4096
v_mfma_f32_16x16x32_bf16 v[44:47], a[236:239], v[236:239], v[44:47]
ds_read_b64_tr_b16 a[234:235], v2 offset:6144
s_waitcnt lgkmcnt(6)
v_mfma_f32_16x16x32_bf16 v[32:35], a[240:243], v[240:243], v[32:35]
ds_read_b64_tr_b16 a[236:237], v3 offset:4096
v_mfma_f32_16x16x32_bf16 v[40:43], a[240:243], v[244:247], v[40:43]
ds_read_b64_tr_b16 a[238:239], v3 offset:6144
s_waitcnt vmcnt(5)
v_mfma_f32_16x16x32_bf16 v[36:39], a[244:247], v[240:243], v[36:39]
ds_read_b64_tr_b16 a[240:241], v2 offset:8192
ds_read_b64_tr_b16 a[242:243], v2 offset:10240
v_mfma_f32_16x16x32_bf16 v[44:47], a[244:247], v[244:247], v[44:47]
buffer_load_dwordx4 v7, s[12:15], s35 offen offset:3072 nt lds
v_mfma_f32_16x16x32_bf16 v[32:35], a[248:251], v[248:251], v[32:35]
ds_read_b64_tr_b16 a[244:245], v3 offset:8192
v_mfma_f32_16x16x32_bf16 v[40:43], a[248:251], v[252:255], v[40:43]
ds_read_b64_tr_b16 a[246:247], v3 offset:10240
v_mfma_f32_16x16x32_bf16 v[36:39], a[252:255], v[248:251], v[36:39]
ds_read_b64_tr_b16 a[248:249], v2 offset:12288
ds_read_b64_tr_b16 a[250:251], v2 offset:14336
v_mfma_f32_16x16x32_bf16 v[44:47], a[252:255], v[252:255], v[44:47]
v_add_u32 v2, 0x14000, v2
s_waitcnt lgkmcnt(6)
v_mfma_f32_16x16x32_bf16 v[48:51], a[224:227], v[224:227], v[48:51]
ds_read_b64_tr_b16 a[252:253], v3 offset:12288
ds_read_b64_tr_b16 a[254:255], v3 offset:14336
v_mfma_f32_16x16x32_bf16 v[56:59], a[224:227], v[228:231], v[56:59]
v_add_u32 v3, 0x14000, v3
s_add_u32 m0, s4, 16384
v_mfma_f32_16x16x32_bf16 v[52:55], a[228:231], v[224:227], v[52:55]
s_barrier
ds_read_b64_tr_b16 a[224:225], v0 offset:16384
ds_read_b64_tr_b16 a[226:227], v0 offset:18432
v_mfma_f32_16x16x32_bf16 v[60:63], a[228:231], v[228:231], v[60:63]
s_mov_b32 s35, 294912
v_mul_f32 v32, v32, v14
v_mul_f32 v33, v33, v14
v_mfma_f32_16x16x32_bf16 v[48:51], a[232:235], v[232:235], v[48:51]
ds_read_b64_tr_b16 a[228:229], v1 offset:16384
ds_read_b64_tr_b16 a[230:231], v1 offset:18432
v_mul_f32 v34, v34, v14
v_mfma_f32_16x16x32_bf16 v[56:59], a[232:235], v[236:239], v[56:59]
v_mul_f32 v35, v35, v14
v_cvt_pk_bf16_f32 v16, v32, v33
v_mul_f32 v36, v36, v14
v_mfma_f32_16x16x32_bf16 v[52:55], a[236:239], v[232:235], v[52:55]
ds_read_b64_tr_b16 a[232:233], v2 offset:16384
ds_read_b64_tr_b16 a[234:235], v2 offset:18432
s_waitcnt vmcnt(5)
v_mfma_f32_16x16x32_bf16 v[60:63], a[236:239], v[236:239], v[60:63]
buffer_load_dwordx4 v6, s[12:15], s35 offen nt lds
v_mul_f32 v37, v37, v14
s_waitcnt lgkmcnt(6)
v_mfma_f32_16x16x32_bf16 v[48:51], a[240:243], v[240:243], v[48:51]
ds_read_b64_tr_b16 a[236:237], v3 offset:16384
ds_read_b64_tr_b16 a[238:239], v3 offset:18432
v_cvt_pk_bf16_f32 v17, v34, v35
v_mfma_f32_16x16x32_bf16 v[56:59], a[240:243], v[244:247], v[56:59]
v_mul_f32 v38, v38, v14
v_mul_f32 v39, v39, v14
v_cvt_pk_bf16_f32 v18, v36, v37
v_mfma_f32_16x16x32_bf16 v[52:55], a[244:247], v[240:243], v[52:55]
ds_read_b64_tr_b16 a[240:241], v0 offset:24576
ds_read_b64_tr_b16 a[242:243], v0 offset:26624
v_cvt_pk_bf16_f32 v19, v38, v39
v_mfma_f32_16x16x32_bf16 v[60:63], a[244:247], v[244:247], v[60:63]
v_mul_f32 v40, v40, v15
v_mul_f32 v41, v41, v15
v_mul_f32 v42, v42, v15
v_mul_f32 v43, v43, v15
v_mfma_f32_16x16x32_bf16 v[48:51], a[248:251], v[248:251], v[48:51]
ds_read_b64_tr_b16 a[244:245], v1 offset:24576
ds_read_b64_tr_b16 a[246:247], v1 offset:26624
v_cvt_pk_bf16_f32 v20, v40, v41
v_mfma_f32_16x16x32_bf16 v[56:59], a[248:251], v[252:255], v[56:59]
v_mul_f32 v44, v44, v15
v_mul_f32 v45, v45, v15
v_cvt_pk_bf16_f32 v21, v42, v43
v_mfma_f32_16x16x32_bf16 v[52:55], a[252:255], v[248:251], v[52:55]
ds_read_b64_tr_b16 a[248:249], v2 offset:24576
ds_read_b64_tr_b16 a[250:251], v2 offset:26624
v_mul_f32 v46, v46, v15
v_mfma_f32_16x16x32_bf16 v[60:63], a[252:255], v[252:255], v[60:63]
v_mul_f32 v47, v47, v15
v_cvt_pk_bf16_f32 v22, v44, v45
v_cvt_pk_bf16_f32 v23, v46, v47
L_step_64:
s_waitcnt lgkmcnt(6)
v_mfma_f32_16x16x32_bf16 a[0:3], a[224:227], v[16:19], a[0:3]
ds_read_b64_tr_b16 a[252:253], v3 offset:24576
v_mfma_f32_16x16x32_bf16 a[8:11], a[224:227], v[20:23], a[8:11]
ds_read_b64_tr_b16 a[254:255], v3 offset:26624
v_mfma_f32_16x16x32_bf16 a[4:7], a[228:231], v[16:19], a[4:7]
ds_read_b64_tr_b16 a[224:225], v0 offset:20480
ds_read_b64_tr_b16 a[226:227], v0 offset:22528
v_mul_f32 v48, v48, v14
v_mfma_f32_16x16x32_bf16 a[12:15], a[228:231], v[20:23], a[12:15]
v_mul_f32 v49, v49, v14
v_mul_f32 v50, v50, v14
v_mul_f32 v51, v51, v14
v_mfma_f32_16x16x32_bf16 a[16:19], a[232:235], v[16:19], a[16:19]
ds_read_b64_tr_b16 a[228:229], v1 offset:20480
ds_read_b64_tr_b16 a[230:231], v1 offset:22528
s_waitcnt vmcnt(4)
v_mfma_f32_16x16x32_bf16 a[24:27], a[232:235], v[20:23], a[24:27]
buffer_load_dwordx4 v7, s[12:15], s35 offen offset:1024 nt lds
v_cvt_pk_bf16_f32 v24, v48, v49
v_mfma_f32_16x16x32_bf16 a[20:23], a[236:239], v[16:19], a[20:23]
ds_read_b64_tr_b16 a[232:233], v2 offset:20480
ds_read_b64_tr_b16 a[234:235], v2 offset:22528
v_mul_f32 v52, v52, v14
v_mfma_f32_16x16x32_bf16 a[28:31], a[236:239], v[20:23], a[28:31]
v_mul_f32 v53, v53, v14
v_cvt_pk_bf16_f32 v25, v50, v51
s_waitcnt lgkmcnt(6)
v_mfma_f32_16x16x32_bf16 a[32:35], a[240:243], v[16:19], a[32:35]
ds_read_b64_tr_b16 a[236:237], v3 offset:20480
ds_read_b64_tr_b16 a[238:239], v3 offset:22528
v_mul_f32 v54, v54, v14
v_mfma_f32_16x16x32_bf16 a[40:43], a[240:243], v[20:23], a[40:43]
v_mul_f32 v55, v55, v14
v_cvt_pk_bf16_f32 v26, v52, v53
v_cvt_pk_bf16_f32 v27, v54, v55
v_mfma_f32_16x16x32_bf16 a[36:39], a[244:247], v[16:19], a[36:39]
ds_read_b64_tr_b16 a[240:241], v0 offset:28672
ds_read_b64_tr_b16 a[242:243], v0 offset:30720
v_mul_f32 v56, v56, v15
v_mfma_f32_16x16x32_bf16 a[44:47], a[244:247], v[20:23], a[44:47]
v_mul_f32 v57, v57, v15
v_mul_f32 v58, v58, v15
v_mul_f32 v59, v59, v15
v_mfma_f32_16x16x32_bf16 a[48:51], a[248:251], v[16:19], a[48:51]
ds_read_b64_tr_b16 a[244:245], v1 offset:28672
ds_read_b64_tr_b16 a[246:247], v1 offset:30720
v_cvt_pk_bf16_f32 v28, v56, v57
v_mfma_f32_16x16x32_bf16 a[56:59], a[248:251], v[20:23], a[56:59]
v_mul_f32 v60, v60, v15
v_mul_f32 v61, v61, v15
v_cvt_pk_bf16_f32 v29, v58, v59
v_mfma_f32_16x16x32_bf16 a[52:55], a[252:255], v[16:19], a[52:55]
ds_read_b64_tr_b16 a[248:249], v2 offset:28672
ds_read_b64_tr_b16 a[250:251], v2 offset:30720
v_mul_f32 v62, v62, v15
v_mfma_f32_16x16x32_bf16 a[60:63], a[252:255], v[20:23], a[60:63]
v_mul_f32 v63, v63, v15
v_cvt_pk_bf16_f32 v30, v60, v61
v_cvt_pk_bf16_f32 v31, v62, v63
s_waitcnt lgkmcnt(6)
v_mfma_f32_16x16x32_bf16 a[0:3], a[224:227], v[24:27], a[0:3]
ds_read_b64_tr_b16 a[252:253], v3 offset:28672
v_mfma_f32_16x16x32_bf16 a[8:11], a[224:227], v[28:31], a[8:11]
ds_read_b64_tr_b16 a[254:255], v3 offset:30720
v_mfma_f32_16x16x32_bf16 a[4:7], a[228:231], v[24:27], a[4:7]
s_barrier
ds_read_b64_tr_b16 a[224:225], v0 offset:0
v_mfma_f32_16x16x32_bf16 a[12:15], a[228:231], v[28:31], a[12:15]
ds_read_b64_tr_b16 a[226:227], v0 offset:2048
s_waitcnt vmcnt(3)
v_mfma_f32_16x16x32_bf16 a[16:19], a[232:235], v[24:27], a[16:19]
ds_read_b64_tr_b16 a[228:229], v1 offset:0
ds_read_b64_tr_b16 a[230:231], v1 offset:2048
v_mfma_f32_16x16x32_bf16 a[24:27], a[232:235], v[28:31], a[24:27]
buffer_load_dwordx4 v6, s[12:15], s35 offen offset:2048 nt lds
v_mfma_f32_16x16x32_bf16 a[20:23], a[236:239], v[24:27], a[20:23]
ds_read_b64_tr_b16 a[232:233], v2 offset:0
v_mfma_f32_16x16x32_bf16 a[28:31], a[236:239], v[28:31], a[28:31]
ds_read_b64_tr_b16 a[234:235], v2 offset:2048
s_waitcnt lgkmcnt(6)
v_mfma_f32_16x16x32_bf16 a[32:35], a[240:243], v[24:27], a[32:35]
ds_read_b64_tr_b16 a[236:237], v3 offset:0
v_mfma_f32_16x16x32_bf16 a[40:43], a[240:243], v[28:31], a[40:43]
ds_read_b64_tr_b16 a[238:239], v3 offset:2048
v_mfma_f32_16x16x32_bf16 a[36:39], a[244:247], v[24:27], a[36:39]
ds_read_b64_tr_b16 a[240:241], v0 offset:4096
v_mfma_f32_16x16x32_bf16 a[44:47], a[244:247], v[28:31], a[44:47]
ds_read_b64_tr_b16 a[242:243], v0 offset:6144
v_mfma_f32_16x16x32_bf16 a[48:51], a[248:251], v[24:27], a[48:51]
ds_read_b64_tr_b16 a[244:245], v1 offset:4096
v_mfma_f32_16x16x32_bf16 a[56:59], a[248:251], v[28:31], a[56:59]
ds_read_b64_tr_b16 a[246:247], v1 offset:6144
v_mfma_f32_16x16x32_bf16 a[52:55], a[252:255], v[24:27], a[52:55]
ds_read_b64_tr_b16 a[248:249], v2 offset:4096
v_mfma_f32_16x16x32_bf16 a[60:63], a[252:255], v[28:31], a[60:63]
ds_read_b64_tr_b16 a[250:251], v2 offset:6144
L_step_65:
s_waitcnt lgkmcnt(6)
v_mfma_f32_16x16x32_bf16 v[32:35], a[224:227], v[128:131], 0
ds_read_b64_tr_b16 a[252:253], v3 offset:4096
v_mfma_f32_16x16x32_bf16 v[40:43], a[224:227], v[132:135], 0
ds_read_b64_tr_b16 a[254:255], v3 offset:6144
s_waitcnt vmcnt(3)
v_mfma_f32_16x16x32_bf16 v[36:39], a[228:231], v[128:131], 0
ds_read_b64_tr_b16 a[224:225], v0 offset:8192
ds_read_b64_tr_b16 a[226:227], v0 offset:10240
v_mfma_f32_16x16x32_bf16 v[44:47], a[228:231], v[132:135], 0
buffer_load_dwordx4 v7, s[12:15], s35 offen offset:3072 nt lds
v_mfma_f32_16x16x32_bf16 v[48:51], a[232:235], v[128:131], 0
ds_read_b64_tr_b16 a[228:229], v1 offset:8192
v_mfma_f32_16x16x32_bf16 v[56:59], a[232:235], v[132:135], 0
ds_read_b64_tr_b16 a[230:231], v1 offset:10240
v_mfma_f32_16x16x32_bf16 v[52:55], a[236:239], v[128:131], 0
ds_read_b64_tr_b16 a[232:233], v2 offset:8192
v_mfma_f32_16x16x32_bf16 v[60:63], a[236:239], v[132:135], 0
ds_read_b64_tr_b16 a[234:235], v2 offset:10240
s_waitcnt lgkmcnt(6)
v_mfma_f32_16x16x32_bf16 v[32:35], a[240:243], v[136:139], v[32:35]
ds_read_b64_tr_b16 a[236:237], v3 offset:8192
ds_read_b64_tr_b16 a[238:239], v3 offset:10240
v_mfma_f32_16x16x32_bf16 v[40:43], a[240:243], v[140:143], v[40:43]
s_add_u32 m0, s4, 49152
s_mov_b32 s35, 311296
v_mfma_f32_16x16x32_bf16 v[36:39], a[244:247], v[136:139], v[36:39]
ds_read_b64_tr_b16 a[240:241], v0 offset:12288
v_mfma_f32_16x16x32_bf16 v[44:47], a[244:247], v[140:143], v[44:47]
ds_read_b64_tr_b16 a[242:243], v0 offset:14336
v_mfma_f32_16x16x32_bf16 v[48:51], a[248:251], v[136:139], v[48:51]
ds_read_b64_tr_b16 a[244:245], v1 offset:12288
v_mfma_f32_16x16x32_bf16 v[56:59], a[248:251], v[140:143], v[56:59]
ds_read_b64_tr_b16 a[246:247], v1 offset:14336
v_mfma_f32_16x16x32_bf16 v[52:55], a[252:255], v[136:139], v[52:55]
ds_read_b64_tr_b16 a[248:249], v2 offset:12288
ds_read_b64_tr_b16 a[250:251], v2 offset:14336
v_mfma_f32_16x16x32_bf16 v[60:63], a[252:255], v[140:143], v[60:63]
s_waitcnt vmcnt(3)
s_waitcnt lgkmcnt(6)
v_mfma_f32_16x16x32_bf16 v[32:35], a[224:227], v[144:147], v[32:35]
ds_read_b64_tr_b16 a[252:253], v3 offset:12288
ds_read_b64_tr_b16 a[254:255], v3 offset:14336
v_mfma_f32_16x16x32_bf16 v[40:43], a[224:227], v[148:151], v[40:43]
buffer_load_dwordx4 v6, s[12:15], s35 offen nt lds
v_mfma_f32_16x16x32_bf16 v[36:39], a[228:231], v[144:147], v[36:39]
s_barrier
ds_read_b64_tr_b16 a[224:225], v0 offset:49152
v_mfma_f32_16x16x32_bf16 v[44:47], a[228:231], v[148:151], v[44:47]
ds_read_b64_tr_b16 a[226:227], v0 offset:51200
s_add_u32 m0, s4, 98304
v_mfma_f32_16x16x32_bf16 v[48:51], a[232:235], v[144:147], v[48:51]
ds_read_b64_tr_b16 a[228:229], v1 offset:49152
v_mfma_f32_16x16x32_bf16 v[56:59], a[232:235], v[148:151], v[56:59]
ds_read_b64_tr_b16 a[230:231], v1 offset:51200
s_mov_b32 s5, 172032
v_mfma_f32_16x16x32_bf16 v[52:55], a[236:239], v[144:147], v[52:55]
ds_read_b64_tr_b16 a[232:233], v2 offset:49152
v_mfma_f32_16x16x32_bf16 v[60:63], a[236:239], v[148:151], v[60:63]
ds_read_b64_tr_b16 a[234:235], v2 offset:51200
s_waitcnt lgkmcnt(6)
v_mfma_f32_16x16x32_bf16 v[32:35], a[240:243], v[152:155], v[32:35]
ds_read_b64_tr_b16 a[236:237], v3 offset:49152
ds_read_b64_tr_b16 a[238:239], v3 offset:51200
v_mfma_f32_16x16x32_bf16 v[40:43], a[240:243], v[156:159], v[40:43]
buffer_load_dwordx4 v9, s[24:27], s5 offen lds
v_mfma_f32_16x16x32_bf16 v[36:39], a[244:247], v[152:155], v[36:39]
ds_read_b64_tr_b16 a[240:241], v0 offset:53248
v_mfma_f32_16x16x32_bf16 v[44:47], a[244:247], v[156:159], v[44:47]
ds_read_b64_tr_b16 a[242:243], v0 offset:55296
s_mov_b32 s5, 178176
v_mfma_f32_16x16x32_bf16 v[48:51], a[248:251], v[152:155], v[48:51]
ds_read_b64_tr_b16 a[244:245], v1 offset:53248
ds_read_b64_tr_b16 a[246:247], v1 offset:55296
v_mfma_f32_16x16x32_bf16 v[56:59], a[248:251], v[156:159], v[56:59]
buffer_load_dwordx4 v9, s[24:27], s5 offen offset:1024 lds
v_mfma_f32_16x16x32_bf16 v[52:55], a[252:255], v[152:155], v[52:55]
ds_read_b64_tr_b16 a[248:249], v2 offset:53248
ds_read_b64_tr_b16 a[250:251], v2 offset:55296
v_mfma_f32_16x16x32_bf16 v[60:63], a[252:255], v[156:159], v[60:63]
s_add_u32 m0, s4, 49152
L_step_66:
s_waitcnt lgkmcnt(6)
v_mfma_f32_16x16x32_bf16 v[32:35], a[224:227], v[160:163], v[32:35]
ds_read_b64_tr_b16 a[252:253], v3 offset:53248
v_mfma_f32_16x16x32_bf16 v[40:43], a[224:227], v[164:167], v[40:43]
ds_read_b64_tr_b16 a[254:255], v3 offset:55296
s_waitcnt vmcnt(5)
v_mfma_f32_16x16x32_bf16 v[36:39], a[228:231], v[160:163], v[36:39]
ds_read_b64_tr_b16 a[224:225], v0 offset:57344
ds_read_b64_tr_b16 a[226:227], v0 offset:59392
v_mfma_f32_16x16x32_bf16 v[44:47], a[228:231], v[164:167], v[44:47]
buffer_load_dwordx4 v7, s[12:15], s35 offen offset:1024 nt lds
v_mfma_f32_16x16x32_bf16 v[48:51], a[232:235], v[160:163], v[48:51]
ds_read_b64_tr_b16 a[228:229], v1 offset:57344
ds_read_b64_tr_b16 a[230:231], v1 offset:59392
v_mfma_f32_16x16x32_bf16 v[56:59], a[232:235], v[164:167], v[56:59]
s_add_u32 m0, s4, 98304
s_mov_b32 s5, 184320
v_mfma_f32_16x16x32_bf16 v[52:55], a[236:239], v[160:163], v[52:55]
ds_read_b64_tr_b16 a[232:233], v2 offset:57344
v_mfma_f32_16x16x32_bf16 v[60:63], a[236:239], v[164:167], v[60:63]
ds_read_b64_tr_b16 a[234:235], v2 offset:59392
s_waitcnt lgkmcnt(6)
v_mfma_f32_16x16x32_bf16 v[32:35], a[240:243], v[168:171], v[32:35]
ds_read_b64_tr_b16 a[236:237], v3 offset:57344
ds_read_b64_tr_b16 a[238:239], v3 offset:59392
v_mfma_f32_16x16x32_bf16 v[40:43], a[240:243], v[172:175], v[40:43]
buffer_load_dwordx4 v9, s[24:27], s5 offen offset:2048 lds
v_mfma_f32_16x16x32_bf16 v[36:39], a[244:247], v[168:171], v[36:39]
ds_read_b64_tr_b16 a[240:241], v0 offset:61440
v_mfma_f32_16x16x32_bf16 v[44:47], a[244:247], v[172:175], v[44:47]
ds_read_b64_tr_b16 a[242:243], v0 offset:63488
s_mov_b32 s5, 190464
v_mfma_f32_16x16x32_bf16 v[48:51], a[248:251], v[168:171], v[48:51]
ds_read_b64_tr_b16 a[244:245], v1 offset:61440
ds_read_b64_tr_b16 a[246:247], v1 offset:63488
v_mfma_f32_16x16x32_bf16 v[56:59], a[248:251], v[172:175], v[56:59]
buffer_load_dwordx4 v9, s[24:27], s5 offen offset:3072 lds
v_mfma_f32_16x16x32_bf16 v[52:55], a[252:255], v[168:171], v[52:55]
ds_read_b64_tr_b16 a[248:249], v2 offset:61440
ds_read_b64_tr_b16 a[250:251], v2 offset:63488
v_mfma_f32_16x16x32_bf16 v[60:63], a[252:255], v[172:175], v[60:63]
s_add_u32 m0, s4, 49152
s_waitcnt lgkmcnt(6)
v_mfma_f32_16x16x32_bf16 v[32:35], a[224:227], v[176:179], v[32:35]
ds_read_b64_tr_b16 a[252:253], v3 offset:61440
ds_read_b64_tr_b16 a[254:255], v3 offset:63488
v_mfma_f32_16x16x32_bf16 v[40:43], a[224:227], v[180:183], v[40:43]
s_waitcnt vmcnt(7)
buffer_load_dwordx4 v6, s[12:15], s35 offen offset:2048 nt lds
v_mfma_f32_16x16x32_bf16 v[36:39], a[228:231], v[176:179], v[36:39]
s_barrier
v_mfma_f32_16x16x32_bf16 v[44:47], a[228:231], v[180:183], v[44:47]
ds_read_b64_tr_b16 a[224:225], v0 offset:32768
ds_read_b64_tr_b16 a[226:227], v0 offset:34816
v_mfma_f32_16x16x32_bf16 v[48:51], a[232:235], v[176:179], v[48:51]
ds_read_b64_tr_b16 a[228:229], v1 offset:32768
v_mfma_f32_16x16x32_bf16 v[56:59], a[232:235], v[180:183], v[56:59]
ds_read_b64_tr_b16 a[230:231], v1 offset:34816
v_mfma_f32_16x16x32_bf16 v[52:55], a[236:239], v[176:179], v[52:55]
ds_read_b64_tr_b16 a[232:233], v2 offset:32768
v_mfma_f32_16x16x32_bf16 v[60:63], a[236:239], v[180:183], v[60:63]
ds_read_b64_tr_b16 a[234:235], v2 offset:34816
s_waitcnt lgkmcnt(6)
v_mfma_f32_16x16x32_bf16 v[32:35], a[240:243], v[184:187], v[32:35]
ds_read_b64_tr_b16 a[236:237], v3 offset:32768
v_mfma_f32_16x16x32_bf16 v[40:43], a[240:243], v[188:191], v[40:43]
ds_read_b64_tr_b16 a[238:239], v3 offset:34816
s_waitcnt vmcnt(7)
v_mfma_f32_16x16x32_bf16 v[36:39], a[244:247], v[184:187], v[36:39]
ds_read_b64_tr_b16 a[240:241], v0 offset:36864
ds_read_b64_tr_b16 a[242:243], v0 offset:38912
v_mfma_f32_16x16x32_bf16 v[44:47], a[244:247], v[188:191], v[44:47]
buffer_load_dwordx4 v7, s[12:15], s35 offen offset:3072 nt lds
v_mfma_f32_16x16x32_bf16 v[48:51], a[248:251], v[184:187], v[48:51]
ds_read_b64_tr_b16 a[244:245], v1 offset:36864
v_mfma_f32_16x16x32_bf16 v[56:59], a[248:251], v[188:191], v[56:59]
ds_read_b64_tr_b16 a[246:247], v1 offset:38912
v_mfma_f32_16x16x32_bf16 v[52:55], a[252:255], v[184:187], v[52:55]
ds_read_b64_tr_b16 a[248:249], v2 offset:36864
v_mfma_f32_16x16x32_bf16 v[60:63], a[252:255], v[188:191], v[60:63]
ds_read_b64_tr_b16 a[250:251], v2 offset:38912
L_pg13:
s_cbranch_scc1 L_tdone
L_step_67:
s_waitcnt lgkmcnt(6)
v_mfma_f32_16x16x32_bf16 v[32:35], a[224:227], v[192:195], v[32:35]
ds_read_b64_tr_b16 a[252:253], v3 offset:36864
ds_read_b64_tr_b16 a[254:255], v3 offset:38912
v_mfma_f32_16x16x32_bf16 v[40:43], a[224:227], v[196:199], v[40:43]
s_add_u32 m0, s4, 0
s_mov_b32 s35, 327680
v_mfma_f32_16x16x32_bf16 v[36:39], a[228:231], v[192:195], v[36:39]
ds_read_b64_tr_b16 a[224:225], v0 offset:40960
v_mfma_f32_16x16x32_bf16 v[44:47], a[228:231], v[196:199], v[44:47]
ds_read_b64_tr_b16 a[226:227], v0 offset:43008
v_mfma_f32_16x16x32_bf16 v[48:51], a[232:235], v[192:195], v[48:51]
ds_read_b64_tr_b16 a[228:229], v1 offset:40960
v_mfma_f32_16x16x32_bf16 v[56:59], a[232:235], v[196:199], v[56:59]
ds_read_b64_tr_b16 a[230:231], v1 offset:43008
v_mfma_f32_16x16x32_bf16 v[52:55], a[236:239], v[192:195], v[52:55]
ds_read_b64_tr_b16 a[232:233], v2 offset:40960
ds_read_b64_tr_b16 a[234:235], v2 offset:43008
v_mfma_f32_16x16x32_bf16 v[60:63], a[236:239], v[196:199], v[60:63]
s_waitcnt vmcnt(7)
s_waitcnt lgkmcnt(6)
v_mfma_f32_16x16x32_bf16 v[32:35], a[240:243], v[200:203], v[32:35]
ds_read_b64_tr_b16 a[236:237], v3 offset:40960
ds_read_b64_tr_b16 a[238:239], v3 offset:43008
v_mfma_f32_16x16x32_bf16 v[40:43], a[240:243], v[204:207], v[40:43]
buffer_load_dwordx4 v6, s[12:15], s35 offen nt lds
v_mfma_f32_16x16x32_bf16 v[36:39], a[244:247], v[200:203], v[36:39]
ds_read_b64_tr_b16 a[240:241], v0 offset:45056
v_mfma_f32_16x16x32_bf16 v[44:47], a[244:247], v[204:207], v[44:47]
ds_read_b64_tr_b16 a[242:243], v0 offset:47104
v_add_u32 v0, 0xffffc000, v0
v_mfma_f32_16x16x32_bf16 v[48:51], a[248:251], v[200:203], v[48:51]
ds_read_b64_tr_b16 a[244:245], v1 offset:45056
v_mfma_f32_16x16x32_bf16 v[56:59], a[248:251], v[204:207], v[56:59]
ds_read_b64_tr_b16 a[246:247], v1 offset:47104
v_add_u32 v1, 0xffffc000, v1
v_mfma_f32_16x16x32_bf16 v[52:55], a[252:255], v[200:203], v[52:55]
ds_read_b64_tr_b16 a[248:249], v2 offset:45056
ds_read_b64_tr_b16 a[250:251], v2 offset:47104
v_mfma_f32_16x16x32_bf16 v[60:63], a[252:255], v[204:207], v[60:63]
v_add_u32 v2, 0xffffc000, v2
s_waitcnt lgkmcnt(6)
v_mfma_f32_16x16x32_bf16 v[32:35], a[224:227], v[208:211], v[32:35]
ds_read_b64_tr_b16 a[252:253], v3 offset:45056
v_mfma_f32_16x16x32_bf16 v[40:43], a[224:227], v[212:215], v[40:43]
ds_read_b64_tr_b16 a[254:255], v3 offset:47104
v_add_u32 v3, 0xffffc000, v3
v_mfma_f32_16x16x32_bf16 v[36:39], a[228:231], v[208:211], v[36:39]
s_barrier
v_mfma_f32_16x16x32_bf16 v[44:47], a[228:231], v[212:215], v[44:47]
ds_read_b64_tr_b16 a[224:225], v0 offset:0
ds_read_b64_tr_b16 a[226:227], v0 offset:2048
v_mfma_f32_16x16x32_bf16 v[48:51], a[232:235], v[208:211], v[48:51]
ds_read_b64_tr_b16 a[228:229], v1 offset:0
ds_read_b64_tr_b16 a[230:231], v1 offset:2048
v_mfma_f32_16x16x32_bf16 v[56:59], a[232:235], v[212:215], v[56:59]
buffer_load_dwordx4 v7, s[12:15], s35 offen offset:1024 nt lds
v_mfma_f32_16x16x32_bf16 v[52:55], a[236:239], v[208:211], v[52:55]
ds_read_b64_tr_b16 a[232:233], v0 offset:4096
v_mfma_f32_16x16x32_bf16 v[60:63], a[236:239], v[212:215], v[60:63]
ds_read_b64_tr_b16 a[234:235], v0 offset:6144
s_waitcnt lgkmcnt(6)
v_mfma_f32_16x16x32_bf16 v[32:35], a[240:243], v[216:219], v[32:35]
ds_read_b64_tr_b16 a[236:237], v1 offset:4096
v_mfma_f32_16x16x32_bf16 v[40:43], a[240:243], v[220:223], v[40:43]
ds_read_b64_tr_b16 a[238:239], v1 offset:6144
v_mfma_f32_16x16x32_bf16 v[36:39], a[244:247], v[216:219], v[36:39]
ds_read_b64_tr_b16 a[240:241], v0 offset:8192
v_mfma_f32_16x16x32_bf16 v[44:47], a[244:247], v[220:223], v[44:47]
ds_read_b64_tr_b16 a[242:243], v0 offset:10240
v_mfma_f32_16x16x32_bf16 v[48:51], a[248:251], v[216:219], v[48:51]
ds_read_b64_tr_b16 a[244:245], v1 offset:8192
v_mfma_f32_16x16x32_bf16 v[56:59], a[248:251], v[220:223], v[56:59]
ds_read_b64_tr_b16 a[246:247], v1 offset:10240
v_mfma_f32_16x16x32_bf16 v[52:55], a[252:255], v[216:219], v[52:55]
ds_read_b64_tr_b16 a[248:249], v0 offset:12288
v_mfma_f32_16x16x32_bf16 v[60:63], a[252:255], v[220:223], v[60:63]
ds_read_b64_tr_b16 a[250:251], v0 offset:14336
L_step_68:
s_waitcnt lgkmcnt(6)
v_mfma_f32_16x16x32_bf16 v[32:35], a[224:227], v[224:227], v[32:35]
ds_read_b64_tr_b16 a[252:253], v1 offset:12288
v_mfma_f32_16x16x32_bf16 v[40:43], a[224:227], v[228:231], v[40:43]
ds_read_b64_tr_b16 a[254:255], v1 offset:14336
v_mfma_f32_16x16x32_bf16 v[36:39], a[228:231], v[224:227], v[36:39]
ds_read_b64_tr_b16 a[224:225], v2 offset:0
v_mfma_f32_16x16x32_bf16 v[44:47], a[228:231], v[228:231], v[44:47]
ds_read_b64_tr_b16 a[226:227], v2 offset:2048
s_waitcnt vmcnt(3)
v_mfma_f32_16x16x32_bf16 v[32:35], a[232:235], v[232:235], v[32:35]
ds_read_b64_tr_b16 a[228:229], v3 offset:0
ds_read_b64_tr_b16 a[230:231], v3 offset:2048
v_mfma_f32_16x16x32_bf16 v[40:43], a[232:235], v[236:239], v[40:43]
buffer_load_dwordx4 v6, s[12:15], s35 offen offset:2048 nt lds
v_mfma_f32_16x16x32_bf16 v[36:39], a[236:239], v[232:235], v[36:39]
ds_read_b64_tr_b16 a[232:233], v2 offset:4096
v_mfma_f32_16x16x32_bf16 v[44:47], a[236:239], v[236:239], v[44:47]
ds_read_b64_tr_b16 a[234:235], v2 offset:6144
s_waitcnt lgkmcnt(6)
v_mfma_f32_16x16x32_bf16 v[32:35], a[240:243], v[240:243], v[32:35]
ds_read_b64_tr_b16 a[236:237], v3 offset:4096
v_mfma_f32_16x16x32_bf16 v[40:43], a[240:243], v[244:247], v[40:43]
ds_read_b64_tr_b16 a[238:239], v3 offset:6144
v_mfma_f32_16x16x32_bf16 v[36:39], a[244:247], v[240:243], v[36:39]
ds_read_b64_tr_b16 a[240:241], v2 offset:8192
v_mfma_f32_16x16x32_bf16 v[44:47], a[244:247], v[244:247], v[44:47]
ds_read_b64_tr_b16 a[242:243], v2 offset:10240
v_mfma_f32_16x16x32_bf16 v[32:35], a[248:251], v[248:251], v[32:35]
ds_read_b64_tr_b16 a[244:245], v3 offset:8192
v_mfma_f32_16x16x32_bf16 v[40:43], a[248:251], v[252:255], v[40:43]
ds_read_b64_tr_b16 a[246:247], v3 offset:10240
v_mfma_f32_16x16x32_bf16 v[36:39], a[252:255], v[248:251], v[36:39]
ds_read_b64_tr_b16 a[248:249], v2 offset:12288
v_mfma_f32_16x16x32_bf16 v[44:47], a[252:255], v[252:255], v[44:47]
ds_read_b64_tr_b16 a[250:251], v2 offset:14336
s_waitcnt lgkmcnt(6)
v_mfma_f32_16x16x32_bf16 v[48:51], a[224:227], v[224:227], v[48:51]
ds_read_b64_tr_b16 a[252:253], v3 offset:12288
ds_read_b64_tr_b16 a[254:255], v3 offset:14336
v_mfma_f32_16x16x32_bf16 v[56:59], a[224:227], v[228:231], v[56:59]
buffer_load_dwordx4 v7, s[12:15], s35 offen offset:3072 nt lds
v_mfma_f32_16x16x32_bf16 v[52:55], a[228:231], v[224:227], v[52:55]
s_barrier
ds_read_b64_tr_b16 a[224:225], v0 offset:32768
ds_read_b64_tr_b16 a[226:227], v0 offset:34816
v_mfma_f32_16x16x32_bf16 v[60:63], a[228:231], v[228:231], v[60:63]
s_add_u32 m0, s4, 81920
s_mov_b32 s5, 172288
v_mul_f32 v32, v32, v14
v_mfma_f32_16x16x32_bf16 v[48:51], a[232:235], v[232:235], v[48:51]
ds_read_b64_tr_b16 a[228:229], v1 offset:32768
ds_read_b64_tr_b16 a[230:231], v1 offset:34816
v_mfma_f32_16x16x32_bf16 v[56:59], a[232:235], v[236:239], v[56:59]
buffer_load_dwordx4 v9, s[24:27], s5 offen lds
v_mul_f32 v33, v33, v14
v_mul_f32 v34, v34, v14
v_mfma_f32_16x16x32_bf16 v[52:55], a[236:239], v[232:235], v[52:55]
ds_read_b64_tr_b16 a[232:233], v2 offset:32768
ds_read_b64_tr_b16 a[234:235], v2 offset:34816
v_mul_f32 v35, v35, v14
v_mfma_f32_16x16x32_bf16 v[60:63], a[236:239], v[236:239], v[60:63]
v_cvt_pk_bf16_f32 v208, v32, v33
v_mul_f32 v36, v36, v14
v_mul_f32 v37, v37, v14
s_waitcnt lgkmcnt(6)
v_mfma_f32_16x16x32_bf16 v[48:51], a[240:243], v[240:243], v[48:51]
ds_read_b64_tr_b16 a[236:237], v3 offset:32768
ds_read_b64_tr_b16 a[238:239], v3 offset:34816
v_cvt_pk_bf16_f32 v209, v34, v35
v_mfma_f32_16x16x32_bf16 v[56:59], a[240:243], v[244:247], v[56:59]
v_mul_f32 v38, v38, v14
v_mul_f32 v39, v39, v14
v_cvt_pk_bf16_f32 v210, v36, v37
v_mfma_f32_16x16x32_bf16 v[52:55], a[244:247], v[240:243], v[52:55]
ds_read_b64_tr_b16 a[240:241], v0 offset:40960
ds_read_b64_tr_b16 a[242:243], v0 offset:43008
v_cvt_pk_bf16_f32 v211, v38, v39
v_mfma_f32_16x16x32_bf16 v[60:63], a[244:247], v[244:247], v[60:63]
v_mul_f32 v40, v40, v15
v_mul_f32 v41, v41, v15
v_mul_f32 v42, v42, v15
v_mul_f32 v43, v43, v15
v_mfma_f32_16x16x32_bf16 v[48:51], a[248:251], v[248:251], v[48:51]
ds_read_b64_tr_b16 a[244:245], v1 offset:40960
ds_read_b64_tr_b16 a[246:247], v1 offset:43008
v_cvt_pk_bf16_f32 v212, v40, v41
v_mfma_f32_16x16x32_bf16 v[56:59], a[248:251], v[252:255], v[56:59]
v_mul_f32 v44, v44, v15
v_mul_f32 v45, v45, v15
v_cvt_pk_bf16_f32 v213, v42, v43
v_mfma_f32_16x16x32_bf16 v[52:55], a[252:255], v[248:251], v[52:55]
ds_read_b64_tr_b16 a[248:249], v2 offset:40960
ds_read_b64_tr_b16 a[250:251], v2 offset:43008
v_mul_f32 v46, v46, v15
v_mfma_f32_16x16x32_bf16 v[60:63], a[252:255], v[252:255], v[60:63]
v_mul_f32 v47, v47, v15
v_cvt_pk_bf16_f32 v214, v44, v45
v_cvt_pk_bf16_f32 v215, v46, v47
L_step_69:
s_waitcnt lgkmcnt(6)
v_mfma_f32_16x16x32_bf16 a[0:3], a[224:227], v[208:211], a[0:3]
ds_read_b64_tr_b16 a[252:253], v3 offset:40960
ds_read_b64_tr_b16 a[254:255], v3 offset:43008
v_mfma_f32_16x16x32_bf16 a[8:11], a[224:227], v[212:215], a[8:11]
s_mov_b32 s5, 178432
buffer_load_dwordx4 v9, s[24:27], s5 offen offset:1024 lds
v_mfma_f32_16x16x32_bf16 a[4:7], a[228:231], v[208:211], a[4:7]
ds_read_b64_tr_b16 a[224:225], v0 offset:36864
ds_read_b64_tr_b16 a[226:227], v0 offset:38912
s_add_u32 m0, s4, 131072
v_mfma_f32_16x16x32_bf16 a[12:15], a[228:231], v[212:215], a[12:15]
s_mov_b32 s35, 344064
s_waitcnt vmcnt(5)
buffer_load_dwordx4 v6, s[12:15], s35 offen nt lds
v_mfma_f32_16x16x32_bf16 a[16:19], a[232:235], v[208:211], a[16:19]
ds_read_b64_tr_b16 a[228:229], v1 offset:36864
ds_read_b64_tr_b16 a[230:231], v1 offset:38912
s_add_u32 m0, s4, 81920
v_mfma_f32_16x16x32_bf16 a[24:27], a[232:235], v[212:215], a[24:27]
s_mov_b32 s5, 184576
buffer_load_dwordx4 v9, s[24:27], s5 offen offset:2048 lds
s_mov_b32 s5, 190720
v_mfma_f32_16x16x32_bf16 a[20:23], a[236:239], v[208:211], a[20:23]
ds_read_b64_tr_b16 a[232:233], v2 offset:36864
ds_read_b64_tr_b16 a[234:235], v2 offset:38912
v_mul_f32 v48, v48, v14
v_mfma_f32_16x16x32_bf16 a[28:31], a[236:239], v[212:215], a[28:31]
v_mul_f32 v49, v49, v14
v_mul_f32 v50, v50, v14
v_mul_f32 v51, v51, v14
s_waitcnt lgkmcnt(6)
v_mfma_f32_16x16x32_bf16 a[32:35], a[240:243], v[208:211], a[32:35]
ds_read_b64_tr_b16 a[236:237], v3 offset:36864
ds_read_b64_tr_b16 a[238:239], v3 offset:38912
buffer_load_dwordx4 v9, s[24:27], s5 offen offset:3072 lds
v_mfma_f32_16x16x32_bf16 a[40:43], a[240:243], v[212:215], a[40:43]
v_cvt_pk_bf16_f32 v216, v48, v49
v_mul_f32 v52, v52, v14
v_mul_f32 v53, v53, v14
v_cvt_pk_bf16_f32 v217, v50, v51
v_mfma_f32_16x16x32_bf16 a[36:39], a[244:247], v[208:211], a[36:39]
ds_read_b64_tr_b16 a[240:241], v0 offset:45056
ds_read_b64_tr_b16 a[242:243], v0 offset:47104
v_mul_f32 v54, v54, v14
v_mul_f32 v55, v55, v14
v_mfma_f32_16x16x32_bf16 a[44:47], a[244:247], v[212:215], a[44:47]
v_cvt_pk_bf16_f32 v218, v52, v53
v_cvt_pk_bf16_f32 v219, v54, v55
v_mul_f32 v56, v56, v15
v_mul_f32 v57, v57, v15
v_mfma_f32_16x16x32_bf16 a[48:51], a[248:251], v[208:211], a[48:51]
ds_read_b64_tr_b16 a[244:245], v1 offset:45056
ds_read_b64_tr_b16 a[246:247], v1 offset:47104
v_mul_f32 v58, v58, v15
v_mfma_f32_16x16x32_bf16 a[56:59], a[248:251], v[212:215], a[56:59]
v_mul_f32 v59, v59, v15
v_cvt_pk_bf16_f32 v220, v56, v57
v_mul_f32 v60, v60, v15
v_mul_f32 v61, v61, v15
v_mfma_f32_16x16x32_bf16 a[52:55], a[252:255], v[208:211], a[52:55]
ds_read_b64_tr_b16 a[248:249], v2 offset:45056
ds_read_b64_tr_b16 a[250:251], v2 offset:47104
v_cvt_pk_bf16_f32 v221, v58, v59
v_mul_f32 v62, v62, v15
v_mfma_f32_16x16x32_bf16 a[60:63], a[252:255], v[212:215], a[60:63]
v_mul_f32 v63, v63, v15
v_cvt_pk_bf16_f32 v222, v60, v61
v_cvt_pk_bf16_f32 v223, v62, v63
s_waitcnt lgkmcnt(6)
v_mfma_f32_16x16x32_bf16 a[0:3], a[224:227], v[216:219], a[0:3]
ds_read_b64_tr_b16 a[252:253], v3 offset:45056
ds_read_b64_tr_b16 a[254:255], v3 offset:47104
v_mfma_f32_16x16x32_bf16 a[8:11], a[224:227], v[220:223], a[8:11]
s_add_u32 m0, s4, 131072
s_nop 0
buffer_load_dwordx4 v7, s[12:15], s35 offen offset:1024 nt lds
v_mfma_f32_16x16x32_bf16 a[4:7], a[228:231], v[216:219], a[4:7]
s_barrier
v_mfma_f32_16x16x32_bf16 a[12:15], a[228:231], v[220:223], a[12:15]
ds_read_b128 a[224:227], v4 offset:49152
v_mfma_f32_16x16x32_bf16 a[16:19], a[232:235], v[216:219], a[16:19]
v_mfma_f32_16x16x32_bf16 a[24:27], a[232:235], v[220:223], a[24:27]
ds_read_b128 a[228:231], v4 offset:51200
v_mfma_f32_16x16x32_bf16 a[20:23], a[236:239], v[216:219], a[20:23]
ds_read_b128 a[232:235], v5 offset:49152
v_mfma_f32_16x16x32_bf16 a[28:31], a[236:239], v[220:223], a[28:31]
s_waitcnt lgkmcnt(3)
v_mfma_f32_16x16x32_bf16 a[32:35], a[240:243], v[216:219], a[32:35]
ds_read_b128 a[236:239], v5 offset:51200
s_waitcnt vmcnt(7)
v_mfma_f32_16x16x32_bf16 a[40:43], a[240:243], v[220:223], a[40:43]
buffer_load_dwordx4 v6, s[12:15], s35 offen offset:2048 nt lds
v_mfma_f32_16x16x32_bf16 a[36:39], a[244:247], v[216:219], a[36:39]
v_mfma_f32_16x16x32_bf16 a[44:47], a[244:247], v[220:223], a[44:47]
ds_read_b128 a[240:243], v4 offset:53248
v_mfma_f32_16x16x32_bf16 a[48:51], a[248:251], v[216:219], a[48:51]
v_mfma_f32_16x16x32_bf16 a[56:59], a[248:251], v[220:223], a[56:59]
ds_read_b128 a[244:247], v4 offset:55296
v_mfma_f32_16x16x32_bf16 a[52:55], a[252:255], v[216:219], a[52:55]
ds_read_b128 a[248:251], v5 offset:53248
v_mfma_f32_16x16x32_bf16 a[60:63], a[252:255], v[220:223], a[60:63]
L_step_70:
s_waitcnt lgkmcnt(3)
v_mfma_f32_16x16x32_bf16 v[32:35], a[224:227], v[64:67], 0
v_mfma_f32_16x16x32_bf16 v[40:43], a[224:227], v[68:71], 0
ds_read_b128 a[252:255], v5 offset:55296
v_mfma_f32_16x16x32_bf16 v[36:39], a[228:231], v[64:67], 0
v_mfma_f32_16x16x32_bf16 v[44:47], a[228:231], v[68:71], 0
ds_read_b128 a[224:227], v4 offset:57344
v_mfma_f32_16x16x32_bf16 v[32:35], a[232:235], v[72:75], v[32:35]
ds_read_b128 a[228:231], v4 offset:59392
v_mfma_f32_16x16x32_bf16 v[40:43], a[232:235], v[76:79], v[40:43]
buffer_load_dwordx4 v7, s[12:15], s35 offen offset:3072 nt lds
v_mfma_f32_16x16x32_bf16 v[36:39], a[236:239], v[72:75], v[36:39]
ds_read_b128 a[232:235], v5 offset:57344
v_mfma_f32_16x16x32_bf16 v[44:47], a[236:239], v[76:79], v[44:47]
s_waitcnt lgkmcnt(3)
v_mfma_f32_16x16x32_bf16 v[32:35], a[240:243], v[80:83], v[32:35]
ds_read_b128 a[236:239], v5 offset:59392
v_mfma_f32_16x16x32_bf16 v[40:43], a[240:243], v[84:87], v[40:43]
s_add_u32 m0, s4, 114688
s_mov_b32 s35, 360448
v_mfma_f32_16x16x32_bf16 v[36:39], a[244:247], v[80:83], v[36:39]
v_mfma_f32_16x16x32_bf16 v[44:47], a[244:247], v[84:87], v[44:47]
ds_read_b128 a[240:243], v4 offset:61440
v_mfma_f32_16x16x32_bf16 v[32:35], a[248:251], v[88:91], v[32:35]
ds_read_b128 a[244:247], v4 offset:63488
v_mfma_f32_16x16x32_bf16 v[40:43], a[248:251], v[92:95], v[40:43]
v_add_u32 v4, 0xfffe8000, v4
v_mfma_f32_16x16x32_bf16 v[36:39], a[252:255], v[88:91], v[36:39]
ds_read_b128 a[248:251], v5 offset:61440
v_mfma_f32_16x16x32_bf16 v[44:47], a[252:255], v[92:95], v[44:47]
s_waitcnt vmcnt(5)
s_waitcnt lgkmcnt(3)
v_mfma_f32_16x16x32_bf16 v[32:35], a[224:227], v[96:99], v[32:35]
ds_read_b128 a[252:255], v5 offset:63488
v_add_u32 v5, 0xfffe8000, v5
v_mfma_f32_16x16x32_bf16 v[40:43], a[224:227], v[100:103], v[40:43]
buffer_load_dwordx4 v6, s[12:15], s35 offen nt lds
v_mfma_f32_16x16x32_bf16 v[36:39], a[228:231], v[96:99], v[36:39]
s_barrier
v_mfma_f32_16x16x32_bf16 v[44:47], a[228:231], v[100:103], v[44:47]
ds_read_b128 a[224:227], v4 offset:32768
v_mfma_f32_16x16x32_bf16 v[32:35], a[232:235], v[104:107], v[32:35]
v_mfma_f32_16x16x32_bf16 v[40:43], a[232:235], v[108:111], v[40:43]
ds_read_b128 a[228:231], v4 offset:34816
v_mfma_f32_16x16x32_bf16 v[36:39], a[236:239], v[104:107], v[36:39]
ds_read_b128 a[232:235], v5 offset:32768
v_mfma_f32_16x16x32_bf16 v[44:47], a[236:239], v[108:111], v[44:47]
s_waitcnt lgkmcnt(3)
v_mfma_f32_16x16x32_bf16 v[32:35], a[240:243], v[112:115], v[32:35]
v_mfma_f32_16x16x32_bf16 v[40:43], a[240:243], v[116:119], v[40:43]
ds_read_b128 a[236:239], v5 offset:34816
v_mfma_f32_16x16x32_bf16 v[36:39], a[244:247], v[112:115], v[36:39]
ds_read_b128 a[240:243], v4 offset:36864
v_mfma_f32_16x16x32_bf16 v[44:47], a[244:247], v[116:119], v[44:47]
buffer_load_dwordx4 v7, s[12:15], s35 offen offset:1024 nt lds
v_mfma_f32_16x16x32_bf16 v[32:35], a[248:251], v[120:123], v[32:35]
v_mfma_f32_16x16x32_bf16 v[40:43], a[248:251], v[124:127], v[40:43]
ds_read_b128 a[244:247], v4 offset:38912
v_mfma_f32_16x16x32_bf16 v[36:39], a[252:255], v[120:123], v[36:39]
ds_read_b128 a[248:251], v5 offset:36864
v_mfma_f32_16x16x32_bf16 v[44:47], a[252:255], v[124:127], v[44:47]
L_step_71:
s_waitcnt lgkmcnt(3)
v_mfma_f32_16x16x32_bf16 v[48:51], a[224:227], v[64:67], 0
v_mfma_f32_16x16x32_bf16 v[56:59], a[224:227], v[68:71], 0
ds_read_b128 a[252:255], v5 offset:38912
v_mfma_f32_16x16x32_bf16 v[52:55], a[228:231], v[64:67], 0
ds_read_b128 a[224:227], v4 offset:40960
v_max3_f32 v12, v32, v33, v34
v_max3_f32 v13, v40, v41, v42
v_mfma_f32_16x16x32_bf16 v[60:63], a[228:231], v[68:71], 0
v_max3_f32 v12, v12, v35, v36
v_max3_f32 v13, v13, v43, v44
v_max3_f32 v12, v12, v37, v38
v_mfma_f32_16x16x32_bf16 v[48:51], a[232:235], v[72:75], v[48:51]
ds_read_b128 a[228:231], v4 offset:43008
v_max3_f32 v13, v13, v45, v46
v_max_f32 v12, v12, v39
v_mfma_f32_16x16x32_bf16 v[56:59], a[232:235], v[76:79], v[56:59]
v_max_f32 v13, v13, v47
s_nop 1
v_permlane32_swap_b32 v12, v13
v_max_f32 v12, v12, v13
v_mfma_f32_16x16x32_bf16 v[52:55], a[236:239], v[72:75], v[52:55]
ds_read_b128 a[232:235], v5 offset:40960
s_waitcnt vmcnt(3)
buffer_load_dwordx4 v6, s[12:15], s35 offen offset:2048 nt lds
v_mfma_f32_16x16x32_bf16 v[60:63], a[236:239], v[76:79], v[60:63]
v_mov_b32 v13, v12
s_nop 1
v_permlane16_swap_b32 v12, v13
s_waitcnt lgkmcnt(3)
v_mfma_f32_16x16x32_bf16 v[48:51], a[240:243], v[80:83], v[48:51]
ds_read_b128 a[236:239], v5 offset:43008
v_max_f32 v12, v12, v13
v_mov_b32 v13, v12
v_mfma_f32_16x16x32_bf16 v[56:59], a[240:243], v[84:87], v[56:59]
s_nop 0
v_permlane32_swap_b32 v12, v13
v_mul_f32 v10, s6, v12
v_mul_f32 v11, s6, v13
v_ceil_f32 v10, v10
v_mfma_f32_16x16x32_bf16 v[52:55], a[244:247], v[80:83], v[52:55]
ds_read_b128 a[240:243], v4 offset:45056
v_ceil_f32 v11, v11
v_fma_f32 v32, v32, s6, -v10
v_mfma_f32_16x16x32_bf16 v[60:63], a[244:247], v[84:87], v[60:63]
v_fma_f32 v33, v33, s6, -v10
v_fma_f32 v34, v34, s6, -v10
v_fma_f32 v35, v35, s6, -v10
v_fma_f32 v36, v36, s6, -v10
v_mfma_f32_16x16x32_bf16 v[48:51], a[248:251], v[88:91], v[48:51]
ds_read_b128 a[244:247], v4 offset:47104
v_fma_f32 v37, v37, s6, -v10
v_fma_f32 v38, v38, s6, -v10
v_mfma_f32_16x16x32_bf16 v[56:59], a[248:251], v[92:95], v[56:59]
v_fma_f32 v39, v39, s6, -v10
v_fma_f32 v40, v40, s6, -v11
v_fma_f32 v41, v41, s6, -v11
v_mfma_f32_16x16x32_bf16 v[52:55], a[252:255], v[88:91], v[52:55]
ds_read_b128 a[248:251], v5 offset:45056
v_fma_f32 v42, v42, s6, -v11
v_fma_f32 v43, v43, s6, -v11
v_mfma_f32_16x16x32_bf16 v[60:63], a[252:255], v[92:95], v[60:63]
v_fma_f32 v44, v44, s6, -v11
v_fma_f32 v45, v45, s6, -v11
v_fma_f32 v46, v46, s6, -v11
s_waitcnt lgkmcnt(3)
v_mfma_f32_16x16x32_bf16 v[48:51], a[224:227], v[96:99], v[48:51]
ds_read_b128 a[252:255], v5 offset:47104
v_fma_f32 v47, v47, s6, -v11
v_mfma_f32_16x16x32_bf16 v[56:59], a[224:227], v[100:103], v[56:59]
v_exp_f32 v32, v32
v_exp_f32 v33, v33
v_mfma_f32_16x16x32_bf16 v[52:55], a[228:231], v[96:99], v[52:55]
s_barrier
ds_read_b128 a[224:227], v4 offset:16384
v_mfma_f32_16x16x32_bf16 v[60:63], a[228:231], v[100:103], v[60:63]
buffer_load_dwordx4 v7, s[12:15], s35 offen offset:3072 nt lds
v_exp_f32 v34, v34
v_mfma_f32_16x16x32_bf16 v[48:51], a[232:235], v[104:107], v[48:51]
ds_read_b128 a[228:231], v4 offset:18432
v_exp_f32 v35, v35
v_mfma_f32_16x16x32_bf16 v[56:59], a[232:235], v[108:111], v[56:59]
v_cvt_pk_bf16_f32 v128, v32, v33
v_exp_f32 v36, v36
v_mfma_f32_16x16x32_bf16 v[52:55], a[236:239], v[104:107], v[52:55]
ds_read_b128 a[232:235], v5 offset:16384
v_exp_f32 v37, v37
v_mfma_f32_16x16x32_bf16 v[60:63], a[236:239], v[108:111], v[60:63]
v_cvt_pk_bf16_f32 v129, v34, v35
v_exp_f32 v38, v38
s_waitcnt lgkmcnt(3)
v_mfma_f32_16x16x32_bf16 v[48:51], a[240:243], v[112:115], v[48:51]
ds_read_b128 a[236:239], v5 offset:18432
v_exp_f32 v39, v39
v_mfma_f32_16x16x32_bf16 v[56:59], a[240:243], v[116:119], v[56:59]
v_cvt_pk_bf16_f32 v130, v36, v37
v_exp_f32 v40, v40
s_add_u32 m0, s4, 98304
v_mfma_f32_16x16x32_bf16 v[52:55], a[244:247], v[112:115], v[52:55]
ds_read_b128 a[240:243], v4 offset:20480
v_exp_f32 v41, v41
v_cvt_pk_bf16_f32 v131, v38, v39
v_mfma_f32_16x16x32_bf16 v[60:63], a[244:247], v[116:119], v[60:63]
v_exp_f32 v42, v42
v_exp_f32 v43, v43
v_mfma_f32_16x16x32_bf16 v[48:51], a[248:251], v[120:123], v[48:51]
ds_read_b128 a[244:247], v4 offset:22528
v_cvt_pk_bf16_f32 v132, v40, v41
v_exp_f32 v44, v44
v_mfma_f32_16x16x32_bf16 v[56:59], a[248:251], v[124:127], v[56:59]
v_exp_f32 v45, v45
v_cvt_pk_bf16_f32 v133, v42, v43
v_mfma_f32_16x16x32_bf16 v[52:55], a[252:255], v[120:123], v[52:55]
ds_read_b128 a[248:251], v5 offset:20480
v_exp_f32 v46, v46
v_mfma_f32_16x16x32_bf16 v[60:63], a[252:255], v[124:127], v[60:63]
v_exp_f32 v47, v47
v_cvt_pk_bf16_f32 v134, v44, v45
v_cvt_pk_bf16_f32 v135, v46, v47
L_step_72:
s_waitcnt lgkmcnt(3)
v_mfma_f32_16x16x32_bf16 v[32:35], a[224:227], v[64:67], 0
ds_read_b128 a[252:255], v5 offset:22528
v_mfma_f32_16x16x32_bf16 v[40:43], a[224:227], v[68:71], 0
s_mov_b32 s35, 376832
s_waitcnt vmcnt(3)
v_mfma_f32_16x16x32_bf16 v[36:39], a[228:231], v[64:67], 0
ds_read_b128 a[224:227], v4 offset:24576
v_mfma_f32_16x16x32_bf16 v[44:47], a[228:231], v[68:71], 0
buffer_load_dwordx4 v6, s[12:15], s35 offen nt lds
v_fma_f32 v48, v48, s6, -v10
v_mfma_f32_16x16x32_bf16 v[32:35], a[232:235], v[72:75], v[32:35]
ds_read_b128 a[228:231], v4 offset:26624
v_fma_f32 v49, v49, s6, -v10
v_mfma_f32_16x16x32_bf16 v[40:43], a[232:235], v[76:79], v[40:43]
v_fma_f32 v50, v50, s6, -v10
v_fma_f32 v51, v51, s6, -v10
v_mfma_f32_16x16x32_bf16 v[36:39], a[236:239], v[72:75], v[36:39]
ds_read_b128 a[232:235], v5 offset:24576
v_max3_f32 v12, v48, v49, v50
v_mfma_f32_16x16x32_bf16 v[44:47], a[236:239], v[76:79], v[44:47]
v_fma_f32 v52, v52, s6, -v10
s_waitcnt lgkmcnt(3)
v_mfma_f32_16x16x32_bf16 v[32:35], a[240:243], v[80:83], v[32:35]
ds_read_b128 a[236:239], v5 offset:26624
v_fma_f32 v53, v53, s6, -v10
v_mfma_f32_16x16x32_bf16 v[40:43], a[240:243], v[84:87], v[40:43]
v_fma_f32 v54, v54, s6, -v10
v_max3_f32 v13, v51, v52, v53
v_mfma_f32_16x16x32_bf16 v[36:39], a[244:247], v[80:83], v[36:39]
ds_read_b128 a[240:243], v4 offset:28672
v_mfma_f32_16x16x32_bf16 v[44:47], a[244:247], v[84:87], v[44:47]
buffer_load_dwordx4 v7, s[12:15], s35 offen offset:1024 nt lds
v_fma_f32 v55, v55, s6, -v10
v_mfma_f32_16x16x32_bf16 v[32:35], a[248:251], v[88:91], v[32:35]
ds_read_b128 a[244:247], v4 offset:30720
v_fma_f32 v56, v56, s6, -v11
v_mfma_f32_16x16x32_bf16 v[40:43], a[248:251], v[92:95], v[40:43]
v_max3_f32 v12, v12, v54, v55
v_fma_f32 v57, v57, s6, -v11
v_mfma_f32_16x16x32_bf16 v[36:39], a[252:255], v[88:91], v[36:39]
ds_read_b128 a[248:251], v5 offset:28672
s_add_u32 m0, s4, 65536
v_mfma_f32_16x16x32_bf16 v[44:47], a[252:255], v[92:95], v[44:47]
s_mov_b32 s5, 172544
s_waitcnt lgkmcnt(3)
v_mfma_f32_16x16x32_bf16 v[32:35], a[224:227], v[96:99], v[32:35]
ds_read_b128 a[252:255], v5 offset:30720
v_fma_f32 v58, v58, s6, -v11
v_mfma_f32_16x16x32_bf16 v[40:43], a[224:227], v[100:103], v[40:43]
v_max3_f32 v13, v13, v56, v57
v_fma_f32 v59, v59, s6, -v11
v_mfma_f32_16x16x32_bf16 v[36:39], a[228:231], v[96:99], v[36:39]
s_barrier
ds_read_b64_tr_b16 a[224:225], v0 offset:16384
v_mfma_f32_16x16x32_bf16 v[44:47], a[228:231], v[100:103], v[44:47]
ds_read_b64_tr_b16 a[226:227], v0 offset:18432
v_fma_f32 v60, v60, s6, -v11
v_mfma_f32_16x16x32_bf16 v[32:35], a[232:235], v[104:107], v[32:35]
ds_read_b64_tr_b16 a[228:229], v1 offset:16384
ds_read_b64_tr_b16 a[230:231], v1 offset:18432
v_mfma_f32_16x16x32_bf16 v[40:43], a[232:235], v[108:111], v[40:43]
buffer_load_dwordx4 v9, s[24:27], s5 offen lds
v_mfma_f32_16x16x32_bf16 v[36:39], a[236:239], v[104:107], v[36:39]
ds_read_b64_tr_b16 a[232:233], v2 offset:16384
ds_read_b64_tr_b16 a[234:235], v2 offset:18432
v_mfma_f32_16x16x32_bf16 v[44:47], a[236:239], v[108:111], v[44:47]
s_add_u32 m0, s4, 98304
s_waitcnt vmcnt(4)
s_waitcnt lgkmcnt(6)
v_mfma_f32_16x16x32_bf16 v[32:35], a[240:243], v[112:115], v[32:35]
ds_read_b64_tr_b16 a[236:237], v3 offset:16384
ds_read_b64_tr_b16 a[238:239], v3 offset:18432
v_mfma_f32_16x16x32_bf16 v[40:43], a[240:243], v[116:119], v[40:43]
buffer_load_dwordx4 v6, s[12:15], s35 offen offset:2048 nt lds
s_add_u32 m0, s4, 65536
v_mfma_f32_16x16x32_bf16 v[36:39], a[244:247], v[112:115], v[36:39]
ds_read_b64_tr_b16 a[240:241], v0 offset:24576
ds_read_b64_tr_b16 a[242:243], v0 offset:26624
v_mfma_f32_16x16x32_bf16 v[44:47], a[244:247], v[116:119], v[44:47]
s_mov_b32 s5, 178688
buffer_load_dwordx4 v9, s[24:27], s5 offen offset:1024 lds
v_mfma_f32_16x16x32_bf16 v[32:35], a[248:251], v[120:123], v[32:35]
ds_read_b64_tr_b16 a[244:245], v1 offset:24576
ds_read_b64_tr_b16 a[246:247], v1 offset:26624
v_mfma_f32_16x16x32_bf16 v[40:43], a[248:251], v[124:127], v[40:43]
s_add_u32 m0, s4, 98304
v_max3_f32 v12, v12, v58, v59
v_fma_f32 v61, v61, s6, -v11
v_mfma_f32_16x16x32_bf16 v[36:39], a[252:255], v[120:123], v[36:39]
ds_read_b64_tr_b16 a[248:249], v2 offset:24576
ds_read_b64_tr_b16 a[250:251], v2 offset:26624
v_mfma_f32_16x16x32_bf16 v[44:47], a[252:255], v[124:127], v[44:47]
v_fma_f32 v62, v62, s6, -v11
v_max3_f32 v13, v13, v60, v61
L_step_73:
s_waitcnt lgkmcnt(6)
v_mfma_f32_16x16x32_bf16 a[64:67], a[224:227], v[208:211], a[64:67]
ds_read_b64_tr_b16 a[252:253], v3 offset:24576
ds_read_b64_tr_b16 a[254:255], v3 offset:26624
v_mfma_f32_16x16x32_bf16 a[72:75], a[224:227], v[212:215], a[72:75]
v_fma_f32 v63, v63, s6, -v11
v_max3_f32 v12, v12, v62, v63
v_max_f32 v12, v12, v13
v_mfma_f32_16x16x32_bf16 a[68:71], a[228:231], v[208:211], a[68:71]
ds_read_b64_tr_b16 a[224:225], v0 offset:20480
ds_read_b64_tr_b16 a[226:227], v0 offset:22528
L_pg14:
s_cbranch_scc1 L_tdone
v_mfma_f32_16x16x32_bf16 a[76:79], a[228:231], v[212:215], a[76:79]
buffer_load_dwordx4 v7, s[12:15], s35 offen offset:3072 nt lds
s_add_u32 m0, s4, 65536
v_mfma_f32_16x16x32_bf16 a[80:83], a[232:235], v[208:211], a[80:83]
ds_read_b64_tr_b16 a[228:229], v1 offset:20480
ds_read_b64_tr_b16 a[230:231], v1 offset:22528
v_mfma_f32_16x16x32_bf16 a[88:91], a[232:235], v[212:215], a[88:91]
s_mov_b32 s5, 184832
buffer_load_dwordx4 v9, s[24:27], s5 offen offset:2048 lds
v_mfma_f32_16x16x32_bf16 a[84:87], a[236:239], v[208:211], a[84:87]
ds_read_b64_tr_b16 a[232:233], v2 offset:20480
ds_read_b64_tr_b16 a[234:235], v2 offset:22528
v_mfma_f32_16x16x32_bf16 a[92:95], a[236:239], v[212:215], a[92:95]
s_mov_b32 s5, 190976
v_cmp_lt_f32 vcc, 0x41000000, v12
s_waitcnt lgkmcnt(6)
v_mfma_f32_16x16x32_bf16 a[96:99], a[240:243], v[208:211], a[96:99]
ds_read_b64_tr_b16 a[236:237], v3 offset:20480
ds_read_b64_tr_b16 a[238:239], v3 offset:22528
v_mfma_f32_16x16x32_bf16 a[104:107], a[240:243], v[212:215], a[104:107]
buffer_load_dwordx4 v9, s[24:27], s5 offen offset:3072 lds
s_cbranch_vccnz L_stub_1_1
L_back_1_1:
v_mfma_f32_16x16x32_bf16 a[100:103], a[244:247], v[208:211], a[100:103]
ds_read_b64_tr_b16 a[240:241], v0 offset:28672
ds_read_b64_tr_b16 a[242:243], v0 offset:30720
s_add_u32 m0, s4, 147456
v_mfma_f32_16x16x32_bf16 a[108:111], a[244:247], v[212:215], a[108:111]
s_mov_b32 s35, 393216
v_exp_f32 v48, v48
v_mfma_f32_16x16x32_bf16 a[112:115], a[248:251], v[208:211], a[112:115]
ds_read_b64_tr_b16 a[244:245], v1 offset:28672
ds_read_b64_tr_b16 a[246:247], v1 offset:30720
v_mfma_f32_16x16x32_bf16 a[120:123], a[248:251], v[212:215], a[120:123]
v_exp_f32 v49, v49
v_mfma_f32_16x16x32_bf16 a[116:119], a[252:255], v[208:211], a[116:119]
ds_read_b64_tr_b16 a[248:249], v2 offset:28672
ds_read_b64_tr_b16 a[250:251], v2 offset:30720
v_mfma_f32_16x16x32_bf16 a[124:127], a[252:255], v[212:215], a[124:127]
v_exp_f32 v50, v50
s_waitcnt lgkmcnt(6)
v_mfma_f32_16x16x32_bf16 a[64:67], a[224:227], v[216:219], a[64:67]
ds_read_b64_tr_b16 a[252:253], v3 offset:28672
ds_read_b64_tr_b16 a[254:255], v3 offset:30720
v_mfma_f32_16x16x32_bf16 a[72:75], a[224:227], v[220:223], a[72:75]
s_waitcnt vmcnt(7)
buffer_load_dwordx4 v6, s[12:15], s35 offen nt lds
v_mfma_f32_16x16x32_bf16 a[68:71], a[228:231], v[216:219], a[68:71]
s_barrier
ds_read_b128 a[224:227], v4 offset:49152
v_mfma_f32_16x16x32_bf16 a[76:79], a[228:231], v[220:223], a[76:79]
v_exp_f32 v51, v51
v_cvt_pk_bf16_f32 v136, v48, v49
v_mfma_f32_16x16x32_bf16 a[80:83], a[232:235], v[216:219], a[80:83]
ds_read_b128 a[228:231], v4 offset:51200
v_exp_f32 v52, v52
v_mfma_f32_16x16x32_bf16 a[88:91], a[232:235], v[220:223], a[88:91]
v_exp_f32 v53, v53
v_cvt_pk_bf16_f32 v137, v50, v51
v_mfma_f32_16x16x32_bf16 a[84:87], a[236:239], v[216:219], a[84:87]
ds_read_b128 a[232:235], v5 offset:49152
v_exp_f32 v54, v54
v_mfma_f32_16x16x32_bf16 a[92:95], a[236:239], v[220:223], a[92:95]
v_exp_f32 v55, v55
v_cvt_pk_bf16_f32 v138, v52, v53
s_waitcnt lgkmcnt(3)
v_mfma_f32_16x16x32_bf16 a[96:99], a[240:243], v[216:219], a[96:99]
ds_read_b128 a[236:239], v5 offset:51200
v_exp_f32 v56, v56
v_mfma_f32_16x16x32_bf16 a[104:107], a[240:243], v[220:223], a[104:107]
v_exp_f32 v57, v57
v_cvt_pk_bf16_f32 v139, v54, v55
v_mfma_f32_16x16x32_bf16 a[100:103], a[244:247], v[216:219], a[100:103]
ds_read_b128 a[240:243], v4 offset:53248
v_exp_f32 v58, v58
v_mfma_f32_16x16x32_bf16 a[108:111], a[244:247], v[220:223], a[108:111]
v_exp_f32 v59, v59
v_cvt_pk_bf16_f32 v140, v56, v57
v_mfma_f32_16x16x32_bf16 a[112:115], a[248:251], v[216:219], a[112:115]
ds_read_b128 a[244:247], v4 offset:55296
v_exp_f32 v60, v60
v_mfma_f32_16x16x32_bf16 a[120:123], a[248:251], v[220:223], a[120:123]
v_exp_f32 v61, v61
v_cvt_pk_bf16_f32 v141, v58, v59
v_mfma_f32_16x16x32_bf16 a[116:119], a[252:255], v[216:219], a[116:119]
ds_read_b128 a[248:251], v5 offset:53248
v_exp_f32 v62, v62
v_mfma_f32_16x16x32_bf16 a[124:127], a[252:255], v[220:223], a[124:127]
v_exp_f32 v63, v63
v_cvt_pk_bf16_f32 v142, v60, v61
v_cvt_pk_bf16_f32 v143, v62, v63
L_step_74:
s_waitcnt lgkmcnt(3)
v_mfma_f32_16x16x32_bf16 v[48:51], a[224:227], v[64:67], 0
ds_read_b128 a[252:255], v5 offset:55296
buffer_load_dwordx4 v7, s[12:15], s35 offen offset:1024 nt lds
v_mfma_f32_16x16x32_bf16 v[56:59], a[224:227], v[68:71], 0
v_fma_f32 v32, v32, s6, -v10
v_fma_f32 v33, v33, s6, -v10
v_fma_f32 v34, v34, s6, -v10
v_mfma_f32_16x16x32_bf16 v[52:55], a[228:231], v[64:67], 0
ds_read_b128 a[224:227], v4 offset:57344
v_fma_f32 v35, v35, s6, -v10
v_max3_f32 v12, v32, v33, v34
v_mfma_f32_16x16x32_bf16 v[60:63], a[228:231], v[68:71], 0
v_fma_f32 v36, v36, s6, -v10
v_fma_f32 v37, v37, s6, -v10
v_fma_f32 v38, v38, s6, -v10
v_mfma_f32_16x16x32_bf16 v[48:51], a[232:235], v[72:75], v[48:51]
ds_read_b128 a[228:231], v4 offset:59392
v_max3_f32 v13, v35, v36, v37
v_mfma_f32_16x16x32_bf16 v[56:59], a[232:235], v[76:79], v[56:59]
v_fma_f32 v39, v39, s6, -v10
v_fma_f32 v40, v40, s6, -v11
v_max3_f32 v12, v12, v38, v39
v_mfma_f32_16x16x32_bf16 v[52:55], a[236:239], v[72:75], v[52:55]
ds_read_b128 a[232:235], v5 offset:57344
v_fma_f32 v41, v41, s6, -v11
v_fma_f32 v42, v42, s6, -v11
v_mfma_f32_16x16x32_bf16 v[60:63], a[236:239], v[76:79], v[60:63]
v_max3_f32 v13, v13, v40, v41
v_fma_f32 v43, v43, s6, -v11
s_waitcnt lgkmcnt(3)
v_mfma_f32_16x16x32_bf16 v[48:51], a[240:243], v[80:83], v[48:51]
ds_read_b128 a[236:239], v5 offset:59392
s_waitcnt vmcnt(6)
v_mfma_f32_16x16x32_bf16 v[56:59], a[240:243], v[84:87], v[56:59]
buffer_load_dwordx4 v6, s[12:15], s35 offen offset:2048 nt lds
v_fma_f32 v44, v44, s6, -v11
v_max3_f32 v12, v12, v42, v43
v_mfma_f32_16x16x32_bf16 v[52:55], a[244:247], v[80:83], v[52:55]
ds_read_b128 a[240:243], v4 offset:61440
v_fma_f32 v45, v45, s6, -v11
v_fma_f32 v46, v46, s6, -v11
v_mfma_f32_16x16x32_bf16 v[60:63], a[244:247], v[84:87], v[60:63]
v_max3_f32 v13, v13, v44, v45
v_fma_f32 v47, v47, s6, -v11
v_max3_f32 v12, v12, v46, v47
v_mfma_f32_16x16x32_bf16 v[48:51], a[248:251], v[88:91], v[48:51]
ds_read_b128 a[244:247], v4 offset:63488
v_max_f32 v12, v12, v13
v_cmp_lt_f32 vcc, 0x41000000, v12
v_mfma_f32_16x16x32_bf16 v[56:59], a[248:251], v[92:95], v[56:59]
s_cbranch_vccnz L_stub_1_2
L_back_1_2:
v_exp_f32 v32, v32
v_mfma_f32_16x16x32_bf16 v[52:55], a[252:255], v[88:91], v[52:55]
ds_read_b128 a[248:251], v5 offset:61440
v_exp_f32 v33, v33
v_mfma_f32_16x16x32_bf16 v[60:63], a[252:255], v[92:95], v[60:63]
v_exp_f32 v34, v34
s_waitcnt lgkmcnt(3)
v_mfma_f32_16x16x32_bf16 v[48:51], a[224:227], v[96:99], v[48:51]
ds_read_b128 a[252:255], v5 offset:63488
v_exp_f32 v35, v35
v_mfma_f32_16x16x32_bf16 v[56:59], a[224:227], v[100:103], v[56:59]
v_cvt_pk_bf16_f32 v144, v32, v33
v_exp_f32 v36, v36
v_mfma_f32_16x16x32_bf16 v[52:55], a[228:231], v[96:99], v[52:55]
s_barrier
ds_read_b128 a[224:227], v4 offset:0
v_mfma_f32_16x16x32_bf16 v[60:63], a[228:231], v[100:103], v[60:63]
v_exp_f32 v37, v37
v_cvt_pk_bf16_f32 v145, v34, v35
v_mfma_f32_16x16x32_bf16 v[48:51], a[232:235], v[104:107], v[48:51]
ds_read_b128 a[228:231], v4 offset:2048
buffer_load_dwordx4 v7, s[12:15], s35 offen offset:3072 nt lds
v_mfma_f32_16x16x32_bf16 v[56:59], a[232:235], v[108:111], v[56:59]
v_exp_f32 v38, v38
v_mfma_f32_16x16x32_bf16 v[52:55], a[236:239], v[104:107], v[52:55]
ds_read_b128 a[232:235], v5 offset:0
v_exp_f32 v39, v39
v_mfma_f32_16x16x32_bf16 v[60:63], a[236:239], v[108:111], v[60:63]
v_cvt_pk_bf16_f32 v146, v36, v37
s_waitcnt lgkmcnt(3)
v_mfma_f32_16x16x32_bf16 v[48:51], a[240:243], v[112:115], v[48:51]
ds_read_b128 a[236:239], v5 offset:2048
v_exp_f32 v40, v40
v_mfma_f32_16x16x32_bf16 v[56:59], a[240:243], v[116:119], v[56:59]
v_exp_f32 v41, v41
v_cvt_pk_bf16_f32 v147, v38, v39
v_mfma_f32_16x16x32_bf16 v[52:55], a[244:247], v[112:115], v[52:55]
ds_read_b128 a[240:243], v4 offset:4096
v_exp_f32 v42, v42
v_mfma_f32_16x16x32_bf16 v[60:63], a[244:247], v[116:119], v[60:63]
v_exp_f32 v43, v43
v_cvt_pk_bf16_f32 v148, v40, v41
s_add_u32 m0, s4, 16384
v_mfma_f32_16x16x32_bf16 v[48:51], a[248:251], v[120:123], v[48:51]
ds_read_b128 a[244:247], v4 offset:6144
v_exp_f32 v44, v44
v_mfma_f32_16x16x32_bf16 v[56:59], a[248:251], v[124:127], v[56:59]
v_exp_f32 v45, v45
v_cvt_pk_bf16_f32 v149, v42, v43
s_mov_b32 s35, 409600
v_mfma_f32_16x16x32_bf16 v[52:55], a[252:255], v[120:123], v[52:55]
ds_read_b128 a[248:251], v5 offset:4096
v_exp_f32 v46, v46
v_mfma_f32_16x16x32_bf16 v[60:63], a[252:255], v[124:127], v[60:63]
v_exp_f32 v47, v47
v_cvt_pk_bf16_f32 v150, v44, v45
v_cvt_pk_bf16_f32 v151, v46, v47
L_step_75:
s_waitcnt lgkmcnt(3)
v_mfma_f32_16x16x32_bf16 v[32:35], a[224:227], v[64:67], 0
ds_read_b128 a[252:255], v5 offset:6144
s_waitcnt vmcnt(3)
v_mfma_f32_16x16x32_bf16 v[40:43], a[224:227], v[68:71], 0
buffer_load_dwordx4 v6, s[12:15], s35 offen nt lds
v_mfma_f32_16x16x32_bf16 v[36:39], a[228:231], v[64:67], 0
ds_read_b128 a[224:227], v4 offset:8192
v_fma_f32 v48, v48, s6, -v10
v_fma_f32 v49, v49, s6, -v10
v_mfma_f32_16x16x32_bf16 v[44:47], a[228:231], v[68:71], 0
v_fma_f32 v50, v50, s6, -v10
v_fma_f32 v51, v51, s6, -v10
v_max3_f32 v12, v48, v49, v50
v_mfma_f32_16x16x32_bf16 v[32:35], a[232:235], v[72:75], v[32:35]
ds_read_b128 a[228:231], v4 offset:10240
v_fma_f32 v52, v52, s6, -v10
v_fma_f32 v53, v53, s6, -v10
v_mfma_f32_16x16x32_bf16 v[40:43], a[232:235], v[76:79], v[40:43]
v_fma_f32 v54, v54, s6, -v10
v_max3_f32 v13, v51, v52, v53
v_fma_f32 v55, v55, s6, -v10
v_mfma_f32_16x16x32_bf16 v[36:39], a[236:239], v[72:75], v[36:39]
ds_read_b128 a[232:235], v5 offset:8192
v_fma_f32 v56, v56, s6, -v11
v_max3_f32 v12, v12, v54, v55
v_mfma_f32_16x16x32_bf16 v[44:47], a[236:239], v[76:79], v[44:47]
v_fma_f32 v57, v57, s6, -v11
v_fma_f32 v58, v58, s6, -v11
s_waitcnt lgkmcnt(3)
v_mfma_f32_16x16x32_bf16 v[32:35], a[240:243], v[80:83], v[32:35]
ds_read_b128 a[236:239], v5 offset:10240
v_max3_f32 v13, v13, v56, v57
v_fma_f32 v59, v59, s6, -v11
v_mfma_f32_16x16x32_bf16 v[40:43], a[240:243], v[84:87], v[40:43]
v_fma_f32 v60, v60, s6, -v11
v_max3_f32 v12, v12, v58, v59
v_fma_f32 v61, v61, s6, -v11
v_mfma_f32_16x16x32_bf16 v[36:39], a[244:247], v[80:83], v[36:39]
ds_read_b128 a[240:243], v4 offset:12288
buffer_load_dwordx4 v7, s[12:15], s35 offen offset:1024 nt lds
v_mfma_f32_16x16x32_bf16 v[44:47], a[244:247], v[84:87], v[44:47]
v_fma_f32 v62, v62, s6, -v11
v_max3_f32 v13, v13, v60, v61
v_fma_f32 v63, v63, s6, -v11
v_mfma_f32_16x16x32_bf16 v[32:35], a[248:251], v[88:91], v[32:35]
ds_read_b128 a[244:247], v4 offset:14336
v_add_u32 v4, 0x18000, v4
v_max3_f32 v12, v12, v62, v63
v_mfma_f32_16x16x32_bf16 v[40:43], a[248:251], v[92:95], v[40:43]
v_max_f32 v12, v12, v13
v_cmp_lt_f32 vcc, 0x41000000, v12
s_cbranch_vccnz L_stub_1_3
L_back_1_3:
v_mfma_f32_16x16x32_bf16 v[36:39], a[252:255], v[88:91], v[36:39]
ds_read_b128 a[248:251], v5 offset:12288
v_exp_f32 v48, v48
v_mfma_f32_16x16x32_bf16 v[44:47], a[252:255], v[92:95], v[44:47]
v_exp_f32 v49, v49
s_waitcnt lgkmcnt(3)
v_mfma_f32_16x16x32_bf16 v[32:35], a[224:227], v[96:99], v[32:35]
ds_read_b128 a[252:255], v5 offset:14336
v_add_u32 v5, 0x18000, v5
v_mfma_f32_16x16x32_bf16 v[40:43], a[224:227], v[100:103], v[40:43]
v_exp_f32 v50, v50
v_exp_f32 v51, v51
v_mfma_f32_16x16x32_bf16 v[36:39], a[228:231], v[96:99], v[36:39]
s_barrier
ds_read_b128 a[224:227], v4 offset:32768
v_mfma_f32_16x16x32_bf16 v[44:47], a[228:231], v[100:103], v[44:47]
v_cvt_pk_bf16_f32 v152, v48, v49
v_exp_f32 v52, v52
v_mfma_f32_16x16x32_bf16 v[32:35], a[232:235], v[104:107], v[32:35]
ds_read_b128 a[228:231], v4 offset:34816
v_exp_f32 v53, v53
v_mfma_f32_16x16x32_bf16 v[40:43], a[232:235], v[108:111], v[40:43]
v_cvt_pk_bf16_f32 v153, v50, v51
v_exp_f32 v54, v54
v_mfma_f32_16x16x32_bf16 v[36:39], a[236:239], v[104:107], v[36:39]
ds_read_b128 a[232:235], v5 offset:32768
s_waitcnt vmcnt(3)
buffer_load_dwordx4 v6, s[12:15], s35 offen offset:2048 nt lds
v_mfma_f32_16x16x32_bf16 v[44:47], a[236:239], v[108:111], v[44:47]
v_exp_f32 v55, v55
s_waitcnt lgkmcnt(3)
v_mfma_f32_16x16x32_bf16 v[32:35], a[240:243], v[112:115], v[32:35]
ds_read_b128 a[236:239], v5 offset:34816
v_cvt_pk_bf16_f32 v154, v52, v53
v_exp_f32 v56, v56
v_mfma_f32_16x16x32_bf16 v[40:43], a[240:243], v[116:119], v[40:43]
v_exp_f32 v57, v57
v_cvt_pk_bf16_f32 v155, v54, v55
v_mfma_f32_16x16x32_bf16 v[36:39], a[244:247], v[112:115], v[36:39]
ds_read_b128 a[240:243], v4 offset:36864
v_exp_f32 v58, v58
v_mfma_f32_16x16x32_bf16 v[44:47], a[244:247], v[116:119], v[44:47]
v_exp_f32 v59, v59
v_cvt_pk_bf16_f32 v156, v56, v57
v_mfma_f32_16x16x32_bf16 v[32:35], a[248:251], v[120:123], v[32:35]
ds_read_b128 a[244:247], v4 offset:38912
v_exp_f32 v60, v60
v_mfma_f32_16x16x32_bf16 v[40:43], a[248:251], v[124:127], v[40:43]
v_exp_f32 v61, v61
v_cvt_pk_bf16_f32 v157, v58, v59
v_mfma_f32_16x16x32_bf16 v[36:39], a[252:255], v[120:123], v[36:39]
ds_read_b128 a[248:251], v5 offset:36864
v_exp_f32 v62, v62
v_mfma_f32_16x16x32_bf16 v[44:47], a[252:255], v[124:127], v[44:47]
v_exp_f32 v63, v63
v_cvt_pk_bf16_f32 v158, v60, v61
v_cvt_pk_bf16_f32 v159, v62, v63
L_step_76:
s_waitcnt lgkmcnt(3)
v_mfma_f32_16x16x32_bf16 v[48:51], a[224:227], v[64:67], 0
v_mfma_f32_16x16x32_bf16 v[56:59], a[224:227], v[68:71], 0
ds_read_b128 a[252:255], v5 offset:38912
v_mfma_f32_16x16x32_bf16 v[52:55], a[228:231], v[64:67], 0
ds_read_b128 a[224:227], v4 offset:40960
v_mfma_f32_16x16x32_bf16 v[60:63], a[228:231], v[68:71], 0
buffer_load_dwordx4 v7, s[12:15], s35 offen offset:3072 nt lds
v_fma_f32 v32, v32, s6, -v10
v_mfma_f32_16x16x32_bf16 v[48:51], a[232:235], v[72:75], v[48:51]
ds_read_b128 a[228:231], v4 offset:43008
v_fma_f32 v33, v33, s6, -v10
v_mfma_f32_16x16x32_bf16 v[56:59], a[232:235], v[76:79], v[56:59]
v_fma_f32 v34, v34, s6, -v10
v_fma_f32 v35, v35, s6, -v10
v_mfma_f32_16x16x32_bf16 v[52:55], a[236:239], v[72:75], v[52:55]
ds_read_b128 a[232:235], v5 offset:40960
v_max3_f32 v12, v32, v33, v34
v_mfma_f32_16x16x32_bf16 v[60:63], a[236:239], v[76:79], v[60:63]
v_fma_f32 v36, v36, s6, -v10
s_waitcnt lgkmcnt(3)
v_mfma_f32_16x16x32_bf16 v[48:51], a[240:243], v[80:83], v[48:51]
ds_read_b128 a[236:239], v5 offset:43008
s_add_u32 m0, s4, 32768
v_mfma_f32_16x16x32_bf16 v[56:59], a[240:243], v[84:87], v[56:59]
s_mov_b32 s35, 425984
v_fma_f32 v37, v37, s6, -v10
v_mfma_f32_16x16x32_bf16 v[52:55], a[244:247], v[80:83], v[52:55]
ds_read_b128 a[240:243], v4 offset:45056
v_fma_f32 v38, v38, s6, -v10
v_mfma_f32_16x16x32_bf16 v[60:63], a[244:247], v[84:87], v[60:63]
v_max3_f32 v13, v35, v36, v37
v_fma_f32 v39, v39, s6, -v10
v_mfma_f32_16x16x32_bf16 v[48:51], a[248:251], v[88:91], v[48:51]
ds_read_b128 a[244:247], v4 offset:47104
v_fma_f32 v40, v40, s6, -v11
v_mfma_f32_16x16x32_bf16 v[56:59], a[248:251], v[92:95], v[56:59]
v_max3_f32 v12, v12, v38, v39
v_fma_f32 v41, v41, s6, -v11
v_mfma_f32_16x16x32_bf16 v[52:55], a[252:255], v[88:91], v[52:55]
ds_read_b128 a[248:251], v5 offset:45056
s_waitcnt vmcnt(3)
v_mfma_f32_16x16x32_bf16 v[60:63], a[252:255], v[92:95], v[60:63]
v_fma_f32 v42, v42, s6, -v11
s_waitcnt lgkmcnt(3)
v_mfma_f32_16x16x32_bf16 v[48:51], a[224:227], v[96:99], v[48:51]
ds_read_b128 a[252:255], v5 offset:47104
v_mfma_f32_16x16x32_bf16 v[56:59], a[224:227], v[100:103], v[56:59]
buffer_load_dwordx4 v6, s[12:15], s35 offen nt lds
s_add_u32 m0, s4, 81920
v_mfma_f32_16x16x32_bf16 v[52:55], a[228:231], v[96:99], v[52:55]
s_barrier
ds_read_b64_tr_b16 a[224:225], v0 offset:0
v_mfma_f32_16x16x32_bf16 v[60:63], a[228:231], v[100:103], v[60:63]
ds_read_b64_tr_b16 a[226:227], v0 offset:2048
s_add_u32 s5, s88, 172800
v_mfma_f32_16x16x32_bf16 v[48:51], a[232:235], v[104:107], v[48:51]
ds_read_b64_tr_b16 a[228:229], v1 offset:0
ds_read_b64_tr_b16 a[230:231], v1 offset:2048
v_mfma_f32_16x16x32_bf16 v[56:59], a[232:235], v[108:111], v[56:59]
buffer_load_dwordx4 v9, s[24:27], s5 offen lds
v_mfma_f32_16x16x32_bf16 v[52:55], a[236:239], v[104:107], v[52:55]
ds_read_b64_tr_b16 a[232:233], v2 offset:0
ds_read_b64_tr_b16 a[234:235], v2 offset:2048
v_mfma_f32_16x16x32_bf16 v[60:63], a[236:239], v[108:111], v[60:63]
s_add_u32 m0, s4, 32768
s_waitcnt lgkmcnt(6)
v_mfma_f32_16x16x32_bf16 v[48:51], a[240:243], v[112:115], v[48:51]
ds_read_b64_tr_b16 a[236:237], v3 offset:0
ds_read_b64_tr_b16 a[238:239], v3 offset:2048
v_mfma_f32_16x16x32_bf16 v[56:59], a[240:243], v[116:119], v[56:59]
v_max3_f32 v13, v13, v40, v41
v_fma_f32 v43, v43, s6, -v11
v_fma_f32 v44, v44, s6, -v11
v_mfma_f32_16x16x32_bf16 v[52:55], a[244:247], v[112:115], v[52:55]
ds_read_b64_tr_b16 a[240:241], v0 offset:8192
ds_read_b64_tr_b16 a[242:243], v0 offset:10240
v_mfma_f32_16x16x32_bf16 v[60:63], a[244:247], v[116:119], v[60:63]
buffer_load_dwordx4 v7, s[12:15], s35 offen offset:1024 nt lds
s_add_u32 m0, s4, 81920
v_mfma_f32_16x16x32_bf16 v[48:51], a[248:251], v[120:123], v[48:51]
ds_read_b64_tr_b16 a[244:245], v1 offset:8192
ds_read_b64_tr_b16 a[246:247], v1 offset:10240
v_mfma_f32_16x16x32_bf16 v[56:59], a[248:251], v[124:127], v[56:59]
s_add_u32 s5, s88, 178944
buffer_load_dwordx4 v9, s[24:27], s5 offen offset:1024 lds
v_mfma_f32_16x16x32_bf16 v[52:55], a[252:255], v[120:123], v[52:55]
ds_read_b64_tr_b16 a[248:249], v2 offset:8192
ds_read_b64_tr_b16 a[250:251], v2 offset:10240
v_mfma_f32_16x16x32_bf16 v[60:63], a[252:255], v[124:127], v[60:63]
s_add_u32 s5, s88, 185088
v_max3_f32 v12, v12, v42, v43
L_step_77:
s_waitcnt lgkmcnt(6)
v_mfma_f32_16x16x32_bf16 a[128:131], a[224:227], v[208:211], a[128:131]
ds_read_b64_tr_b16 a[252:253], v3 offset:8192
ds_read_b64_tr_b16 a[254:255], v3 offset:10240
v_mfma_f32_16x16x32_bf16 a[136:139], a[224:227], v[212:215], a[136:139]
v_fma_f32 v45, v45, s6, -v11
v_fma_f32 v46, v46, s6, -v11
v_max3_f32 v13, v13, v44, v45
v_mfma_f32_16x16x32_bf16 a[132:135], a[228:231], v[208:211], a[132:135]
ds_read_b64_tr_b16 a[224:225], v0 offset:4096
ds_read_b64_tr_b16 a[226:227], v0 offset:6144
v_mfma_f32_16x16x32_bf16 a[140:143], a[228:231], v[212:215], a[140:143]
buffer_load_dwordx4 v9, s[24:27], s5 offen offset:2048 lds
s_add_u32 m0, s4, 32768
v_mfma_f32_16x16x32_bf16 a[144:147], a[232:235], v[208:211], a[144:147]
ds_read_b64_tr_b16 a[228:229], v1 offset:4096
ds_read_b64_tr_b16 a[230:231], v1 offset:6144
v_mfma_f32_16x16x32_bf16 a[152:155], a[232:235], v[212:215], a[152:155]
v_fma_f32 v47, v47, s6, -v11
v_max3_f32 v12, v12, v46, v47
v_max_f32 v12, v12, v13
v_mfma_f32_16x16x32_bf16 a[148:151], a[236:239], v[208:211], a[148:151]
ds_read_b64_tr_b16 a[232:233], v2 offset:4096
ds_read_b64_tr_b16 a[234:235], v2 offset:6144
v_mfma_f32_16x16x32_bf16 a[156:159], a[236:239], v[212:215], a[156:159]
v_cmp_lt_f32 vcc, 0x41000000, v12
s_cbranch_vccnz L_stub_1_4
L_back_1_4:
s_waitcnt lgkmcnt(6)
v_mfma_f32_16x16x32_bf16 a[160:163], a[240:243], v[208:211], a[160:163]
ds_read_b64_tr_b16 a[236:237], v3 offset:4096
ds_read_b64_tr_b16 a[238:239], v3 offset:6144
s_waitcnt vmcnt(6)
v_mfma_f32_16x16x32_bf16 a[168:171], a[240:243], v[212:215], a[168:171]
buffer_load_dwordx4 v6, s[12:15], s35 offen offset:2048 nt lds
s_add_u32 m0, s4, 81920
v_mfma_f32_16x16x32_bf16 a[164:167], a[244:247], v[208:211], a[164:167]
ds_read_b64_tr_b16 a[240:241], v0 offset:12288
ds_read_b64_tr_b16 a[242:243], v0 offset:14336
v_mfma_f32_16x16x32_bf16 a[172:175], a[244:247], v[212:215], a[172:175]
s_add_u32 s5, s88, 191232
buffer_load_dwordx4 v9, s[24:27], s5 offen offset:3072 lds
v_mfma_f32_16x16x32_bf16 a[176:179], a[248:251], v[208:211], a[176:179]
ds_read_b64_tr_b16 a[244:245], v1 offset:12288
ds_read_b64_tr_b16 a[246:247], v1 offset:14336
v_mfma_f32_16x16x32_bf16 a[184:187], a[248:251], v[212:215], a[184:187]
v_exp_f32 v32, v32
v_exp_f32 v33, v33
v_mfma_f32_16x16x32_bf16 a[180:183], a[252:255], v[208:211], a[180:183]
ds_read_b64_tr_b16 a[248:249], v2 offset:12288
ds_read_b64_tr_b16 a[250:251], v2 offset:14336
v_mfma_f32_16x16x32_bf16 a[188:191], a[252:255], v[212:215], a[188:191]
v_exp_f32 v34, v34
s_waitcnt lgkmcnt(6)
v_mfma_f32_16x16x32_bf16 a[128:131], a[224:227], v[216:219], a[128:131]
ds_read_b64_tr_b16 a[252:253], v3 offset:12288
ds_read_b64_tr_b16 a[254:255], v3 offset:14336
s_add_u32 m0, s4, 32768
v_mfma_f32_16x16x32_bf16 a[136:139], a[224:227], v[220:223], a[136:139]
v_exp_f32 v35, v35
v_cvt_pk_bf16_f32 v160, v32, v33
v_mfma_f32_16x16x32_bf16 a[132:135], a[228:231], v[216:219], a[132:135]
s_barrier
ds_read_b128 a[224:227], v4 offset:16384
v_mfma_f32_16x16x32_bf16 a[140:143], a[228:231], v[220:223], a[140:143]
v_exp_f32 v36, v36
v_exp_f32 v37, v37
v_mfma_f32_16x16x32_bf16 a[144:147], a[232:235], v[216:219], a[144:147]
ds_read_b128 a[228:231], v4 offset:18432
v_cvt_pk_bf16_f32 v161, v34, v35
v_mfma_f32_16x16x32_bf16 a[152:155], a[232:235], v[220:223], a[152:155]
v_exp_f32 v38, v38
v_exp_f32 v39, v39
v_mfma_f32_16x16x32_bf16 a[148:151], a[236:239], v[216:219], a[148:151]
ds_read_b128 a[232:235], v5 offset:16384
buffer_load_dwordx4 v7, s[12:15], s35 offen offset:3072 nt lds
v_mfma_f32_16x16x32_bf16 a[156:159], a[236:239], v[220:223], a[156:159]
v_cvt_pk_bf16_f32 v162, v36, v37
s_waitcnt lgkmcnt(3)
v_mfma_f32_16x16x32_bf16 a[160:163], a[240:243], v[216:219], a[160:163]
ds_read_b128 a[236:239], v5 offset:18432
v_exp_f32 v40, v40
v_mfma_f32_16x16x32_bf16 a[168:171], a[240:243], v[220:223], a[168:171]
v_exp_f32 v41, v41
v_cvt_pk_bf16_f32 v163, v38, v39
v_mfma_f32_16x16x32_bf16 a[164:167], a[244:247], v[216:219], a[164:167]
ds_read_b128 a[240:243], v4 offset:20480
v_exp_f32 v42, v42
v_mfma_f32_16x16x32_bf16 a[172:175], a[244:247], v[220:223], a[172:175]
v_exp_f32 v43, v43
v_cvt_pk_bf16_f32 v164, v40, v41
v_mfma_f32_16x16x32_bf16 a[176:179], a[248:251], v[216:219], a[176:179]
ds_read_b128 a[244:247], v4 offset:22528
v_exp_f32 v44, v44
v_mfma_f32_16x16x32_bf16 a[184:187], a[248:251], v[220:223], a[184:187]
v_exp_f32 v45, v45
v_cvt_pk_bf16_f32 v165, v42, v43
s_add_u32 m0, s4, 49152
v_mfma_f32_16x16x32_bf16 a[180:183], a[252:255], v[216:219], a[180:183]
ds_read_b128 a[248:251], v5 offset:20480
v_exp_f32 v46, v46
v_mfma_f32_16x16x32_bf16 a[188:191], a[252:255], v[220:223], a[188:191]
v_exp_f32 v47, v47
v_cvt_pk_bf16_f32 v166, v44, v45
v_cvt_pk_bf16_f32 v167, v46, v47
L_step_78:
s_waitcnt lgkmcnt(3)
v_mfma_f32_16x16x32_bf16 v[32:35], a[224:227], v[64:67], 0
ds_read_b128 a[252:255], v5 offset:22528
s_mov_b32 s35, 442368
v_mfma_f32_16x16x32_bf16 v[40:43], a[224:227], v[68:71], 0
v_fma_f32 v48, v48, s6, -v10
v_fma_f32 v49, v49, s6, -v10
v_fma_f32 v50, v50, s6, -v10
v_mfma_f32_16x16x32_bf16 v[36:39], a[228:231], v[64:67], 0
ds_read_b128 a[224:227], v4 offset:24576
s_waitcnt vmcnt(7)
v_mfma_f32_16x16x32_bf16 v[44:47], a[228:231], v[68:71], 0
buffer_load_dwordx4 v6, s[12:15], s35 offen nt lds
v_fma_f32 v51, v51, s6, -v10
v_max3_f32 v12, v48, v49, v50
v_mfma_f32_16x16x32_bf16 v[32:35], a[232:235], v[72:75], v[32:35]
ds_read_b128 a[228:231], v4 offset:26624
v_fma_f32 v52, v52, s6, -v10
v_fma_f32 v53, v53, s6, -v10
v_mfma_f32_16x16x32_bf16 v[40:43], a[232:235], v[76:79], v[40:43]
v_fma_f32 v54, v54, s6, -v10
v_max3_f32 v13, v51, v52, v53
v_fma_f32 v55, v55, s6, -v10
v_mfma_f32_16x16x32_bf16 v[36:39], a[236:239], v[72:75], v[36:39]
ds_read_b128 a[232:235], v5 offset:24576
v_fma_f32 v56, v56, s6, -v11
v_max3_f32 v12, v12, v54, v55
v_mfma_f32_16x16x32_bf16 v[44:47], a[236:239], v[76:79], v[44:47]
v_fma_f32 v57, v57, s6, -v11
v_fma_f32 v58, v58, s6, -v11
s_waitcnt lgkmcnt(3)
v_mfma_f32_16x16x32_bf16 v[32:35], a[240:243], v[80:83], v[32:35]
ds_read_b128 a[236:239], v5 offset:26624
v_max3_f32 v13, v13, v56, v57
v_fma_f32 v59, v59, s6, -v11
v_mfma_f32_16x16x32_bf16 v[40:43], a[240:243], v[84:87], v[40:43]
v_fma_f32 v60, v60, s6, -v11
v_max3_f32 v12, v12, v58, v59
v_fma_f32 v61, v61, s6, -v11
v_mfma_f32_16x16x32_bf16 v[36:39], a[244:247], v[80:83], v[36:39]
ds_read_b128 a[240:243], v4 offset:28672
v_fma_f32 v62, v62, s6, -v11
v_max3_f32 v13, v13, v60, v61
v_mfma_f32_16x16x32_bf16 v[44:47], a[244:247], v[84:87], v[44:47]
v_fma_f32 v63, v63, s6, -v11
v_max3_f32 v12, v12, v62, v63
v_max_f32 v12, v12, v13
v_mfma_f32_16x16x32_bf16 v[32:35], a[248:251], v[88:91], v[32:35]
ds_read_b128 a[244:247], v4 offset:30720
buffer_load_dwordx4 v7, s[12:15], s35 offen offset:1024 nt lds
v_mfma_f32_16x16x32_bf16 v[40:43], a[248:251], v[92:95], v[40:43]
v_cmp_lt_f32 vcc, 0x41000000, v12
s_cbranch_vccnz L_stub_1_5
L_back_1_5:
v_mfma_f32_16x16x32_bf16 v[36:39], a[252:255], v[88:91], v[36:39]
ds_read_b128 a[248:251], v5 offset:28672
v_exp_f32 v48, v48
v_mfma_f32_16x16x32_bf16 v[44:47], a[252:255], v[92:95], v[44:47]
v_exp_f32 v49, v49
s_waitcnt lgkmcnt(3)
v_mfma_f32_16x16x32_bf16 v[32:35], a[224:227], v[96:99], v[32:35]
ds_read_b128 a[252:255], v5 offset:30720
L_pg15:
s_cbranch_scc1 L_tdone
v_exp_f32 v50, v50
v_mfma_f32_16x16x32_bf16 v[40:43], a[224:227], v[100:103], v[40:43]
v_exp_f32 v51, v51
v_cvt_pk_bf16_f32 v168, v48, v49
v_mfma_f32_16x16x32_bf16 v[36:39], a[228:231], v[96:99], v[36:39]
s_barrier
ds_read_b128 a[224:227], v4 offset:0
v_mfma_f32_16x16x32_bf16 v[44:47], a[228:231], v[100:103], v[44:47]
v_exp_f32 v52, v52
v_exp_f32 v53, v53
v_mfma_f32_16x16x32_bf16 v[32:35], a[232:235], v[104:107], v[32:35]
ds_read_b128 a[228:231], v4 offset:2048
v_cvt_pk_bf16_f32 v169, v50, v51
v_mfma_f32_16x16x32_bf16 v[40:43], a[232:235], v[108:111], v[40:43]
v_exp_f32 v54, v54
v_exp_f32 v55, v55
v_mfma_f32_16x16x32_bf16 v[36:39], a[236:239], v[104:107], v[36:39]
ds_read_b128 a[232:235], v5 offset:0
v_cvt_pk_bf16_f32 v170, v52, v53
v_mfma_f32_16x16x32_bf16 v[44:47], a[236:239], v[108:111], v[44:47]
v_exp_f32 v56, v56
s_waitcnt lgkmcnt(3)
v_mfma_f32_16x16x32_bf16 v[32:35], a[240:243], v[112:115], v[32:35]
ds_read_b128 a[236:239], v5 offset:2048
s_waitcnt vmcnt(4)
buffer_load_dwordx4 v6, s[12:15], s35 offen offset:2048 nt lds
v_mfma_f32_16x16x32_bf16 v[40:43], a[240:243], v[116:119], v[40:43]
v_exp_f32 v57, v57
v_cvt_pk_bf16_f32 v171, v54, v55
v_mfma_f32_16x16x32_bf16 v[36:39], a[244:247], v[112:115], v[36:39]
ds_read_b128 a[240:243], v4 offset:4096
v_exp_f32 v58, v58
v_mfma_f32_16x16x32_bf16 v[44:47], a[244:247], v[116:119], v[44:47]
v_exp_f32 v59, v59
v_cvt_pk_bf16_f32 v172, v56, v57
v_mfma_f32_16x16x32_bf16 v[32:35], a[248:251], v[120:123], v[32:35]
ds_read_b128 a[244:247], v4 offset:6144
v_exp_f32 v60, v60
v_mfma_f32_16x16x32_bf16 v[40:43], a[248:251], v[124:127], v[40:43]
v_exp_f32 v61, v61
v_cvt_pk_bf16_f32 v173, v58, v59
v_mfma_f32_16x16x32_bf16 v[36:39], a[252:255], v[120:123], v[36:39]
ds_read_b128 a[248:251], v5 offset:4096
v_exp_f32 v62, v62
v_mfma_f32_16x16x32_bf16 v[44:47], a[252:255], v[124:127], v[44:47]
v_exp_f32 v63, v63
v_cvt_pk_bf16_f32 v174, v60, v61
v_cvt_pk_bf16_f32 v175, v62, v63
L_step_79:
s_waitcnt lgkmcnt(3)
v_mfma_f32_16x16x32_bf16 v[48:51], a[224:227], v[64:67], 0
v_mfma_f32_16x16x32_bf16 v[56:59], a[224:227], v[68:71], 0
ds_read_b128 a[252:255], v5 offset:6144
v_mfma_f32_16x16x32_bf16 v[52:55], a[228:231], v[64:67], 0
ds_read_b128 a[224:227], v4 offset:8192
v_fma_f32 v32, v32, s6, -v10
v_fma_f32 v33, v33, s6, -v10
v_mfma_f32_16x16x32_bf16 v[60:63], a[228:231], v[68:71], 0
v_fma_f32 v34, v34, s6, -v10
v_fma_f32 v35, v35, s6, -v10
v_max3_f32 v12, v32, v33, v34
v_mfma_f32_16x16x32_bf16 v[48:51], a[232:235], v[72:75], v[48:51]
ds_read_b128 a[228:231], v4 offset:10240
buffer_load_dwordx4 v7, s[12:15], s35 offen offset:3072 nt lds
v_mfma_f32_16x16x32_bf16 v[56:59], a[232:235], v[76:79], v[56:59]
v_fma_f32 v36, v36, s6, -v10
v_fma_f32 v37, v37, s6, -v10
v_fma_f32 v38, v38, s6, -v10
v_mfma_f32_16x16x32_bf16 v[52:55], a[236:239], v[72:75], v[52:55]
ds_read_b128 a[232:235], v5 offset:8192
v_max3_f32 v13, v35, v36, v37
v_fma_f32 v39, v39, s6, -v10
v_mfma_f32_16x16x32_bf16 v[60:63], a[236:239], v[76:79], v[60:63]
s_cmp_eq_u32 s3, 0
s_cbranch_scc1 L_pg17
s_cmp_eq_u32 s3, 1
s_cbranch_scc1 L_pg18
s_cmp_eq_u32 s3, 2
s_cbranch_scc1 L_pg19
s_cmp_eq_u32 s3, 3
s_cbranch_scc1 L_pg20
L_rt0:
s_cmp_eq_u32 s3, 77
v_fma_f32 v40, v40, s6, -v11
v_max3_f32 v12, v12, v38, v39
s_waitcnt lgkmcnt(3)
v_mfma_f32_16x16x32_bf16 v[48:51], a[240:243], v[80:83], v[48:51]
ds_read_b128 a[236:239], v5 offset:10240
v_fma_f32 v41, v41, s6, -v11
v_fma_f32 v42, v42, s6, -v11
v_mfma_f32_16x16x32_bf16 v[56:59], a[240:243], v[84:87], v[56:59]
v_max3_f32 v13, v13, v40, v41
v_fma_f32 v43, v43, s6, -v11
v_fma_f32 v44, v44, s6, -v11
v_mfma_f32_16x16x32_bf16 v[52:55], a[244:247], v[80:83], v[52:55]
ds_read_b128 a[240:243], v4 offset:12288
s_add_u32 m0, s4, 65536
s_mov_b32 s35, 458752
v_mfma_f32_16x16x32_bf16 v[60:63], a[244:247], v[84:87], v[60:63]
v_max3_f32 v12, v12, v42, v43
v_fma_f32 v45, v45, s6, -v11
v_fma_f32 v46, v46, s6, -v11
v_mfma_f32_16x16x32_bf16 v[48:51], a[248:251], v[88:91], v[48:51]
ds_read_b128 a[244:247], v4 offset:14336
v_max3_f32 v13, v13, v44, v45
v_fma_f32 v47, v47, s6, -v11
v_mfma_f32_16x16x32_bf16 v[56:59], a[248:251], v[92:95], v[56:59]
v_max3_f32 v12, v12, v46, v47
v_max_f32 v12, v12, v13
v_cmp_lt_f32 vcc, 0x41000000, v12
v_mfma_f32_16x16x32_bf16 v[52:55], a[252:255], v[88:91], v[52:55]
ds_read_b128 a[248:251], v5 offset:12288
s_cbranch_vccnz L_stub_1_6
L_back_1_6:
v_mfma_f32_16x16x32_bf16 v[60:63], a[252:255], v[92:95], v[60:63]
v_exp_f32 v32, v32
s_waitcnt lgkmcnt(3)
v_mfma_f32_16x16x32_bf16 v[48:51], a[224:227], v[96:99], v[48:51]
ds_read_b128 a[252:255], v5 offset:14336
s_waitcnt vmcnt(3)
v_mfma_f32_16x16x32_bf16 v[56:59], a[224:227], v[100:103], v[56:59]
buffer_load_dwordx4 v6, s[12:15], s35 offen nt lds
s_add_u32 m0, s4, 114688
s_mov_b32 s5, 114944
v_mfma_f32_16x16x32_bf16 v[52:55], a[228:231], v[96:99], v[52:55]
s_barrier
ds_read_b128 a[224:227], v4 offset:49152
v_mfma_f32_16x16x32_bf16 v[60:63], a[228:231], v[100:103], v[60:63]
v_exp_f32 v33, v33
v_exp_f32 v34, v34
v_mfma_f32_16x16x32_bf16 v[48:51], a[232:235], v[104:107], v[48:51]
ds_read_b128 a[228:231], v4 offset:51200
buffer_load_dwordx4 v9, s[24:27], s5 offen lds
v_mfma_f32_16x16x32_bf16 v[56:59], a[232:235], v[108:111], v[56:59]
v_exp_f32 v35, v35
v_cvt_pk_bf16_f32 v176, v32, v33
s_mov_b32 s5, 121088
v_mfma_f32_16x16x32_bf16 v[52:55], a[236:239], v[104:107], v[52:55]
ds_read_b128 a[232:235], v5 offset:49152
v_exp_f32 v36, v36
v_mfma_f32_16x16x32_bf16 v[60:63], a[236:239], v[108:111], v[60:63]
v_exp_f32 v37, v37
v_cvt_pk_bf16_f32 v177, v34, v35
s_waitcnt lgkmcnt(3)
v_mfma_f32_16x16x32_bf16 v[48:51], a[240:243], v[112:115], v[48:51]
ds_read_b128 a[236:239], v5 offset:51200
v_exp_f32 v38, v38
v_mfma_f32_16x16x32_bf16 v[56:59], a[240:243], v[116:119], v[56:59]
v_exp_f32 v39, v39
v_cvt_pk_bf16_f32 v178, v36, v37
v_exp_f32 v40, v40
v_mfma_f32_16x16x32_bf16 v[52:55], a[244:247], v[112:115], v[52:55]
ds_read_b128 a[240:243], v4 offset:53248
v_exp_f32 v41, v41
v_cvt_pk_bf16_f32 v179, v38, v39
v_mfma_f32_16x16x32_bf16 v[60:63], a[244:247], v[116:119], v[60:63]
v_exp_f32 v42, v42
v_exp_f32 v43, v43
v_mfma_f32_16x16x32_bf16 v[48:51], a[248:251], v[120:123], v[48:51]
ds_read_b128 a[244:247], v4 offset:55296
v_cvt_pk_bf16_f32 v180, v40, v41
v_exp_f32 v44, v44
v_mfma_f32_16x16x32_bf16 v[56:59], a[248:251], v[124:127], v[56:59]
v_exp_f32 v45, v45
v_cvt_pk_bf16_f32 v181, v42, v43
v_mfma_f32_16x16x32_bf16 v[52:55], a[252:255], v[120:123], v[52:55]
ds_read_b128 a[248:251], v5 offset:53248
v_exp_f32 v46, v46
v_mfma_f32_16x16x32_bf16 v[60:63], a[252:255], v[124:127], v[60:63]
v_exp_f32 v47, v47
v_cvt_pk_bf16_f32 v182, v44, v45
v_cvt_pk_bf16_f32 v183, v46, v47
L_step_80:
s_waitcnt lgkmcnt(3)
v_mfma_f32_16x16x32_bf16 v[32:35], a[224:227], v[64:67], 0
ds_read_b128 a[252:255], v5 offset:55296
v_mfma_f32_16x16x32_bf16 v[40:43], a[224:227], v[68:71], 0
buffer_load_dwordx4 v9, s[24:27], s5 offen offset:1024 lds
s_add_u32 m0, s4, 65536
v_mfma_f32_16x16x32_bf16 v[36:39], a[228:231], v[64:67], 0
ds_read_b128 a[224:227], v4 offset:57344
buffer_load_dwordx4 v7, s[12:15], s35 offen offset:1024 nt lds
v_mfma_f32_16x16x32_bf16 v[44:47], a[228:231], v[68:71], 0
s_add_u32 m0, s4, 114688
s_mov_b32 s5, 127232
v_mfma_f32_16x16x32_bf16 v[32:35], a[232:235], v[72:75], v[32:35]
ds_read_b128 a[228:231], v4 offset:59392
buffer_load_dwordx4 v9, s[24:27], s5 offen offset:2048 lds
v_mfma_f32_16x16x32_bf16 v[40:43], a[232:235], v[76:79], v[40:43]
s_add_u32 m0, s4, 65536
v_fma_f32 v48, v48, s6, -v10
v_mfma_f32_16x16x32_bf16 v[36:39], a[236:239], v[72:75], v[36:39]
ds_read_b128 a[232:235], v5 offset:57344
s_waitcnt vmcnt(6)
v_mfma_f32_16x16x32_bf16 v[44:47], a[236:239], v[76:79], v[44:47]
buffer_load_dwordx4 v6, s[12:15], s35 offen offset:2048 nt lds
s_waitcnt lgkmcnt(3)
v_mfma_f32_16x16x32_bf16 v[32:35], a[240:243], v[80:83], v[32:35]
ds_read_b128 a[236:239], v5 offset:59392
s_add_u32 m0, s4, 114688
v_mfma_f32_16x16x32_bf16 v[40:43], a[240:243], v[84:87], v[40:43]
s_mov_b32 s5, 133376
buffer_load_dwordx4 v9, s[24:27], s5 offen offset:3072 lds
v_mfma_f32_16x16x32_bf16 v[36:39], a[244:247], v[80:83], v[36:39]
ds_read_b128 a[240:243], v4 offset:61440
v_fma_f32 v49, v49, s6, -v10
v_mfma_f32_16x16x32_bf16 v[44:47], a[244:247], v[84:87], v[44:47]
v_fma_f32 v50, v50, s6, -v10
v_fma_f32 v51, v51, s6, -v10
v_max3_f32 v12, v48, v49, v50
v_mfma_f32_16x16x32_bf16 v[32:35], a[248:251], v[88:91], v[32:35]
ds_read_b128 a[244:247], v4 offset:63488
s_add_u32 m0, s4, 65536
v_mfma_f32_16x16x32_bf16 v[40:43], a[248:251], v[92:95], v[40:43]
v_add_u32 v4, 0xfffec000, v4
v_fma_f32 v52, v52, s6, -v10
v_fma_f32 v53, v53, s6, -v10
v_mfma_f32_16x16x32_bf16 v[36:39], a[252:255], v[88:91], v[36:39]
ds_read_b128 a[248:251], v5 offset:61440
v_fma_f32 v54, v54, s6, -v10
v_mfma_f32_16x16x32_bf16 v[44:47], a[252:255], v[92:95], v[44:47]
v_max3_f32 v13, v51, v52, v53
v_fma_f32 v55, v55, s6, -v10
s_waitcnt lgkmcnt(3)
v_mfma_f32_16x16x32_bf16 v[32:35], a[224:227], v[96:99], v[32:35]
ds_read_b128 a[252:255], v5 offset:63488
v_add_u32 v5, 0xfffec000, v5
v_mfma_f32_16x16x32_bf16 v[40:43], a[224:227], v[100:103], v[40:43]
v_fma_f32 v56, v56, s6, -v11
v_max3_f32 v12, v12, v54, v55
v_fma_f32 v57, v57, s6, -v11
v_mfma_f32_16x16x32_bf16 v[36:39], a[228:231], v[96:99], v[36:39]
s_barrier
ds_read_b64_tr_b16 a[224:225], v0 offset:16384
ds_read_b64_tr_b16 a[226:227], v0 offset:18432
v_mfma_f32_16x16x32_bf16 v[44:47], a[228:231], v[100:103], v[44:47]
buffer_load_dwordx4 v7, s[12:15], s35 offen offset:3072 nt lds
v_fma_f32 v58, v58, s6, -v11
v_mfma_f32_16x16x32_bf16 v[32:35], a[232:235], v[104:107], v[32:35]
ds_read_b64_tr_b16 a[228:229], v1 offset:16384
ds_read_b64_tr_b16 a[230:231], v1 offset:18432
v_max3_f32 v13, v13, v56, v57
v_mfma_f32_16x16x32_bf16 v[40:43], a[232:235], v[108:111], v[40:43]
v_fma_f32 v59, v59, s6, -v11
v_fma_f32 v60, v60, s6, -v11
v_max3_f32 v12, v12, v58, v59
v_mfma_f32_16x16x32_bf16 v[36:39], a[236:239], v[104:107], v[36:39]
ds_read_b64_tr_b16 a[232:233], v2 offset:16384
ds_read_b64_tr_b16 a[234:235], v2 offset:18432
v_fma_f32 v61, v61, s6, -v11
v_mfma_f32_16x16x32_bf16 v[44:47], a[236:239], v[108:111], v[44:47]
v_fma_f32 v62, v62, s6, -v11
v_max3_f32 v13, v13, v60, v61
s_waitcnt lgkmcnt(6)
v_mfma_f32_16x16x32_bf16 v[32:35], a[240:243], v[112:115], v[32:35]
ds_read_b64_tr_b16 a[236:237], v3 offset:16384
ds_read_b64_tr_b16 a[238:239], v3 offset:18432
v_mfma_f32_16x16x32_bf16 v[40:43], a[240:243], v[116:119], v[40:43]
v_fma_f32 v63, v63, s6, -v11
v_max3_f32 v12, v12, v62, v63
v_max_f32 v12, v12, v13
v_mfma_f32_16x16x32_bf16 v[36:39], a[244:247], v[112:115], v[36:39]
ds_read_b64_tr_b16 a[240:241], v0 offset:20480
ds_read_b64_tr_b16 a[242:243], v0 offset:22528
s_add_u32 m0, s4, 98304
v_mfma_f32_16x16x32_bf16 v[44:47], a[244:247], v[116:119], v[44:47]
s_mov_b32 s35, 475136
v_cmp_lt_f32 vcc, 0x41000000, v12
s_cbranch_vccnz L_stub_1_7
L_back_1_7:
v_mfma_f32_16x16x32_bf16 v[32:35], a[248:251], v[120:123], v[32:35]
ds_read_b64_tr_b16 a[244:245], v1 offset:20480
ds_read_b64_tr_b16 a[246:247], v1 offset:22528
v_mfma_f32_16x16x32_bf16 v[40:43], a[248:251], v[124:127], v[40:43]
v_exp_f32 v48, v48
v_exp_f32 v49, v49
v_mfma_f32_16x16x32_bf16 v[36:39], a[252:255], v[120:123], v[36:39]
ds_read_b64_tr_b16 a[248:249], v2 offset:20480
ds_read_b64_tr_b16 a[250:251], v2 offset:22528
v_mfma_f32_16x16x32_bf16 v[44:47], a[252:255], v[124:127], v[44:47]
v_exp_f32 v50, v50
L_step_81:
s_waitcnt lgkmcnt(6)
v_mfma_f32_16x16x32_bf16 a[192:195], a[224:227], v[208:211], a[192:195]
ds_read_b64_tr_b16 a[252:253], v3 offset:20480
ds_read_b64_tr_b16 a[254:255], v3 offset:22528
v_mfma_f32_16x16x32_bf16 a[200:203], a[224:227], v[212:215], a[200:203]
s_waitcnt vmcnt(7)
buffer_load_dwordx4 v6, s[12:15], s35 offen nt lds
v_mfma_f32_16x16x32_bf16 a[196:199], a[228:231], v[208:211], a[196:199]
s_barrier
ds_read_b128 a[224:227], v4 offset:0
v_mfma_f32_16x16x32_bf16 a[204:207], a[228:231], v[212:215], a[204:207]
v_exp_f32 v51, v51
v_cvt_pk_bf16_f32 v184, v48, v49
v_mfma_f32_16x16x32_bf16 a[208:211], a[232:235], v[208:211], a[208:211]
ds_read_b128 a[228:231], v4 offset:2048
v_exp_f32 v52, v52
v_mfma_f32_16x16x32_bf16 a[216:219], a[232:235], v[212:215], a[216:219]
v_exp_f32 v53, v53
v_cvt_pk_bf16_f32 v185, v50, v51
v_mfma_f32_16x16x32_bf16 a[212:215], a[236:239], v[208:211], a[212:215]
ds_read_b128 a[232:235], v5 offset:0
v_exp_f32 v54, v54
v_mfma_f32_16x16x32_bf16 a[220:223], a[236:239], v[212:215], a[220:223]
v_exp_f32 v55, v55
v_cvt_pk_bf16_f32 v186, v52, v53
s_waitcnt lgkmcnt(3)
v_mfma_f32_16x16x32_bf16 a[192:195], a[240:243], v[216:219], a[192:195]
ds_read_b128 a[236:239], v5 offset:2048
v_exp_f32 v56, v56
v_mfma_f32_16x16x32_bf16 a[200:203], a[240:243], v[220:223], a[200:203]
v_exp_f32 v57, v57
v_cvt_pk_bf16_f32 v187, v54, v55
v_mfma_f32_16x16x32_bf16 a[196:199], a[244:247], v[216:219], a[196:199]
ds_read_b128 a[240:243], v4 offset:4096
v_exp_f32 v58, v58
v_mfma_f32_16x16x32_bf16 a[204:207], a[244:247], v[220:223], a[204:207]
v_exp_f32 v59, v59
v_cvt_pk_bf16_f32 v188, v56, v57
v_mfma_f32_16x16x32_bf16 a[208:211], a[248:251], v[216:219], a[208:211]
ds_read_b128 a[244:247], v4 offset:6144
v_exp_f32 v60, v60
v_mfma_f32_16x16x32_bf16 a[216:219], a[248:251], v[220:223], a[216:219]
v_exp_f32 v61, v61
v_cvt_pk_bf16_f32 v189, v58, v59
v_mfma_f32_16x16x32_bf16 a[212:215], a[252:255], v[216:219], a[212:215]
ds_read_b128 a[248:251], v5 offset:4096
v_exp_f32 v62, v62
v_mfma_f32_16x16x32_bf16 a[220:223], a[252:255], v[220:223], a[220:223]
v_exp_f32 v63, v63
v_cvt_pk_bf16_f32 v190, v60, v61
v_cvt_pk_bf16_f32 v191, v62, v63
L_step_82:
s_waitcnt lgkmcnt(3)
v_mfma_f32_16x16x32_bf16 v[48:51], a[224:227], v[64:67], 0
ds_read_b128 a[252:255], v5 offset:6144
buffer_load_dwordx4 v7, s[12:15], s35 offen offset:1024 nt lds
v_mfma_f32_16x16x32_bf16 v[56:59], a[224:227], v[68:71], 0
v_fma_f32 v32, v32, s6, -v10
v_fma_f32 v33, v33, s6, -v10
v_fma_f32 v34, v34, s6, -v10
v_mfma_f32_16x16x32_bf16 v[52:55], a[228:231], v[64:67], 0
ds_read_b128 a[224:227], v4 offset:8192
v_fma_f32 v35, v35, s6, -v10
v_max3_f32 v12, v32, v33, v34
v_mfma_f32_16x16x32_bf16 v[60:63], a[228:231], v[68:71], 0
v_fma_f32 v36, v36, s6, -v10
v_fma_f32 v37, v37, s6, -v10
v_fma_f32 v38, v38, s6, -v10
v_mfma_f32_16x16x32_bf16 v[48:51], a[232:235], v[72:75], v[48:51]
ds_read_b128 a[228:231], v4 offset:10240
v_max3_f32 v13, v35, v36, v37
v_mfma_f32_16x16x32_bf16 v[56:59], a[232:235], v[76:79], v[56:59]
v_fma_f32 v39, v39, s6, -v10
v_fma_f32 v40, v40, s6, -v11
v_max3_f32 v12, v12, v38, v39
v_mfma_f32_16x16x32_bf16 v[52:55], a[236:239], v[72:75], v[52:55]
ds_read_b128 a[232:235], v5 offset:8192
s_waitcnt vmcnt(4)
v_mfma_f32_16x16x32_bf16 v[60:63], a[236:239], v[76:79], v[60:63]
buffer_load_dwordx4 v6, s[12:15], s35 offen offset:2048 nt lds
v_fma_f32 v41, v41, s6, -v11
s_waitcnt lgkmcnt(3)
v_mfma_f32_16x16x32_bf16 v[48:51], a[240:243], v[80:83], v[48:51]
ds_read_b128 a[236:239], v5 offset:10240
v_fma_f32 v42, v42, s6, -v11
v_max3_f32 v13, v13, v40, v41
v_mfma_f32_16x16x32_bf16 v[56:59], a[240:243], v[84:87], v[56:59]
v_fma_f32 v43, v43, s6, -v11
v_fma_f32 v44, v44, s6, -v11
v_max3_f32 v12, v12, v42, v43
v_mfma_f32_16x16x32_bf16 v[52:55], a[244:247], v[80:83], v[52:55]
ds_read_b128 a[240:243], v4 offset:12288
v_fma_f32 v45, v45, s6, -v11
v_fma_f32 v46, v46, s6, -v11
v_mfma_f32_16x16x32_bf16 v[60:63], a[244:247], v[84:87], v[60:63]
v_max3_f32 v13, v13, v44, v45
v_fma_f32 v47, v47, s6, -v11
v_max3_f32 v12, v12, v46, v47
v_mfma_f32_16x16x32_bf16 v[48:51], a[248:251], v[88:91], v[48:51]
ds_read_b128 a[244:247], v4 offset:14336
v_max_f32 v12, v12, v13
v_cmp_lt_f32 vcc, 0x41000000, v12
v_mfma_f32_16x16x32_bf16 v[56:59], a[248:251], v[92:95], v[56:59]
s_cbranch_vccnz L_stub_1_8
L_back_1_8:
v_exp_f32 v32, v32
v_mfma_f32_16x16x32_bf16 v[52:55], a[252:255], v[88:91], v[52:55]
ds_read_b128 a[248:251], v5 offset:12288
v_exp_f32 v33, v33
v_mfma_f32_16x16x32_bf16 v[60:63], a[252:255], v[92:95], v[60:63]
v_exp_f32 v34, v34
s_waitcnt lgkmcnt(3)
v_mfma_f32_16x16x32_bf16 v[48:51], a[224:227], v[96:99], v[48:51]
ds_read_b128 a[252:255], v5 offset:14336
v_exp_f32 v35, v35
v_mfma_f32_16x16x32_bf16 v[56:59], a[224:227], v[100:103], v[56:59]
v_cvt_pk_bf16_f32 v192, v32, v33
v_exp_f32 v36, v36
v_mfma_f32_16x16x32_bf16 v[52:55], a[228:231], v[96:99], v[52:55]
s_barrier
ds_read_b128 a[224:227], v4 offset:16384
v_mfma_f32_16x16x32_bf16 v[60:63], a[228:231], v[100:103], v[60:63]
buffer_load_dwordx4 v7, s[12:15], s35 offen offset:3072 nt lds
v_exp_f32 v37, v37
v_mfma_f32_16x16x32_bf16 v[48:51], a[232:235], v[104:107], v[48:51]
ds_read_b128 a[228:231], v4 offset:18432
v_cvt_pk_bf16_f32 v193, v34, v35
v_mfma_f32_16x16x32_bf16 v[56:59], a[232:235], v[108:111], v[56:59]
v_exp_f32 v38, v38
v_exp_f32 v39, v39
v_mfma_f32_16x16x32_bf16 v[52:55], a[236:239], v[104:107], v[52:55]
ds_read_b128 a[232:235], v5 offset:16384
v_cvt_pk_bf16_f32 v194, v36, v37
v_mfma_f32_16x16x32_bf16 v[60:63], a[236:239], v[108:111], v[60:63]
v_exp_f32 v40, v40
s_waitcnt lgkmcnt(3)
v_mfma_f32_16x16x32_bf16 v[48:51], a[240:243], v[112:115], v[48:51]
ds_read_b128 a[236:239], v5 offset:18432
v_exp_f32 v41, v41
v_mfma_f32_16x16x32_bf16 v[56:59], a[240:243], v[116:119], v[56:59]
v_cvt_pk_bf16_f32 v195, v38, v39
v_exp_f32 v42, v42
v_mfma_f32_16x16x32_bf16 v[52:55], a[244:247], v[112:115], v[52:55]
ds_read_b128 a[240:243], v4 offset:20480
v_exp_f32 v43, v43
v_mfma_f32_16x16x32_bf16 v[60:63], a[244:247], v[116:119], v[60:63]
v_cvt_pk_bf16_f32 v196, v40, v41
v_exp_f32 v44, v44
v_mfma_f32_16x16x32_bf16 v[48:51], a[248:251], v[120:123], v[48:51]
ds_read_b128 a[244:247], v4 offset:22528
v_exp_f32 v45, v45
v_mfma_f32_16x16x32_bf16 v[56:59], a[248:251], v[124:127], v[56:59]
v_cvt_pk_bf16_f32 v197, v42, v43
v_exp_f32 v46, v46
v_mfma_f32_16x16x32_bf16 v[52:55], a[252:255], v[120:123], v[52:55]
ds_read_b128 a[248:251], v5 offset:20480
v_exp_f32 v47, v47
v_mfma_f32_16x16x32_bf16 v[60:63], a[252:255], v[124:127], v[60:63]
v_cvt_pk_bf16_f32 v198, v44, v45
v_cvt_pk_bf16_f32 v199, v46, v47
L_step_83:
s_waitcnt lgkmcnt(3)
v_mfma_f32_16x16x32_bf16 v[32:35], a[224:227], v[64:67], 0
ds_read_b128 a[252:255], v5 offset:22528
s_add_u32 m0, s4, 147456
v_mfma_f32_16x16x32_bf16 v[40:43], a[224:227], v[68:71], 0
s_mov_b32 s35, 491520
s_waitcnt vmcnt(3)
v_mfma_f32_16x16x32_bf16 v[36:39], a[228:231], v[64:67], 0
ds_read_b128 a[224:227], v4 offset:24576
v_mfma_f32_16x16x32_bf16 v[44:47], a[228:231], v[68:71], 0
buffer_load_dwordx4 v6, s[12:15], s35 offen nt lds
v_fma_f32 v48, v48, s6, -v10
v_mfma_f32_16x16x32_bf16 v[32:35], a[232:235], v[72:75], v[32:35]
ds_read_b128 a[228:231], v4 offset:26624
v_fma_f32 v49, v49, s6, -v10
v_mfma_f32_16x16x32_bf16 v[40:43], a[232:235], v[76:79], v[40:43]
v_fma_f32 v50, v50, s6, -v10
v_fma_f32 v51, v51, s6, -v10
v_mfma_f32_16x16x32_bf16 v[36:39], a[236:239], v[72:75], v[36:39]
ds_read_b128 a[232:235], v5 offset:24576
v_max3_f32 v12, v48, v49, v50
v_mfma_f32_16x16x32_bf16 v[44:47], a[236:239], v[76:79], v[44:47]
v_fma_f32 v52, v52, s6, -v10
s_waitcnt lgkmcnt(3)
v_mfma_f32_16x16x32_bf16 v[32:35], a[240:243], v[80:83], v[32:35]
ds_read_b128 a[236:239], v5 offset:26624
v_fma_f32 v53, v53, s6, -v10
v_mfma_f32_16x16x32_bf16 v[40:43], a[240:243], v[84:87], v[40:43]
v_fma_f32 v54, v54, s6, -v10
v_max3_f32 v13, v51, v52, v53
v_mfma_f32_16x16x32_bf16 v[36:39], a[244:247], v[80:83], v[36:39]
ds_read_b128 a[240:243], v4 offset:28672
v_mfma_f32_16x16x32_bf16 v[44:47], a[244:247], v[84:87], v[44:47]
buffer_load_dwordx4 v7, s[12:15], s35 offen offset:1024 nt lds
v_fma_f32 v55, v55, s6, -v10
v_mfma_f32_16x16x32_bf16 v[32:35], a[248:251], v[88:91], v[32:35]
ds_read_b128 a[244:247], v4 offset:30720
v_fma_f32 v56, v56, s6, -v11
v_mfma_f32_16x16x32_bf16 v[40:43], a[248:251], v[92:95], v[40:43]
v_max3_f32 v12, v12, v54, v55
v_fma_f32 v57, v57, s6, -v11
v_mfma_f32_16x16x32_bf16 v[36:39], a[252:255], v[88:91], v[36:39]
ds_read_b128 a[248:251], v5 offset:28672
s_add_u32 m0, s4, 0
v_mfma_f32_16x16x32_bf16 v[44:47], a[252:255], v[92:95], v[44:47]
s_mov_b32 s5, 115200
s_waitcnt lgkmcnt(3)
v_mfma_f32_16x16x32_bf16 v[32:35], a[224:227], v[96:99], v[32:35]
ds_read_b128 a[252:255], v5 offset:30720
v_fma_f32 v58, v58, s6, -v11
v_mfma_f32_16x16x32_bf16 v[40:43], a[224:227], v[100:103], v[40:43]
v_max3_f32 v13, v13, v56, v57
v_fma_f32 v59, v59, s6, -v11
v_mfma_f32_16x16x32_bf16 v[36:39], a[228:231], v[96:99], v[36:39]
s_barrier
ds_read_b64_tr_b16 a[224:225], v0 offset:49152
v_mfma_f32_16x16x32_bf16 v[44:47], a[228:231], v[100:103], v[44:47]
ds_read_b64_tr_b16 a[226:227], v0 offset:51200
v_fma_f32 v60, v60, s6, -v11
v_mfma_f32_16x16x32_bf16 v[32:35], a[232:235], v[104:107], v[32:35]
ds_read_b64_tr_b16 a[228:229], v1 offset:49152
ds_read_b64_tr_b16 a[230:231], v1 offset:51200
v_mfma_f32_16x16x32_bf16 v[40:43], a[232:235], v[108:111], v[40:43]
buffer_load_dwordx4 v9, s[24:27], s5 offen lds
v_mfma_f32_16x16x32_bf16 v[36:39], a[236:239], v[104:107], v[36:39]
ds_read_b64_tr_b16 a[232:233], v2 offset:49152
ds_read_b64_tr_b16 a[234:235], v2 offset:51200
v_mfma_f32_16x16x32_bf16 v[44:47], a[236:239], v[108:111], v[44:47]
s_add_u32 m0, s4, 147456
s_waitcnt vmcnt(4)
s_waitcnt lgkmcnt(6)
v_mfma_f32_16x16x32_bf16 v[32:35], a[240:243], v[112:115], v[32:35]
ds_read_b64_tr_b16 a[236:237], v3 offset:49152
ds_read_b64_tr_b16 a[238:239], v3 offset:51200
v_mfma_f32_16x16x32_bf16 v[40:43], a[240:243], v[116:119], v[40:43]
buffer_load_dwordx4 v6, s[12:15], s35 offen offset:2048 nt lds
s_add_u32 m0, s4, 0
v_mfma_f32_16x16x32_bf16 v[36:39], a[244:247], v[112:115], v[36:39]
ds_read_b64_tr_b16 a[240:241], v0 offset:57344
ds_read_b64_tr_b16 a[242:243], v0 offset:59392
v_mfma_f32_16x16x32_bf16 v[44:47], a[244:247], v[116:119], v[44:47]
s_mov_b32 s5, 121344
buffer_load_dwordx4 v9, s[24:27], s5 offen offset:1024 lds
v_mfma_f32_16x16x32_bf16 v[32:35], a[248:251], v[120:123], v[32:35]
ds_read_b64_tr_b16 a[244:245], v1 offset:57344
ds_read_b64_tr_b16 a[246:247], v1 offset:59392
v_mfma_f32_16x16x32_bf16 v[40:43], a[248:251], v[124:127], v[40:43]
s_mov_b32 s5, 127488
v_max3_f32 v12, v12, v58, v59
v_fma_f32 v61, v61, s6, -v11
v_mfma_f32_16x16x32_bf16 v[36:39], a[252:255], v[120:123], v[36:39]
ds_read_b64_tr_b16 a[248:249], v2 offset:57344
ds_read_b64_tr_b16 a[250:251], v2 offset:59392
v_mfma_f32_16x16x32_bf16 v[44:47], a[252:255], v[124:127], v[44:47]
v_fma_f32 v62, v62, s6, -v11
v_max3_f32 v13, v13, v60, v61
L_step_84:
s_waitcnt lgkmcnt(6)
v_mfma_f32_16x16x32_bf16 a[64:67], a[224:227], v[16:19], a[64:67]
ds_read_b64_tr_b16 a[252:253], v3 offset:57344
ds_read_b64_tr_b16 a[254:255], v3 offset:59392
v_mfma_f32_16x16x32_bf16 a[72:75], a[224:227], v[20:23], a[72:75]
v_fma_f32 v63, v63, s6, -v11
v_max3_f32 v12, v12, v62, v63
v_max_f32 v12, v12, v13
v_mfma_f32_16x16x32_bf16 a[68:71], a[228:231], v[16:19], a[68:71]
ds_read_b64_tr_b16 a[224:225], v0 offset:53248
ds_read_b64_tr_b16 a[226:227], v0 offset:55296
v_mfma_f32_16x16x32_bf16 a[76:79], a[228:231], v[20:23], a[76:79]
buffer_load_dwordx4 v9, s[24:27], s5 offen offset:2048 lds
s_add_u32 m0, s4, 147456
v_mfma_f32_16x16x32_bf16 a[80:83], a[232:235], v[16:19], a[80:83]
ds_read_b64_tr_b16 a[228:229], v1 offset:53248
ds_read_b64_tr_b16 a[230:231], v1 offset:55296
v_mfma_f32_16x16x32_bf16 a[88:91], a[232:235], v[20:23], a[88:91]
buffer_load_dwordx4 v7, s[12:15], s35 offen offset:3072 nt lds
s_add_u32 m0, s4, 0
v_mfma_f32_16x16x32_bf16 a[84:87], a[236:239], v[16:19], a[84:87]
ds_read_b64_tr_b16 a[232:233], v2 offset:53248
ds_read_b64_tr_b16 a[234:235], v2 offset:55296
v_mfma_f32_16x16x32_bf16 a[92:95], a[236:239], v[20:23], a[92:95]
s_mov_b32 s5, 133632
v_cmp_lt_f32 vcc, 0x41000000, v12
s_waitcnt lgkmcnt(6)
v_mfma_f32_16x16x32_bf16 a[96:99], a[240:243], v[16:19], a[96:99]
ds_read_b64_tr_b16 a[236:237], v3 offset:53248
ds_read_b64_tr_b16 a[238:239], v3 offset:55296
v_mfma_f32_16x16x32_bf16 a[104:107], a[240:243], v[20:23], a[104:107]
buffer_load_dwordx4 v9, s[24:27], s5 offen offset:3072 lds
s_cbranch_vccnz L_stub_1_9
L_back_1_9:
v_mfma_f32_16x16x32_bf16 a[100:103], a[244:247], v[16:19], a[100:103]
ds_read_b64_tr_b16 a[240:241], v0 offset:61440
ds_read_b64_tr_b16 a[242:243], v0 offset:63488
s_add_u32 m0, s4, 131072
v_mfma_f32_16x16x32_bf16 a[108:111], a[244:247], v[20:23], a[108:111]
s_mov_b32 s35, 507904
L_pg16:
s_cbranch_scc1 L_tdone
v_exp_f32 v48, v48
v_mfma_f32_16x16x32_bf16 a[112:115], a[248:251], v[16:19], a[112:115]
ds_read_b64_tr_b16 a[244:245], v1 offset:61440
ds_read_b64_tr_b16 a[246:247], v1 offset:63488
v_mfma_f32_16x16x32_bf16 a[120:123], a[248:251], v[20:23], a[120:123]
v_exp_f32 v49, v49
v_mfma_f32_16x16x32_bf16 a[116:119], a[252:255], v[16:19], a[116:119]
ds_read_b64_tr_b16 a[248:249], v2 offset:61440
ds_read_b64_tr_b16 a[250:251], v2 offset:63488
v_mfma_f32_16x16x32_bf16 a[124:127], a[252:255], v[20:23], a[124:127]
v_exp_f32 v50, v50
s_waitcnt lgkmcnt(6)
v_mfma_f32_16x16x32_bf16 a[64:67], a[224:227], v[24:27], a[64:67]
ds_read_b64_tr_b16 a[252:253], v3 offset:61440
ds_read_b64_tr_b16 a[254:255], v3 offset:63488
v_mfma_f32_16x16x32_bf16 a[72:75], a[224:227], v[28:31], a[72:75]
s_waitcnt vmcnt(7)
buffer_load_dwordx4 v6, s[12:15], s35 offen nt lds
v_mfma_f32_16x16x32_bf16 a[68:71], a[228:231], v[24:27], a[68:71]
s_barrier
ds_read_b128 a[224:227], v4 offset:32768
v_mfma_f32_16x16x32_bf16 a[76:79], a[228:231], v[28:31], a[76:79]
v_exp_f32 v51, v51
v_cvt_pk_bf16_f32 v200, v48, v49
v_mfma_f32_16x16x32_bf16 a[80:83], a[232:235], v[24:27], a[80:83]
ds_read_b128 a[228:231], v4 offset:34816
v_exp_f32 v52, v52
v_mfma_f32_16x16x32_bf16 a[88:91], a[232:235], v[28:31], a[88:91]
v_exp_f32 v53, v53
v_cvt_pk_bf16_f32 v201, v50, v51
v_mfma_f32_16x16x32_bf16 a[84:87], a[236:239], v[24:27], a[84:87]
ds_read_b128 a[232:235], v5 offset:32768
v_exp_f32 v54, v54
v_mfma_f32_16x16x32_bf16 a[92:95], a[236:239], v[28:31], a[92:95]
v_exp_f32 v55, v55
v_cvt_pk_bf16_f32 v202, v52, v53
s_waitcnt lgkmcnt(3)
v_mfma_f32_16x16x32_bf16 a[96:99], a[240:243], v[24:27], a[96:99]
ds_read_b128 a[236:239], v5 offset:34816
v_exp_f32 v56, v56
v_mfma_f32_16x16x32_bf16 a[104:107], a[240:243], v[28:31], a[104:107]
v_exp_f32 v57, v57
v_cvt_pk_bf16_f32 v203, v54, v55
v_mfma_f32_16x16x32_bf16 a[100:103], a[244:247], v[24:27], a[100:103]
ds_read_b128 a[240:243], v4 offset:36864
v_exp_f32 v58, v58
v_mfma_f32_16x16x32_bf16 a[108:111], a[244:247], v[28:31], a[108:111]
v_exp_f32 v59, v59
v_cvt_pk_bf16_f32 v204, v56, v57
v_mfma_f32_16x16x32_bf16 a[112:115], a[248:251], v[24:27], a[112:115]
ds_read_b128 a[244:247], v4 offset:38912
v_exp_f32 v60, v60
v_mfma_f32_16x16x32_bf16 a[120:123], a[248:251], v[28:31], a[120:123]
v_exp_f32 v61, v61
v_cvt_pk_bf16_f32 v205, v58, v59
v_mfma_f32_16x16x32_bf16 a[116:119], a[252:255], v[24:27], a[116:119]
ds_read_b128 a[248:251], v5 offset:36864
v_exp_f32 v62, v62
v_mfma_f32_16x16x32_bf16 a[124:127], a[252:255], v[28:31], a[124:127]
v_exp_f32 v63, v63
v_cvt_pk_bf16_f32 v206, v60, v61
v_cvt_pk_bf16_f32 v207, v62, v63
L_step_85:
s_waitcnt lgkmcnt(3)
v_mfma_f32_16x16x32_bf16 v[48:51], a[224:227], v[64:67], 0
ds_read_b128 a[252:255], v5 offset:38912
buffer_load_dwordx4 v7, s[12:15], s35 offen offset:1024 nt lds
v_mfma_f32_16x16x32_bf16 v[56:59], a[224:227], v[68:71], 0
v_fma_f32 v32, v32, s6, -v10
v_fma_f32 v33, v33, s6, -v10
v_fma_f32 v34, v34, s6, -v10
v_mfma_f32_16x16x32_bf16 v[52:55], a[228:231], v[64:67], 0
ds_read_b128 a[224:227], v4 offset:40960
v_fma_f32 v35, v35, s6, -v10
v_max3_f32 v12, v32, v33, v34
v_mfma_f32_16x16x32_bf16 v[60:63], a[228:231], v[68:71], 0
v_fma_f32 v36, v36, s6, -v10
v_fma_f32 v37, v37, s6, -v10
v_fma_f32 v38, v38, s6, -v10
v_mfma_f32_16x16x32_bf16 v[48:51], a[232:235], v[72:75], v[48:51]
ds_read_b128 a[228:231], v4 offset:43008
v_max3_f32 v13, v35, v36, v37
v_mfma_f32_16x16x32_bf16 v[56:59], a[232:235], v[76:79], v[56:59]
v_fma_f32 v39, v39, s6, -v10
v_fma_f32 v40, v40, s6, -v11
v_max3_f32 v12, v12, v38, v39
v_mfma_f32_16x16x32_bf16 v[52:55], a[236:239], v[72:75], v[52:55]
ds_read_b128 a[232:235], v5 offset:40960
v_fma_f32 v41, v41, s6, -v11
v_fma_f32 v42, v42, s6, -v11
v_mfma_f32_16x16x32_bf16 v[60:63], a[236:239], v[76:79], v[60:63]
v_max3_f32 v13, v13, v40, v41
v_fma_f32 v43, v43, s6, -v11
s_waitcnt lgkmcnt(3)
v_mfma_f32_16x16x32_bf16 v[48:51], a[240:243], v[80:83], v[48:51]
ds_read_b128 a[236:239], v5 offset:43008
s_waitcnt vmcnt(6)
v_mfma_f32_16x16x32_bf16 v[56:59], a[240:243], v[84:87], v[56:59]
buffer_load_dwordx4 v6, s[12:15], s35 offen offset:2048 nt lds
v_fma_f32 v44, v44, s6, -v11
v_max3_f32 v12, v12, v42, v43
v_mfma_f32_16x16x32_bf16 v[52:55], a[244:247], v[80:83], v[52:55]
ds_read_b128 a[240:243], v4 offset:45056
v_fma_f32 v45, v45, s6, -v11
v_fma_f32 v46, v46, s6, -v11
v_mfma_f32_16x16x32_bf16 v[60:63], a[244:247], v[84:87], v[60:63]
v_max3_f32 v13, v13, v44, v45
v_fma_f32 v47, v47, s6, -v11
v_max3_f32 v12, v12, v46, v47
v_mfma_f32_16x16x32_bf16 v[48:51], a[248:251], v[88:91], v[48:51]
ds_read_b128 a[244:247], v4 offset:47104
v_max_f32 v12, v12, v13
v_cmp_lt_f32 vcc, 0x41000000, v12
v_mfma_f32_16x16x32_bf16 v[56:59], a[248:251], v[92:95], v[56:59]
s_cbranch_vccnz L_stub_1_10
L_back_1_10:
v_exp_f32 v32, v32
v_mfma_f32_16x16x32_bf16 v[52:55], a[252:255], v[88:91], v[52:55]
ds_read_b128 a[248:251], v5 offset:45056
v_exp_f32 v33, v33
v_mfma_f32_16x16x32_bf16 v[60:63], a[252:255], v[92:95], v[60:63]
v_exp_f32 v34, v34
s_waitcnt lgkmcnt(3)
v_mfma_f32_16x16x32_bf16 v[48:51], a[224:227], v[96:99], v[48:51]
ds_read_b128 a[252:255], v5 offset:47104
v_exp_f32 v35, v35
v_mfma_f32_16x16x32_bf16 v[56:59], a[224:227], v[100:103], v[56:59]
v_cvt_pk_bf16_f32 v208, v32, v33
v_exp_f32 v36, v36
v_mfma_f32_16x16x32_bf16 v[52:55], a[228:231], v[96:99], v[52:55]
s_barrier
ds_read_b128 a[224:227], v4 offset:49152
v_mfma_f32_16x16x32_bf16 v[60:63], a[228:231], v[100:103], v[60:63]
v_exp_f32 v37, v37
v_cvt_pk_bf16_f32 v209, v34, v35
v_mfma_f32_16x16x32_bf16 v[48:51], a[232:235], v[104:107], v[48:51]
ds_read_b128 a[228:231], v4 offset:51200
buffer_load_dwordx4 v7, s[12:15], s35 offen offset:3072 nt lds
v_mfma_f32_16x16x32_bf16 v[56:59], a[232:235], v[108:111], v[56:59]
v_exp_f32 v38, v38
v_mfma_f32_16x16x32_bf16 v[52:55], a[236:239], v[104:107], v[52:55]
ds_read_b128 a[232:235], v5 offset:49152
v_exp_f32 v39, v39
v_mfma_f32_16x16x32_bf16 v[60:63], a[236:239], v[108:111], v[60:63]
v_cvt_pk_bf16_f32 v210, v36, v37
s_waitcnt lgkmcnt(3)
v_mfma_f32_16x16x32_bf16 v[48:51], a[240:243], v[112:115], v[48:51]
ds_read_b128 a[236:239], v5 offset:51200
v_exp_f32 v40, v40
v_mfma_f32_16x16x32_bf16 v[56:59], a[240:243], v[116:119], v[56:59]
v_exp_f32 v41, v41
v_cvt_pk_bf16_f32 v211, v38, v39
v_mfma_f32_16x16x32_bf16 v[52:55], a[244:247], v[112:115], v[52:55]
ds_read_b128 a[240:243], v4 offset:53248
v_exp_f32 v42, v42
v_mfma_f32_16x16x32_bf16 v[60:63], a[244:247], v[116:119], v[60:63]
v_exp_f32 v43, v43
v_cvt_pk_bf16_f32 v212, v40, v41
s_add_u32 m0, s4, 32768
v_mfma_f32_16x16x32_bf16 v[48:51], a[248:251], v[120:123], v[48:51]
ds_read_b128 a[244:247], v4 offset:55296
v_exp_f32 v44, v44
v_mfma_f32_16x16x32_bf16 v[56:59], a[248:251], v[124:127], v[56:59]
v_exp_f32 v45, v45
v_cvt_pk_bf16_f32 v213, v42, v43
s_mov_b32 s35, 262144
v_mfma_f32_16x16x32_bf16 v[52:55], a[252:255], v[120:123], v[52:55]
ds_read_b128 a[248:251], v5 offset:53248
v_exp_f32 v46, v46
v_mfma_f32_16x16x32_bf16 v[60:63], a[252:255], v[124:127], v[60:63]
v_exp_f32 v47, v47
v_cvt_pk_bf16_f32 v214, v44, v45
v_cvt_pk_bf16_f32 v215, v46, v47
L_step_86:
s_waitcnt lgkmcnt(3)
v_mfma_f32_16x16x32_bf16 v[32:35], a[224:227], v[64:67], 0
ds_read_b128 a[252:255], v5 offset:55296
s_waitcnt vmcnt(3)
v_mfma_f32_16x16x32_bf16 v[40:43], a[224:227], v[68:71], 0
buffer_load_dwordx4 v8, s[16:19], s35 offen nt lds
v_mfma_f32_16x16x32_bf16 v[36:39], a[228:231], v[64:67], 0
ds_read_b128 a[224:227], v4 offset:57344
v_fma_f32 v48, v48, s6, -v10
v_fma_f32 v49, v49, s6, -v10
v_mfma_f32_16x16x32_bf16 v[44:47], a[228:231], v[68:71], 0
v_fma_f32 v50, v50, s6, -v10
v_fma_f32 v51, v51, s6, -v10
v_max3_f32 v12, v48, v49, v50
v_mfma_f32_16x16x32_bf16 v[32:35], a[232:235], v[72:75], v[32:35]
ds_read_b128 a[228:231], v4 offset:59392
v_fma_f32 v52, v52, s6, -v10
v_fma_f32 v53, v53, s6, -v10
v_mfma_f32_16x16x32_bf16 v[40:43], a[232:235], v[76:79], v[40:43]
v_fma_f32 v54, v54, s6, -v10
v_max3_f32 v13, v51, v52, v53
v_fma_f32 v55, v55, s6, -v10
v_mfma_f32_16x16x32_bf16 v[36:39], a[236:239], v[72:75], v[36:39]
ds_read_b128 a[232:235], v5 offset:57344
v_fma_f32 v56, v56, s6, -v11
v_max3_f32 v12, v12, v54, v55
v_mfma_f32_16x16x32_bf16 v[44:47], a[236:239], v[76:79], v[44:47]
v_fma_f32 v57, v57, s6, -v11
v_fma_f32 v58, v58, s6, -v11
s_waitcnt lgkmcnt(3)
v_mfma_f32_16x16x32_bf16 v[32:35], a[240:243], v[80:83], v[32:35]
ds_read_b128 a[236:239], v5 offset:59392
v_max3_f32 v13, v13, v56, v57
v_fma_f32 v59, v59, s6, -v11
v_mfma_f32_16x16x32_bf16 v[40:43], a[240:243], v[84:87], v[40:43]
v_fma_f32 v60, v60, s6, -v11
v_max3_f32 v12, v12, v58, v59
v_fma_f32 v61, v61, s6, -v11
v_mfma_f32_16x16x32_bf16 v[36:39], a[244:247], v[80:83], v[36:39]
ds_read_b128 a[240:243], v4 offset:61440
v_fma_f32 v62, v62, s6, -v11
v_max3_f32 v13, v13, v60, v61
v_mfma_f32_16x16x32_bf16 v[44:47], a[244:247], v[84:87], v[44:47]
v_fma_f32 v63, v63, s6, -v11
v_max3_f32 v12, v12, v62, v63
v_max_f32 v12, v12, v13
v_mfma_f32_16x16x32_bf16 v[32:35], a[248:251], v[88:91], v[32:35]
ds_read_b128 a[244:247], v4 offset:63488
v_add_u32 v4, 0x14000, v4
v_mfma_f32_16x16x32_bf16 v[40:43], a[248:251], v[92:95], v[40:43]
buffer_load_dwordx4 v8, s[16:19], s35 offen offset:1024 nt lds
v_cmp_lt_f32 vcc, 0x41000000, v12
s_cbranch_vccnz L_stub_1_11
L_back_1_11:
v_mfma_f32_16x16x32_bf16 v[36:39], a[252:255], v[88:91], v[36:39]
ds_read_b128 a[248:251], v5 offset:61440
v_exp_f32 v48, v48
v_mfma_f32_16x16x32_bf16 v[44:47], a[252:255], v[92:95], v[44:47]
v_exp_f32 v49, v49
s_waitcnt lgkmcnt(3)
v_mfma_f32_16x16x32_bf16 v[32:35], a[224:227], v[96:99], v[32:35]
ds_read_b128 a[252:255], v5 offset:63488
v_add_u32 v5, 0x14000, v5
v_mfma_f32_16x16x32_bf16 v[40:43], a[224:227], v[100:103], v[40:43]
v_exp_f32 v50, v50
v_exp_f32 v51, v51
v_mfma_f32_16x16x32_bf16 v[36:39], a[228:231], v[96:99], v[36:39]
s_barrier
ds_read_b128 a[224:227], v4 offset:0
v_mfma_f32_16x16x32_bf16 v[44:47], a[228:231], v[100:103], v[44:47]
v_cvt_pk_bf16_f32 v216, v48, v49
v_exp_f32 v52, v52
v_mfma_f32_16x16x32_bf16 v[32:35], a[232:235], v[104:107], v[32:35]
ds_read_b128 a[228:231], v4 offset:2048
v_exp_f32 v53, v53
v_mfma_f32_16x16x32_bf16 v[40:43], a[232:235], v[108:111], v[40:43]
v_cvt_pk_bf16_f32 v217, v50, v51
v_exp_f32 v54, v54
v_mfma_f32_16x16x32_bf16 v[36:39], a[236:239], v[104:107], v[36:39]
ds_read_b128 a[232:235], v5 offset:0
s_waitcnt vmcnt(3)
buffer_load_dwordx4 v8, s[16:19], s35 offen offset:2048 nt lds
v_mfma_f32_16x16x32_bf16 v[44:47], a[236:239], v[108:111], v[44:47]
v_exp_f32 v55, v55
s_waitcnt lgkmcnt(3)
v_mfma_f32_16x16x32_bf16 v[32:35], a[240:243], v[112:115], v[32:35]
ds_read_b128 a[236:239], v5 offset:2048
v_cvt_pk_bf16_f32 v218, v52, v53
v_exp_f32 v56, v56
v_mfma_f32_16x16x32_bf16 v[40:43], a[240:243], v[116:119], v[40:43]
v_exp_f32 v57, v57
v_cvt_pk_bf16_f32 v219, v54, v55
v_mfma_f32_16x16x32_bf16 v[36:39], a[244:247], v[112:115], v[36:39]
ds_read_b128 a[240:243], v4 offset:4096
v_exp_f32 v58, v58
v_mfma_f32_16x16x32_bf16 v[44:47], a[244:247], v[116:119], v[44:47]
v_exp_f32 v59, v59
v_cvt_pk_bf16_f32 v220, v56, v57
v_add_u32 v0, 0xffff0000, v0
v_mfma_f32_16x16x32_bf16 v[32:35], a[248:251], v[120:123], v[32:35]
ds_read_b128 a[244:247], v4 offset:6144
v_exp_f32 v60, v60
v_mfma_f32_16x16x32_bf16 v[40:43], a[248:251], v[124:127], v[40:43]
v_exp_f32 v61, v61
v_cvt_pk_bf16_f32 v221, v58, v59
v_add_u32 v1, 0xffff0000, v1
v_mfma_f32_16x16x32_bf16 v[36:39], a[252:255], v[120:123], v[36:39]
ds_read_b128 a[248:251], v5 offset:4096
v_exp_f32 v62, v62
v_mfma_f32_16x16x32_bf16 v[44:47], a[252:255], v[124:127], v[44:47]
v_exp_f32 v63, v63
v_cvt_pk_bf16_f32 v222, v60, v61
v_cvt_pk_bf16_f32 v223, v62, v63
L_step_87:
s_waitcnt lgkmcnt(3)
v_mfma_f32_16x16x32_bf16 v[48:51], a[224:227], v[64:67], 0
ds_read_b128 a[252:255], v5 offset:6144
v_mfma_f32_16x16x32_bf16 v[56:59], a[224:227], v[68:71], 0
v_add_u32 v2, 0xffff0000, v2
v_add_u32 v3, 0xffff0000, v3
v_mfma_f32_16x16x32_bf16 v[52:55], a[228:231], v[64:67], 0
ds_read_b128 a[224:227], v4 offset:8192
v_mfma_f32_16x16x32_bf16 v[60:63], a[228:231], v[68:71], 0
buffer_load_dwordx4 v8, s[16:19], s35 offen offset:3072 nt lds
v_fma_f32 v32, v32, s6, -v10
v_mfma_f32_16x16x32_bf16 v[48:51], a[232:235], v[72:75], v[48:51]
ds_read_b128 a[228:231], v4 offset:10240
v_fma_f32 v33, v33, s6, -v10
v_mfma_f32_16x16x32_bf16 v[56:59], a[232:235], v[76:79], v[56:59]
v_fma_f32 v34, v34, s6, -v10
v_fma_f32 v35, v35, s6, -v10
v_mfma_f32_16x16x32_bf16 v[52:55], a[236:239], v[72:75], v[52:55]
ds_read_b128 a[232:235], v5 offset:8192
v_max3_f32 v12, v32, v33, v34
v_mfma_f32_16x16x32_bf16 v[60:63], a[236:239], v[76:79], v[60:63]
v_fma_f32 v36, v36, s6, -v10
s_waitcnt lgkmcnt(3)
v_mfma_f32_16x16x32_bf16 v[48:51], a[240:243], v[80:83], v[48:51]
ds_read_b128 a[236:239], v5 offset:10240
s_add_u32 m0, s4, 49152
v_mfma_f32_16x16x32_bf16 v[56:59], a[240:243], v[84:87], v[56:59]
s_mov_b32 s35, 327680
v_fma_f32 v37, v37, s6, -v10
v_mfma_f32_16x16x32_bf16 v[52:55], a[244:247], v[80:83], v[52:55]
ds_read_b128 a[240:243], v4 offset:12288
v_fma_f32 v38, v38, s6, -v10
v_mfma_f32_16x16x32_bf16 v[60:63], a[244:247], v[84:87], v[60:63]
v_max3_f32 v13, v35, v36, v37
v_fma_f32 v39, v39, s6, -v10
v_mfma_f32_16x16x32_bf16 v[48:51], a[248:251], v[88:91], v[48:51]
ds_read_b128 a[244:247], v4 offset:14336
v_fma_f32 v40, v40, s6, -v11
v_mfma_f32_16x16x32_bf16 v[56:59], a[248:251], v[92:95], v[56:59]
v_max3_f32 v12, v12, v38, v39
v_fma_f32 v41, v41, s6, -v11
v_mfma_f32_16x16x32_bf16 v[52:55], a[252:255], v[88:91], v[52:55]
ds_read_b128 a[248:251], v5 offset:12288
s_waitcnt vmcnt(3)
v_mfma_f32_16x16x32_bf16 v[60:63], a[252:255], v[92:95], v[60:63]
v_fma_f32 v42, v42, s6, -v11
s_waitcnt lgkmcnt(3)
v_mfma_f32_16x16x32_bf16 v[48:51], a[224:227], v[96:99], v[48:51]
ds_read_b128 a[252:255], v5 offset:14336
v_mfma_f32_16x16x32_bf16 v[56:59], a[224:227], v[100:103], v[56:59]
buffer_load_dwordx4 v8, s[16:19], s35 offen nt lds
s_add_u32 m0, s4, 16384
v_mfma_f32_16x16x32_bf16 v[52:55], a[228:231], v[96:99], v[52:55]
s_barrier
ds_read_b64_tr_b16 a[224:225], v0 offset:0
v_mfma_f32_16x16x32_bf16 v[60:63], a[228:231], v[100:103], v[60:63]
ds_read_b64_tr_b16 a[226:227], v0 offset:2048
s_add_u32 s5, s88, 115456
v_mfma_f32_16x16x32_bf16 v[48:51], a[232:235], v[104:107], v[48:51]
ds_read_b64_tr_b16 a[228:229], v1 offset:0
ds_read_b64_tr_b16 a[230:231], v1 offset:2048
v_mfma_f32_16x16x32_bf16 v[56:59], a[232:235], v[108:111], v[56:59]
buffer_load_dwordx4 v9, s[24:27], s5 offen lds
v_mfma_f32_16x16x32_bf16 v[52:55], a[236:239], v[104:107], v[52:55]
ds_read_b64_tr_b16 a[232:233], v2 offset:0
ds_read_b64_tr_b16 a[234:235], v2 offset:2048
v_mfma_f32_16x16x32_bf16 v[60:63], a[236:239], v[108:111], v[60:63]
s_add_u32 s5, s88, 121600
s_waitcnt lgkmcnt(6)
v_mfma_f32_16x16x32_bf16 v[48:51], a[240:243], v[112:115], v[48:51]
ds_read_b64_tr_b16 a[236:237], v3 offset:0
ds_read_b64_tr_b16 a[238:239], v3 offset:2048
v_mfma_f32_16x16x32_bf16 v[56:59], a[240:243], v[116:119], v[56:59]
v_max3_f32 v13, v13, v40, v41
v_fma_f32 v43, v43, s6, -v11
v_fma_f32 v44, v44, s6, -v11
v_mfma_f32_16x16x32_bf16 v[52:55], a[244:247], v[112:115], v[52:55]
ds_read_b64_tr_b16 a[240:241], v0 offset:8192
ds_read_b64_tr_b16 a[242:243], v0 offset:10240
v_mfma_f32_16x16x32_bf16 v[60:63], a[244:247], v[116:119], v[60:63]
buffer_load_dwordx4 v9, s[24:27], s5 offen offset:1024 lds
s_add_u32 m0, s4, 49152
v_mfma_f32_16x16x32_bf16 v[48:51], a[248:251], v[120:123], v[48:51]
ds_read_b64_tr_b16 a[244:245], v1 offset:8192
ds_read_b64_tr_b16 a[246:247], v1 offset:10240
v_mfma_f32_16x16x32_bf16 v[56:59], a[248:251], v[124:127], v[56:59]
buffer_load_dwordx4 v8, s[16:19], s35 offen offset:1024 nt lds
s_add_u32 m0, s4, 16384
v_mfma_f32_16x16x32_bf16 v[52:55], a[252:255], v[120:123], v[52:55]
ds_read_b64_tr_b16 a[248:249], v2 offset:8192
ds_read_b64_tr_b16 a[250:251], v2 offset:10240
v_mfma_f32_16x16x32_bf16 v[60:63], a[252:255], v[124:127], v[60:63]
s_add_u32 s5, s88, 127744
v_max3_f32 v12, v12, v42, v43
L_step_88:
s_waitcnt lgkmcnt(6)
v_mfma_f32_16x16x32_bf16 a[128:131], a[224:227], v[16:19], a[128:131]
ds_read_b64_tr_b16 a[252:253], v3 offset:8192
ds_read_b64_tr_b16 a[254:255], v3 offset:10240
v_mfma_f32_16x16x32_bf16 a[136:139], a[224:227], v[20:23], a[136:139]
v_fma_f32 v45, v45, s6, -v11
v_fma_f32 v46, v46, s6, -v11
v_max3_f32 v13, v13, v44, v45
v_mfma_f32_16x16x32_bf16 a[132:135], a[228:231], v[16:19], a[132:135]
ds_read_b64_tr_b16 a[224:225], v0 offset:4096
ds_read_b64_tr_b16 a[226:227], v0 offset:6144
v_mfma_f32_16x16x32_bf16 a[140:143], a[228:231], v[20:23], a[140:143]
buffer_load_dwordx4 v9, s[24:27], s5 offen offset:2048 lds
s_add_u32 m0, s4, 49152
v_mfma_f32_16x16x32_bf16 a[144:147], a[232:235], v[16:19], a[144:147]
ds_read_b64_tr_b16 a[228:229], v1 offset:4096
ds_read_b64_tr_b16 a[230:231], v1 offset:6144
v_mfma_f32_16x16x32_bf16 a[152:155], a[232:235], v[20:23], a[152:155]
v_fma_f32 v47, v47, s6, -v11
v_max3_f32 v12, v12, v46, v47
v_max_f32 v12, v12, v13
v_mfma_f32_16x16x32_bf16 a[148:151], a[236:239], v[16:19], a[148:151]
ds_read_b64_tr_b16 a[232:233], v2 offset:4096
ds_read_b64_tr_b16 a[234:235], v2 offset:6144
v_mfma_f32_16x16x32_bf16 a[156:159], a[236:239], v[20:23], a[156:159]
v_cmp_lt_f32 vcc, 0x41000000, v12
s_cbranch_vccnz L_stub_1_12
L_back_1_12:
s_waitcnt lgkmcnt(6)
v_mfma_f32_16x16x32_bf16 a[160:163], a[240:243], v[16:19], a[160:163]
ds_read_b64_tr_b16 a[236:237], v3 offset:4096
ds_read_b64_tr_b16 a[238:239], v3 offset:6144
s_waitcnt vmcnt(6)
v_mfma_f32_16x16x32_bf16 a[168:171], a[240:243], v[20:23], a[168:171]
buffer_load_dwordx4 v8, s[16:19], s35 offen offset:2048 nt lds
s_add_u32 m0, s4, 16384
v_mfma_f32_16x16x32_bf16 a[164:167], a[244:247], v[16:19], a[164:167]
ds_read_b64_tr_b16 a[240:241], v0 offset:12288
ds_read_b64_tr_b16 a[242:243], v0 offset:14336
v_mfma_f32_16x16x32_bf16 a[172:175], a[244:247], v[20:23], a[172:175]
s_add_u32 s5, s88, 133888
buffer_load_dwordx4 v9, s[24:27], s5 offen offset:3072 lds
v_mfma_f32_16x16x32_bf16 a[176:179], a[248:251], v[16:19], a[176:179]
ds_read_b64_tr_b16 a[244:245], v1 offset:12288
ds_read_b64_tr_b16 a[246:247], v1 offset:14336
v_mfma_f32_16x16x32_bf16 a[184:187], a[248:251], v[20:23], a[184:187]
v_exp_f32 v32, v32
v_exp_f32 v33, v33
v_mfma_f32_16x16x32_bf16 a[180:183], a[252:255], v[16:19], a[180:183]
ds_read_b64_tr_b16 a[248:249], v2 offset:12288
ds_read_b64_tr_b16 a[250:251], v2 offset:14336
v_mfma_f32_16x16x32_bf16 a[188:191], a[252:255], v[20:23], a[188:191]
v_exp_f32 v34, v34
s_waitcnt lgkmcnt(6)
v_mfma_f32_16x16x32_bf16 a[128:131], a[224:227], v[24:27], a[128:131]
ds_read_b64_tr_b16 a[252:253], v3 offset:12288
ds_read_b64_tr_b16 a[254:255], v3 offset:14336
s_add_u32 m0, s4, 49152
v_mfma_f32_16x16x32_bf16 a[136:139], a[224:227], v[28:31], a[136:139]
v_exp_f32 v35, v35
v_cvt_pk_bf16_f32 v224, v32, v33
v_mfma_f32_16x16x32_bf16 a[132:135], a[228:231], v[24:27], a[132:135]
s_barrier
ds_read_b128 a[224:227], v4 offset:49152
v_mfma_f32_16x16x32_bf16 a[140:143], a[228:231], v[28:31], a[140:143]
v_exp_f32 v36, v36
v_exp_f32 v37, v37
v_mfma_f32_16x16x32_bf16 a[144:147], a[232:235], v[24:27], a[144:147]
ds_read_b128 a[228:231], v4 offset:51200
v_cvt_pk_bf16_f32 v225, v34, v35
v_mfma_f32_16x16x32_bf16 a[152:155], a[232:235], v[28:31], a[152:155]
v_exp_f32 v38, v38
v_exp_f32 v39, v39
v_mfma_f32_16x16x32_bf16 a[148:151], a[236:239], v[24:27], a[148:151]
ds_read_b128 a[232:235], v5 offset:49152
buffer_load_dwordx4 v8, s[16:19], s35 offen offset:3072 nt lds
v_mfma_f32_16x16x32_bf16 a[156:159], a[236:239], v[28:31], a[156:159]
v_cvt_pk_bf16_f32 v226, v36, v37
s_waitcnt lgkmcnt(3)
v_mfma_f32_16x16x32_bf16 a[160:163], a[240:243], v[24:27], a[160:163]
ds_read_b128 a[236:239], v5 offset:51200
v_exp_f32 v40, v40
v_mfma_f32_16x16x32_bf16 a[168:171], a[240:243], v[28:31], a[168:171]
v_exp_f32 v41, v41
v_cvt_pk_bf16_f32 v227, v38, v39
v_mfma_f32_16x16x32_bf16 a[164:167], a[244:247], v[24:27], a[164:167]
ds_read_b128 a[240:243], v4 offset:53248
v_exp_f32 v42, v42
v_mfma_f32_16x16x32_bf16 a[172:175], a[244:247], v[28:31], a[172:175]
v_exp_f32 v43, v43
v_cvt_pk_bf16_f32 v228, v40, v41
v_mfma_f32_16x16x32_bf16 a[176:179], a[248:251], v[24:27], a[176:179]
ds_read_b128 a[244:247], v4 offset:55296
v_exp_f32 v44, v44
v_mfma_f32_16x16x32_bf16 a[184:187], a[248:251], v[28:31], a[184:187]
v_exp_f32 v45, v45
v_cvt_pk_bf16_f32 v229, v42, v43
s_add_u32 m0, s4, 98304
v_mfma_f32_16x16x32_bf16 a[180:183], a[252:255], v[24:27], a[180:183]
ds_read_b128 a[248:251], v5 offset:53248
v_exp_f32 v46, v46
v_mfma_f32_16x16x32_bf16 a[188:191], a[252:255], v[28:31], a[188:191]
v_exp_f32 v47, v47
v_cvt_pk_bf16_f32 v230, v44, v45
v_cvt_pk_bf16_f32 v231, v46, v47
L_step_89:
s_waitcnt lgkmcnt(3)
v_mfma_f32_16x16x32_bf16 v[32:35], a[224:227], v[64:67], 0
ds_read_b128 a[252:255], v5 offset:55296
s_mov_b32 s35, 393216
v_mfma_f32_16x16x32_bf16 v[40:43], a[224:227], v[68:71], 0
v_fma_f32 v48, v48, s6, -v10
v_fma_f32 v49, v49, s6, -v10
v_fma_f32 v50, v50, s6, -v10
v_mfma_f32_16x16x32_bf16 v[36:39], a[228:231], v[64:67], 0
ds_read_b128 a[224:227], v4 offset:57344
s_waitcnt vmcnt(7)
v_mfma_f32_16x16x32_bf16 v[44:47], a[228:231], v[68:71], 0
buffer_load_dwordx4 v8, s[16:19], s35 offen nt lds
v_fma_f32 v51, v51, s6, -v10
v_max3_f32 v12, v48, v49, v50
v_mfma_f32_16x16x32_bf16 v[32:35], a[232:235], v[72:75], v[32:35]
ds_read_b128 a[228:231], v4 offset:59392
v_fma_f32 v52, v52, s6, -v10
v_fma_f32 v53, v53, s6, -v10
v_mfma_f32_16x16x32_bf16 v[40:43], a[232:235], v[76:79], v[40:43]
v_fma_f32 v54, v54, s6, -v10
v_max3_f32 v13, v51, v52, v53
v_fma_f32 v55, v55, s6, -v10
v_mfma_f32_16x16x32_bf16 v[36:39], a[236:239], v[72:75], v[36:39]
ds_read_b128 a[232:235], v5 offset:57344
v_fma_f32 v56, v56, s6, -v11
v_max3_f32 v12, v12, v54, v55
v_mfma_f32_16x16x32_bf16 v[44:47], a[236:239], v[76:79], v[44:47]
v_fma_f32 v57, v57, s6, -v11
v_fma_f32 v58, v58, s6, -v11
s_waitcnt lgkmcnt(3)
v_mfma_f32_16x16x32_bf16 v[32:35], a[240:243], v[80:83], v[32:35]
ds_read_b128 a[236:239], v5 offset:59392
v_max3_f32 v13, v13, v56, v57
v_fma_f32 v59, v59, s6, -v11
v_mfma_f32_16x16x32_bf16 v[40:43], a[240:243], v[84:87], v[40:43]
v_fma_f32 v60, v60, s6, -v11
v_max3_f32 v12, v12, v58, v59
v_fma_f32 v61, v61, s6, -v11
v_mfma_f32_16x16x32_bf16 v[36:39], a[244:247], v[80:83], v[36:39]
ds_read_b128 a[240:243], v4 offset:61440
v_fma_f32 v62, v62, s6, -v11
v_max3_f32 v13, v13, v60, v61
v_mfma_f32_16x16x32_bf16 v[44:47], a[244:247], v[84:87], v[44:47]
v_fma_f32 v63, v63, s6, -v11
v_max3_f32 v12, v12, v62, v63
v_max_f32 v12, v12, v13
v_mfma_f32_16x16x32_bf16 v[32:35], a[248:251], v[88:91], v[32:35]
ds_read_b128 a[244:247], v4 offset:63488
v_cmp_lt_f32 vcc, 0x41000000, v12
v_mfma_f32_16x16x32_bf16 v[40:43], a[248:251], v[92:95], v[40:43]
s_cbranch_vccnz L_stub_1_13
L_back_1_13:
v_exp_f32 v48, v48
v_mfma_f32_16x16x32_bf16 v[36:39], a[252:255], v[88:91], v[36:39]
ds_read_b128 a[248:251], v5 offset:61440
buffer_load_dwordx4 v8, s[16:19], s35 offen offset:1024 nt lds
v_mfma_f32_16x16x32_bf16 v[44:47], a[252:255], v[92:95], v[44:47]
v_exp_f32 v49, v49
s_waitcnt lgkmcnt(3)
v_mfma_f32_16x16x32_bf16 v[32:35], a[224:227], v[96:99], v[32:35]
ds_read_b128 a[252:255], v5 offset:63488
v_exp_f32 v50, v50
v_mfma_f32_16x16x32_bf16 v[40:43], a[224:227], v[100:103], v[40:43]
v_exp_f32 v51, v51
v_cvt_pk_bf16_f32 v232, v48, v49
v_mfma_f32_16x16x32_bf16 v[36:39], a[228:231], v[96:99], v[36:39]
s_barrier
ds_read_b128 a[224:227], v4 offset:32768
v_mfma_f32_16x16x32_bf16 v[44:47], a[228:231], v[100:103], v[44:47]
v_exp_f32 v52, v52
v_exp_f32 v53, v53
v_mfma_f32_16x16x32_bf16 v[32:35], a[232:235], v[104:107], v[32:35]
ds_read_b128 a[228:231], v4 offset:34816
v_cvt_pk_bf16_f32 v233, v50, v51
v_mfma_f32_16x16x32_bf16 v[40:43], a[232:235], v[108:111], v[40:43]
v_exp_f32 v54, v54
v_exp_f32 v55, v55
v_mfma_f32_16x16x32_bf16 v[36:39], a[236:239], v[104:107], v[36:39]
ds_read_b128 a[232:235], v5 offset:32768
v_cvt_pk_bf16_f32 v234, v52, v53
v_mfma_f32_16x16x32_bf16 v[44:47], a[236:239], v[108:111], v[44:47]
v_exp_f32 v56, v56
s_waitcnt lgkmcnt(3)
v_mfma_f32_16x16x32_bf16 v[32:35], a[240:243], v[112:115], v[32:35]
ds_read_b128 a[236:239], v5 offset:34816
s_waitcnt vmcnt(4)
buffer_load_dwordx4 v8, s[16:19], s35 offen offset:2048 nt lds
v_mfma_f32_16x16x32_bf16 v[40:43], a[240:243], v[116:119], v[40:43]
v_exp_f32 v57, v57
v_cvt_pk_bf16_f32 v235, v54, v55
L_pg17:
s_cbranch_scc1 L_rt0
v_mfma_f32_16x16x32_bf16 v[36:39], a[244:247], v[112:115], v[36:39]
ds_read_b128 a[240:243], v4 offset:36864
v_exp_f32 v58, v58
v_mfma_f32_16x16x32_bf16 v[44:47], a[244:247], v[116:119], v[44:47]
v_exp_f32 v59, v59
v_cvt_pk_bf16_f32 v236, v56, v57
v_mfma_f32_16x16x32_bf16 v[32:35], a[248:251], v[120:123], v[32:35]
ds_read_b128 a[244:247], v4 offset:38912
v_exp_f32 v60, v60
v_mfma_f32_16x16x32_bf16 v[40:43], a[248:251], v[124:127], v[40:43]
v_exp_f32 v61, v61
v_cvt_pk_bf16_f32 v237, v58, v59
v_mfma_f32_16x16x32_bf16 v[36:39], a[252:255], v[120:123], v[36:39]
ds_read_b128 a[248:251], v5 offset:36864
v_exp_f32 v62, v62
v_mfma_f32_16x16x32_bf16 v[44:47], a[252:255], v[124:127], v[44:47]
v_exp_f32 v63, v63
v_cvt_pk_bf16_f32 v238, v60, v61
v_cvt_pk_bf16_f32 v239, v62, v63
L_step_90:
s_waitcnt lgkmcnt(3)
v_mfma_f32_16x16x32_bf16 v[48:51], a[224:227], v[64:67], 0
v_mfma_f32_16x16x32_bf16 v[56:59], a[224:227], v[68:71], 0
ds_read_b128 a[252:255], v5 offset:38912
v_mfma_f32_16x16x32_bf16 v[52:55], a[228:231], v[64:67], 0
ds_read_b128 a[224:227], v4 offset:40960
v_fma_f32 v32, v32, s6, -v10
v_mfma_f32_16x16x32_bf16 v[60:63], a[228:231], v[68:71], 0
v_fma_f32 v33, v33, s6, -v10
v_fma_f32 v34, v34, s6, -v10
v_fma_f32 v35, v35, s6, -v10
v_mfma_f32_16x16x32_bf16 v[48:51], a[232:235], v[72:75], v[48:51]
ds_read_b128 a[228:231], v4 offset:43008
buffer_load_dwordx4 v8, s[16:19], s35 offen offset:3072 nt lds
v_mfma_f32_16x16x32_bf16 v[56:59], a[232:235], v[76:79], v[56:59]
v_max3_f32 v12, v32, v33, v34
v_fma_f32 v36, v36, s6, -v10
v_mfma_f32_16x16x32_bf16 v[52:55], a[236:239], v[72:75], v[52:55]
ds_read_b128 a[232:235], v5 offset:40960
v_fma_f32 v37, v37, s6, -v10
v_mfma_f32_16x16x32_bf16 v[60:63], a[236:239], v[76:79], v[60:63]
v_fma_f32 v38, v38, s6, -v10
v_max3_f32 v13, v35, v36, v37
s_waitcnt lgkmcnt(3)
v_mfma_f32_16x16x32_bf16 v[48:51], a[240:243], v[80:83], v[48:51]
ds_read_b128 a[236:239], v5 offset:43008
v_fma_f32 v39, v39, s6, -v10
v_mfma_f32_16x16x32_bf16 v[56:59], a[240:243], v[84:87], v[56:59]
v_fma_f32 v40, v40, s6, -v11
v_max3_f32 v12, v12, v38, v39
v_fma_f32 v41, v41, s6, -v11
v_mfma_f32_16x16x32_bf16 v[52:55], a[244:247], v[80:83], v[52:55]
ds_read_b128 a[240:243], v4 offset:45056
s_add_u32 m0, s4, 65536
v_mfma_f32_16x16x32_bf16 v[60:63], a[244:247], v[84:87], v[60:63]
s_mov_b32 s35, 458752
v_fma_f32 v42, v42, s6, -v11
v_max3_f32 v13, v13, v40, v41
v_mfma_f32_16x16x32_bf16 v[48:51], a[248:251], v[88:91], v[48:51]
ds_read_b128 a[244:247], v4 offset:47104
v_fma_f32 v43, v43, s6, -v11
v_mfma_f32_16x16x32_bf16 v[56:59], a[248:251], v[92:95], v[56:59]
v_fma_f32 v44, v44, s6, -v11
v_max3_f32 v12, v12, v42, v43
v_fma_f32 v45, v45, s6, -v11
v_mfma_f32_16x16x32_bf16 v[52:55], a[252:255], v[88:91], v[52:55]
ds_read_b128 a[248:251], v5 offset:45056
v_fma_f32 v46, v46, s6, -v11
v_mfma_f32_16x16x32_bf16 v[60:63], a[252:255], v[92:95], v[60:63]
v_max3_f32 v13, v13, v44, v45
v_fma_f32 v47, v47, s6, -v11
s_waitcnt lgkmcnt(3)
v_mfma_f32_16x16x32_bf16 v[48:51], a[224:227], v[96:99], v[48:51]
ds_read_b128 a[252:255], v5 offset:47104
s_waitcnt vmcnt(3)
v_mfma_f32_16x16x32_bf16 v[56:59], a[224:227], v[100:103], v[56:59]
buffer_load_dwordx4 v8, s[16:19], s35 offen nt lds
v_max3_f32 v12, v12, v46, v47
v_mfma_f32_16x16x32_bf16 v[52:55], a[228:231], v[96:99], v[52:55]
s_barrier
ds_read_b64_tr_b16 a[224:225], v0 offset:32768
v_mfma_f32_16x16x32_bf16 v[60:63], a[228:231], v[100:103], v[60:63]
ds_read_b64_tr_b16 a[226:227], v0 offset:34816
v_max_f32 v12, v12, v13
v_cmp_lt_f32 vcc, 0x41000000, v12
v_mfma_f32_16x16x32_bf16 v[48:51], a[232:235], v[104:107], v[48:51]
ds_read_b64_tr_b16 a[228:229], v1 offset:32768
ds_read_b64_tr_b16 a[230:231], v1 offset:34816
v_mfma_f32_16x16x32_bf16 v[56:59], a[232:235], v[108:111], v[56:59]
s_cbranch_vccnz L_stub_1_14
L_back_1_14:
v_exp_f32 v32, v32
v_mfma_f32_16x16x32_bf16 v[52:55], a[236:239], v[104:107], v[52:55]
ds_read_b64_tr_b16 a[232:233], v2 offset:32768
ds_read_b64_tr_b16 a[234:235], v2 offset:34816
v_mfma_f32_16x16x32_bf16 v[60:63], a[236:239], v[108:111], v[60:63]
v_exp_f32 v33, v33
s_waitcnt lgkmcnt(6)
v_mfma_f32_16x16x32_bf16 v[48:51], a[240:243], v[112:115], v[48:51]
ds_read_b64_tr_b16 a[236:237], v3 offset:32768
ds_read_b64_tr_b16 a[238:239], v3 offset:34816
v_mfma_f32_16x16x32_bf16 v[56:59], a[240:243], v[116:119], v[56:59]
v_exp_f32 v34, v34
v_mfma_f32_16x16x32_bf16 v[52:55], a[244:247], v[112:115], v[52:55]
ds_read_b64_tr_b16 a[240:241], v0 offset:36864
ds_read_b64_tr_b16 a[242:243], v0 offset:38912
v_mfma_f32_16x16x32_bf16 v[60:63], a[244:247], v[116:119], v[60:63]
v_exp_f32 v35, v35
v_cvt_pk_bf16_f32 v240, v32, v33
v_mfma_f32_16x16x32_bf16 v[48:51], a[248:251], v[120:123], v[48:51]
ds_read_b64_tr_b16 a[244:245], v1 offset:36864
ds_read_b64_tr_b16 a[246:247], v1 offset:38912
v_mfma_f32_16x16x32_bf16 v[56:59], a[248:251], v[124:127], v[56:59]
v_exp_f32 v36, v36
v_exp_f32 v37, v37
v_mfma_f32_16x16x32_bf16 v[52:55], a[252:255], v[120:123], v[52:55]
ds_read_b64_tr_b16 a[248:249], v2 offset:36864
ds_read_b64_tr_b16 a[250:251], v2 offset:38912
v_mfma_f32_16x16x32_bf16 v[60:63], a[252:255], v[124:127], v[60:63]
buffer_load_dwordx4 v8, s[16:19], s35 offen offset:1024 nt lds
v_cvt_pk_bf16_f32 v241, v34, v35
L_step_91:
s_waitcnt lgkmcnt(6)
v_mfma_f32_16x16x32_bf16 v[96:99], a[224:227], v[128:131], 0
ds_read_b64_tr_b16 a[252:253], v3 offset:36864
ds_read_b64_tr_b16 a[254:255], v3 offset:38912
v_mfma_f32_16x16x32_bf16 v[104:107], a[224:227], v[132:135], 0
v_exp_f32 v38, v38
v_exp_f32 v39, v39
v_mfma_f32_16x16x32_bf16 v[100:103], a[228:231], v[128:131], 0
ds_read_b64_tr_b16 a[224:225], v0 offset:40960
ds_read_b64_tr_b16 a[226:227], v0 offset:43008
v_mfma_f32_16x16x32_bf16 v[108:111], a[228:231], v[132:135], 0
v_cvt_pk_bf16_f32 v242, v36, v37
v_exp_f32 v40, v40
v_mfma_f32_16x16x32_bf16 v[112:115], a[232:235], v[128:131], 0
ds_read_b64_tr_b16 a[228:229], v1 offset:40960
ds_read_b64_tr_b16 a[230:231], v1 offset:43008
v_mfma_f32_16x16x32_bf16 v[120:123], a[232:235], v[132:135], 0
v_exp_f32 v41, v41
v_cvt_pk_bf16_f32 v243, v38, v39
v_mfma_f32_16x16x32_bf16 v[116:119], a[236:239], v[128:131], 0
ds_read_b64_tr_b16 a[232:233], v2 offset:40960
ds_read_b64_tr_b16 a[234:235], v2 offset:43008
v_mfma_f32_16x16x32_bf16 v[124:127], a[236:239], v[132:135], 0
v_exp_f32 v42, v42
s_waitcnt lgkmcnt(6)
v_mfma_f32_16x16x32_bf16 v[96:99], a[240:243], v[136:139], v[96:99]
ds_read_b64_tr_b16 a[236:237], v3 offset:40960
ds_read_b64_tr_b16 a[238:239], v3 offset:43008
v_exp_f32 v43, v43
v_mfma_f32_16x16x32_bf16 v[104:107], a[240:243], v[140:143], v[104:107]
v_cvt_pk_bf16_f32 v244, v40, v41
v_exp_f32 v44, v44
v_mfma_f32_16x16x32_bf16 v[100:103], a[244:247], v[136:139], v[100:103]
ds_read_b64_tr_b16 a[240:241], v0 offset:45056
ds_read_b64_tr_b16 a[242:243], v0 offset:47104
v_mfma_f32_16x16x32_bf16 v[108:111], a[244:247], v[140:143], v[108:111]
v_exp_f32 v45, v45
v_cvt_pk_bf16_f32 v245, v42, v43
v_mfma_f32_16x16x32_bf16 v[112:115], a[248:251], v[136:139], v[112:115]
ds_read_b64_tr_b16 a[244:245], v1 offset:45056
ds_read_b64_tr_b16 a[246:247], v1 offset:47104
v_exp_f32 v46, v46
v_mfma_f32_16x16x32_bf16 v[120:123], a[248:251], v[140:143], v[120:123]
v_exp_f32 v47, v47
v_cvt_pk_bf16_f32 v246, v44, v45
v_cvt_pk_bf16_f32 v247, v46, v47
v_mfma_f32_16x16x32_bf16 v[116:119], a[252:255], v[136:139], v[116:119]
ds_read_b64_tr_b16 a[248:249], v2 offset:45056
ds_read_b64_tr_b16 a[250:251], v2 offset:47104
v_mfma_f32_16x16x32_bf16 v[124:127], a[252:255], v[140:143], v[124:127]
s_waitcnt vmcnt(3)
v_fma_f32 v48, v48, s6, -v10
s_waitcnt lgkmcnt(6)
v_mfma_f32_16x16x32_bf16 v[96:99], a[224:227], v[144:147], v[96:99]
ds_read_b64_tr_b16 a[252:253], v3 offset:45056
ds_read_b64_tr_b16 a[254:255], v3 offset:47104
v_mfma_f32_16x16x32_bf16 v[104:107], a[224:227], v[148:151], v[104:107]
buffer_load_dwordx4 v8, s[16:19], s35 offen offset:2048 nt lds
v_fma_f32 v49, v49, s6, -v10
v_mfma_f32_16x16x32_bf16 v[100:103], a[228:231], v[144:147], v[100:103]
v_fma_f32 v50, v50, s6, -v10
v_fma_f32 v51, v51, s6, -v10
v_mfma_f32_16x16x32_bf16 v[108:111], a[228:231], v[148:151], v[108:111]
v_max3_f32 v12, v48, v49, v50
v_fma_f32 v52, v52, s6, -v10
v_fma_f32 v53, v53, s6, -v10
v_mfma_f32_16x16x32_bf16 v[112:115], a[232:235], v[144:147], v[112:115]
v_fma_f32 v54, v54, s6, -v10
v_max3_f32 v13, v51, v52, v53
v_mfma_f32_16x16x32_bf16 v[120:123], a[232:235], v[148:151], v[120:123]
v_fma_f32 v55, v55, s6, -v10
v_fma_f32 v56, v56, s6, -v11
v_max3_f32 v12, v12, v54, v55
v_mfma_f32_16x16x32_bf16 v[116:119], a[236:239], v[144:147], v[116:119]
v_fma_f32 v57, v57, s6, -v11
v_fma_f32 v58, v58, s6, -v11
v_mfma_f32_16x16x32_bf16 v[124:127], a[236:239], v[148:151], v[124:127]
v_max3_f32 v13, v13, v56, v57
v_fma_f32 v59, v59, s6, -v11
s_waitcnt lgkmcnt(0)
v_mfma_f32_16x16x32_bf16 v[96:99], a[240:243], v[152:155], v[96:99]
v_fma_f32 v60, v60, s6, -v11
v_max3_f32 v12, v12, v58, v59
v_mfma_f32_16x16x32_bf16 v[104:107], a[240:243], v[156:159], v[104:107]
v_fma_f32 v61, v61, s6, -v11
v_fma_f32 v62, v62, s6, -v11
v_max3_f32 v13, v13, v60, v61
v_mfma_f32_16x16x32_bf16 v[100:103], a[244:247], v[152:155], v[100:103]
v_fma_f32 v63, v63, s6, -v11
v_max3_f32 v12, v12, v62, v63
v_mfma_f32_16x16x32_bf16 v[108:111], a[244:247], v[156:159], v[108:111]
v_max_f32 v12, v12, v13
v_cmp_lt_f32 vcc, 0x41000000, v12
v_mfma_f32_16x16x32_bf16 v[112:115], a[248:251], v[152:155], v[112:115]
s_cbranch_vccnz L_stub_1_15
L_back_1_15:
v_mov_b32 v10, 0x3f803f80
v_mfma_f32_16x16x32_bf16 v[120:123], a[248:251], v[156:159], v[120:123]
v_mov_b32 v11, 0x3f803f80
v_mov_b32 v12, 0x3f803f80
v_mov_b32 v13, 0x3f803f80
v_mfma_f32_16x16x32_bf16 v[116:119], a[252:255], v[152:155], v[116:119]
buffer_load_dwordx4 v8, s[16:19], s35 offen offset:3072 nt lds
v_mfma_f32_16x16x32_bf16 v[124:127], a[252:255], v[156:159], v[124:127]
v_exp_f32 v48, v48
v_mfma_f32_16x16x32_bf16 v[80:83], v[10:13], v[128:131], 0
v_exp_f32 v49, v49
v_mfma_f32_16x16x32_bf16 v[88:91], v[10:13], v[132:135], 0
v_exp_f32 v50, v50
v_mfma_f32_16x16x32_bf16 v[80:83], v[10:13], v[136:139], v[80:83]
s_add_u32 m0, s4, 81920
s_mov_b32 s35, 262272
v_mfma_f32_16x16x32_bf16 v[88:91], v[10:13], v[140:143], v[88:91]
v_exp_f32 v51, v51
v_mfma_f32_16x16x32_bf16 v[80:83], v[10:13], v[144:147], v[80:83]
v_cvt_pk_bf16_f32 v248, v48, v49
v_mfma_f32_16x16x32_bf16 v[88:91], v[10:13], v[148:151], v[88:91]
v_exp_f32 v52, v52
v_mfma_f32_16x16x32_bf16 v[80:83], v[10:13], v[152:155], v[80:83]
v_exp_f32 v53, v53
v_mfma_f32_16x16x32_bf16 v[88:91], v[10:13], v[156:159], v[88:91]
v_cvt_pk_bf16_f32 v249, v50, v51
v_mfma_f32_16x16x32_bf16 v[80:83], v[10:13], v[160:163], v[80:83]
s_waitcnt vmcnt(3)
v_mfma_f32_16x16x32_bf16 v[88:91], v[10:13], v[164:167], v[88:91]
buffer_load_dwordx4 v8, s[16:19], s35 offen nt lds
v_mfma_f32_16x16x32_bf16 v[80:83], v[10:13], v[168:171], v[80:83]
v_exp_f32 v54, v54
v_mfma_f32_16x16x32_bf16 v[88:91], v[10:13], v[172:175], v[88:91]
v_exp_f32 v55, v55
v_mfma_f32_16x16x32_bf16 v[80:83], v[10:13], v[176:179], v[80:83]
s_add_u32 m0, s4, 114688
v_mfma_f32_16x16x32_bf16 v[88:91], v[10:13], v[180:183], v[88:91]
s_mov_b32 s5, 229376
v_cvt_pk_bf16_f32 v250, v52, v53
v_mfma_f32_16x16x32_bf16 v[80:83], v[10:13], v[184:187], v[80:83]
v_exp_f32 v56, v56
v_mfma_f32_16x16x32_bf16 v[88:91], v[10:13], v[188:191], v[88:91]
v_exp_f32 v57, v57
v_mfma_f32_16x16x32_bf16 v[80:83], v[10:13], v[192:195], v[80:83]
s_barrier
ds_read_b64_tr_b16 a[252:253], v0 offset:16384
v_mfma_f32_16x16x32_bf16 v[88:91], v[10:13], v[196:199], v[88:91]
ds_read_b64_tr_b16 a[254:255], v0 offset:18432
v_cvt_pk_bf16_f32 v251, v54, v55
v_mfma_f32_16x16x32_bf16 v[80:83], v[10:13], v[200:203], v[80:83]
ds_read_b64_tr_b16 a[224:225], v1 offset:16384
ds_read_b64_tr_b16 a[226:227], v1 offset:18432
v_mfma_f32_16x16x32_bf16 v[88:91], v[10:13], v[204:207], v[88:91]
buffer_load_dwordx4 v9, s[24:27], s5 offen lds
v_mfma_f32_16x16x32_bf16 v[80:83], v[10:13], v[208:211], v[80:83]
ds_read_b64_tr_b16 a[228:229], v2 offset:16384
v_mfma_f32_16x16x32_bf16 v[88:91], v[10:13], v[212:215], v[88:91]
ds_read_b64_tr_b16 a[230:231], v2 offset:18432
s_mov_b32 s5, 235520
v_mfma_f32_16x16x32_bf16 v[80:83], v[10:13], v[216:219], v[80:83]
ds_read_b64_tr_b16 a[232:233], v3 offset:16384
ds_read_b64_tr_b16 a[234:235], v3 offset:18432
v_mfma_f32_16x16x32_bf16 v[88:91], v[10:13], v[220:223], v[88:91]
buffer_load_dwordx4 v9, s[24:27], s5 offen offset:1024 lds
v_mfma_f32_16x16x32_bf16 v[80:83], v[10:13], v[224:227], v[80:83]
ds_read_b64_tr_b16 a[236:237], v0 offset:20480
v_mfma_f32_16x16x32_bf16 v[88:91], v[10:13], v[228:231], v[88:91]
ds_read_b64_tr_b16 a[238:239], v0 offset:22528
s_add_u32 m0, s4, 81920
v_mfma_f32_16x16x32_bf16 v[80:83], v[10:13], v[232:235], v[80:83]
ds_read_b64_tr_b16 a[240:241], v1 offset:20480
ds_read_b64_tr_b16 a[242:243], v1 offset:22528
v_mfma_f32_16x16x32_bf16 v[88:91], v[10:13], v[236:239], v[88:91]
buffer_load_dwordx4 v8, s[16:19], s35 offen offset:1024 nt lds
s_add_u32 m0, s4, 114688
s_mov_b32 s5, 241664
v_mfma_f32_16x16x32_bf16 v[80:83], v[10:13], v[240:243], v[80:83]
ds_read_b64_tr_b16 a[244:245], v2 offset:20480
ds_read_b64_tr_b16 a[246:247], v2 offset:22528
v_mfma_f32_16x16x32_bf16 v[88:91], v[10:13], v[244:247], v[88:91]
buffer_load_dwordx4 v9, s[24:27], s5 offen offset:2048 lds
L_step_92:
s_waitcnt lgkmcnt(12)
v_mfma_f32_16x16x32_bf16 a[192:195], a[252:255], v[16:19], a[192:195]
ds_read_b64_tr_b16 a[248:249], v3 offset:20480
ds_read_b64_tr_b16 a[250:251], v3 offset:22528
s_mov_b32 s5, 247808
v_mfma_f32_16x16x32_bf16 a[200:203], a[252:255], v[20:23], a[200:203]
buffer_load_dwordx4 v9, s[24:27], s5 offen offset:3072 lds
s_waitcnt lgkmcnt(6)
v_mfma_f32_16x16x32_bf16 a[196:199], a[224:227], v[16:19], a[196:199]
s_barrier
ds_read_b64_tr_b16 a[252:253], v0 offset:49152
v_mfma_f32_16x16x32_bf16 a[204:207], a[224:227], v[20:23], a[204:207]
ds_read_b64_tr_b16 a[254:255], v0 offset:51200
s_add_u32 m0, s4, 81920
v_mfma_f32_16x16x32_bf16 a[208:211], a[228:231], v[16:19], a[208:211]
ds_read_b64_tr_b16 a[224:225], v1 offset:49152
v_mfma_f32_16x16x32_bf16 a[216:219], a[228:231], v[20:23], a[216:219]
ds_read_b64_tr_b16 a[226:227], v1 offset:51200
s_waitcnt vmcnt(7)
v_mfma_f32_16x16x32_bf16 a[212:215], a[232:235], v[16:19], a[212:215]
ds_read_b64_tr_b16 a[228:229], v2 offset:49152
ds_read_b64_tr_b16 a[230:231], v2 offset:51200
v_mfma_f32_16x16x32_bf16 a[220:223], a[232:235], v[20:23], a[220:223]
buffer_load_dwordx4 v8, s[16:19], s35 offen offset:2048 nt lds
v_mfma_f32_16x16x32_bf16 a[192:195], a[236:239], v[24:27], a[192:195]
ds_read_b64_tr_b16 a[232:233], v3 offset:49152
v_mfma_f32_16x16x32_bf16 a[200:203], a[236:239], v[28:31], a[200:203]
ds_read_b64_tr_b16 a[234:235], v3 offset:51200
s_waitcnt lgkmcnt(6)
v_mfma_f32_16x16x32_bf16 a[196:199], a[240:243], v[24:27], a[196:199]
ds_read_b64_tr_b16 a[236:237], v0 offset:53248
ds_read_b64_tr_b16 a[238:239], v0 offset:55296
v_mfma_f32_16x16x32_bf16 a[204:207], a[240:243], v[28:31], a[204:207]
v_exp_f32 v58, v58
v_mfma_f32_16x16x32_bf16 a[208:211], a[244:247], v[24:27], a[208:211]
ds_read_b64_tr_b16 a[240:241], v1 offset:53248
ds_read_b64_tr_b16 a[242:243], v1 offset:55296
v_mfma_f32_16x16x32_bf16 a[216:219], a[244:247], v[28:31], a[216:219]
v_exp_f32 v59, v59
v_mfma_f32_16x16x32_bf16 a[212:215], a[248:251], v[24:27], a[212:215]
ds_read_b64_tr_b16 a[244:245], v2 offset:53248
v_mfma_f32_16x16x32_bf16 a[220:223], a[248:251], v[28:31], a[220:223]
ds_read_b64_tr_b16 a[246:247], v2 offset:55296
v_cvt_pk_bf16_f32 v252, v56, v57
L_step_93:
v_mfma_f32_16x16x32_bf16 v[96:99], a[252:255], v[160:163], v[96:99]
ds_read_b64_tr_b16 a[248:249], v3 offset:53248
v_mfma_f32_16x16x32_bf16 v[104:107], a[252:255], v[164:167], v[104:107]
ds_read_b64_tr_b16 a[250:251], v3 offset:55296
s_waitcnt lgkmcnt(6)
v_mfma_f32_16x16x32_bf16 v[100:103], a[224:227], v[160:163], v[100:103]
ds_read_b64_tr_b16 a[252:253], v0 offset:57344
ds_read_b64_tr_b16 a[254:255], v0 offset:59392
v_mfma_f32_16x16x32_bf16 v[108:111], a[224:227], v[164:167], v[108:111]
buffer_load_dwordx4 v8, s[16:19], s35 offen offset:3072 nt lds
v_mfma_f32_16x16x32_bf16 v[112:115], a[228:231], v[160:163], v[112:115]
ds_read_b64_tr_b16 a[224:225], v1 offset:57344
ds_read_b64_tr_b16 a[226:227], v1 offset:59392
v_mfma_f32_16x16x32_bf16 v[120:123], a[228:231], v[164:167], v[120:123]
v_exp_f32 v60, v60
v_mfma_f32_16x16x32_bf16 v[116:119], a[232:235], v[160:163], v[116:119]
ds_read_b64_tr_b16 a[228:229], v2 offset:57344
ds_read_b64_tr_b16 a[230:231], v2 offset:59392
v_mfma_f32_16x16x32_bf16 v[124:127], a[232:235], v[164:167], v[124:127]
v_exp_f32 v61, v61
v_mfma_f32_16x16x32_bf16 v[96:99], a[236:239], v[168:171], v[96:99]
ds_read_b64_tr_b16 a[232:233], v3 offset:57344
ds_read_b64_tr_b16 a[234:235], v3 offset:59392
v_mfma_f32_16x16x32_bf16 v[104:107], a[236:239], v[172:175], v[104:107]
v_cvt_pk_bf16_f32 v253, v58, v59
s_waitcnt lgkmcnt(6)
v_mfma_f32_16x16x32_bf16 v[100:103], a[240:243], v[168:171], v[100:103]
ds_read_b64_tr_b16 a[236:237], v0 offset:61440
ds_read_b64_tr_b16 a[238:239], v0 offset:63488
v_mfma_f32_16x16x32_bf16 v[108:111], a[240:243], v[172:175], v[108:111]
v_add_u32 v0, 0x10000, v0
s_add_u32 m0, s4, 0
v_mfma_f32_16x16x32_bf16 v[112:115], a[244:247], v[168:171], v[112:115]
ds_read_b64_tr_b16 a[240:241], v1 offset:61440
ds_read_b64_tr_b16 a[242:243], v1 offset:63488
v_mfma_f32_16x16x32_bf16 v[120:123], a[244:247], v[172:175], v[120:123]
v_add_u32 v1, 0x10000, v1
s_mov_b32 s35, 327808
v_mfma_f32_16x16x32_bf16 v[116:119], a[248:251], v[168:171], v[116:119]
ds_read_b64_tr_b16 a[244:245], v2 offset:61440
v_mfma_f32_16x16x32_bf16 v[124:127], a[248:251], v[172:175], v[124:127]
ds_read_b64_tr_b16 a[246:247], v2 offset:63488
v_add_u32 v2, 0x10000, v2
v_mfma_f32_16x16x32_bf16 v[96:99], a[252:255], v[176:179], v[96:99]
ds_read_b64_tr_b16 a[248:249], v3 offset:61440
ds_read_b64_tr_b16 a[250:251], v3 offset:63488
v_mfma_f32_16x16x32_bf16 v[104:107], a[252:255], v[180:183], v[104:107]
v_add_u32 v3, 0x10000, v3
s_waitcnt lgkmcnt(6)
v_mfma_f32_16x16x32_bf16 v[100:103], a[224:227], v[176:179], v[100:103]
s_barrier
ds_read_b64_tr_b16 a[252:253], v0 offset:32768
v_mfma_f32_16x16x32_bf16 v[108:111], a[224:227], v[180:183], v[108:111]
ds_read_b64_tr_b16 a[254:255], v0 offset:34816
s_waitcnt vmcnt(7)
v_mfma_f32_16x16x32_bf16 v[112:115], a[228:231], v[176:179], v[112:115]
ds_read_b64_tr_b16 a[224:225], v1 offset:32768
ds_read_b64_tr_b16 a[226:227], v1 offset:34816
v_mfma_f32_16x16x32_bf16 v[120:123], a[228:231], v[180:183], v[120:123]
buffer_load_dwordx4 v8, s[16:19], s35 offen nt lds
v_mfma_f32_16x16x32_bf16 v[116:119], a[232:235], v[176:179], v[116:119]
ds_read_b64_tr_b16 a[228:229], v2 offset:32768
ds_read_b64_tr_b16 a[230:231], v2 offset:34816
v_mfma_f32_16x16x32_bf16 v[124:127], a[232:235], v[180:183], v[124:127]
s_add_u32 m0, s4, 16384
s_mov_b32 s5, 229632
v_mfma_f32_16x16x32_bf16 v[96:99], a[236:239], v[184:187], v[96:99]
ds_read_b64_tr_b16 a[232:233], v3 offset:32768
v_mfma_f32_16x16x32_bf16 v[104:107], a[236:239], v[188:191], v[104:107]
ds_read_b64_tr_b16 a[234:235], v3 offset:34816
s_waitcnt lgkmcnt(6)
v_mfma_f32_16x16x32_bf16 v[100:103], a[240:243], v[184:187], v[100:103]
ds_read_b64_tr_b16 a[236:237], v0 offset:36864
ds_read_b64_tr_b16 a[238:239], v0 offset:38912
v_mfma_f32_16x16x32_bf16 v[108:111], a[240:243], v[188:191], v[108:111]
buffer_load_dwordx4 v9, s[24:27], s5 offen lds
s_mov_b32 s5, 235776
v_mfma_f32_16x16x32_bf16 v[112:115], a[244:247], v[184:187], v[112:115]
ds_read_b64_tr_b16 a[240:241], v1 offset:36864
ds_read_b64_tr_b16 a[242:243], v1 offset:38912
v_mfma_f32_16x16x32_bf16 v[120:123], a[244:247], v[188:191], v[120:123]
v_exp_f32 v62, v62
v_mfma_f32_16x16x32_bf16 v[116:119], a[248:251], v[184:187], v[116:119]
ds_read_b64_tr_b16 a[244:245], v2 offset:36864
ds_read_b64_tr_b16 a[246:247], v2 offset:38912
v_mfma_f32_16x16x32_bf16 v[124:127], a[248:251], v[188:191], v[124:127]
v_exp_f32 v63, v63
v_cvt_pk_bf16_f32 v254, v60, v61
v_cvt_pk_bf16_f32 v255, v62, v63
L_step_94:
v_mfma_f32_16x16x32_bf16 v[96:99], a[252:255], v[192:195], v[96:99]
ds_read_b64_tr_b16 a[248:249], v3 offset:36864
ds_read_b64_tr_b16 a[250:251], v3 offset:38912
v_mfma_f32_16x16x32_bf16 v[104:107], a[252:255], v[196:199], v[104:107]
buffer_load_dwordx4 v9, s[24:27], s5 offen offset:1024 lds
s_waitcnt lgkmcnt(6)
v_mfma_f32_16x16x32_bf16 v[100:103], a[224:227], v[192:195], v[100:103]
ds_read_b64_tr_b16 a[252:253], v0 offset:40960
v_mfma_f32_16x16x32_bf16 v[108:111], a[224:227], v[196:199], v[108:111]
ds_read_b64_tr_b16 a[254:255], v0 offset:43008
s_add_u32 m0, s4, 0
v_mfma_f32_16x16x32_bf16 v[112:115], a[228:231], v[192:195], v[112:115]
ds_read_b64_tr_b16 a[224:225], v1 offset:40960
ds_read_b64_tr_b16 a[226:227], v1 offset:43008
v_mfma_f32_16x16x32_bf16 v[120:123], a[228:231], v[196:199], v[120:123]
buffer_load_dwordx4 v8, s[16:19], s35 offen offset:1024 nt lds
v_mfma_f32_16x16x32_bf16 v[116:119], a[232:235], v[192:195], v[116:119]
ds_read_b64_tr_b16 a[228:229], v2 offset:40960
ds_read_b64_tr_b16 a[230:231], v2 offset:43008
v_mfma_f32_16x16x32_bf16 v[124:127], a[232:235], v[196:199], v[124:127]
s_add_u32 m0, s4, 16384
s_mov_b32 s5, 241920
v_mfma_f32_16x16x32_bf16 v[96:99], a[236:239], v[200:203], v[96:99]
ds_read_b64_tr_b16 a[232:233], v3 offset:40960
ds_read_b64_tr_b16 a[234:235], v3 offset:43008
v_mfma_f32_16x16x32_bf16 v[104:107], a[236:239], v[204:207], v[104:107]
buffer_load_dwordx4 v9, s[24:27], s5 offen offset:2048 lds
s_waitcnt lgkmcnt(6)
v_mfma_f32_16x16x32_bf16 v[100:103], a[240:243], v[200:203], v[100:103]
ds_read_b64_tr_b16 a[236:237], v0 offset:45056
v_mfma_f32_16x16x32_bf16 v[108:111], a[240:243], v[204:207], v[108:111]
ds_read_b64_tr_b16 a[238:239], v0 offset:47104
s_mov_b32 s5, 248064
v_mfma_f32_16x16x32_bf16 v[112:115], a[244:247], v[200:203], v[112:115]
ds_read_b64_tr_b16 a[240:241], v1 offset:45056
ds_read_b64_tr_b16 a[242:243], v1 offset:47104
v_mfma_f32_16x16x32_bf16 v[120:123], a[244:247], v[204:207], v[120:123]
buffer_load_dwordx4 v9, s[24:27], s5 offen offset:3072 lds
v_mfma_f32_16x16x32_bf16 v[116:119], a[248:251], v[200:203], v[116:119]
ds_read_b64_tr_b16 a[244:245], v2 offset:45056
ds_read_b64_tr_b16 a[246:247], v2 offset:47104
v_mfma_f32_16x16x32_bf16 v[124:127], a[248:251], v[204:207], v[124:127]
s_add_u32 m0, s4, 0
s_waitcnt vmcnt(7)
v_mfma_f32_16x16x32_bf16 v[96:99], a[252:255], v[208:211], v[96:99]
ds_read_b64_tr_b16 a[248:249], v3 offset:45056
v_mfma_f32_16x16x32_bf16 v[104:107], a[252:255], v[212:215], v[104:107]
ds_read_b64_tr_b16 a[250:251], v3 offset:47104
s_waitcnt lgkmcnt(6)
v_mfma_f32_16x16x32_bf16 v[100:103], a[224:227], v[208:211], v[100:103]
v_mfma_f32_16x16x32_bf16 v[108:111], a[224:227], v[212:215], v[108:111]
buffer_load_dwordx4 v8, s[16:19], s35 offen offset:2048 nt lds
v_mfma_f32_16x16x32_bf16 v[112:115], a[228:231], v[208:211], v[112:115]
s_barrier
s_load_dword s93, s[64:65], 0
v_mfma_f32_16x16x32_bf16 v[120:123], a[228:231], v[212:215], v[120:123]
ds_read_b64_tr_b16 a[224:225], v0 offset:0
ds_read_b64_tr_b16 a[226:227], v0 offset:2048
v_mfma_f32_16x16x32_bf16 v[116:119], a[232:235], v[208:211], v[116:119]
ds_read_b64_tr_b16 a[228:229], v1 offset:0
v_mfma_f32_16x16x32_bf16 v[124:127], a[232:235], v[212:215], v[124:127]
ds_read_b64_tr_b16 a[230:231], v1 offset:2048
v_mfma_f32_16x16x32_bf16 v[96:99], a[236:239], v[216:219], v[96:99]
ds_read_b64_tr_b16 a[232:233], v0 offset:4096
v_mfma_f32_16x16x32_bf16 v[104:107], a[236:239], v[220:223], v[104:107]
ds_read_b64_tr_b16 a[234:235], v0 offset:6144
s_waitcnt lgkmcnt(6)
v_mfma_f32_16x16x32_bf16 v[100:103], a[240:243], v[216:219], v[100:103]
ds_read_b64_tr_b16 a[236:237], v1 offset:4096
v_mfma_f32_16x16x32_bf16 v[108:111], a[240:243], v[220:223], v[108:111]
ds_read_b64_tr_b16 a[238:239], v1 offset:6144
v_mfma_f32_16x16x32_bf16 v[112:115], a[244:247], v[216:219], v[112:115]
ds_read_b64_tr_b16 a[240:241], v0 offset:8192
ds_read_b64_tr_b16 a[242:243], v0 offset:10240
v_mfma_f32_16x16x32_bf16 v[120:123], a[244:247], v[220:223], v[120:123]
buffer_load_dwordx4 v8, s[16:19], s35 offen offset:3072 nt lds
v_mfma_f32_16x16x32_bf16 v[116:119], a[248:251], v[216:219], v[116:119]
ds_read_b64_tr_b16 a[244:245], v1 offset:8192
v_mfma_f32_16x16x32_bf16 v[124:127], a[248:251], v[220:223], v[124:127]
ds_read_b64_tr_b16 a[246:247], v1 offset:10240
v_mfma_f32_16x16x32_bf16 v[80:83], v[10:13], v[248:251], v[80:83]
ds_read_b64_tr_b16 a[248:249], v0 offset:12288
v_mfma_f32_16x16x32_bf16 v[88:91], v[10:13], v[252:255], v[88:91]
ds_read_b64_tr_b16 a[250:251], v0 offset:14336
L_step_95:
s_waitcnt lgkmcnt(6)
v_mfma_f32_16x16x32_bf16 v[96:99], a[224:227], v[224:227], v[96:99]
ds_read_b64_tr_b16 a[252:253], v1 offset:12288
v_mfma_f32_16x16x32_bf16 v[104:107], a[224:227], v[228:231], v[104:107]
ds_read_b64_tr_b16 a[254:255], v1 offset:14336
v_mfma_f32_16x16x32_bf16 v[100:103], a[228:231], v[224:227], v[100:103]
ds_read_b64_tr_b16 a[224:225], v2 offset:0
ds_read_b64_tr_b16 a[226:227], v2 offset:2048
v_mfma_f32_16x16x32_bf16 v[108:111], a[228:231], v[228:231], v[108:111]
v_rcp_f32 v14, v80
v_mfma_f32_16x16x32_bf16 v[96:99], a[232:235], v[232:235], v[96:99]
ds_read_b64_tr_b16 a[228:229], v3 offset:0
ds_read_b64_tr_b16 a[230:231], v3 offset:2048
v_mfma_f32_16x16x32_bf16 v[104:107], a[232:235], v[236:239], v[104:107]
v_rcp_f32 v15, v88
v_mfma_f32_16x16x32_bf16 v[100:103], a[236:239], v[232:235], v[100:103]
ds_read_b64_tr_b16 a[232:233], v2 offset:4096
ds_read_b64_tr_b16 a[234:235], v2 offset:6144
v_mfma_f32_16x16x32_bf16 v[108:111], a[236:239], v[236:239], v[108:111]
s_add_u32 m0, s4, 49152
s_waitcnt lgkmcnt(6)
v_mfma_f32_16x16x32_bf16 v[96:99], a[240:243], v[240:243], v[96:99]
ds_read_b64_tr_b16 a[236:237], v3 offset:4096
ds_read_b64_tr_b16 a[238:239], v3 offset:6144
v_mfma_f32_16x16x32_bf16 v[104:107], a[240:243], v[244:247], v[104:107]
s_mov_b32 s35, 393344
s_waitcnt vmcnt(7)
v_mfma_f32_16x16x32_bf16 v[100:103], a[244:247], v[240:243], v[100:103]
ds_read_b64_tr_b16 a[240:241], v2 offset:8192
ds_read_b64_tr_b16 a[242:243], v2 offset:10240
v_mfma_f32_16x16x32_bf16 v[108:111], a[244:247], v[244:247], v[108:111]
buffer_load_dwordx4 v8, s[16:19], s35 offen nt lds
v_mfma_f32_16x16x32_bf16 v[96:99], a[248:251], v[248:251], v[96:99]
ds_read_b64_tr_b16 a[244:245], v3 offset:8192
v_mfma_f32_16x16x32_bf16 v[104:107], a[248:251], v[252:255], v[104:107]
ds_read_b64_tr_b16 a[246:247], v3 offset:10240
v_mfma_f32_16x16x32_bf16 v[100:103], a[252:255], v[248:251], v[100:103]
ds_read_b64_tr_b16 a[248:249], v2 offset:12288
ds_read_b64_tr_b16 a[250:251], v2 offset:14336
L_pg18:
s_cbranch_scc1 L_rt0
v_mfma_f32_16x16x32_bf16 v[108:111], a[252:255], v[252:255], v[108:111]
s_add_u32 m0, s4, 32768
s_waitcnt lgkmcnt(6)
v_mfma_f32_16x16x32_bf16 v[112:115], a[224:227], v[224:227], v[112:115]
ds_read_b64_tr_b16 a[252:253], v3 offset:12288
v_mfma_f32_16x16x32_bf16 v[120:123], a[224:227], v[228:231], v[120:123]
ds_read_b64_tr_b16 a[254:255], v3 offset:14336
s_mov_b32 s5, 229888
v_mfma_f32_16x16x32_bf16 v[116:119], a[228:231], v[224:227], v[116:119]
s_barrier
ds_read_b64_tr_b16 a[224:225], v0 offset:49152
ds_read_b64_tr_b16 a[226:227], v0 offset:51200
v_mfma_f32_16x16x32_bf16 v[124:127], a[228:231], v[228:231], v[124:127]
v_mul_f32 v96, v96, v14
v_mul_f32 v97, v97, v14
v_mul_f32 v98, v98, v14
v_mfma_f32_16x16x32_bf16 v[112:115], a[232:235], v[232:235], v[112:115]
ds_read_b64_tr_b16 a[228:229], v1 offset:49152
ds_read_b64_tr_b16 a[230:231], v1 offset:51200
v_mfma_f32_16x16x32_bf16 v[120:123], a[232:235], v[236:239], v[120:123]
buffer_load_dwordx4 v9, s[24:27], s5 offen lds
s_add_u32 m0, s4, 49152
v_mul_f32 v99, v99, v14
v_mfma_f32_16x16x32_bf16 v[116:119], a[236:239], v[232:235], v[116:119]
ds_read_b64_tr_b16 a[232:233], v2 offset:49152
ds_read_b64_tr_b16 a[234:235], v2 offset:51200
buffer_load_dwordx4 v8, s[16:19], s35 offen offset:1024 nt lds
v_mfma_f32_16x16x32_bf16 v[124:127], a[236:239], v[236:239], v[124:127]
v_cvt_pk_bf16_f32 v64, v96, v97
v_mul_f32 v100, v100, v14
s_waitcnt lgkmcnt(6)
v_mfma_f32_16x16x32_bf16 v[112:115], a[240:243], v[240:243], v[112:115]
ds_read_b64_tr_b16 a[236:237], v3 offset:49152
ds_read_b64_tr_b16 a[238:239], v3 offset:51200
v_mul_f32 v101, v101, v14
v_mfma_f32_16x16x32_bf16 v[120:123], a[240:243], v[244:247], v[120:123]
v_cvt_pk_bf16_f32 v65, v98, v99
v_mul_f32 v102, v102, v14
v_mul_f32 v103, v103, v14
v_cvt_pk_bf16_f32 v66, v100, v101
v_mfma_f32_16x16x32_bf16 v[116:119], a[244:247], v[240:243], v[116:119]
ds_read_b64_tr_b16 a[240:241], v0 offset:57344
ds_read_b64_tr_b16 a[242:243], v0 offset:59392
v_cvt_pk_bf16_f32 v67, v102, v103
v_mfma_f32_16x16x32_bf16 v[124:127], a[244:247], v[244:247], v[124:127]
v_mul_f32 v104, v104, v15
v_mul_f32 v105, v105, v15
v_mul_f32 v106, v106, v15
v_mul_f32 v107, v107, v15
v_mfma_f32_16x16x32_bf16 v[112:115], a[248:251], v[248:251], v[112:115]
ds_read_b64_tr_b16 a[244:245], v1 offset:57344
ds_read_b64_tr_b16 a[246:247], v1 offset:59392
v_cvt_pk_bf16_f32 v68, v104, v105
v_mfma_f32_16x16x32_bf16 v[120:123], a[248:251], v[252:255], v[120:123]
v_mul_f32 v108, v108, v15
v_mul_f32 v109, v109, v15
v_cvt_pk_bf16_f32 v69, v106, v107
v_mfma_f32_16x16x32_bf16 v[116:119], a[252:255], v[248:251], v[116:119]
ds_read_b64_tr_b16 a[248:249], v2 offset:57344
ds_read_b64_tr_b16 a[250:251], v2 offset:59392
v_mul_f32 v110, v110, v15
v_mfma_f32_16x16x32_bf16 v[124:127], a[252:255], v[252:255], v[124:127]
v_mul_f32 v111, v111, v15
v_cvt_pk_bf16_f32 v70, v108, v109
v_cvt_pk_bf16_f32 v71, v110, v111
L_step_96:
s_waitcnt lgkmcnt(6)
v_mfma_f32_16x16x32_bf16 a[0:3], a[224:227], v[64:67], a[0:3]
ds_read_b64_tr_b16 a[252:253], v3 offset:57344
ds_read_b64_tr_b16 a[254:255], v3 offset:59392
s_add_u32 m0, s4, 32768
v_mfma_f32_16x16x32_bf16 a[8:11], a[224:227], v[68:71], a[8:11]
s_mov_b32 s5, 236032
buffer_load_dwordx4 v9, s[24:27], s5 offen offset:1024 lds
v_mfma_f32_16x16x32_bf16 a[4:7], a[228:231], v[64:67], a[4:7]
ds_read_b64_tr_b16 a[224:225], v0 offset:53248
ds_read_b64_tr_b16 a[226:227], v0 offset:55296
s_mov_b32 s5, 242176
v_mfma_f32_16x16x32_bf16 a[12:15], a[228:231], v[68:71], a[12:15]
buffer_load_dwordx4 v9, s[24:27], s5 offen offset:2048 lds
s_add_u32 m0, s4, 49152
v_mfma_f32_16x16x32_bf16 a[16:19], a[232:235], v[64:67], a[16:19]
ds_read_b64_tr_b16 a[228:229], v1 offset:53248
ds_read_b64_tr_b16 a[230:231], v1 offset:55296
s_waitcnt vmcnt(6)
v_mfma_f32_16x16x32_bf16 a[24:27], a[232:235], v[68:71], a[24:27]
buffer_load_dwordx4 v8, s[16:19], s35 offen offset:2048 nt lds
s_add_u32 m0, s4, 32768
s_mov_b32 s5, 248320
v_mfma_f32_16x16x32_bf16 a[20:23], a[236:239], v[64:67], a[20:23]
ds_read_b64_tr_b16 a[232:233], v2 offset:53248
ds_read_b64_tr_b16 a[234:235], v2 offset:55296
v_mul_f32 v112, v112, v14
v_mfma_f32_16x16x32_bf16 a[28:31], a[236:239], v[68:71], a[28:31]
v_mul_f32 v113, v113, v14
v_mul_f32 v114, v114, v14
v_mul_f32 v115, v115, v14
s_waitcnt lgkmcnt(6)
v_mfma_f32_16x16x32_bf16 a[32:35], a[240:243], v[64:67], a[32:35]
ds_read_b64_tr_b16 a[236:237], v3 offset:53248
ds_read_b64_tr_b16 a[238:239], v3 offset:55296
buffer_load_dwordx4 v9, s[24:27], s5 offen offset:3072 lds
v_mfma_f32_16x16x32_bf16 a[40:43], a[240:243], v[68:71], a[40:43]
v_cvt_pk_bf16_f32 v72, v112, v113
v_mul_f32 v116, v116, v14
v_mul_f32 v117, v117, v14
v_cvt_pk_bf16_f32 v73, v114, v115
v_mfma_f32_16x16x32_bf16 a[36:39], a[244:247], v[64:67], a[36:39]
ds_read_b64_tr_b16 a[240:241], v0 offset:61440
ds_read_b64_tr_b16 a[242:243], v0 offset:63488
v_mul_f32 v118, v118, v14
v_mul_f32 v119, v119, v14
v_mfma_f32_16x16x32_bf16 a[44:47], a[244:247], v[68:71], a[44:47]
v_cvt_pk_bf16_f32 v74, v116, v117
v_cvt_pk_bf16_f32 v75, v118, v119
v_mul_f32 v120, v120, v15
v_mul_f32 v121, v121, v15
v_mfma_f32_16x16x32_bf16 a[48:51], a[248:251], v[64:67], a[48:51]
ds_read_b64_tr_b16 a[244:245], v1 offset:61440
ds_read_b64_tr_b16 a[246:247], v1 offset:63488
v_mul_f32 v122, v122, v15
v_mfma_f32_16x16x32_bf16 a[56:59], a[248:251], v[68:71], a[56:59]
v_mul_f32 v123, v123, v15
v_cvt_pk_bf16_f32 v76, v120, v121
v_mul_f32 v124, v124, v15
v_mul_f32 v125, v125, v15
v_mfma_f32_16x16x32_bf16 a[52:55], a[252:255], v[64:67], a[52:55]
ds_read_b64_tr_b16 a[248:249], v2 offset:61440
ds_read_b64_tr_b16 a[250:251], v2 offset:63488
v_cvt_pk_bf16_f32 v77, v122, v123
v_mul_f32 v126, v126, v15
v_mfma_f32_16x16x32_bf16 a[60:63], a[252:255], v[68:71], a[60:63]
v_mul_f32 v127, v127, v15
v_cvt_pk_bf16_f32 v78, v124, v125
v_cvt_pk_bf16_f32 v79, v126, v127
s_waitcnt lgkmcnt(6)
v_mfma_f32_16x16x32_bf16 a[0:3], a[224:227], v[72:75], a[0:3]
ds_read_b64_tr_b16 a[252:253], v3 offset:61440
v_mfma_f32_16x16x32_bf16 a[8:11], a[224:227], v[76:79], a[8:11]
ds_read_b64_tr_b16 a[254:255], v3 offset:63488
s_add_u32 m0, s4, 49152
v_mfma_f32_16x16x32_bf16 a[4:7], a[228:231], v[72:75], a[4:7]
s_barrier
v_mfma_f32_16x16x32_bf16 a[12:15], a[228:231], v[76:79], a[12:15]
ds_read_b64_tr_b16 a[224:225], v0 offset:16384
ds_read_b64_tr_b16 a[226:227], v0 offset:18432
v_mfma_f32_16x16x32_bf16 a[16:19], a[232:235], v[72:75], a[16:19]
ds_read_b64_tr_b16 a[228:229], v1 offset:16384
ds_read_b64_tr_b16 a[230:231], v1 offset:18432
v_mfma_f32_16x16x32_bf16 a[24:27], a[232:235], v[76:79], a[24:27]
buffer_load_dwordx4 v8, s[16:19], s35 offen offset:3072 nt lds
v_mfma_f32_16x16x32_bf16 a[20:23], a[236:239], v[72:75], a[20:23]
ds_read_b64_tr_b16 a[232:233], v2 offset:16384
v_mfma_f32_16x16x32_bf16 a[28:31], a[236:239], v[76:79], a[28:31]
ds_read_b64_tr_b16 a[234:235], v2 offset:18432
s_waitcnt lgkmcnt(6)
v_mfma_f32_16x16x32_bf16 a[32:35], a[240:243], v[72:75], a[32:35]
ds_read_b64_tr_b16 a[236:237], v3 offset:16384
v_mfma_f32_16x16x32_bf16 a[40:43], a[240:243], v[76:79], a[40:43]
ds_read_b64_tr_b16 a[238:239], v3 offset:18432
v_mfma_f32_16x16x32_bf16 a[36:39], a[244:247], v[72:75], a[36:39]
ds_read_b64_tr_b16 a[240:241], v0 offset:20480
ds_read_b64_tr_b16 a[242:243], v0 offset:22528
v_mfma_f32_16x16x32_bf16 a[44:47], a[244:247], v[76:79], a[44:47]
s_add_u32 m0, s4, 65536
s_mov_b32 s35, 458880
v_mfma_f32_16x16x32_bf16 a[48:51], a[248:251], v[72:75], a[48:51]
ds_read_b64_tr_b16 a[244:245], v1 offset:20480
v_mfma_f32_16x16x32_bf16 a[56:59], a[248:251], v[76:79], a[56:59]
ds_read_b64_tr_b16 a[246:247], v1 offset:22528
v_mfma_f32_16x16x32_bf16 a[52:55], a[252:255], v[72:75], a[52:55]
ds_read_b64_tr_b16 a[248:249], v2 offset:20480
v_mfma_f32_16x16x32_bf16 a[60:63], a[252:255], v[76:79], a[60:63]
ds_read_b64_tr_b16 a[250:251], v2 offset:22528
L_step_97:
s_waitcnt lgkmcnt(6)
v_mfma_f32_16x16x32_bf16 v[32:35], a[224:227], v[128:131], 0
ds_read_b64_tr_b16 a[252:253], v3 offset:20480
ds_read_b64_tr_b16 a[254:255], v3 offset:22528
v_mfma_f32_16x16x32_bf16 v[40:43], a[224:227], v[132:135], 0
s_waitcnt vmcnt(7)
v_mbcnt_lo_u32_b32 v24, -1, 0
v_mfma_f32_16x16x32_bf16 v[36:39], a[228:231], v[128:131], 0
ds_read_b64_tr_b16 a[224:225], v0 offset:24576
ds_read_b64_tr_b16 a[226:227], v0 offset:26624
v_mfma_f32_16x16x32_bf16 v[44:47], a[228:231], v[132:135], 0
buffer_load_dwordx4 v8, s[16:19], s35 offen nt lds
v_mfma_f32_16x16x32_bf16 v[48:51], a[232:235], v[128:131], 0
ds_read_b64_tr_b16 a[228:229], v1 offset:24576
ds_read_b64_tr_b16 a[230:231], v1 offset:26624
v_mfma_f32_16x16x32_bf16 v[56:59], a[232:235], v[132:135], 0
v_mbcnt_hi_u32_b32 v24, -1, v24
v_lshlrev_b32 v21, 4, v24
v_mfma_f32_16x16x32_bf16 v[52:55], a[236:239], v[128:131], 0
ds_read_b64_tr_b16 a[232:233], v2 offset:24576
ds_read_b64_tr_b16 a[234:235], v2 offset:26624
v_mfma_f32_16x16x32_bf16 v[60:63], a[236:239], v[132:135], 0
v_add_u32 v21, s4, v21
s_waitcnt lgkmcnt(6)
v_mfma_f32_16x16x32_bf16 v[32:35], a[240:243], v[136:139], v[32:35]
ds_read_b64_tr_b16 a[236:237], v3 offset:24576
ds_read_b64_tr_b16 a[238:239], v3 offset:26624
v_mfma_f32_16x16x32_bf16 v[40:43], a[240:243], v[140:143], v[40:43]
v_add_u32 v27, 65536, v21
v_lshlrev_b32 v20, 10, v24
v_mfma_f32_16x16x32_bf16 v[36:39], a[244:247], v[136:139], v[36:39]
ds_read_b64_tr_b16 a[240:241], v0 offset:28672
ds_read_b64_tr_b16 a[242:243], v0 offset:30720
v_mfma_f32_16x16x32_bf16 v[44:47], a[244:247], v[140:143], v[44:47]
v_add_u32 v0, 0xffff0000, v0
v_min_u32 v23, 8, v24
v_mfma_f32_16x16x32_bf16 v[48:51], a[248:251], v[136:139], v[48:51]
ds_read_b64_tr_b16 a[244:245], v1 offset:28672
ds_read_b64_tr_b16 a[246:247], v1 offset:30720
v_mfma_f32_16x16x32_bf16 v[56:59], a[248:251], v[140:143], v[56:59]
v_add_u32 v1, 0xffff0000, v1
v_lshrrev_b32 v22, 3, v23
v_mfma_f32_16x16x32_bf16 v[52:55], a[252:255], v[136:139], v[52:55]
ds_read_b64_tr_b16 a[248:249], v2 offset:28672
ds_read_b64_tr_b16 a[250:251], v2 offset:30720
v_mfma_f32_16x16x32_bf16 v[60:63], a[252:255], v[140:143], v[60:63]
v_add_u32 v2, 0xffff0000, v2
s_waitcnt lgkmcnt(6)
v_mfma_f32_16x16x32_bf16 v[32:35], a[224:227], v[144:147], v[32:35]
ds_read_b64_tr_b16 a[252:253], v3 offset:28672
ds_read_b64_tr_b16 a[254:255], v3 offset:30720
v_mfma_f32_16x16x32_bf16 v[40:43], a[224:227], v[148:151], v[40:43]
buffer_load_dwordx4 v8, s[16:19], s35 offen offset:1024 nt lds
v_mfma_f32_16x16x32_bf16 v[36:39], a[228:231], v[144:147], v[36:39]
s_barrier
ds_read_b64_tr_b16 a[224:225], v0 offset:16384
v_mfma_f32_16x16x32_bf16 v[44:47], a[228:231], v[148:151], v[44:47]
ds_read_b64_tr_b16 a[226:227], v0 offset:18432
v_add_u32 v3, 0xffff0000, v3
v_mfma_f32_16x16x32_bf16 v[48:51], a[232:235], v[144:147], v[48:51]
ds_read_b64_tr_b16 a[228:229], v1 offset:16384
ds_read_b64_tr_b16 a[230:231], v1 offset:18432
v_mfma_f32_16x16x32_bf16 v[56:59], a[232:235], v[148:151], v[56:59]
s_add_u32 m0, s4, 98304
s_add_u32 s5, s88, 230144
v_mfma_f32_16x16x32_bf16 v[52:55], a[236:239], v[144:147], v[52:55]
ds_read_b64_tr_b16 a[232:233], v2 offset:16384
ds_read_b64_tr_b16 a[234:235], v2 offset:18432
v_mfma_f32_16x16x32_bf16 v[60:63], a[236:239], v[148:151], v[60:63]
v_lshlrev_b32 v22, 10, v22
s_waitcnt lgkmcnt(6)
v_mfma_f32_16x16x32_bf16 v[32:35], a[240:243], v[152:155], v[32:35]
ds_read_b64_tr_b16 a[236:237], v3 offset:16384
ds_read_b64_tr_b16 a[238:239], v3 offset:18432
v_mfma_f32_16x16x32_bf16 v[40:43], a[240:243], v[156:159], v[40:43]
buffer_load_dwordx4 v9, s[24:27], s5 offen lds
v_mfma_f32_16x16x32_bf16 v[36:39], a[244:247], v[152:155], v[36:39]
ds_read_b64_tr_b16 a[240:241], v0 offset:24576
ds_read_b64_tr_b16 a[242:243], v0 offset:26624
v_mfma_f32_16x16x32_bf16 v[44:47], a[244:247], v[156:159], v[44:47]
s_add_u32 s5, s88, 236288
v_lshl_add_u32 v23, v23, 2, v22
v_mfma_f32_16x16x32_bf16 v[48:51], a[248:251], v[152:155], v[48:51]
ds_read_b64_tr_b16 a[244:245], v1 offset:24576
ds_read_b64_tr_b16 a[246:247], v1 offset:26624
v_mfma_f32_16x16x32_bf16 v[56:59], a[248:251], v[156:159], v[56:59]
buffer_load_dwordx4 v9, s[24:27], s5 offen offset:1024 lds
v_mfma_f32_16x16x32_bf16 v[52:55], a[252:255], v[152:155], v[52:55]
ds_read_b64_tr_b16 a[248:249], v2 offset:24576
ds_read_b64_tr_b16 a[250:251], v2 offset:26624
v_mfma_f32_16x16x32_bf16 v[60:63], a[252:255], v[156:159], v[60:63]
s_add_u32 m0, s4, 65536
L_step_98:
s_waitcnt lgkmcnt(6)
v_mfma_f32_16x16x32_bf16 a[64:67], a[224:227], v[64:67], a[64:67]
ds_read_b64_tr_b16 a[252:253], v3 offset:24576
ds_read_b64_tr_b16 a[254:255], v3 offset:26624
v_mfma_f32_16x16x32_bf16 a[72:75], a[224:227], v[68:71], a[72:75]
s_waitcnt vmcnt(6)
v_and_b32 v25, 3, v24
v_mfma_f32_16x16x32_bf16 a[68:71], a[228:231], v[64:67], a[68:71]
ds_read_b64_tr_b16 a[224:225], v0 offset:20480
ds_read_b64_tr_b16 a[226:227], v0 offset:22528
v_mfma_f32_16x16x32_bf16 a[76:79], a[228:231], v[68:71], a[76:79]
buffer_load_dwordx4 v8, s[16:19], s35 offen offset:2048 nt lds
v_mfma_f32_16x16x32_bf16 a[80:83], a[232:235], v[64:67], a[80:83]
ds_read_b64_tr_b16 a[228:229], v1 offset:20480
ds_read_b64_tr_b16 a[230:231], v1 offset:22528
v_mfma_f32_16x16x32_bf16 a[88:91], a[232:235], v[68:71], a[88:91]
s_add_u32 m0, s4, 98304
s_add_u32 s5, s88, 242432
v_mfma_f32_16x16x32_bf16 a[84:87], a[236:239], v[64:67], a[84:87]
ds_read_b64_tr_b16 a[232:233], v2 offset:20480
ds_read_b64_tr_b16 a[234:235], v2 offset:22528
v_mfma_f32_16x16x32_bf16 a[92:95], a[236:239], v[68:71], a[92:95]
v_lshrrev_b32 v26, 4, v24
s_waitcnt lgkmcnt(6)
v_mfma_f32_16x16x32_bf16 a[96:99], a[240:243], v[64:67], a[96:99]
ds_read_b64_tr_b16 a[236:237], v3 offset:20480
ds_read_b64_tr_b16 a[238:239], v3 offset:22528
v_mfma_f32_16x16x32_bf16 a[104:107], a[240:243], v[68:71], a[104:107]
buffer_load_dwordx4 v9, s[24:27], s5 offen offset:2048 lds
v_mfma_f32_16x16x32_bf16 a[100:103], a[244:247], v[64:67], a[100:103]
ds_read_b64_tr_b16 a[240:241], v0 offset:28672
ds_read_b64_tr_b16 a[242:243], v0 offset:30720
v_mfma_f32_16x16x32_bf16 a[108:111], a[244:247], v[68:71], a[108:111]
s_add_u32 s5, s88, 248576
v_lshl_add_u32 v25, v25, 2, v26
v_mfma_f32_16x16x32_bf16 a[112:115], a[248:251], v[64:67], a[112:115]
ds_read_b64_tr_b16 a[244:245], v1 offset:28672
ds_read_b64_tr_b16 a[246:247], v1 offset:30720
v_mfma_f32_16x16x32_bf16 a[120:123], a[248:251], v[68:71], a[120:123]
buffer_load_dwordx4 v9, s[24:27], s5 offen offset:3072 lds
v_mfma_f32_16x16x32_bf16 a[116:119], a[252:255], v[64:67], a[116:119]
ds_read_b64_tr_b16 a[248:249], v2 offset:28672
ds_read_b64_tr_b16 a[250:251], v2 offset:30720
v_mfma_f32_16x16x32_bf16 a[124:127], a[252:255], v[68:71], a[124:127]
s_add_u32 m0, s4, 65536
s_waitcnt lgkmcnt(6)
v_mfma_f32_16x16x32_bf16 a[64:67], a[224:227], v[72:75], a[64:67]
ds_read_b64_tr_b16 a[252:253], v3 offset:28672
ds_read_b64_tr_b16 a[254:255], v3 offset:30720
v_mfma_f32_16x16x32_bf16 a[72:75], a[224:227], v[76:79], a[72:75]
buffer_load_dwordx4 v8, s[16:19], s35 offen offset:3072 nt lds
v_mfma_f32_16x16x32_bf16 a[68:71], a[228:231], v[72:75], a[68:71]
s_barrier
ds_read_b64_tr_b16 a[224:225], v0 offset:0
v_mfma_f32_16x16x32_bf16 a[76:79], a[228:231], v[76:79], a[76:79]
ds_read_b64_tr_b16 a[226:227], v0 offset:2048
s_add_u32 m0, s4, 114688
v_mfma_f32_16x16x32_bf16 a[80:83], a[232:235], v[72:75], a[80:83]
ds_read_b64_tr_b16 a[228:229], v1 offset:0
ds_read_b64_tr_b16 a[230:231], v1 offset:2048
v_mfma_f32_16x16x32_bf16 a[88:91], a[232:235], v[76:79], a[88:91]
s_mov_b32 s35, 262400
v_lshlrev_b32 v25, 4, v25
v_mfma_f32_16x16x32_bf16 a[84:87], a[236:239], v[72:75], a[84:87]
ds_read_b64_tr_b16 a[232:233], v2 offset:0
ds_read_b64_tr_b16 a[234:235], v2 offset:2048
v_mfma_f32_16x16x32_bf16 a[92:95], a[236:239], v[76:79], a[92:95]
s_waitcnt vmcnt(7)
s_waitcnt lgkmcnt(6)
v_mfma_f32_16x16x32_bf16 a[96:99], a[240:243], v[72:75], a[96:99]
ds_read_b64_tr_b16 a[236:237], v3 offset:0
ds_read_b64_tr_b16 a[238:239], v3 offset:2048
v_mfma_f32_16x16x32_bf16 a[104:107], a[240:243], v[76:79], a[104:107]
buffer_load_dwordx4 v8, s[16:19], s35 offen nt lds
v_mfma_f32_16x16x32_bf16 a[100:103], a[244:247], v[72:75], a[100:103]
ds_read_b64_tr_b16 a[240:241], v0 offset:4096
ds_read_b64_tr_b16 a[242:243], v0 offset:6144
v_mfma_f32_16x16x32_bf16 a[108:111], a[244:247], v[76:79], a[108:111]
v_add_u32 v25, s4, v25
v_mov_b32 v28, 0x7f000000
v_mfma_f32_16x16x32_bf16 a[112:115], a[248:251], v[72:75], a[112:115]
ds_read_b64_tr_b16 a[244:245], v1 offset:4096
ds_read_b64_tr_b16 a[246:247], v1 offset:6144
v_mfma_f32_16x16x32_bf16 a[120:123], a[248:251], v[76:79], a[120:123]
v_bfe_u32 v26, v24, 2, 2
v_or_b32 v26, 0, v26
v_mfma_f32_16x16x32_bf16 a[116:119], a[252:255], v[72:75], a[116:119]
ds_read_b64_tr_b16 a[248:249], v2 offset:4096
ds_read_b64_tr_b16 a[250:251], v2 offset:6144
v_mfma_f32_16x16x32_bf16 a[124:127], a[252:255], v[76:79], a[124:127]
v_lshl_add_u32 v16, v26, 17, v25
L_step_99:
s_waitcnt lgkmcnt(6)
v_mfma_f32_16x16x32_bf16 v[32:35], a[224:227], v[160:163], v[32:35]
ds_read_b64_tr_b16 a[252:253], v3 offset:4096
ds_read_b64_tr_b16 a[254:255], v3 offset:6144
v_mfma_f32_16x16x32_bf16 v[40:43], a[224:227], v[164:167], v[40:43]
v_xor_b32 v26, s34, v26
v_lshl_add_u32 v16, v26, 14, v16
v_mfma_f32_16x16x32_bf16 v[36:39], a[228:231], v[160:163], v[36:39]
ds_read_b64_tr_b16 a[224:225], v0 offset:8192
ds_read_b64_tr_b16 a[226:227], v0 offset:10240
v_mfma_f32_16x16x32_bf16 v[44:47], a[228:231], v[164:167], v[44:47]
v_cmp_eq_u32 s[90:91], 0, v26
v_add_u32 v22, 65536, v25
v_mfma_f32_16x16x32_bf16 v[48:51], a[232:235], v[160:163], v[48:51]
ds_read_b64_tr_b16 a[228:229], v1 offset:8192
ds_read_b64_tr_b16 a[230:231], v1 offset:10240
v_mfma_f32_16x16x32_bf16 v[56:59], a[232:235], v[164:167], v[56:59]
buffer_load_dwordx4 v8, s[16:19], s35 offen offset:1024 nt lds
v_mfma_f32_16x16x32_bf16 v[52:55], a[236:239], v[160:163], v[52:55]
ds_read_b64_tr_b16 a[232:233], v2 offset:8192
ds_read_b64_tr_b16 a[234:235], v2 offset:10240
v_mfma_f32_16x16x32_bf16 v[60:63], a[236:239], v[164:167], v[60:63]
v_lshlrev_b32 v18, 4, v24
s_waitcnt lgkmcnt(6)
v_mfma_f32_16x16x32_bf16 v[32:35], a[240:243], v[168:171], v[32:35]
ds_read_b64_tr_b16 a[236:237], v3 offset:8192
ds_read_b64_tr_b16 a[238:239], v3 offset:10240
v_mfma_f32_16x16x32_bf16 v[40:43], a[240:243], v[172:175], v[40:43]
v_add_u32 v18, 81920, v18
v_cndmask_b32 v18, v18, v22, s[90:91]
v_mfma_f32_16x16x32_bf16 v[36:39], a[244:247], v[168:171], v[36:39]
ds_read_b64_tr_b16 a[240:241], v0 offset:12288
ds_read_b64_tr_b16 a[242:243], v0 offset:14336
v_mfma_f32_16x16x32_bf16 v[44:47], a[244:247], v[172:175], v[44:47]
v_cndmask_b32 v16, v16, v28, s[90:91]
v_bfe_u32 v26, v24, 2, 2
v_mfma_f32_16x16x32_bf16 v[48:51], a[248:251], v[168:171], v[48:51]
ds_read_b64_tr_b16 a[244:245], v1 offset:12288
ds_read_b64_tr_b16 a[246:247], v1 offset:14336
v_mfma_f32_16x16x32_bf16 v[56:59], a[248:251], v[172:175], v[56:59]
v_or_b32 v26, 4, v26
v_lshl_add_u32 v17, v26, 17, v25
v_mfma_f32_16x16x32_bf16 v[52:55], a[252:255], v[168:171], v[52:55]
ds_read_b64_tr_b16 a[248:249], v2 offset:12288
ds_read_b64_tr_b16 a[250:251], v2 offset:14336
v_mfma_f32_16x16x32_bf16 v[60:63], a[252:255], v[172:175], v[60:63]
v_xor_b32 v26, s34, v26
s_waitcnt lgkmcnt(6)
v_mfma_f32_16x16x32_bf16 v[32:35], a[224:227], v[176:179], v[32:35]
ds_read_b64_tr_b16 a[252:253], v3 offset:12288
ds_read_b64_tr_b16 a[254:255], v3 offset:14336
v_mfma_f32_16x16x32_bf16 v[40:43], a[224:227], v[180:183], v[40:43]
v_lshl_add_u32 v17, v26, 14, v17
v_cmp_eq_u32 s[90:91], 0, v26
v_mfma_f32_16x16x32_bf16 v[36:39], a[228:231], v[176:179], v[36:39]
s_barrier
ds_read_b64_tr_b16 a[224:225], v0 offset:32768
v_mfma_f32_16x16x32_bf16 v[44:47], a[228:231], v[180:183], v[44:47]
ds_read_b64_tr_b16 a[226:227], v0 offset:34816
s_waitcnt vmcnt(5)
v_mfma_f32_16x16x32_bf16 v[48:51], a[232:235], v[176:179], v[48:51]
ds_read_b64_tr_b16 a[228:229], v1 offset:32768
ds_read_b64_tr_b16 a[230:231], v1 offset:34816
v_mfma_f32_16x16x32_bf16 v[56:59], a[232:235], v[180:183], v[56:59]
buffer_load_dwordx4 v8, s[16:19], s35 offen offset:2048 nt lds
v_mfma_f32_16x16x32_bf16 v[52:55], a[236:239], v[176:179], v[52:55]
ds_read_b64_tr_b16 a[232:233], v2 offset:32768
ds_read_b64_tr_b16 a[234:235], v2 offset:34816
v_mfma_f32_16x16x32_bf16 v[60:63], a[236:239], v[180:183], v[60:63]
s_add_u32 m0, s4, 81920
s_waitcnt lgkmcnt(6)
v_mfma_f32_16x16x32_bf16 v[32:35], a[240:243], v[184:187], v[32:35]
ds_read_b64_tr_b16 a[236:237], v3 offset:32768
ds_read_b64_tr_b16 a[238:239], v3 offset:34816
v_mfma_f32_16x16x32_bf16 v[40:43], a[240:243], v[188:191], v[40:43]
s_mov_b32 s5, 286720
v_add_u32 v22, 65536, v25
v_mfma_f32_16x16x32_bf16 v[36:39], a[244:247], v[184:187], v[36:39]
ds_read_b64_tr_b16 a[240:241], v0 offset:40960
ds_read_b64_tr_b16 a[242:243], v0 offset:43008
v_mfma_f32_16x16x32_bf16 v[44:47], a[244:247], v[188:191], v[44:47]
buffer_load_dwordx4 v9, s[24:27], s5 offen lds
v_mfma_f32_16x16x32_bf16 v[48:51], a[248:251], v[184:187], v[48:51]
ds_read_b64_tr_b16 a[244:245], v1 offset:40960
ds_read_b64_tr_b16 a[246:247], v1 offset:43008
v_mfma_f32_16x16x32_bf16 v[56:59], a[248:251], v[188:191], v[56:59]
s_mov_b32 s5, 292864
v_lshlrev_b32 v19, 4, v24
v_mfma_f32_16x16x32_bf16 v[52:55], a[252:255], v[184:187], v[52:55]
ds_read_b64_tr_b16 a[248:249], v2 offset:40960
ds_read_b64_tr_b16 a[250:251], v2 offset:43008
v_mfma_f32_16x16x32_bf16 v[60:63], a[252:255], v[188:191], v[60:63]
v_add_u32 v19, 81920, v19
L_step_100:
s_waitcnt lgkmcnt(6)
v_mfma_f32_16x16x32_bf16 a[128:131], a[224:227], v[64:67], a[128:131]
ds_read_b64_tr_b16 a[252:253], v3 offset:40960
ds_read_b64_tr_b16 a[254:255], v3 offset:43008
v_mfma_f32_16x16x32_bf16 a[136:139], a[224:227], v[68:71], a[136:139]
buffer_load_dwordx4 v9, s[24:27], s5 offen offset:1024 lds
v_mfma_f32_16x16x32_bf16 a[132:135], a[228:231], v[64:67], a[132:135]
ds_read_b64_tr_b16 a[224:225], v0 offset:36864
ds_read_b64_tr_b16 a[226:227], v0 offset:38912
v_mfma_f32_16x16x32_bf16 a[140:143], a[228:231], v[68:71], a[140:143]
s_add_u32 m0, s4, 114688
v_cndmask_b32 v19, v19, v22, s[90:91]
v_mfma_f32_16x16x32_bf16 a[144:147], a[232:235], v[64:67], a[144:147]
ds_read_b64_tr_b16 a[228:229], v1 offset:36864
ds_read_b64_tr_b16 a[230:231], v1 offset:38912
v_mfma_f32_16x16x32_bf16 a[152:155], a[232:235], v[68:71], a[152:155]
buffer_load_dwordx4 v8, s[16:19], s35 offen offset:3072 nt lds
v_mfma_f32_16x16x32_bf16 a[148:151], a[236:239], v[64:67], a[148:151]
ds_read_b64_tr_b16 a[232:233], v2 offset:36864
ds_read_b64_tr_b16 a[234:235], v2 offset:38912
v_mfma_f32_16x16x32_bf16 a[156:159], a[236:239], v[68:71], a[156:159]
s_add_u32 m0, s4, 81920
s_waitcnt lgkmcnt(6)
v_mfma_f32_16x16x32_bf16 a[160:163], a[240:243], v[64:67], a[160:163]
ds_read_b64_tr_b16 a[236:237], v3 offset:36864
ds_read_b64_tr_b16 a[238:239], v3 offset:38912
v_mfma_f32_16x16x32_bf16 a[168:171], a[240:243], v[68:71], a[168:171]
s_mov_b32 s5, 299008
buffer_load_dwordx4 v9, s[24:27], s5 offen offset:2048 lds
v_mfma_f32_16x16x32_bf16 a[164:167], a[244:247], v[64:67], a[164:167]
ds_read_b64_tr_b16 a[240:241], v0 offset:45056
ds_read_b64_tr_b16 a[242:243], v0 offset:47104
v_mfma_f32_16x16x32_bf16 a[172:175], a[244:247], v[68:71], a[172:175]
s_mov_b32 s5, 305152
v_cndmask_b32 v17, v17, v28, s[90:91]
v_mfma_f32_16x16x32_bf16 a[176:179], a[248:251], v[64:67], a[176:179]
ds_read_b64_tr_b16 a[244:245], v1 offset:45056
ds_read_b64_tr_b16 a[246:247], v1 offset:47104
v_mfma_f32_16x16x32_bf16 a[184:187], a[248:251], v[68:71], a[184:187]
buffer_load_dwordx4 v9, s[24:27], s5 offen offset:3072 lds
v_mfma_f32_16x16x32_bf16 a[180:183], a[252:255], v[64:67], a[180:183]
ds_read_b64_tr_b16 a[248:249], v2 offset:45056
ds_read_b64_tr_b16 a[250:251], v2 offset:47104
v_mfma_f32_16x16x32_bf16 a[188:191], a[252:255], v[68:71], a[188:191]
s_add_u32 m0, s4, 16384
s_waitcnt lgkmcnt(6)
v_mfma_f32_16x16x32_bf16 a[128:131], a[224:227], v[72:75], a[128:131]
ds_read_b64_tr_b16 a[252:253], v3 offset:45056
ds_read_b64_tr_b16 a[254:255], v3 offset:47104
v_mfma_f32_16x16x32_bf16 a[136:139], a[224:227], v[76:79], a[136:139]
s_mov_b32 s35, 327936
s_waitcnt vmcnt(7)
v_mfma_f32_16x16x32_bf16 a[132:135], a[228:231], v[72:75], a[132:135]
s_barrier
ds_read_b64_tr_b16 a[224:225], v0 offset:49152
v_mfma_f32_16x16x32_bf16 a[140:143], a[228:231], v[76:79], a[140:143]
ds_read_b64_tr_b16 a[226:227], v0 offset:51200
v_cmp_gt_u32 s[90:91], 32, v24
v_mfma_f32_16x16x32_bf16 a[144:147], a[232:235], v[72:75], a[144:147]
ds_read_b64_tr_b16 a[228:229], v1 offset:49152
ds_read_b64_tr_b16 a[230:231], v1 offset:51200
v_mfma_f32_16x16x32_bf16 a[152:155], a[232:235], v[76:79], a[152:155]
buffer_load_dwordx4 v8, s[16:19], s35 offen nt lds
v_mfma_f32_16x16x32_bf16 a[148:151], a[236:239], v[72:75], a[148:151]
ds_read_b64_tr_b16 a[232:233], v2 offset:49152
ds_read_b64_tr_b16 a[234:235], v2 offset:51200
v_mfma_f32_16x16x32_bf16 a[156:159], a[236:239], v[76:79], a[156:159]
v_bfe_u32 v22, v24, 2, 2
s_waitcnt lgkmcnt(6)
v_mfma_f32_16x16x32_bf16 a[160:163], a[240:243], v[72:75], a[160:163]
ds_read_b64_tr_b16 a[236:237], v3 offset:49152
ds_read_b64_tr_b16 a[238:239], v3 offset:51200
v_mfma_f32_16x16x32_bf16 a[168:171], a[240:243], v[76:79], a[168:171]
v_mul_u32_u24 v22, 896, v22
v_lshrrev_b32 v25, 4, v24
v_mfma_f32_16x16x32_bf16 a[164:167], a[244:247], v[72:75], a[164:167]
ds_read_b64_tr_b16 a[240:241], v0 offset:53248
ds_read_b64_tr_b16 a[242:243], v0 offset:55296
v_mfma_f32_16x16x32_bf16 a[172:175], a[244:247], v[76:79], a[172:175]
v_lshl_add_u32 v22, v25, 6, v22
v_and_b32 v25, 3, v24
v_mfma_f32_16x16x32_bf16 a[176:179], a[248:251], v[72:75], a[176:179]
ds_read_b64_tr_b16 a[244:245], v1 offset:53248
ds_read_b64_tr_b16 a[246:247], v1 offset:55296
v_mfma_f32_16x16x32_bf16 a[184:187], a[248:251], v[76:79], a[184:187]
buffer_load_dwordx4 v8, s[16:19], s35 offen offset:1024 nt lds
v_mfma_f32_16x16x32_bf16 a[180:183], a[252:255], v[72:75], a[180:183]
ds_read_b64_tr_b16 a[248:249], v2 offset:53248
ds_read_b64_tr_b16 a[250:251], v2 offset:55296
v_mfma_f32_16x16x32_bf16 a[188:191], a[252:255], v[76:79], a[188:191]
v_lshl_add_u32 v22, v25, 3, v22
L_step_101:
s_waitcnt lgkmcnt(6)
v_mfma_f32_16x16x32_bf16 v[32:35], a[224:227], v[192:195], v[32:35]
ds_read_b64_tr_b16 a[252:253], v3 offset:53248
ds_read_b64_tr_b16 a[254:255], v3 offset:55296
v_mfma_f32_16x16x32_bf16 v[40:43], a[224:227], v[196:199], v[40:43]
v_cndmask_b32 v29, v28, v22, s[90:91]
v_cndmask_b32 v28, v28, v21, s[90:91]
v_mfma_f32_16x16x32_bf16 v[36:39], a[228:231], v[192:195], v[36:39]
ds_read_b64_tr_b16 a[224:225], v0 offset:57344
v_mfma_f32_16x16x32_bf16 v[44:47], a[228:231], v[196:199], v[44:47]
ds_read_b64_tr_b16 a[226:227], v0 offset:59392
v_mfma_f32_16x16x32_bf16 v[48:51], a[232:235], v[192:195], v[48:51]
ds_read_b64_tr_b16 a[228:229], v1 offset:57344
v_mfma_f32_16x16x32_bf16 v[56:59], a[232:235], v[196:199], v[56:59]
L_pg19:
s_cbranch_scc1 L_rt0
ds_read_b64_tr_b16 a[230:231], v1 offset:59392
v_mfma_f32_16x16x32_bf16 v[52:55], a[236:239], v[192:195], v[52:55]
ds_read_b64_tr_b16 a[232:233], v2 offset:57344
v_mfma_f32_16x16x32_bf16 v[60:63], a[236:239], v[196:199], v[60:63]
ds_read_b64_tr_b16 a[234:235], v2 offset:59392
s_waitcnt lgkmcnt(6)
v_mfma_f32_16x16x32_bf16 v[32:35], a[240:243], v[200:203], v[32:35]
ds_read_b64_tr_b16 a[236:237], v3 offset:57344
v_mfma_f32_16x16x32_bf16 v[40:43], a[240:243], v[204:207], v[40:43]
ds_read_b64_tr_b16 a[238:239], v3 offset:59392
v_mfma_f32_16x16x32_bf16 v[36:39], a[244:247], v[200:203], v[36:39]
ds_read_b64_tr_b16 a[240:241], v0 offset:61440
ds_read_b64_tr_b16 a[242:243], v0 offset:63488
v_mfma_f32_16x16x32_bf16 v[44:47], a[244:247], v[204:207], v[44:47]
v_add_u32 v0, 0x10000, v0
s_waitcnt vmcnt(7)
v_mfma_f32_16x16x32_bf16 v[48:51], a[248:251], v[200:203], v[48:51]
ds_read_b64_tr_b16 a[244:245], v1 offset:61440
ds_read_b64_tr_b16 a[246:247], v1 offset:63488
v_mfma_f32_16x16x32_bf16 v[56:59], a[248:251], v[204:207], v[56:59]
buffer_load_dwordx4 v8, s[16:19], s35 offen offset:2048 nt lds
v_mfma_f32_16x16x32_bf16 v[52:55], a[252:255], v[200:203], v[52:55]
ds_read_b64_tr_b16 a[248:249], v2 offset:61440
ds_read_b64_tr_b16 a[250:251], v2 offset:63488
v_mfma_f32_16x16x32_bf16 v[60:63], a[252:255], v[204:207], v[60:63]
v_add_u32 v1, 0x10000, v1
s_waitcnt lgkmcnt(6)
v_mfma_f32_16x16x32_bf16 v[32:35], a[224:227], v[208:211], v[32:35]
ds_read_b64_tr_b16 a[252:253], v3 offset:61440
ds_read_b64_tr_b16 a[254:255], v3 offset:63488
v_mfma_f32_16x16x32_bf16 v[40:43], a[224:227], v[212:215], v[40:43]
v_add_u32 v2, 0x10000, v2
v_add_u32 v3, 0x10000, v3
v_mfma_f32_16x16x32_bf16 v[36:39], a[228:231], v[208:211], v[36:39]
s_barrier
ds_read_b64_tr_b16 a[224:225], v0 offset:32768
v_mfma_f32_16x16x32_bf16 v[44:47], a[228:231], v[212:215], v[44:47]
ds_read_b64_tr_b16 a[226:227], v0 offset:34816
s_add_u32 m0, s4, 0
v_mfma_f32_16x16x32_bf16 v[48:51], a[232:235], v[208:211], v[48:51]
ds_read_b64_tr_b16 a[228:229], v1 offset:32768
v_mfma_f32_16x16x32_bf16 v[56:59], a[232:235], v[212:215], v[56:59]
ds_read_b64_tr_b16 a[230:231], v1 offset:34816
s_mov_b32 s5, 286976
v_mfma_f32_16x16x32_bf16 v[52:55], a[236:239], v[208:211], v[52:55]
ds_read_b64_tr_b16 a[232:233], v2 offset:32768
v_mfma_f32_16x16x32_bf16 v[60:63], a[236:239], v[212:215], v[60:63]
ds_read_b64_tr_b16 a[234:235], v2 offset:34816
s_waitcnt lgkmcnt(6)
v_mfma_f32_16x16x32_bf16 v[32:35], a[240:243], v[216:219], v[32:35]
ds_read_b64_tr_b16 a[236:237], v3 offset:32768
ds_read_b64_tr_b16 a[238:239], v3 offset:34816
v_mfma_f32_16x16x32_bf16 v[40:43], a[240:243], v[220:223], v[40:43]
buffer_load_dwordx4 v9, s[24:27], s5 offen lds
s_add_u32 m0, s4, 16384
v_mfma_f32_16x16x32_bf16 v[36:39], a[244:247], v[216:219], v[36:39]
ds_read_b64_tr_b16 a[240:241], v0 offset:36864
ds_read_b64_tr_b16 a[242:243], v0 offset:38912
v_mfma_f32_16x16x32_bf16 v[44:47], a[244:247], v[220:223], v[44:47]
buffer_load_dwordx4 v8, s[16:19], s35 offen offset:3072 nt lds
s_add_u32 m0, s4, 0
v_mfma_f32_16x16x32_bf16 v[48:51], a[248:251], v[216:219], v[48:51]
ds_read_b64_tr_b16 a[244:245], v1 offset:36864
ds_read_b64_tr_b16 a[246:247], v1 offset:38912
v_mfma_f32_16x16x32_bf16 v[56:59], a[248:251], v[220:223], v[56:59]
s_mov_b32 s5, 293120
buffer_load_dwordx4 v9, s[24:27], s5 offen offset:1024 lds
v_mfma_f32_16x16x32_bf16 v[52:55], a[252:255], v[216:219], v[52:55]
s_cmp_eq_u32 s3, 0
s_cbranch_scc1 L_pg21
s_cmp_eq_u32 s3, 1
s_cbranch_scc1 L_pg22
s_cmp_eq_u32 s3, 2
s_cbranch_scc1 L_pg23
s_cmp_eq_u32 s3, 3
s_cbranch_scc1 L_pg24
L_rt1:
s_cmp_eq_u32 s3, 77
ds_read_b64_tr_b16 a[248:249], v2 offset:36864
ds_read_b64_tr_b16 a[250:251], v2 offset:38912
v_mfma_f32_16x16x32_bf16 v[60:63], a[252:255], v[220:223], v[60:63]
s_mov_b32 s5, 299264
L_step_102:
s_waitcnt lgkmcnt(6)
v_mfma_f32_16x16x32_bf16 a[192:195], a[224:227], v[64:67], a[192:195]
ds_read_b64_tr_b16 a[252:253], v3 offset:36864
ds_read_b64_tr_b16 a[254:255], v3 offset:38912
buffer_load_dwordx4 v9, s[24:27], s5 offen offset:2048 lds
v_mfma_f32_16x16x32_bf16 a[200:203], a[224:227], v[68:71], a[200:203]
s_mov_b32 s5, 305408
buffer_load_dwordx4 v9, s[24:27], s5 offen offset:3072 lds
v_mfma_f32_16x16x32_bf16 a[196:199], a[228:231], v[64:67], a[196:199]
s_barrier
ds_read_b64_tr_b16 a[224:225], v0 offset:0
v_mfma_f32_16x16x32_bf16 a[204:207], a[228:231], v[68:71], a[204:207]
ds_read_b64_tr_b16 a[226:227], v0 offset:2048
s_add_u32 m0, s4, 32768
v_mfma_f32_16x16x32_bf16 a[208:211], a[232:235], v[64:67], a[208:211]
ds_read_b64_tr_b16 a[228:229], v1 offset:0
ds_read_b64_tr_b16 a[230:231], v1 offset:2048
v_mfma_f32_16x16x32_bf16 a[216:219], a[232:235], v[68:71], a[216:219]
s_mov_b32 s35, 393472
s_waitcnt vmcnt(7)
v_mfma_f32_16x16x32_bf16 a[212:215], a[236:239], v[64:67], a[212:215]
ds_read_b64_tr_b16 a[232:233], v0 offset:4096
v_mfma_f32_16x16x32_bf16 a[220:223], a[236:239], v[68:71], a[220:223]
ds_read_b64_tr_b16 a[234:235], v0 offset:6144
s_waitcnt lgkmcnt(6)
v_mfma_f32_16x16x32_bf16 a[192:195], a[240:243], v[72:75], a[192:195]
ds_read_b64_tr_b16 a[236:237], v1 offset:4096
ds_read_b64_tr_b16 a[238:239], v1 offset:6144
v_mfma_f32_16x16x32_bf16 a[200:203], a[240:243], v[76:79], a[200:203]
buffer_load_dwordx4 v8, s[16:19], s35 offen nt lds
v_mfma_f32_16x16x32_bf16 a[196:199], a[244:247], v[72:75], a[196:199]
ds_read_b64_tr_b16 a[240:241], v0 offset:8192
v_mfma_f32_16x16x32_bf16 a[204:207], a[244:247], v[76:79], a[204:207]
ds_read_b64_tr_b16 a[242:243], v0 offset:10240
v_mfma_f32_16x16x32_bf16 a[208:211], a[248:251], v[72:75], a[208:211]
ds_read_b64_tr_b16 a[244:245], v1 offset:8192
v_mfma_f32_16x16x32_bf16 a[216:219], a[248:251], v[76:79], a[216:219]
ds_read_b64_tr_b16 a[246:247], v1 offset:10240
v_mfma_f32_16x16x32_bf16 a[212:215], a[252:255], v[72:75], a[212:215]
ds_read_b64_tr_b16 a[248:249], v0 offset:12288
v_mfma_f32_16x16x32_bf16 a[220:223], a[252:255], v[76:79], a[220:223]
ds_read_b64_tr_b16 a[250:251], v0 offset:14336
L_step_103:
s_waitcnt lgkmcnt(6)
v_mfma_f32_16x16x32_bf16 v[32:35], a[224:227], v[224:227], v[32:35]
ds_read_b64_tr_b16 a[252:253], v1 offset:12288
v_mfma_f32_16x16x32_bf16 v[40:43], a[224:227], v[228:231], v[40:43]
ds_read_b64_tr_b16 a[254:255], v1 offset:14336
v_mfma_f32_16x16x32_bf16 v[36:39], a[228:231], v[224:227], v[36:39]
ds_read_b64_tr_b16 a[224:225], v2 offset:0
ds_read_b64_tr_b16 a[226:227], v2 offset:2048
v_mfma_f32_16x16x32_bf16 v[44:47], a[228:231], v[228:231], v[44:47]
buffer_load_dwordx4 v8, s[16:19], s35 offen offset:1024 nt lds
v_mfma_f32_16x16x32_bf16 v[32:35], a[232:235], v[232:235], v[32:35]
ds_read_b64_tr_b16 a[228:229], v3 offset:0
v_mfma_f32_16x16x32_bf16 v[40:43], a[232:235], v[236:239], v[40:43]
ds_read_b64_tr_b16 a[230:231], v3 offset:2048
v_mfma_f32_16x16x32_bf16 v[36:39], a[236:239], v[232:235], v[36:39]
ds_read_b64_tr_b16 a[232:233], v2 offset:4096
v_mfma_f32_16x16x32_bf16 v[44:47], a[236:239], v[236:239], v[44:47]
ds_read_b64_tr_b16 a[234:235], v2 offset:6144
s_waitcnt lgkmcnt(6)
v_mfma_f32_16x16x32_bf16 v[32:35], a[240:243], v[240:243], v[32:35]
ds_read_b64_tr_b16 a[236:237], v3 offset:4096
v_mfma_f32_16x16x32_bf16 v[40:43], a[240:243], v[244:247], v[40:43]
ds_read_b64_tr_b16 a[238:239], v3 offset:6144
v_mfma_f32_16x16x32_bf16 v[36:39], a[244:247], v[240:243], v[36:39]
ds_read_b64_tr_b16 a[240:241], v2 offset:8192
v_mfma_f32_16x16x32_bf16 v[44:47], a[244:247], v[244:247], v[44:47]
ds_read_b64_tr_b16 a[242:243], v2 offset:10240
v_mfma_f32_16x16x32_bf16 v[32:35], a[248:251], v[248:251], v[32:35]
ds_read_b64_tr_b16 a[244:245], v3 offset:8192
v_mfma_f32_16x16x32_bf16 v[40:43], a[248:251], v[252:255], v[40:43]
ds_read_b64_tr_b16 a[246:247], v3 offset:10240
v_mfma_f32_16x16x32_bf16 v[36:39], a[252:255], v[248:251], v[36:39]
ds_read_b64_tr_b16 a[248:249], v2 offset:12288
v_mfma_f32_16x16x32_bf16 v[44:47], a[252:255], v[252:255], v[44:47]
ds_read_b64_tr_b16 a[250:251], v2 offset:14336
s_waitcnt lgkmcnt(6)
v_mfma_f32_16x16x32_bf16 v[48:51], a[224:227], v[224:227], v[48:51]
ds_read_b64_tr_b16 a[252:253], v3 offset:12288
v_mfma_f32_16x16x32_bf16 v[56:59], a[224:227], v[228:231], v[56:59]
ds_read_b64_tr_b16 a[254:255], v3 offset:14336
s_waitcnt vmcnt(7)
v_mfma_f32_16x16x32_bf16 v[52:55], a[228:231], v[224:227], v[52:55]
s_barrier
ds_read_b64_tr_b16 a[224:225], v0 offset:16384
ds_read_b64_tr_b16 a[226:227], v0 offset:18432
v_mfma_f32_16x16x32_bf16 v[60:63], a[228:231], v[228:231], v[60:63]
buffer_load_dwordx4 v8, s[16:19], s35 offen offset:2048 nt lds
s_add_u32 m0, s4, 49152
v_mfma_f32_16x16x32_bf16 v[48:51], a[232:235], v[232:235], v[48:51]
ds_read_b64_tr_b16 a[228:229], v1 offset:16384
ds_read_b64_tr_b16 a[230:231], v1 offset:18432
s_mov_b32 s5, 287232
v_mfma_f32_16x16x32_bf16 v[56:59], a[232:235], v[236:239], v[56:59]
buffer_load_dwordx4 v9, s[24:27], s5 offen lds
v_mul_f32 v32, v32, v14
v_mul_f32 v33, v33, v14
v_mfma_f32_16x16x32_bf16 v[52:55], a[236:239], v[232:235], v[52:55]
ds_read_b64_tr_b16 a[232:233], v2 offset:16384
ds_read_b64_tr_b16 a[234:235], v2 offset:18432
v_mul_f32 v34, v34, v14
v_mfma_f32_16x16x32_bf16 v[60:63], a[236:239], v[236:239], v[60:63]
v_mul_f32 v35, v35, v14
v_cvt_pk_bf16_f32 v80, v32, v33
v_mul_f32 v36, v36, v14
s_waitcnt lgkmcnt(6)
v_mfma_f32_16x16x32_bf16 v[48:51], a[240:243], v[240:243], v[48:51]
ds_read_b64_tr_b16 a[236:237], v3 offset:16384
ds_read_b64_tr_b16 a[238:239], v3 offset:18432
v_mul_f32 v37, v37, v14
v_mfma_f32_16x16x32_bf16 v[56:59], a[240:243], v[244:247], v[56:59]
v_cvt_pk_bf16_f32 v81, v34, v35
v_mul_f32 v38, v38, v14
v_mul_f32 v39, v39, v14
v_cvt_pk_bf16_f32 v82, v36, v37
v_mfma_f32_16x16x32_bf16 v[52:55], a[244:247], v[240:243], v[52:55]
ds_read_b64_tr_b16 a[240:241], v0 offset:24576
ds_read_b64_tr_b16 a[242:243], v0 offset:26624
v_cvt_pk_bf16_f32 v83, v38, v39
v_mfma_f32_16x16x32_bf16 v[60:63], a[244:247], v[244:247], v[60:63]
v_mul_f32 v40, v40, v15
v_mul_f32 v41, v41, v15
v_mul_f32 v42, v42, v15
v_mul_f32 v43, v43, v15
v_mfma_f32_16x16x32_bf16 v[48:51], a[248:251], v[248:251], v[48:51]
ds_read_b64_tr_b16 a[244:245], v1 offset:24576
ds_read_b64_tr_b16 a[246:247], v1 offset:26624
v_cvt_pk_bf16_f32 v84, v40, v41
v_mfma_f32_16x16x32_bf16 v[56:59], a[248:251], v[252:255], v[56:59]
v_mul_f32 v44, v44, v15
v_mul_f32 v45, v45, v15
v_cvt_pk_bf16_f32 v85, v42, v43
v_mfma_f32_16x16x32_bf16 v[52:55], a[252:255], v[248:251], v[52:55]
ds_read_b64_tr_b16 a[248:249], v2 offset:24576
ds_read_b64_tr_b16 a[250:251], v2 offset:26624
v_mul_f32 v46, v46, v15
v_mfma_f32_16x16x32_bf16 v[60:63], a[252:255], v[252:255], v[60:63]
v_mul_f32 v47, v47, v15
v_cvt_pk_bf16_f32 v86, v44, v45
v_cvt_pk_bf16_f32 v87, v46, v47
L_step_104:
s_waitcnt lgkmcnt(6)
v_mfma_f32_16x16x32_bf16 a[0:3], a[224:227], v[80:83], a[0:3]
ds_read_b64_tr_b16 a[252:253], v3 offset:24576
ds_read_b64_tr_b16 a[254:255], v3 offset:26624
v_mfma_f32_16x16x32_bf16 a[8:11], a[224:227], v[84:87], a[8:11]
s_mov_b32 s5, 293376
buffer_load_dwordx4 v9, s[24:27], s5 offen offset:1024 lds
v_mfma_f32_16x16x32_bf16 a[4:7], a[228:231], v[80:83], a[4:7]
ds_read_b64_tr_b16 a[224:225], v0 offset:20480
ds_read_b64_tr_b16 a[226:227], v0 offset:22528
s_add_u32 m0, s4, 32768
v_mfma_f32_16x16x32_bf16 a[12:15], a[228:231], v[84:87], a[12:15]
buffer_load_dwordx4 v8, s[16:19], s35 offen offset:3072 nt lds
s_add_u32 m0, s4, 49152
s_mov_b32 s5, 299520
v_mfma_f32_16x16x32_bf16 a[16:19], a[232:235], v[80:83], a[16:19]
ds_read_b64_tr_b16 a[228:229], v1 offset:20480
ds_read_b64_tr_b16 a[230:231], v1 offset:22528
buffer_load_dwordx4 v9, s[24:27], s5 offen offset:2048 lds
v_mfma_f32_16x16x32_bf16 a[24:27], a[232:235], v[84:87], a[24:27]
s_mov_b32 s5, 305664
v_mul_f32 v48, v48, v14
v_mul_f32 v49, v49, v14
v_mfma_f32_16x16x32_bf16 a[20:23], a[236:239], v[80:83], a[20:23]
ds_read_b64_tr_b16 a[232:233], v2 offset:20480
ds_read_b64_tr_b16 a[234:235], v2 offset:22528
v_mul_f32 v50, v50, v14
v_mfma_f32_16x16x32_bf16 a[28:31], a[236:239], v[84:87], a[28:31]
v_mul_f32 v51, v51, v14
v_cvt_pk_bf16_f32 v88, v48, v49
v_mul_f32 v52, v52, v14
s_waitcnt lgkmcnt(6)
v_mfma_f32_16x16x32_bf16 a[32:35], a[240:243], v[80:83], a[32:35]
ds_read_b64_tr_b16 a[236:237], v3 offset:20480
ds_read_b64_tr_b16 a[238:239], v3 offset:22528
buffer_load_dwordx4 v9, s[24:27], s5 offen offset:3072 lds
v_mfma_f32_16x16x32_bf16 a[40:43], a[240:243], v[84:87], a[40:43]
v_mul_f32 v53, v53, v14
v_cvt_pk_bf16_f32 v89, v50, v51
v_mul_f32 v54, v54, v14
v_mfma_f32_16x16x32_bf16 a[36:39], a[244:247], v[80:83], a[36:39]
ds_read_b64_tr_b16 a[240:241], v0 offset:28672
ds_read_b64_tr_b16 a[242:243], v0 offset:30720
v_mul_f32 v55, v55, v14
v_mfma_f32_16x16x32_bf16 a[44:47], a[244:247], v[84:87], a[44:47]
v_cvt_pk_bf16_f32 v90, v52, v53
v_cvt_pk_bf16_f32 v91, v54, v55
v_mul_f32 v56, v56, v15
v_mul_f32 v57, v57, v15
v_mfma_f32_16x16x32_bf16 a[48:51], a[248:251], v[80:83], a[48:51]
ds_read_b64_tr_b16 a[244:245], v1 offset:28672
ds_read_b64_tr_b16 a[246:247], v1 offset:30720
v_mul_f32 v58, v58, v15
v_mfma_f32_16x16x32_bf16 a[56:59], a[248:251], v[84:87], a[56:59]
v_mul_f32 v59, v59, v15
v_cvt_pk_bf16_f32 v92, v56, v57
v_mul_f32 v60, v60, v15
v_mul_f32 v61, v61, v15
v_mfma_f32_16x16x32_bf16 a[52:55], a[252:255], v[80:83], a[52:55]
ds_read_b64_tr_b16 a[248:249], v2 offset:28672
ds_read_b64_tr_b16 a[250:251], v2 offset:30720
v_cvt_pk_bf16_f32 v93, v58, v59
v_mul_f32 v62, v62, v15
v_mfma_f32_16x16x32_bf16 a[60:63], a[252:255], v[84:87], a[60:63]
v_mul_f32 v63, v63, v15
v_cvt_pk_bf16_f32 v94, v60, v61
v_cvt_pk_bf16_f32 v95, v62, v63
s_waitcnt lgkmcnt(6)
v_mfma_f32_16x16x32_bf16 a[0:3], a[224:227], v[88:91], a[0:3]
ds_read_b64_tr_b16 a[252:253], v3 offset:28672
ds_read_b64_tr_b16 a[254:255], v3 offset:30720
s_add_u32 m0, s4, 98304
v_mfma_f32_16x16x32_bf16 a[8:11], a[224:227], v[92:95], a[8:11]
s_mov_b32 s35, 459008
s_waitcnt vmcnt(7)
buffer_load_dwordx4 v8, s[16:19], s35 offen nt lds
v_mfma_f32_16x16x32_bf16 a[4:7], a[228:231], v[88:91], a[4:7]
s_barrier
v_mfma_f32_16x16x32_bf16 a[12:15], a[228:231], v[92:95], a[12:15]
ds_read_b64_tr_b16 a[224:225], v0 offset:49152
ds_read_b64_tr_b16 a[226:227], v0 offset:51200
v_mfma_f32_16x16x32_bf16 a[16:19], a[232:235], v[88:91], a[16:19]
ds_read_b64_tr_b16 a[228:229], v1 offset:49152
v_mfma_f32_16x16x32_bf16 a[24:27], a[232:235], v[92:95], a[24:27]
ds_read_b64_tr_b16 a[230:231], v1 offset:51200
v_mfma_f32_16x16x32_bf16 a[20:23], a[236:239], v[88:91], a[20:23]
ds_read_b64_tr_b16 a[232:233], v2 offset:49152
v_mfma_f32_16x16x32_bf16 a[28:31], a[236:239], v[92:95], a[28:31]
ds_read_b64_tr_b16 a[234:235], v2 offset:51200
s_waitcnt lgkmcnt(6)
v_mfma_f32_16x16x32_bf16 a[32:35], a[240:243], v[88:91], a[32:35]
ds_read_b64_tr_b16 a[236:237], v3 offset:49152
ds_read_b64_tr_b16 a[238:239], v3 offset:51200
v_mfma_f32_16x16x32_bf16 a[40:43], a[240:243], v[92:95], a[40:43]
buffer_load_dwordx4 v8, s[16:19], s35 offen offset:1024 nt lds
v_mfma_f32_16x16x32_bf16 a[36:39], a[244:247], v[88:91], a[36:39]
ds_read_b64_tr_b16 a[240:241], v0 offset:53248
v_mfma_f32_16x16x32_bf16 a[44:47], a[244:247], v[92:95], a[44:47]
ds_read_b64_tr_b16 a[242:243], v0 offset:55296
v_mfma_f32_16x16x32_bf16 a[48:51], a[248:251], v[88:91], a[48:51]
ds_read_b64_tr_b16 a[244:245], v1 offset:53248
v_mfma_f32_16x16x32_bf16 a[56:59], a[248:251], v[92:95], a[56:59]
ds_read_b64_tr_b16 a[246:247], v1 offset:55296
v_mfma_f32_16x16x32_bf16 a[52:55], a[252:255], v[88:91], a[52:55]
ds_read_b64_tr_b16 a[248:249], v2 offset:53248
v_mfma_f32_16x16x32_bf16 a[60:63], a[252:255], v[92:95], a[60:63]
ds_read_b64_tr_b16 a[250:251], v2 offset:55296
L_step_105:
s_waitcnt lgkmcnt(6)
v_mfma_f32_16x16x32_bf16 v[32:35], a[224:227], v[128:131], 0
ds_read_b64_tr_b16 a[252:253], v3 offset:53248
v_mfma_f32_16x16x32_bf16 v[40:43], a[224:227], v[132:135], 0
ds_read_b64_tr_b16 a[254:255], v3 offset:55296
v_mfma_f32_16x16x32_bf16 v[36:39], a[228:231], v[128:131], 0
ds_read_b64_tr_b16 a[224:225], v0 offset:57344
v_mfma_f32_16x16x32_bf16 v[44:47], a[228:231], v[132:135], 0
ds_read_b64_tr_b16 a[226:227], v0 offset:59392
v_mfma_f32_16x16x32_bf16 v[48:51], a[232:235], v[128:131], 0
ds_read_b64_tr_b16 a[228:229], v1 offset:57344
v_mfma_f32_16x16x32_bf16 v[56:59], a[232:235], v[132:135], 0
ds_read_b64_tr_b16 a[230:231], v1 offset:59392
v_mfma_f32_16x16x32_bf16 v[52:55], a[236:239], v[128:131], 0
ds_read_b64_tr_b16 a[232:233], v2 offset:57344
ds_read_b64_tr_b16 a[234:235], v2 offset:59392
v_mfma_f32_16x16x32_bf16 v[60:63], a[236:239], v[132:135], 0
s_waitcnt vmcnt(7)
s_waitcnt lgkmcnt(6)
v_mfma_f32_16x16x32_bf16 v[32:35], a[240:243], v[136:139], v[32:35]
ds_read_b64_tr_b16 a[236:237], v3 offset:57344
ds_read_b64_tr_b16 a[238:239], v3 offset:59392
v_mfma_f32_16x16x32_bf16 v[40:43], a[240:243], v[140:143], v[40:43]
buffer_load_dwordx4 v8, s[16:19], s35 offen offset:2048 nt lds
v_mfma_f32_16x16x32_bf16 v[36:39], a[244:247], v[136:139], v[36:39]
ds_read_b64_tr_b16 a[240:241], v0 offset:61440
v_mfma_f32_16x16x32_bf16 v[44:47], a[244:247], v[140:143], v[44:47]
ds_read_b64_tr_b16 a[242:243], v0 offset:63488
v_add_u32 v0, 0xffff0000, v0
v_mfma_f32_16x16x32_bf16 v[48:51], a[248:251], v[136:139], v[48:51]
ds_read_b64_tr_b16 a[244:245], v1 offset:61440
v_mfma_f32_16x16x32_bf16 v[56:59], a[248:251], v[140:143], v[56:59]
ds_read_b64_tr_b16 a[246:247], v1 offset:63488
v_add_u32 v1, 0xffff0000, v1
v_mfma_f32_16x16x32_bf16 v[52:55], a[252:255], v[136:139], v[52:55]
ds_read_b64_tr_b16 a[248:249], v2 offset:61440
ds_read_b64_tr_b16 a[250:251], v2 offset:63488
v_mfma_f32_16x16x32_bf16 v[60:63], a[252:255], v[140:143], v[60:63]
v_add_u32 v2, 0xffff0000, v2
s_waitcnt lgkmcnt(6)
v_mfma_f32_16x16x32_bf16 v[32:35], a[224:227], v[144:147], v[32:35]
ds_read_b64_tr_b16 a[252:253], v3 offset:61440
v_mfma_f32_16x16x32_bf16 v[40:43], a[224:227], v[148:151], v[40:43]
ds_read_b64_tr_b16 a[254:255], v3 offset:63488
v_add_u32 v3, 0xffff0000, v3
v_mfma_f32_16x16x32_bf16 v[36:39], a[228:231], v[144:147], v[36:39]
s_barrier
v_mfma_f32_16x16x32_bf16 v[44:47], a[228:231], v[148:151], v[44:47]
ds_read_b64_tr_b16 a[224:225], v0 offset:0
ds_read_b64_tr_b16 a[226:227], v0 offset:2048
v_mfma_f32_16x16x32_bf16 v[48:51], a[232:235], v[144:147], v[48:51]
ds_read_b64_tr_b16 a[228:229], v1 offset:0
ds_read_b64_tr_b16 a[230:231], v1 offset:2048
v_mfma_f32_16x16x32_bf16 v[56:59], a[232:235], v[148:151], v[56:59]
buffer_load_dwordx4 v8, s[16:19], s35 offen offset:3072 nt lds
v_mfma_f32_16x16x32_bf16 v[52:55], a[236:239], v[144:147], v[52:55]
ds_read_b64_tr_b16 a[232:233], v2 offset:0
ds_read_b64_tr_b16 a[234:235], v2 offset:2048
v_mfma_f32_16x16x32_bf16 v[60:63], a[236:239], v[148:151], v[60:63]
s_add_u32 m0, s4, 81920
s_waitcnt lgkmcnt(6)
v_mfma_f32_16x16x32_bf16 v[32:35], a[240:243], v[152:155], v[32:35]
ds_read_b64_tr_b16 a[236:237], v3 offset:0
v_mfma_f32_16x16x32_bf16 v[40:43], a[240:243], v[156:159], v[40:43]
ds_read_b64_tr_b16 a[238:239], v3 offset:2048
s_add_u32 s5, s88, 287488
v_mfma_f32_16x16x32_bf16 v[36:39], a[244:247], v[152:155], v[36:39]
ds_read_b64_tr_b16 a[240:241], v0 offset:8192
ds_read_b64_tr_b16 a[242:243], v0 offset:10240
v_mfma_f32_16x16x32_bf16 v[44:47], a[244:247], v[156:159], v[44:47]
buffer_load_dwordx4 v9, s[24:27], s5 offen lds
v_mfma_f32_16x16x32_bf16 v[48:51], a[248:251], v[152:155], v[48:51]
ds_read_b64_tr_b16 a[244:245], v1 offset:8192
v_mfma_f32_16x16x32_bf16 v[56:59], a[248:251], v[156:159], v[56:59]
ds_read_b64_tr_b16 a[246:247], v1 offset:10240
s_add_u32 s5, s88, 293632
v_mfma_f32_16x16x32_bf16 v[52:55], a[252:255], v[152:155], v[52:55]
ds_read_b64_tr_b16 a[248:249], v2 offset:8192
v_mfma_f32_16x16x32_bf16 v[60:63], a[252:255], v[156:159], v[60:63]
ds_read_b64_tr_b16 a[250:251], v2 offset:10240
L_step_106:
s_waitcnt lgkmcnt(6)
v_mfma_f32_16x16x32_bf16 a[64:67], a[224:227], v[80:83], a[64:67]
ds_read_b64_tr_b16 a[252:253], v3 offset:8192
ds_read_b64_tr_b16 a[254:255], v3 offset:10240
v_mfma_f32_16x16x32_bf16 a[72:75], a[224:227], v[84:87], a[72:75]
buffer_load_dwordx4 v9, s[24:27], s5 offen offset:1024 lds
v_mfma_f32_16x16x32_bf16 a[68:71], a[228:231], v[80:83], a[68:71]
ds_read_b64_tr_b16 a[224:225], v0 offset:4096
ds_read_b64_tr_b16 a[226:227], v0 offset:6144
v_mfma_f32_16x16x32_bf16 a[76:79], a[228:231], v[84:87], a[76:79]
s_add_u32 m0, s4, 65536
s_mov_b32 s35, 262528
v_mfma_f32_16x16x32_bf16 a[80:83], a[232:235], v[80:83], a[80:83]
ds_read_b64_tr_b16 a[228:229], v1 offset:4096
ds_read_b64_tr_b16 a[230:231], v1 offset:6144
v_mfma_f32_16x16x32_bf16 a[88:91], a[232:235], v[84:87], a[88:91]
s_waitcnt vmcnt(5)
buffer_load_dwordx4 v8, s[16:19], s35 offen nt lds
v_mfma_f32_16x16x32_bf16 a[84:87], a[236:239], v[80:83], a[84:87]
ds_read_b64_tr_b16 a[232:233], v2 offset:4096
ds_read_b64_tr_b16 a[234:235], v2 offset:6144
v_mfma_f32_16x16x32_bf16 a[92:95], a[236:239], v[84:87], a[92:95]
s_add_u32 m0, s4, 81920
s_waitcnt lgkmcnt(6)
v_mfma_f32_16x16x32_bf16 a[96:99], a[240:243], v[80:83], a[96:99]
ds_read_b64_tr_b16 a[236:237], v3 offset:4096
ds_read_b64_tr_b16 a[238:239], v3 offset:6144
v_mfma_f32_16x16x32_bf16 a[104:107], a[240:243], v[84:87], a[104:107]
s_add_u32 s5, s88, 299776
buffer_load_dwordx4 v9, s[24:27], s5 offen offset:2048 lds
v_mfma_f32_16x16x32_bf16 a[100:103], a[244:247], v[80:83], a[100:103]
ds_read_b64_tr_b16 a[240:241], v0 offset:12288
v_mfma_f32_16x16x32_bf16 a[108:111], a[244:247], v[84:87], a[108:111]
ds_read_b64_tr_b16 a[242:243], v0 offset:14336
s_add_u32 s5, s88, 305920
v_mfma_f32_16x16x32_bf16 a[112:115], a[248:251], v[80:83], a[112:115]
ds_read_b64_tr_b16 a[244:245], v1 offset:12288
ds_read_b64_tr_b16 a[246:247], v1 offset:14336
v_mfma_f32_16x16x32_bf16 a[120:123], a[248:251], v[84:87], a[120:123]
buffer_load_dwordx4 v9, s[24:27], s5 offen offset:3072 lds
v_mfma_f32_16x16x32_bf16 a[116:119], a[252:255], v[80:83], a[116:119]
ds_read_b64_tr_b16 a[248:249], v2 offset:12288
ds_read_b64_tr_b16 a[250:251], v2 offset:14336
v_mfma_f32_16x16x32_bf16 a[124:127], a[252:255], v[84:87], a[124:127]
s_add_u32 m0, s4, 65536
s_waitcnt lgkmcnt(6)
v_mfma_f32_16x16x32_bf16 a[64:67], a[224:227], v[88:91], a[64:67]
ds_read_b64_tr_b16 a[252:253], v3 offset:12288
ds_read_b64_tr_b16 a[254:255], v3 offset:14336
v_mfma_f32_16x16x32_bf16 a[72:75], a[224:227], v[92:95], a[72:75]
buffer_load_dwordx4 v8, s[16:19], s35 offen offset:1024 nt lds
v_mfma_f32_16x16x32_bf16 a[68:71], a[228:231], v[88:91], a[68:71]
s_barrier
v_mfma_f32_16x16x32_bf16 a[76:79], a[228:231], v[92:95], a[76:79]
ds_read_b64_tr_b16 a[224:225], v0 offset:16384
ds_read_b64_tr_b16 a[226:227], v0 offset:18432
v_mfma_f32_16x16x32_bf16 a[80:83], a[232:235], v[88:91], a[80:83]
ds_read_b64_tr_b16 a[228:229], v1 offset:16384
v_mfma_f32_16x16x32_bf16 a[88:91], a[232:235], v[92:95], a[88:91]
ds_read_b64_tr_b16 a[230:231], v1 offset:18432
v_mfma_f32_16x16x32_bf16 a[84:87], a[236:239], v[88:91], a[84:87]
ds_read_b64_tr_b16 a[232:233], v2 offset:16384
v_mfma_f32_16x16x32_bf16 a[92:95], a[236:239], v[92:95], a[92:95]
ds_read_b64_tr_b16 a[234:235], v2 offset:18432
s_waitcnt lgkmcnt(6)
v_mfma_f32_16x16x32_bf16 a[96:99], a[240:243], v[88:91], a[96:99]
ds_read_b64_tr_b16 a[236:237], v3 offset:16384
v_mfma_f32_16x16x32_bf16 a[104:107], a[240:243], v[92:95], a[104:107]
ds_read_b64_tr_b16 a[238:239], v3 offset:18432
v_mfma_f32_16x16x32_bf16 a[100:103], a[244:247], v[88:91], a[100:103]
ds_read_b64_tr_b16 a[240:241], v0 offset:20480
v_mfma_f32_16x16x32_bf16 a[108:111], a[244:247], v[92:95], a[108:111]
ds_read_b64_tr_b16 a[242:243], v0 offset:22528
v_mfma_f32_16x16x32_bf16 a[112:115], a[248:251], v[88:91], a[112:115]
ds_read_b64_tr_b16 a[244:245], v1 offset:20480
v_mfma_f32_16x16x32_bf16 a[120:123], a[248:251], v[92:95], a[120:123]
ds_read_b64_tr_b16 a[246:247], v1 offset:22528
v_mfma_f32_16x16x32_bf16 a[116:119], a[252:255], v[88:91], a[116:119]
ds_read_b64_tr_b16 a[248:249], v2 offset:20480
ds_read_b64_tr_b16 a[250:251], v2 offset:22528
v_mfma_f32_16x16x32_bf16 a[124:127], a[252:255], v[92:95], a[124:127]
s_waitcnt vmcnt(7)
L_step_107:
s_waitcnt lgkmcnt(6)
v_mfma_f32_16x16x32_bf16 v[32:35], a[224:227], v[160:163], v[32:35]
ds_read_b64_tr_b16 a[252:253], v3 offset:20480
ds_read_b64_tr_b16 a[254:255], v3 offset:22528
v_mfma_f32_16x16x32_bf16 v[40:43], a[224:227], v[164:167], v[40:43]
buffer_load_dwordx4 v8, s[16:19], s35 offen offset:2048 nt lds
v_mfma_f32_16x16x32_bf16 v[36:39], a[228:231], v[160:163], v[36:39]
ds_read_b64_tr_b16 a[224:225], v0 offset:24576
v_mfma_f32_16x16x32_bf16 v[44:47], a[228:231], v[164:167], v[44:47]
ds_read_b64_tr_b16 a[226:227], v0 offset:26624
v_mfma_f32_16x16x32_bf16 v[48:51], a[232:235], v[160:163], v[48:51]
ds_read_b64_tr_b16 a[228:229], v1 offset:24576
v_mfma_f32_16x16x32_bf16 v[56:59], a[232:235], v[164:167], v[56:59]
ds_read_b64_tr_b16 a[230:231], v1 offset:26624
v_mfma_f32_16x16x32_bf16 v[52:55], a[236:239], v[160:163], v[52:55]
ds_read_b64_tr_b16 a[232:233], v2 offset:24576
v_mfma_f32_16x16x32_bf16 v[60:63], a[236:239], v[164:167], v[60:63]
ds_read_b64_tr_b16 a[234:235], v2 offset:26624
s_waitcnt lgkmcnt(6)
v_mfma_f32_16x16x32_bf16 v[32:35], a[240:243], v[168:171], v[32:35]
ds_read_b64_tr_b16 a[236:237], v3 offset:24576
v_mfma_f32_16x16x32_bf16 v[40:43], a[240:243], v[172:175], v[40:43]
ds_read_b64_tr_b16 a[238:239], v3 offset:26624
v_mfma_f32_16x16x32_bf16 v[36:39], a[244:247], v[168:171], v[36:39]
ds_read_b64_tr_b16 a[240:241], v0 offset:28672
v_mfma_f32_16x16x32_bf16 v[44:47], a[244:247], v[172:175], v[44:47]
ds_read_b64_tr_b16 a[242:243], v0 offset:30720
v_mfma_f32_16x16x32_bf16 v[48:51], a[248:251], v[168:171], v[48:51]
ds_read_b64_tr_b16 a[244:245], v1 offset:28672
ds_read_b64_tr_b16 a[246:247], v1 offset:30720
v_mfma_f32_16x16x32_bf16 v[56:59], a[248:251], v[172:175], v[56:59]
buffer_load_dwordx4 v8, s[16:19], s35 offen offset:3072 nt lds
v_mfma_f32_16x16x32_bf16 v[52:55], a[252:255], v[168:171], v[52:55]
ds_read_b64_tr_b16 a[248:249], v2 offset:28672
ds_read_b64_tr_b16 a[250:251], v2 offset:30720
v_mfma_f32_16x16x32_bf16 v[60:63], a[252:255], v[172:175], v[60:63]
s_add_u32 m0, s4, 114688
s_waitcnt lgkmcnt(6)
v_mfma_f32_16x16x32_bf16 v[32:35], a[224:227], v[176:179], v[32:35]
ds_read_b64_tr_b16 a[252:253], v3 offset:28672
v_mfma_f32_16x16x32_bf16 v[40:43], a[224:227], v[180:183], v[40:43]
ds_read_b64_tr_b16 a[254:255], v3 offset:30720
s_mov_b32 s5, 344064
v_mfma_f32_16x16x32_bf16 v[36:39], a[228:231], v[176:179], v[36:39]
s_barrier
v_mfma_f32_16x16x32_bf16 v[44:47], a[228:231], v[180:183], v[44:47]
ds_read_b64_tr_b16 a[224:225], v0 offset:49152
ds_read_b64_tr_b16 a[226:227], v0 offset:51200
v_mfma_f32_16x16x32_bf16 v[48:51], a[232:235], v[176:179], v[48:51]
ds_read_b64_tr_b16 a[228:229], v1 offset:49152
ds_read_b64_tr_b16 a[230:231], v1 offset:51200
v_mfma_f32_16x16x32_bf16 v[56:59], a[232:235], v[180:183], v[56:59]
buffer_load_dwordx4 v9, s[24:27], s5 offen lds
v_mfma_f32_16x16x32_bf16 v[52:55], a[236:239], v[176:179], v[52:55]
ds_read_b64_tr_b16 a[232:233], v2 offset:49152
ds_read_b64_tr_b16 a[234:235], v2 offset:51200
v_mfma_f32_16x16x32_bf16 v[60:63], a[236:239], v[180:183], v[60:63]
s_add_u32 m0, s4, 0
s_waitcnt lgkmcnt(6)
v_mfma_f32_16x16x32_bf16 v[32:35], a[240:243], v[184:187], v[32:35]
ds_read_b64_tr_b16 a[236:237], v3 offset:49152
v_mfma_f32_16x16x32_bf16 v[40:43], a[240:243], v[188:191], v[40:43]
L_pg20:
s_cbranch_scc1 L_rt0
ds_read_b64_tr_b16 a[238:239], v3 offset:51200
s_mov_b32 s35, 328064
v_mfma_f32_16x16x32_bf16 v[36:39], a[244:247], v[184:187], v[36:39]
ds_read_b64_tr_b16 a[240:241], v0 offset:57344
ds_read_b64_tr_b16 a[242:243], v0 offset:59392
v_mfma_f32_16x16x32_bf16 v[44:47], a[244:247], v[188:191], v[44:47]
buffer_load_dwordx4 v8, s[16:19], s35 offen nt lds
v_mfma_f32_16x16x32_bf16 v[48:51], a[248:251], v[184:187], v[48:51]
ds_read_b64_tr_b16 a[244:245], v1 offset:57344
ds_read_b64_tr_b16 a[246:247], v1 offset:59392
v_mfma_f32_16x16x32_bf16 v[56:59], a[248:251], v[188:191], v[56:59]
s_add_u32 m0, s4, 114688
s_mov_b32 s5, 350208
v_mfma_f32_16x16x32_bf16 v[52:55], a[252:255], v[184:187], v[52:55]
ds_read_b64_tr_b16 a[248:249], v2 offset:57344
v_mfma_f32_16x16x32_bf16 v[60:63], a[252:255], v[188:191], v[60:63]
ds_read_b64_tr_b16 a[250:251], v2 offset:59392
L_step_108:
s_waitcnt lgkmcnt(6)
v_mfma_f32_16x16x32_bf16 a[128:131], a[224:227], v[80:83], a[128:131]
ds_read_b64_tr_b16 a[252:253], v3 offset:57344
ds_read_b64_tr_b16 a[254:255], v3 offset:59392
v_mfma_f32_16x16x32_bf16 a[136:139], a[224:227], v[84:87], a[136:139]
buffer_load_dwordx4 v9, s[24:27], s5 offen offset:1024 lds
v_mfma_f32_16x16x32_bf16 a[132:135], a[228:231], v[80:83], a[132:135]
ds_read_b64_tr_b16 a[224:225], v0 offset:53248
v_mfma_f32_16x16x32_bf16 a[140:143], a[228:231], v[84:87], a[140:143]
ds_read_b64_tr_b16 a[226:227], v0 offset:55296
s_mov_b32 s5, 356352
v_mfma_f32_16x16x32_bf16 a[144:147], a[232:235], v[80:83], a[144:147]
ds_read_b64_tr_b16 a[228:229], v1 offset:53248
ds_read_b64_tr_b16 a[230:231], v1 offset:55296
v_mfma_f32_16x16x32_bf16 a[152:155], a[232:235], v[84:87], a[152:155]
buffer_load_dwordx4 v9, s[24:27], s5 offen offset:2048 lds
v_mfma_f32_16x16x32_bf16 a[148:151], a[236:239], v[80:83], a[148:151]
ds_read_b64_tr_b16 a[232:233], v2 offset:53248
ds_read_b64_tr_b16 a[234:235], v2 offset:55296
v_mfma_f32_16x16x32_bf16 a[156:159], a[236:239], v[84:87], a[156:159]
s_add_u32 m0, s4, 0
s_waitcnt lgkmcnt(6)
v_mfma_f32_16x16x32_bf16 a[160:163], a[240:243], v[80:83], a[160:163]
ds_read_b64_tr_b16 a[236:237], v3 offset:53248
ds_read_b64_tr_b16 a[238:239], v3 offset:55296
v_mfma_f32_16x16x32_bf16 a[168:171], a[240:243], v[84:87], a[168:171]
buffer_load_dwordx4 v8, s[16:19], s35 offen offset:1024 nt lds
v_mfma_f32_16x16x32_bf16 a[164:167], a[244:247], v[80:83], a[164:167]
ds_read_b64_tr_b16 a[240:241], v0 offset:61440
ds_read_b64_tr_b16 a[242:243], v0 offset:63488
v_mfma_f32_16x16x32_bf16 a[172:175], a[244:247], v[84:87], a[172:175]
s_add_u32 m0, s4, 114688
s_mov_b32 s5, 362496
v_mfma_f32_16x16x32_bf16 a[176:179], a[248:251], v[80:83], a[176:179]
ds_read_b64_tr_b16 a[244:245], v1 offset:61440
ds_read_b64_tr_b16 a[246:247], v1 offset:63488
v_mfma_f32_16x16x32_bf16 a[184:187], a[248:251], v[84:87], a[184:187]
buffer_load_dwordx4 v9, s[24:27], s5 offen offset:3072 lds
v_mfma_f32_16x16x32_bf16 a[180:183], a[252:255], v[80:83], a[180:183]
ds_read_b64_tr_b16 a[248:249], v2 offset:61440
ds_read_b64_tr_b16 a[250:251], v2 offset:63488
v_mfma_f32_16x16x32_bf16 a[188:191], a[252:255], v[84:87], a[188:191]
s_add_u32 m0, s4, 0
s_waitcnt lgkmcnt(6)
v_mfma_f32_16x16x32_bf16 a[128:131], a[224:227], v[88:91], a[128:131]
ds_read_b64_tr_b16 a[252:253], v3 offset:61440
v_mfma_f32_16x16x32_bf16 a[136:139], a[224:227], v[92:95], a[136:139]
ds_read_b64_tr_b16 a[254:255], v3 offset:63488
v_mfma_f32_16x16x32_bf16 a[132:135], a[228:231], v[88:91], a[132:135]
s_barrier
v_mfma_f32_16x16x32_bf16 a[140:143], a[228:231], v[92:95], a[140:143]
ds_read_b64_tr_b16 a[224:225], v0 offset:32768
ds_read_b64_tr_b16 a[226:227], v0 offset:34816
v_mfma_f32_16x16x32_bf16 a[144:147], a[232:235], v[88:91], a[144:147]
ds_read_b64_tr_b16 a[228:229], v1 offset:32768
ds_read_b64_tr_b16 a[230:231], v1 offset:34816
v_mfma_f32_16x16x32_bf16 a[152:155], a[232:235], v[92:95], a[152:155]
buffer_load_dwordx4 v8, s[16:19], s35 offen offset:2048 nt lds
v_mfma_f32_16x16x32_bf16 a[148:151], a[236:239], v[88:91], a[148:151]
ds_read_b64_tr_b16 a[232:233], v2 offset:32768
v_mfma_f32_16x16x32_bf16 a[156:159], a[236:239], v[92:95], a[156:159]
ds_read_b64_tr_b16 a[234:235], v2 offset:34816
s_waitcnt lgkmcnt(6)
v_mfma_f32_16x16x32_bf16 a[160:163], a[240:243], v[88:91], a[160:163]
ds_read_b64_tr_b16 a[236:237], v3 offset:32768
v_mfma_f32_16x16x32_bf16 a[168:171], a[240:243], v[92:95], a[168:171]
ds_read_b64_tr_b16 a[238:239], v3 offset:34816
v_mfma_f32_16x16x32_bf16 a[164:167], a[244:247], v[88:91], a[164:167]
ds_read_b64_tr_b16 a[240:241], v0 offset:36864
v_mfma_f32_16x16x32_bf16 a[172:175], a[244:247], v[92:95], a[172:175]
ds_read_b64_tr_b16 a[242:243], v0 offset:38912
v_mfma_f32_16x16x32_bf16 a[176:179], a[248:251], v[88:91], a[176:179]
ds_read_b64_tr_b16 a[244:245], v1 offset:36864
v_mfma_f32_16x16x32_bf16 a[184:187], a[248:251], v[92:95], a[184:187]
ds_read_b64_tr_b16 a[246:247], v1 offset:38912
v_mfma_f32_16x16x32_bf16 a[180:183], a[252:255], v[88:91], a[180:183]
ds_read_b64_tr_b16 a[248:249], v2 offset:36864
v_mfma_f32_16x16x32_bf16 a[188:191], a[252:255], v[92:95], a[188:191]
ds_read_b64_tr_b16 a[250:251], v2 offset:38912
L_step_109:
s_waitcnt lgkmcnt(6)
v_mfma_f32_16x16x32_bf16 v[32:35], a[224:227], v[192:195], v[32:35]
ds_read_b64_tr_b16 a[252:253], v3 offset:36864
v_mfma_f32_16x16x32_bf16 v[40:43], a[224:227], v[196:199], v[40:43]
ds_read_b64_tr_b16 a[254:255], v3 offset:38912
v_mfma_f32_16x16x32_bf16 v[36:39], a[228:231], v[192:195], v[36:39]
ds_read_b64_tr_b16 a[224:225], v0 offset:40960
ds_read_b64_tr_b16 a[226:227], v0 offset:43008
v_mfma_f32_16x16x32_bf16 v[44:47], a[228:231], v[196:199], v[44:47]
buffer_load_dwordx4 v8, s[16:19], s35 offen offset:3072 nt lds
v_mfma_f32_16x16x32_bf16 v[48:51], a[232:235], v[192:195], v[48:51]
ds_read_b64_tr_b16 a[228:229], v1 offset:40960
v_mfma_f32_16x16x32_bf16 v[56:59], a[232:235], v[196:199], v[56:59]
ds_read_b64_tr_b16 a[230:231], v1 offset:43008
v_mfma_f32_16x16x32_bf16 v[52:55], a[236:239], v[192:195], v[52:55]
ds_read_b64_tr_b16 a[232:233], v2 offset:40960
v_mfma_f32_16x16x32_bf16 v[60:63], a[236:239], v[196:199], v[60:63]
ds_read_b64_tr_b16 a[234:235], v2 offset:43008
s_waitcnt lgkmcnt(6)
v_mfma_f32_16x16x32_bf16 v[32:35], a[240:243], v[200:203], v[32:35]
ds_read_b64_tr_b16 a[236:237], v3 offset:40960
v_mfma_f32_16x16x32_bf16 v[40:43], a[240:243], v[204:207], v[40:43]
ds_read_b64_tr_b16 a[238:239], v3 offset:43008
v_mfma_f32_16x16x32_bf16 v[36:39], a[244:247], v[200:203], v[36:39]
ds_read_b64_tr_b16 a[240:241], v0 offset:45056
ds_read_b64_tr_b16 a[242:243], v0 offset:47104
v_mfma_f32_16x16x32_bf16 v[44:47], a[244:247], v[204:207], v[44:47]
v_add_u32 v0, 0x10000, v0
s_add_u32 m0, s4, 131072
v_mfma_f32_16x16x32_bf16 v[48:51], a[248:251], v[200:203], v[48:51]
ds_read_b64_tr_b16 a[244:245], v1 offset:45056
ds_read_b64_tr_b16 a[246:247], v1 offset:47104
v_mfma_f32_16x16x32_bf16 v[56:59], a[248:251], v[204:207], v[56:59]
v_add_u32 v1, 0x10000, v1
s_mov_b32 s35, 393600
v_mfma_f32_16x16x32_bf16 v[52:55], a[252:255], v[200:203], v[52:55]
ds_read_b64_tr_b16 a[248:249], v2 offset:45056
ds_read_b64_tr_b16 a[250:251], v2 offset:47104
v_mfma_f32_16x16x32_bf16 v[60:63], a[252:255], v[204:207], v[60:63]
v_add_u32 v2, 0x10000, v2
s_waitcnt lgkmcnt(6)
v_mfma_f32_16x16x32_bf16 v[32:35], a[224:227], v[208:211], v[32:35]
ds_read_b64_tr_b16 a[252:253], v3 offset:45056
v_mfma_f32_16x16x32_bf16 v[40:43], a[224:227], v[212:215], v[40:43]
ds_read_b64_tr_b16 a[254:255], v3 offset:47104
v_add_u32 v3, 0x10000, v3
v_mfma_f32_16x16x32_bf16 v[36:39], a[228:231], v[208:211], v[36:39]
s_waitcnt vmcnt(11)
s_barrier
v_mfma_f32_16x16x32_bf16 v[44:47], a[228:231], v[212:215], v[44:47]
ds_read_b64_tr_b16 a[224:225], v0 offset:16384
ds_read_b64_tr_b16 a[226:227], v0 offset:18432
v_mfma_f32_16x16x32_bf16 v[48:51], a[232:235], v[208:211], v[48:51]
ds_read_b64_tr_b16 a[228:229], v1 offset:16384
ds_read_b64_tr_b16 a[230:231], v1 offset:18432
v_mfma_f32_16x16x32_bf16 v[56:59], a[232:235], v[212:215], v[56:59]
buffer_load_dwordx4 v8, s[16:19], s35 offen nt lds
v_mfma_f32_16x16x32_bf16 v[52:55], a[236:239], v[208:211], v[52:55]
ds_read_b64_tr_b16 a[232:233], v2 offset:16384
v_mfma_f32_16x16x32_bf16 v[60:63], a[236:239], v[212:215], v[60:63]
ds_read_b64_tr_b16 a[234:235], v2 offset:18432
s_waitcnt lgkmcnt(6)
v_mfma_f32_16x16x32_bf16 v[32:35], a[240:243], v[216:219], v[32:35]
ds_read_b64_tr_b16 a[236:237], v3 offset:16384
v_mfma_f32_16x16x32_bf16 v[40:43], a[240:243], v[220:223], v[40:43]
ds_read_b64_tr_b16 a[238:239], v3 offset:18432
v_mfma_f32_16x16x32_bf16 v[36:39], a[244:247], v[216:219], v[36:39]
ds_read_b64_tr_b16 a[240:241], v0 offset:20480
v_mfma_f32_16x16x32_bf16 v[44:47], a[244:247], v[220:223], v[44:47]
ds_read_b64_tr_b16 a[242:243], v0 offset:22528
v_mfma_f32_16x16x32_bf16 v[48:51], a[248:251], v[216:219], v[48:51]
ds_read_b64_tr_b16 a[244:245], v1 offset:20480
v_mfma_f32_16x16x32_bf16 v[56:59], a[248:251], v[220:223], v[56:59]
ds_read_b64_tr_b16 a[246:247], v1 offset:22528
v_mfma_f32_16x16x32_bf16 v[52:55], a[252:255], v[216:219], v[52:55]
ds_read_b64_tr_b16 a[248:249], v2 offset:20480
v_mfma_f32_16x16x32_bf16 v[60:63], a[252:255], v[220:223], v[60:63]
ds_read_b64_tr_b16 a[250:251], v2 offset:22528
L_step_110:
s_waitcnt lgkmcnt(6)
v_mfma_f32_16x16x32_bf16 a[192:195], a[224:227], v[80:83], a[192:195]
ds_read_b64_tr_b16 a[252:253], v3 offset:20480
ds_read_b64_tr_b16 a[254:255], v3 offset:22528
v_mfma_f32_16x16x32_bf16 a[200:203], a[224:227], v[84:87], a[200:203]
buffer_load_dwordx4 v8, s[16:19], s35 offen offset:1024 nt lds
v_mfma_f32_16x16x32_bf16 a[196:199], a[228:231], v[80:83], a[196:199]
s_barrier
ds_read_b64_tr_b16 a[224:225], v0 offset:32768
v_mfma_f32_16x16x32_bf16 a[204:207], a[228:231], v[84:87], a[204:207]
ds_read_b64_tr_b16 a[226:227], v0 offset:34816
s_add_u32 m0, s4, 32768
v_mfma_f32_16x16x32_bf16 a[208:211], a[232:235], v[80:83], a[208:211]
ds_read_b64_tr_b16 a[228:229], v1 offset:32768
v_mfma_f32_16x16x32_bf16 a[216:219], a[232:235], v[84:87], a[216:219]
ds_read_b64_tr_b16 a[230:231], v1 offset:34816
s_mov_b32 s5, 344320
v_mfma_f32_16x16x32_bf16 a[212:215], a[236:239], v[80:83], a[212:215]
ds_read_b64_tr_b16 a[232:233], v0 offset:36864
v_mfma_f32_16x16x32_bf16 a[220:223], a[236:239], v[84:87], a[220:223]
ds_read_b64_tr_b16 a[234:235], v0 offset:38912
s_waitcnt lgkmcnt(6)
v_mfma_f32_16x16x32_bf16 a[192:195], a[240:243], v[88:91], a[192:195]
ds_read_b64_tr_b16 a[236:237], v1 offset:36864
ds_read_b64_tr_b16 a[238:239], v1 offset:38912
v_mfma_f32_16x16x32_bf16 a[200:203], a[240:243], v[92:95], a[200:203]
buffer_load_dwordx4 v9, s[24:27], s5 offen lds
v_mfma_f32_16x16x32_bf16 a[196:199], a[244:247], v[88:91], a[196:199]
ds_read_b64_tr_b16 a[240:241], v0 offset:40960
v_mfma_f32_16x16x32_bf16 a[204:207], a[244:247], v[92:95], a[204:207]
ds_read_b64_tr_b16 a[242:243], v0 offset:43008
s_add_u32 m0, s4, 131072
v_mfma_f32_16x16x32_bf16 a[208:211], a[248:251], v[88:91], a[208:211]
ds_read_b64_tr_b16 a[244:245], v1 offset:40960
ds_read_b64_tr_b16 a[246:247], v1 offset:43008
v_mfma_f32_16x16x32_bf16 a[216:219], a[248:251], v[92:95], a[216:219]
buffer_load_dwordx4 v8, s[16:19], s35 offen offset:2048 nt lds
v_mfma_f32_16x16x32_bf16 a[212:215], a[252:255], v[88:91], a[212:215]
ds_read_b64_tr_b16 a[248:249], v0 offset:45056
ds_read_b64_tr_b16 a[250:251], v0 offset:47104
v_mfma_f32_16x16x32_bf16 a[220:223], a[252:255], v[92:95], a[220:223]
s_add_u32 m0, s4, 32768
L_step_111:
s_waitcnt lgkmcnt(6)
v_mfma_f32_16x16x32_bf16 v[32:35], a[224:227], v[224:227], v[32:35]
ds_read_b64_tr_b16 a[252:253], v1 offset:45056
ds_read_b64_tr_b16 a[254:255], v1 offset:47104
v_mfma_f32_16x16x32_bf16 v[40:43], a[224:227], v[228:231], v[40:43]
s_mov_b32 s5, 350464
buffer_load_dwordx4 v9, s[24:27], s5 offen offset:1024 lds
v_mfma_f32_16x16x32_bf16 v[36:39], a[228:231], v[224:227], v[36:39]
ds_read_b64_tr_b16 a[224:225], v2 offset:32768
v_mfma_f32_16x16x32_bf16 v[44:47], a[228:231], v[228:231], v[44:47]
ds_read_b64_tr_b16 a[226:227], v2 offset:34816
s_mov_b32 s5, 356608
v_mfma_f32_16x16x32_bf16 v[32:35], a[232:235], v[232:235], v[32:35]
ds_read_b64_tr_b16 a[228:229], v3 offset:32768
ds_read_b64_tr_b16 a[230:231], v3 offset:34816
v_mfma_f32_16x16x32_bf16 v[40:43], a[232:235], v[236:239], v[40:43]
buffer_load_dwordx4 v9, s[24:27], s5 offen offset:2048 lds
v_mfma_f32_16x16x32_bf16 v[36:39], a[236:239], v[232:235], v[36:39]
ds_read_b64_tr_b16 a[232:233], v2 offset:36864
ds_read_b64_tr_b16 a[234:235], v2 offset:38912
v_mfma_f32_16x16x32_bf16 v[44:47], a[236:239], v[236:239], v[44:47]
s_add_u32 m0, s4, 131072
s_waitcnt lgkmcnt(6)
v_mfma_f32_16x16x32_bf16 v[32:35], a[240:243], v[240:243], v[32:35]
ds_read_b64_tr_b16 a[236:237], v3 offset:36864
ds_read_b64_tr_b16 a[238:239], v3 offset:38912
v_mfma_f32_16x16x32_bf16 v[40:43], a[240:243], v[244:247], v[40:43]
buffer_load_dwordx4 v8, s[16:19], s35 offen offset:3072 nt lds
v_mfma_f32_16x16x32_bf16 v[36:39], a[244:247], v[240:243], v[36:39]
ds_read_b64_tr_b16 a[240:241], v2 offset:40960
ds_read_b64_tr_b16 a[242:243], v2 offset:43008
v_mfma_f32_16x16x32_bf16 v[44:47], a[244:247], v[244:247], v[44:47]
s_add_u32 m0, s4, 32768
s_mov_b32 s5, 362752
v_mfma_f32_16x16x32_bf16 v[32:35], a[248:251], v[248:251], v[32:35]
ds_read_b64_tr_b16 a[244:245], v3 offset:40960
ds_read_b64_tr_b16 a[246:247], v3 offset:43008
v_mfma_f32_16x16x32_bf16 v[40:43], a[248:251], v[252:255], v[40:43]
buffer_load_dwordx4 v9, s[24:27], s5 offen offset:3072 lds
v_mfma_f32_16x16x32_bf16 v[36:39], a[252:255], v[248:251], v[36:39]
ds_read_b64_tr_b16 a[248:249], v2 offset:45056
v_mfma_f32_16x16x32_bf16 v[44:47], a[252:255], v[252:255], v[44:47]
ds_read_b64_tr_b16 a[250:251], v2 offset:47104
s_waitcnt lgkmcnt(6)
v_mfma_f32_16x16x32_bf16 v[48:51], a[224:227], v[224:227], v[48:51]
ds_read_b64_tr_b16 a[252:253], v3 offset:45056
ds_read_b64_tr_b16 a[254:255], v3 offset:47104
v_mfma_f32_16x16x32_bf16 v[56:59], a[224:227], v[228:231], v[56:59]
s_add_u32 m0, s4, 81920
s_mov_b32 s35, 459136
v_mfma_f32_16x16x32_bf16 v[52:55], a[228:231], v[224:227], v[52:55]
s_waitcnt vmcnt(10)
s_barrier
ds_read_b64_tr_b16 a[224:225], v0 offset:49152
v_mfma_f32_16x16x32_bf16 v[60:63], a[228:231], v[228:231], v[60:63]
ds_read_b64_tr_b16 a[226:227], v0 offset:51200
v_mul_f32 v32, v32, v14
v_mul_f32 v33, v33, v14
v_mfma_f32_16x16x32_bf16 v[48:51], a[232:235], v[232:235], v[48:51]
ds_read_b64_tr_b16 a[228:229], v1 offset:49152
ds_read_b64_tr_b16 a[230:231], v1 offset:51200
v_mul_f32 v34, v34, v14
v_mfma_f32_16x16x32_bf16 v[56:59], a[232:235], v[236:239], v[56:59]
v_mul_f32 v35, v35, v14
v_cvt_pk_bf16_f32 v96, v32, v33
v_mul_f32 v36, v36, v14
v_mfma_f32_16x16x32_bf16 v[52:55], a[236:239], v[232:235], v[52:55]
ds_read_b64_tr_b16 a[232:233], v2 offset:49152
ds_read_b64_tr_b16 a[234:235], v2 offset:51200
v_mfma_f32_16x16x32_bf16 v[60:63], a[236:239], v[236:239], v[60:63]
buffer_load_dwordx4 v8, s[16:19], s35 offen nt lds
v_mul_f32 v37, v37, v14
s_waitcnt lgkmcnt(6)
v_mfma_f32_16x16x32_bf16 v[48:51], a[240:243], v[240:243], v[48:51]
ds_read_b64_tr_b16 a[236:237], v3 offset:49152
ds_read_b64_tr_b16 a[238:239], v3 offset:51200
v_cvt_pk_bf16_f32 v97, v34, v35
v_mfma_f32_16x16x32_bf16 v[56:59], a[240:243], v[244:247], v[56:59]
v_mul_f32 v38, v38, v14
v_mul_f32 v39, v39, v14
v_cvt_pk_bf16_f32 v98, v36, v37
v_mfma_f32_16x16x32_bf16 v[52:55], a[244:247], v[240:243], v[52:55]
ds_read_b64_tr_b16 a[240:241], v0 offset:57344
ds_read_b64_tr_b16 a[242:243], v0 offset:59392
v_cvt_pk_bf16_f32 v99, v38, v39
v_mfma_f32_16x16x32_bf16 v[60:63], a[244:247], v[244:247], v[60:63]
v_mul_f32 v40, v40, v15
v_mul_f32 v41, v41, v15
v_mul_f32 v42, v42, v15
v_mul_f32 v43, v43, v15
v_mfma_f32_16x16x32_bf16 v[48:51], a[248:251], v[248:251], v[48:51]
ds_read_b64_tr_b16 a[244:245], v1 offset:57344
ds_read_b64_tr_b16 a[246:247], v1 offset:59392
v_cvt_pk_bf16_f32 v100, v40, v41
v_mfma_f32_16x16x32_bf16 v[56:59], a[248:251], v[252:255], v[56:59]
v_mul_f32 v44, v44, v15
v_mul_f32 v45, v45, v15
v_cvt_pk_bf16_f32 v101, v42, v43
v_mfma_f32_16x16x32_bf16 v[52:55], a[252:255], v[248:251], v[52:55]
ds_read_b64_tr_b16 a[248:249], v2 offset:57344
ds_read_b64_tr_b16 a[250:251], v2 offset:59392
v_mul_f32 v46, v46, v15
v_mfma_f32_16x16x32_bf16 v[60:63], a[252:255], v[252:255], v[60:63]
v_mul_f32 v47, v47, v15
v_cvt_pk_bf16_f32 v102, v44, v45
v_cvt_pk_bf16_f32 v103, v46, v47
L_step_112:
s_waitcnt lgkmcnt(6)
v_mfma_f32_16x16x32_bf16 a[0:3], a[224:227], v[96:99], a[0:3]
ds_read_b64_tr_b16 a[252:253], v3 offset:57344
v_mfma_f32_16x16x32_bf16 a[8:11], a[224:227], v[100:103], a[8:11]
ds_read_b64_tr_b16 a[254:255], v3 offset:59392
v_mfma_f32_16x16x32_bf16 a[4:7], a[228:231], v[96:99], a[4:7]
ds_read_b64_tr_b16 a[224:225], v0 offset:53248
ds_read_b64_tr_b16 a[226:227], v0 offset:55296
v_mul_f32 v48, v48, v14
v_mfma_f32_16x16x32_bf16 a[12:15], a[228:231], v[100:103], a[12:15]
v_mul_f32 v49, v49, v14
v_mul_f32 v50, v50, v14
v_mul_f32 v51, v51, v14
v_mfma_f32_16x16x32_bf16 a[16:19], a[232:235], v[96:99], a[16:19]
ds_read_b64_tr_b16 a[228:229], v1 offset:53248
ds_read_b64_tr_b16 a[230:231], v1 offset:55296
v_mfma_f32_16x16x32_bf16 a[24:27], a[232:235], v[100:103], a[24:27]
buffer_load_dwordx4 v8, s[16:19], s35 offen offset:1024 nt lds
v_cvt_pk_bf16_f32 v104, v48, v49
v_mul_f32 v52, v52, v14
v_mfma_f32_16x16x32_bf16 a[20:23], a[236:239], v[96:99], a[20:23]
ds_read_b64_tr_b16 a[232:233], v2 offset:53248
ds_read_b64_tr_b16 a[234:235], v2 offset:55296
v_mul_f32 v53, v53, v14
v_mfma_f32_16x16x32_bf16 a[28:31], a[236:239], v[100:103], a[28:31]
v_cvt_pk_bf16_f32 v105, v50, v51
v_mul_f32 v54, v54, v14
s_waitcnt lgkmcnt(6)
v_mfma_f32_16x16x32_bf16 a[32:35], a[240:243], v[96:99], a[32:35]
ds_read_b64_tr_b16 a[236:237], v3 offset:53248
ds_read_b64_tr_b16 a[238:239], v3 offset:55296
v_mul_f32 v55, v55, v14
v_mfma_f32_16x16x32_bf16 a[40:43], a[240:243], v[100:103], a[40:43]
v_cvt_pk_bf16_f32 v106, v52, v53
v_cvt_pk_bf16_f32 v107, v54, v55
v_mul_f32 v56, v56, v15
v_mfma_f32_16x16x32_bf16 a[36:39], a[244:247], v[96:99], a[36:39]
ds_read_b64_tr_b16 a[240:241], v0 offset:61440
ds_read_b64_tr_b16 a[242:243], v0 offset:63488
v_mul_f32 v57, v57, v15
v_mfma_f32_16x16x32_bf16 a[44:47], a[244:247], v[100:103], a[44:47]
v_mul_f32 v58, v58, v15
v_mul_f32 v59, v59, v15
v_cvt_pk_bf16_f32 v108, v56, v57
v_mfma_f32_16x16x32_bf16 a[48:51], a[248:251], v[96:99], a[48:51]
ds_read_b64_tr_b16 a[244:245], v1 offset:61440
ds_read_b64_tr_b16 a[246:247], v1 offset:63488
v_mul_f32 v60, v60, v15
v_mfma_f32_16x16x32_bf16 a[56:59], a[248:251], v[100:103], a[56:59]
v_mul_f32 v61, v61, v15
v_cvt_pk_bf16_f32 v109, v58, v59
v_mul_f32 v62, v62, v15
v_mfma_f32_16x16x32_bf16 a[52:55], a[252:255], v[96:99], a[52:55]
ds_read_b64_tr_b16 a[248:249], v2 offset:61440
ds_read_b64_tr_b16 a[250:251], v2 offset:63488
v_mul_f32 v63, v63, v15
v_mfma_f32_16x16x32_bf16 a[60:63], a[252:255], v[100:103], a[60:63]
v_cvt_pk_bf16_f32 v110, v60, v61
v_cvt_pk_bf16_f32 v111, v62, v63
s_waitcnt lgkmcnt(6)
v_mfma_f32_16x16x32_bf16 a[0:3], a[224:227], v[104:107], a[0:3]
ds_read_b64_tr_b16 a[252:253], v3 offset:61440
v_mfma_f32_16x16x32_bf16 a[8:11], a[224:227], v[108:111], a[8:11]
ds_read_b64_tr_b16 a[254:255], v3 offset:63488
v_mfma_f32_16x16x32_bf16 a[4:7], a[228:231], v[104:107], a[4:7]
s_barrier
v_mfma_f32_16x16x32_bf16 a[12:15], a[228:231], v[108:111], a[12:15]
ds_read_b64_tr_b16 a[224:225], v0 offset:0
ds_read_b64_tr_b16 a[226:227], v0 offset:2048
v_mfma_f32_16x16x32_bf16 a[16:19], a[232:235], v[104:107], a[16:19]
ds_read_b64_tr_b16 a[228:229], v1 offset:0
ds_read_b64_tr_b16 a[230:231], v1 offset:2048
v_mfma_f32_16x16x32_bf16 a[24:27], a[232:235], v[108:111], a[24:27]
buffer_load_dwordx4 v8, s[16:19], s35 offen offset:2048 nt lds
v_mfma_f32_16x16x32_bf16 a[20:23], a[236:239], v[104:107], a[20:23]
ds_read_b64_tr_b16 a[232:233], v2 offset:0
ds_read_b64_tr_b16 a[234:235], v2 offset:2048
v_mfma_f32_16x16x32_bf16 a[28:31], a[236:239], v[108:111], a[28:31]
s_add_u32 m0, s4, 98304
s_waitcnt lgkmcnt(6)
v_mfma_f32_16x16x32_bf16 a[32:35], a[240:243], v[104:107], a[32:35]
ds_read_b64_tr_b16 a[236:237], v3 offset:0
v_mfma_f32_16x16x32_bf16 a[40:43], a[240:243], v[108:111], a[40:43]
ds_read_b64_tr_b16 a[238:239], v3 offset:2048
s_mov_b32 s5, 401408
v_mfma_f32_16x16x32_bf16 a[36:39], a[244:247], v[104:107], a[36:39]
ds_read_b64_tr_b16 a[240:241], v0 offset:4096
ds_read_b64_tr_b16 a[242:243], v0 offset:6144
v_mfma_f32_16x16x32_bf16 a[44:47], a[244:247], v[108:111], a[44:47]
buffer_load_dwordx4 v9, s[24:27], s5 offen lds
v_mfma_f32_16x16x32_bf16 a[48:51], a[248:251], v[104:107], a[48:51]
ds_read_b64_tr_b16 a[244:245], v1 offset:4096
v_mfma_f32_16x16x32_bf16 a[56:59], a[248:251], v[108:111], a[56:59]
ds_read_b64_tr_b16 a[246:247], v1 offset:6144
s_mov_b32 s5, 407552
v_mfma_f32_16x16x32_bf16 a[52:55], a[252:255], v[104:107], a[52:55]
ds_read_b64_tr_b16 a[248:249], v2 offset:4096
v_mfma_f32_16x16x32_bf16 a[60:63], a[252:255], v[108:111], a[60:63]
ds_read_b64_tr_b16 a[250:251], v2 offset:6144
L_step_113:
s_waitcnt lgkmcnt(6)
v_mfma_f32_16x16x32_bf16 v[32:35], a[224:227], v[128:131], 0
ds_read_b64_tr_b16 a[252:253], v3 offset:4096
ds_read_b64_tr_b16 a[254:255], v3 offset:6144
v_mfma_f32_16x16x32_bf16 v[40:43], a[224:227], v[132:135], 0
buffer_load_dwordx4 v9, s[24:27], s5 offen offset:1024 lds
v_mfma_f32_16x16x32_bf16 v[36:39], a[228:231], v[128:131], 0
ds_read_b64_tr_b16 a[224:225], v0 offset:8192
v_mfma_f32_16x16x32_bf16 v[44:47], a[228:231], v[132:135], 0
ds_read_b64_tr_b16 a[226:227], v0 offset:10240
s_add_u32 m0, s4, 81920
v_mfma_f32_16x16x32_bf16 v[48:51], a[232:235], v[128:131], 0
ds_read_b64_tr_b16 a[228:229], v1 offset:8192
ds_read_b64_tr_b16 a[230:231], v1 offset:10240
v_mfma_f32_16x16x32_bf16 v[56:59], a[232:235], v[132:135], 0
buffer_load_dwordx4 v8, s[16:19], s35 offen offset:3072 nt lds
v_mfma_f32_16x16x32_bf16 v[52:55], a[236:239], v[128:131], 0
ds_read_b64_tr_b16 a[232:233], v2 offset:8192
ds_read_b64_tr_b16 a[234:235], v2 offset:10240
v_mfma_f32_16x16x32_bf16 v[60:63], a[236:239], v[132:135], 0
s_add_u32 m0, s4, 98304
s_waitcnt lgkmcnt(6)
v_mfma_f32_16x16x32_bf16 v[32:35], a[240:243], v[136:139], v[32:35]
ds_read_b64_tr_b16 a[236:237], v3 offset:8192
ds_read_b64_tr_b16 a[238:239], v3 offset:10240
v_mfma_f32_16x16x32_bf16 v[40:43], a[240:243], v[140:143], v[40:43]
s_mov_b32 s5, 413696
buffer_load_dwordx4 v9, s[24:27], s5 offen offset:2048 lds
v_mfma_f32_16x16x32_bf16 v[36:39], a[244:247], v[136:139], v[36:39]
ds_read_b64_tr_b16 a[240:241], v0 offset:12288
ds_read_b64_tr_b16 a[242:243], v0 offset:14336
v_mfma_f32_16x16x32_bf16 v[44:47], a[244:247], v[140:143], v[44:47]
s_mov_b32 s5, 419840
v_add_u32 v0, 0xffff0000, v0
v_mfma_f32_16x16x32_bf16 v[48:51], a[248:251], v[136:139], v[48:51]
ds_read_b64_tr_b16 a[244:245], v1 offset:12288
ds_read_b64_tr_b16 a[246:247], v1 offset:14336
v_mfma_f32_16x16x32_bf16 v[56:59], a[248:251], v[140:143], v[56:59]
buffer_load_dwordx4 v9, s[24:27], s5 offen offset:3072 lds
v_mfma_f32_16x16x32_bf16 v[52:55], a[252:255], v[136:139], v[52:55]
ds_read_b64_tr_b16 a[248:249], v2 offset:12288
ds_read_b64_tr_b16 a[250:251], v2 offset:14336
v_mfma_f32_16x16x32_bf16 v[60:63], a[252:255], v[140:143], v[60:63]
v_add_u32 v1, 0xffff0000, v1
s_waitcnt lgkmcnt(6)
v_mfma_f32_16x16x32_bf16 v[32:35], a[224:227], v[144:147], v[32:35]
ds_read_b64_tr_b16 a[252:253], v3 offset:12288
ds_read_b64_tr_b16 a[254:255], v3 offset:14336
v_mfma_f32_16x16x32_bf16 v[40:43], a[224:227], v[148:151], v[40:43]
v_add_u32 v2, 0xffff0000, v2
v_add_u32 v3, 0xffff0000, v3
v_mfma_f32_16x16x32_bf16 v[36:39], a[228:231], v[144:147], v[36:39]
s_waitcnt vmcnt(16)
s_barrier
v_mfma_f32_16x16x32_bf16 v[44:47], a[228:231], v[148:151], v[44:47]
ds_read_b64_tr_b16 a[224:225], v0 offset:0
ds_read_b64_tr_b16 a[226:227], v0 offset:2048
v_mfma_f32_16x16x32_bf16 v[48:51], a[232:235], v[144:147], v[48:51]
ds_read_b64_tr_b16 a[228:229], v1 offset:0
ds_read_b64_tr_b16 a[230:231], v1 offset:2048
v_mfma_f32_16x16x32_bf16 v[56:59], a[232:235], v[148:151], v[56:59]
s_add_u32 m0, s4, 114688
s_mov_b32 s5, 401664
v_mfma_f32_16x16x32_bf16 v[52:55], a[236:239], v[144:147], v[52:55]
ds_read_b64_tr_b16 a[232:233], v2 offset:0
v_mfma_f32_16x16x32_bf16 v[60:63], a[236:239], v[148:151], v[60:63]
ds_read_b64_tr_b16 a[234:235], v2 offset:2048
s_waitcnt lgkmcnt(6)
v_mfma_f32_16x16x32_bf16 v[32:35], a[240:243], v[152:155], v[32:35]
ds_read_b64_tr_b16 a[236:237], v3 offset:0
ds_read_b64_tr_b16 a[238:239], v3 offset:2048
v_mfma_f32_16x16x32_bf16 v[40:43], a[240:243], v[156:159], v[40:43]
buffer_load_dwordx4 v9, s[24:27], s5 offen lds
v_mfma_f32_16x16x32_bf16 v[36:39], a[244:247], v[152:155], v[36:39]
ds_read_b64_tr_b16 a[240:241], v0 offset:4096
v_mfma_f32_16x16x32_bf16 v[44:47], a[244:247], v[156:159], v[44:47]
ds_read_b64_tr_b16 a[242:243], v0 offset:6144
s_mov_b32 s5, 407808
v_mfma_f32_16x16x32_bf16 v[48:51], a[248:251], v[152:155], v[48:51]
ds_read_b64_tr_b16 a[244:245], v1 offset:4096
ds_read_b64_tr_b16 a[246:247], v1 offset:6144
v_mfma_f32_16x16x32_bf16 v[56:59], a[248:251], v[156:159], v[56:59]
buffer_load_dwordx4 v9, s[24:27], s5 offen offset:1024 lds
v_mfma_f32_16x16x32_bf16 v[52:55], a[252:255], v[152:155], v[52:55]
ds_read_b64_tr_b16 a[248:249], v2 offset:4096
ds_read_b64_tr_b16 a[250:251], v2 offset:6144
v_mfma_f32_16x16x32_bf16 v[60:63], a[252:255], v[156:159], v[60:63]
s_mov_b32 s5, 413952
L_step_114:
s_waitcnt lgkmcnt(6)
v_mfma_f32_16x16x32_bf16 v[32:35], a[224:227], v[160:163], v[32:35]
ds_read_b64_tr_b16 a[252:253], v3 offset:4096
v_mfma_f32_16x16x32_bf16 v[40:43], a[224:227], v[164:167], v[40:43]
ds_read_b64_tr_b16 a[254:255], v3 offset:6144
v_mfma_f32_16x16x32_bf16 v[36:39], a[228:231], v[160:163], v[36:39]
ds_read_b64_tr_b16 a[224:225], v0 offset:8192
ds_read_b64_tr_b16 a[226:227], v0 offset:10240
v_mfma_f32_16x16x32_bf16 v[44:47], a[228:231], v[164:167], v[44:47]
buffer_load_dwordx4 v9, s[24:27], s5 offen offset:2048 lds
v_mfma_f32_16x16x32_bf16 v[48:51], a[232:235], v[160:163], v[48:51]
ds_read_b64_tr_b16 a[228:229], v1 offset:8192
v_mfma_f32_16x16x32_bf16 v[56:59], a[232:235], v[164:167], v[56:59]
ds_read_b64_tr_b16 a[230:231], v1 offset:10240
s_mov_b32 s5, 420096
v_mfma_f32_16x16x32_bf16 v[52:55], a[236:239], v[160:163], v[52:55]
ds_read_b64_tr_b16 a[232:233], v2 offset:8192
v_mfma_f32_16x16x32_bf16 v[60:63], a[236:239], v[164:167], v[60:63]
ds_read_b64_tr_b16 a[234:235], v2 offset:10240
s_waitcnt lgkmcnt(6)
v_mfma_f32_16x16x32_bf16 v[32:35], a[240:243], v[168:171], v[32:35]
ds_read_b64_tr_b16 a[236:237], v3 offset:8192
ds_read_b64_tr_b16 a[238:239], v3 offset:10240
v_mfma_f32_16x16x32_bf16 v[40:43], a[240:243], v[172:175], v[40:43]
buffer_load_dwordx4 v9, s[24:27], s5 offen offset:3072 lds
v_mfma_f32_16x16x32_bf16 v[36:39], a[244:247], v[168:171], v[36:39]
ds_read_b64_tr_b16 a[240:241], v0 offset:12288
v_mfma_f32_16x16x32_bf16 v[44:47], a[244:247], v[172:175], v[44:47]
ds_read_b64_tr_b16 a[242:243], v0 offset:14336
v_mfma_f32_16x16x32_bf16 v[48:51], a[248:251], v[168:171], v[48:51]
ds_read_b64_tr_b16 a[244:245], v1 offset:12288
v_mfma_f32_16x16x32_bf16 v[56:59], a[248:251], v[172:175], v[56:59]
ds_read_b64_tr_b16 a[246:247], v1 offset:14336
v_mfma_f32_16x16x32_bf16 v[52:55], a[252:255], v[168:171], v[52:55]
ds_read_b64_tr_b16 a[248:249], v2 offset:12288
ds_read_b64_tr_b16 a[250:251], v2 offset:14336
L_pg21:
s_cbranch_scc1 L_rt1
v_mfma_f32_16x16x32_bf16 v[60:63], a[252:255], v[172:175], v[60:63]
s_add_u32 m0, s4, 16384
s_waitcnt lgkmcnt(6)
v_mfma_f32_16x16x32_bf16 v[32:35], a[224:227], v[176:179], v[32:35]
ds_read_b64_tr_b16 a[252:253], v3 offset:12288
v_mfma_f32_16x16x32_bf16 v[40:43], a[224:227], v[180:183], v[40:43]
ds_read_b64_tr_b16 a[254:255], v3 offset:14336
s_mov_b32 s5, 344576
v_mfma_f32_16x16x32_bf16 v[36:39], a[228:231], v[176:179], v[36:39]
s_waitcnt vmcnt(12)
s_barrier
v_mfma_f32_16x16x32_bf16 v[44:47], a[228:231], v[180:183], v[44:47]
ds_read_b64_tr_b16 a[224:225], v0 offset:32768
ds_read_b64_tr_b16 a[226:227], v0 offset:34816
v_mfma_f32_16x16x32_bf16 v[48:51], a[232:235], v[176:179], v[48:51]
ds_read_b64_tr_b16 a[228:229], v1 offset:32768
ds_read_b64_tr_b16 a[230:231], v1 offset:34816
v_mfma_f32_16x16x32_bf16 v[56:59], a[232:235], v[180:183], v[56:59]
buffer_load_dwordx4 v9, s[24:27], s5 offen lds
v_mfma_f32_16x16x32_bf16 v[52:55], a[236:239], v[176:179], v[52:55]
ds_read_b64_tr_b16 a[232:233], v2 offset:32768
ds_read_b64_tr_b16 a[234:235], v2 offset:34816
v_mfma_f32_16x16x32_bf16 v[60:63], a[236:239], v[180:183], v[60:63]
s_mov_b32 s5, 350720
s_waitcnt lgkmcnt(6)
v_mfma_f32_16x16x32_bf16 v[32:35], a[240:243], v[184:187], v[32:35]
ds_read_b64_tr_b16 a[236:237], v3 offset:32768
v_mfma_f32_16x16x32_bf16 v[40:43], a[240:243], v[188:191], v[40:43]
ds_read_b64_tr_b16 a[238:239], v3 offset:34816
v_mfma_f32_16x16x32_bf16 v[36:39], a[244:247], v[184:187], v[36:39]
ds_read_b64_tr_b16 a[240:241], v0 offset:40960
ds_read_b64_tr_b16 a[242:243], v0 offset:43008
v_mfma_f32_16x16x32_bf16 v[44:47], a[244:247], v[188:191], v[44:47]
buffer_load_dwordx4 v9, s[24:27], s5 offen offset:1024 lds
v_mfma_f32_16x16x32_bf16 v[48:51], a[248:251], v[184:187], v[48:51]
ds_read_b64_tr_b16 a[244:245], v1 offset:40960
v_mfma_f32_16x16x32_bf16 v[56:59], a[248:251], v[188:191], v[56:59]
ds_read_b64_tr_b16 a[246:247], v1 offset:43008
s_mov_b32 s5, 356864
v_mfma_f32_16x16x32_bf16 v[52:55], a[252:255], v[184:187], v[52:55]
ds_read_b64_tr_b16 a[248:249], v2 offset:40960
v_mfma_f32_16x16x32_bf16 v[60:63], a[252:255], v[188:191], v[60:63]
ds_read_b64_tr_b16 a[250:251], v2 offset:43008
L_step_115:
s_waitcnt lgkmcnt(6)
v_mfma_f32_16x16x32_bf16 a[64:67], a[224:227], v[96:99], a[64:67]
ds_read_b64_tr_b16 a[252:253], v3 offset:40960
v_mfma_f32_16x16x32_bf16 a[72:75], a[224:227], v[100:103], a[72:75]
ds_read_b64_tr_b16 a[254:255], v3 offset:43008
v_mfma_f32_16x16x32_bf16 a[68:71], a[228:231], v[96:99], a[68:71]
ds_read_b64_tr_b16 a[224:225], v0 offset:36864
ds_read_b64_tr_b16 a[226:227], v0 offset:38912
v_mfma_f32_16x16x32_bf16 a[76:79], a[228:231], v[100:103], a[76:79]
buffer_load_dwordx4 v9, s[24:27], s5 offen offset:2048 lds
v_mfma_f32_16x16x32_bf16 a[80:83], a[232:235], v[96:99], a[80:83]
ds_read_b64_tr_b16 a[228:229], v1 offset:36864
v_mfma_f32_16x16x32_bf16 a[88:91], a[232:235], v[100:103], a[88:91]
ds_read_b64_tr_b16 a[230:231], v1 offset:38912
s_mov_b32 s5, 363008
v_mfma_f32_16x16x32_bf16 a[84:87], a[236:239], v[96:99], a[84:87]
ds_read_b64_tr_b16 a[232:233], v2 offset:36864
v_mfma_f32_16x16x32_bf16 a[92:95], a[236:239], v[100:103], a[92:95]
ds_read_b64_tr_b16 a[234:235], v2 offset:38912
s_waitcnt lgkmcnt(6)
v_mfma_f32_16x16x32_bf16 a[96:99], a[240:243], v[96:99], a[96:99]
ds_read_b64_tr_b16 a[236:237], v3 offset:36864
ds_read_b64_tr_b16 a[238:239], v3 offset:38912
v_mfma_f32_16x16x32_bf16 a[104:107], a[240:243], v[100:103], a[104:107]
buffer_load_dwordx4 v9, s[24:27], s5 offen offset:3072 lds
v_mfma_f32_16x16x32_bf16 a[100:103], a[244:247], v[96:99], a[100:103]
ds_read_b64_tr_b16 a[240:241], v0 offset:45056
v_mfma_f32_16x16x32_bf16 a[108:111], a[244:247], v[100:103], a[108:111]
ds_read_b64_tr_b16 a[242:243], v0 offset:47104
v_add_u32 v0, 0x14000, v0
v_mfma_f32_16x16x32_bf16 a[112:115], a[248:251], v[96:99], a[112:115]
ds_read_b64_tr_b16 a[244:245], v1 offset:45056
v_mfma_f32_16x16x32_bf16 a[120:123], a[248:251], v[100:103], a[120:123]
ds_read_b64_tr_b16 a[246:247], v1 offset:47104
v_add_u32 v1, 0x14000, v1
v_mfma_f32_16x16x32_bf16 a[116:119], a[252:255], v[96:99], a[116:119]
ds_read_b64_tr_b16 a[248:249], v2 offset:45056
ds_read_b64_tr_b16 a[250:251], v2 offset:47104
v_mfma_f32_16x16x32_bf16 a[124:127], a[252:255], v[100:103], a[124:127]
v_add_u32 v2, 0x14000, v2
s_waitcnt lgkmcnt(6)
v_mfma_f32_16x16x32_bf16 a[64:67], a[224:227], v[104:107], a[64:67]
ds_read_b64_tr_b16 a[252:253], v3 offset:45056
ds_read_b64_tr_b16 a[254:255], v3 offset:47104
v_mfma_f32_16x16x32_bf16 a[72:75], a[224:227], v[108:111], a[72:75]
v_add_u32 v3, 0x14000, v3
s_add_u32 m0, s4, 0
v_mfma_f32_16x16x32_bf16 a[68:71], a[228:231], v[104:107], a[68:71]
s_barrier
ds_read_b64_tr_b16 a[224:225], v0 offset:49152
v_mfma_f32_16x16x32_bf16 a[76:79], a[228:231], v[108:111], a[76:79]
ds_read_b64_tr_b16 a[226:227], v0 offset:51200
s_mov_b32 s5, 401920
v_mfma_f32_16x16x32_bf16 a[80:83], a[232:235], v[104:107], a[80:83]
ds_read_b64_tr_b16 a[228:229], v1 offset:49152
ds_read_b64_tr_b16 a[230:231], v1 offset:51200
v_mfma_f32_16x16x32_bf16 a[88:91], a[232:235], v[108:111], a[88:91]
buffer_load_dwordx4 v9, s[24:27], s5 offen lds
v_mfma_f32_16x16x32_bf16 a[84:87], a[236:239], v[104:107], a[84:87]
ds_read_b64_tr_b16 a[232:233], v2 offset:49152
ds_read_b64_tr_b16 a[234:235], v2 offset:51200
v_mfma_f32_16x16x32_bf16 a[92:95], a[236:239], v[108:111], a[92:95]
s_mov_b32 s5, 408064
s_waitcnt lgkmcnt(6)
v_mfma_f32_16x16x32_bf16 a[96:99], a[240:243], v[104:107], a[96:99]
ds_read_b64_tr_b16 a[236:237], v3 offset:49152
v_mfma_f32_16x16x32_bf16 a[104:107], a[240:243], v[108:111], a[104:107]
ds_read_b64_tr_b16 a[238:239], v3 offset:51200
v_mfma_f32_16x16x32_bf16 a[100:103], a[244:247], v[104:107], a[100:103]
ds_read_b64_tr_b16 a[240:241], v0 offset:53248
ds_read_b64_tr_b16 a[242:243], v0 offset:55296
v_mfma_f32_16x16x32_bf16 a[108:111], a[244:247], v[108:111], a[108:111]
buffer_load_dwordx4 v9, s[24:27], s5 offen offset:1024 lds
v_mfma_f32_16x16x32_bf16 a[112:115], a[248:251], v[104:107], a[112:115]
ds_read_b64_tr_b16 a[244:245], v1 offset:53248
v_mfma_f32_16x16x32_bf16 a[120:123], a[248:251], v[108:111], a[120:123]
ds_read_b64_tr_b16 a[246:247], v1 offset:55296
s_mov_b32 s5, 414208
v_mfma_f32_16x16x32_bf16 a[116:119], a[252:255], v[104:107], a[116:119]
ds_read_b64_tr_b16 a[248:249], v2 offset:53248
v_mfma_f32_16x16x32_bf16 a[124:127], a[252:255], v[108:111], a[124:127]
ds_read_b64_tr_b16 a[250:251], v2 offset:55296
L_step_116:
s_waitcnt lgkmcnt(6)
v_mfma_f32_16x16x32_bf16 v[32:35], a[224:227], v[192:195], v[32:35]
ds_read_b64_tr_b16 a[252:253], v3 offset:53248
v_mfma_f32_16x16x32_bf16 v[40:43], a[224:227], v[196:199], v[40:43]
ds_read_b64_tr_b16 a[254:255], v3 offset:55296
v_mfma_f32_16x16x32_bf16 v[36:39], a[228:231], v[192:195], v[36:39]
ds_read_b64_tr_b16 a[224:225], v0 offset:57344
ds_read_b64_tr_b16 a[226:227], v0 offset:59392
v_mfma_f32_16x16x32_bf16 v[44:47], a[228:231], v[196:199], v[44:47]
buffer_load_dwordx4 v9, s[24:27], s5 offen offset:2048 lds
v_mfma_f32_16x16x32_bf16 v[48:51], a[232:235], v[192:195], v[48:51]
ds_read_b64_tr_b16 a[228:229], v1 offset:57344
v_mfma_f32_16x16x32_bf16 v[56:59], a[232:235], v[196:199], v[56:59]
ds_read_b64_tr_b16 a[230:231], v1 offset:59392
s_mov_b32 s5, 420352
v_mfma_f32_16x16x32_bf16 v[52:55], a[236:239], v[192:195], v[52:55]
ds_read_b64_tr_b16 a[232:233], v2 offset:57344
v_mfma_f32_16x16x32_bf16 v[60:63], a[236:239], v[196:199], v[60:63]
ds_read_b64_tr_b16 a[234:235], v2 offset:59392
s_waitcnt lgkmcnt(6)
v_mfma_f32_16x16x32_bf16 v[32:35], a[240:243], v[200:203], v[32:35]
ds_read_b64_tr_b16 a[236:237], v3 offset:57344
ds_read_b64_tr_b16 a[238:239], v3 offset:59392
v_mfma_f32_16x16x32_bf16 v[40:43], a[240:243], v[204:207], v[40:43]
buffer_load_dwordx4 v9, s[24:27], s5 offen offset:3072 lds
v_mfma_f32_16x16x32_bf16 v[36:39], a[244:247], v[200:203], v[36:39]
ds_read_b64_tr_b16 a[240:241], v0 offset:61440
v_mfma_f32_16x16x32_bf16 v[44:47], a[244:247], v[204:207], v[44:47]
ds_read_b64_tr_b16 a[242:243], v0 offset:63488
v_mfma_f32_16x16x32_bf16 v[48:51], a[248:251], v[200:203], v[48:51]
ds_read_b64_tr_b16 a[244:245], v1 offset:61440
v_mfma_f32_16x16x32_bf16 v[56:59], a[248:251], v[204:207], v[56:59]
ds_read_b64_tr_b16 a[246:247], v1 offset:63488
v_mfma_f32_16x16x32_bf16 v[52:55], a[252:255], v[200:203], v[52:55]
ds_read_b64_tr_b16 a[248:249], v2 offset:61440
ds_read_b64_tr_b16 a[250:251], v2 offset:63488
v_mfma_f32_16x16x32_bf16 v[60:63], a[252:255], v[204:207], v[60:63]
s_add_u32 m0, s4, 32768
s_waitcnt lgkmcnt(6)
v_mfma_f32_16x16x32_bf16 v[32:35], a[224:227], v[208:211], v[32:35]
ds_read_b64_tr_b16 a[252:253], v3 offset:61440
v_mfma_f32_16x16x32_bf16 v[40:43], a[224:227], v[212:215], v[40:43]
ds_read_b64_tr_b16 a[254:255], v3 offset:63488
s_add_u32 s5, s88, 344832
v_mfma_f32_16x16x32_bf16 v[36:39], a[228:231], v[208:211], v[36:39]
s_waitcnt vmcnt(14)
s_barrier
v_mfma_f32_16x16x32_bf16 v[44:47], a[228:231], v[212:215], v[44:47]
ds_read_b64_tr_b16 a[224:225], v0 offset:0
ds_read_b64_tr_b16 a[226:227], v0 offset:2048
v_mfma_f32_16x16x32_bf16 v[48:51], a[232:235], v[208:211], v[48:51]
ds_read_b64_tr_b16 a[228:229], v1 offset:0
v_mfma_f32_16x16x32_bf16 v[56:59], a[232:235], v[212:215], v[56:59]
ds_read_b64_tr_b16 a[230:231], v1 offset:2048
v_mov_b32 v26, 1
v_mfma_f32_16x16x32_bf16 v[52:55], a[236:239], v[208:211], v[52:55]
ds_read_b64_tr_b16 a[232:233], v0 offset:4096
ds_read_b64_tr_b16 a[234:235], v0 offset:6144
v_mfma_f32_16x16x32_bf16 v[60:63], a[236:239], v[212:215], v[60:63]
buffer_store_dword v26, v20, s[68:71], s89 offen sc1
s_waitcnt lgkmcnt(6)
v_mfma_f32_16x16x32_bf16 v[32:35], a[240:243], v[216:219], v[32:35]
ds_read_b64_tr_b16 a[236:237], v1 offset:4096
ds_read_b64_tr_b16 a[238:239], v1 offset:6144
v_mfma_f32_16x16x32_bf16 v[40:43], a[240:243], v[220:223], v[40:43]
buffer_load_dwordx4 v9, s[24:27], s5 offen lds
v_mfma_f32_16x16x32_bf16 v[36:39], a[244:247], v[216:219], v[36:39]
ds_read_b64_tr_b16 a[240:241], v0 offset:8192
v_mfma_f32_16x16x32_bf16 v[44:47], a[244:247], v[220:223], v[44:47]
ds_read_b64_tr_b16 a[242:243], v0 offset:10240
s_add_u32 s5, s88, 350976
v_mfma_f32_16x16x32_bf16 v[48:51], a[248:251], v[216:219], v[48:51]
ds_read_b64_tr_b16 a[244:245], v1 offset:8192
ds_read_b64_tr_b16 a[246:247], v1 offset:10240
v_mfma_f32_16x16x32_bf16 v[56:59], a[248:251], v[220:223], v[56:59]
buffer_load_dwordx4 v9, s[24:27], s5 offen offset:1024 lds
v_mfma_f32_16x16x32_bf16 v[52:55], a[252:255], v[216:219], v[52:55]
ds_read_b64_tr_b16 a[248:249], v0 offset:12288
ds_read_b64_tr_b16 a[250:251], v0 offset:14336
v_mfma_f32_16x16x32_bf16 v[60:63], a[252:255], v[220:223], v[60:63]
s_add_u32 s5, s88, 357120
L_step_117:
s_waitcnt lgkmcnt(6)
v_mfma_f32_16x16x32_bf16 v[32:35], a[224:227], v[224:227], v[32:35]
ds_read_b64_tr_b16 a[252:253], v1 offset:12288
ds_read_b64_tr_b16 a[254:255], v1 offset:14336
v_mfma_f32_16x16x32_bf16 v[40:43], a[224:227], v[228:231], v[40:43]
buffer_load_dwordx4 v9, s[24:27], s5 offen offset:2048 lds
v_mfma_f32_16x16x32_bf16 v[36:39], a[228:231], v[224:227], v[36:39]
ds_read_b64_tr_b16 a[224:225], v2 offset:0
v_mfma_f32_16x16x32_bf16 v[44:47], a[228:231], v[228:231], v[44:47]
ds_read_b64_tr_b16 a[226:227], v2 offset:2048
s_add_u32 s5, s88, 363264
v_mfma_f32_16x16x32_bf16 v[32:35], a[232:235], v[232:235], v[32:35]
ds_read_b64_tr_b16 a[228:229], v3 offset:0
ds_read_b64_tr_b16 a[230:231], v3 offset:2048
v_mfma_f32_16x16x32_bf16 v[40:43], a[232:235], v[236:239], v[40:43]
buffer_load_dwordx4 v9, s[24:27], s5 offen offset:3072 lds
v_mfma_f32_16x16x32_bf16 v[36:39], a[236:239], v[232:235], v[36:39]
ds_read_b64_tr_b16 a[232:233], v2 offset:4096
ds_read_b64_tr_b16 a[234:235], v2 offset:6144
v_mfma_f32_16x16x32_bf16 v[44:47], a[236:239], v[236:239], v[44:47]
s_add_u32 m0, s4, 49152
s_add_u32 s5, s88, 402176
s_waitcnt lgkmcnt(6)
v_mfma_f32_16x16x32_bf16 v[32:35], a[240:243], v[240:243], v[32:35]
ds_read_b64_tr_b16 a[236:237], v3 offset:4096
ds_read_b64_tr_b16 a[238:239], v3 offset:6144
v_mfma_f32_16x16x32_bf16 v[40:43], a[240:243], v[244:247], v[40:43]
buffer_load_dwordx4 v9, s[24:27], s5 offen lds
v_mfma_f32_16x16x32_bf16 v[36:39], a[244:247], v[240:243], v[36:39]
ds_read_b64_tr_b16 a[240:241], v2 offset:8192
ds_read_b64_tr_b16 a[242:243], v2 offset:10240
v_mfma_f32_16x16x32_bf16 v[44:47], a[244:247], v[244:247], v[44:47]
s_add_u32 s5, s88, 408320
buffer_load_dwordx4 v9, s[24:27], s5 offen offset:1024 lds
v_mfma_f32_16x16x32_bf16 v[32:35], a[248:251], v[248:251], v[32:35]
ds_read_b64_tr_b16 a[244:245], v3 offset:8192
v_mfma_f32_16x16x32_bf16 v[40:43], a[248:251], v[252:255], v[40:43]
ds_read_b64_tr_b16 a[246:247], v3 offset:10240
s_add_u32 s5, s88, 414464
v_mfma_f32_16x16x32_bf16 v[36:39], a[252:255], v[248:251], v[36:39]
ds_read_b64_tr_b16 a[248:249], v2 offset:12288
ds_read_b64_tr_b16 a[250:251], v2 offset:14336
v_mfma_f32_16x16x32_bf16 v[44:47], a[252:255], v[252:255], v[44:47]
buffer_load_dwordx4 v9, s[24:27], s5 offen offset:2048 lds
s_waitcnt lgkmcnt(6)
v_mfma_f32_16x16x32_bf16 v[48:51], a[224:227], v[224:227], v[48:51]
ds_read_b64_tr_b16 a[252:253], v3 offset:12288
ds_read_b64_tr_b16 a[254:255], v3 offset:14336
v_mfma_f32_16x16x32_bf16 v[56:59], a[224:227], v[228:231], v[56:59]
s_add_u32 s5, s88, 420608
buffer_load_dwordx4 v9, s[24:27], s5 offen offset:3072 lds
v_mfma_f32_16x16x32_bf16 v[52:55], a[228:231], v[224:227], v[52:55]
s_waitcnt vmcnt(21)
s_barrier
ds_read_b64_tr_b16 a[224:225], v0 offset:16384
v_mfma_f32_16x16x32_bf16 v[60:63], a[228:231], v[228:231], v[60:63]
ds_read_b64_tr_b16 a[226:227], v0 offset:18432
v_mul_f32 v32, v32, v14
v_mul_f32 v33, v33, v14
v_mfma_f32_16x16x32_bf16 v[48:51], a[232:235], v[232:235], v[48:51]
ds_read_b64_tr_b16 a[228:229], v1 offset:16384
ds_read_b64_tr_b16 a[230:231], v1 offset:18432
v_mul_f32 v34, v34, v14
v_mfma_f32_16x16x32_bf16 v[56:59], a[232:235], v[236:239], v[56:59]
v_mul_f32 v35, v35, v14
v_cvt_pk_bf16_f32 v112, v32, v33
v_mul_f32 v36, v36, v14
v_mfma_f32_16x16x32_bf16 v[52:55], a[236:239], v[232:235], v[52:55]
ds_read_b64_tr_b16 a[232:233], v2 offset:16384
ds_read_b64_tr_b16 a[234:235], v2 offset:18432
v_mul_f32 v37, v37, v14
v_mfma_f32_16x16x32_bf16 v[60:63], a[236:239], v[236:239], v[60:63]
v_cvt_pk_bf16_f32 v113, v34, v35
v_mul_f32 v38, v38, v14
s_waitcnt lgkmcnt(6)
v_mfma_f32_16x16x32_bf16 v[48:51], a[240:243], v[240:243], v[48:51]
ds_read_b64_tr_b16 a[236:237], v3 offset:16384
ds_read_b64_tr_b16 a[238:239], v3 offset:18432
v_mul_f32 v39, v39, v14
v_mfma_f32_16x16x32_bf16 v[56:59], a[240:243], v[244:247], v[56:59]
v_cvt_pk_bf16_f32 v114, v36, v37
v_cvt_pk_bf16_f32 v115, v38, v39
v_mul_f32 v40, v40, v15
v_mfma_f32_16x16x32_bf16 v[52:55], a[244:247], v[240:243], v[52:55]
ds_read_b64_tr_b16 a[240:241], v0 offset:24576
ds_read_b64_tr_b16 a[242:243], v0 offset:26624
v_mul_f32 v41, v41, v15
v_mfma_f32_16x16x32_bf16 v[60:63], a[244:247], v[244:247], v[60:63]
v_mul_f32 v42, v42, v15
v_mul_f32 v43, v43, v15
v_cvt_pk_bf16_f32 v116, v40, v41
v_mfma_f32_16x16x32_bf16 v[48:51], a[248:251], v[248:251], v[48:51]
ds_read_b64_tr_b16 a[244:245], v1 offset:24576
ds_read_b64_tr_b16 a[246:247], v1 offset:26624
v_mul_f32 v44, v44, v15
v_mfma_f32_16x16x32_bf16 v[56:59], a[248:251], v[252:255], v[56:59]
v_mul_f32 v45, v45, v15
v_cvt_pk_bf16_f32 v117, v42, v43
v_mul_f32 v46, v46, v15
v_mfma_f32_16x16x32_bf16 v[52:55], a[252:255], v[248:251], v[52:55]
ds_read_b64_tr_b16 a[248:249], v2 offset:24576
ds_read_b64_tr_b16 a[250:251], v2 offset:26624
v_mul_f32 v47, v47, v15
v_mfma_f32_16x16x32_bf16 v[60:63], a[252:255], v[252:255], v[60:63]
v_cvt_pk_bf16_f32 v118, v44, v45
v_cvt_pk_bf16_f32 v119, v46, v47
L_step_118:
s_waitcnt lgkmcnt(6)
v_mfma_f32_16x16x32_bf16 a[0:3], a[224:227], v[112:115], a[0:3]
ds_read_b64_tr_b16 a[252:253], v3 offset:24576
v_mfma_f32_16x16x32_bf16 a[8:11], a[224:227], v[116:119], a[8:11]
ds_read_b64_tr_b16 a[254:255], v3 offset:26624
v_mfma_f32_16x16x32_bf16 a[4:7], a[228:231], v[112:115], a[4:7]
ds_read_b64_tr_b16 a[224:225], v0 offset:20480
ds_read_b64_tr_b16 a[226:227], v0 offset:22528
v_mul_f32 v48, v48, v14
v_mfma_f32_16x16x32_bf16 a[12:15], a[228:231], v[116:119], a[12:15]
v_mul_f32 v49, v49, v14
v_mul_f32 v50, v50, v14
v_mul_f32 v51, v51, v14
v_mfma_f32_16x16x32_bf16 a[16:19], a[232:235], v[112:115], a[16:19]
ds_read_b64_tr_b16 a[228:229], v1 offset:20480
ds_read_b64_tr_b16 a[230:231], v1 offset:22528
v_cvt_pk_bf16_f32 v120, v48, v49
v_mfma_f32_16x16x32_bf16 a[24:27], a[232:235], v[116:119], a[24:27]
v_mul_f32 v52, v52, v14
v_mul_f32 v53, v53, v14
v_cvt_pk_bf16_f32 v121, v50, v51
v_mfma_f32_16x16x32_bf16 a[20:23], a[236:239], v[112:115], a[20:23]
ds_read_b64_tr_b16 a[232:233], v2 offset:20480
ds_read_b64_tr_b16 a[234:235], v2 offset:22528
v_mul_f32 v54, v54, v14
v_mfma_f32_16x16x32_bf16 a[28:31], a[236:239], v[116:119], a[28:31]
v_mul_f32 v55, v55, v14
v_cvt_pk_bf16_f32 v122, v52, v53
s_waitcnt lgkmcnt(6)
v_mfma_f32_16x16x32_bf16 a[32:35], a[240:243], v[112:115], a[32:35]
ds_read_b64_tr_b16 a[236:237], v3 offset:20480
ds_read_b64_tr_b16 a[238:239], v3 offset:22528
v_mfma_f32_16x16x32_bf16 a[40:43], a[240:243], v[116:119], a[40:43]
buffer_load_dword v25, v23, s[68:71], s1 offen sc1
v_cvt_pk_bf16_f32 v123, v54, v55
v_mul_f32 v56, v56, v15
v_mfma_f32_16x16x32_bf16 a[36:39], a[244:247], v[112:115], a[36:39]
ds_read_b64_tr_b16 a[240:241], v0 offset:28672
ds_read_b64_tr_b16 a[242:243], v0 offset:30720
v_mul_f32 v57, v57, v15
v_mfma_f32_16x16x32_bf16 a[44:47], a[244:247], v[116:119], a[44:47]
v_mul_f32 v58, v58, v15
v_mul_f32 v59, v59, v15
v_cvt_pk_bf16_f32 v124, v56, v57
v_mfma_f32_16x16x32_bf16 a[48:51], a[248:251], v[112:115], a[48:51]
ds_read_b64_tr_b16 a[244:245], v1 offset:28672
ds_read_b64_tr_b16 a[246:247], v1 offset:30720
v_mul_f32 v60, v60, v15
v_mfma_f32_16x16x32_bf16 a[56:59], a[248:251], v[116:119], a[56:59]
v_mul_f32 v61, v61, v15
v_cvt_pk_bf16_f32 v125, v58, v59
v_mul_f32 v62, v62, v15
v_mfma_f32_16x16x32_bf16 a[52:55], a[252:255], v[112:115], a[52:55]
ds_read_b64_tr_b16 a[248:249], v2 offset:28672
ds_read_b64_tr_b16 a[250:251], v2 offset:30720
v_mul_f32 v63, v63, v15
v_mfma_f32_16x16x32_bf16 a[60:63], a[252:255], v[116:119], a[60:63]
v_cvt_pk_bf16_f32 v126, v60, v61
v_cvt_pk_bf16_f32 v127, v62, v63
s_waitcnt lgkmcnt(6)
v_mfma_f32_16x16x32_bf16 a[0:3], a[224:227], v[120:123], a[0:3]
ds_read_b64_tr_b16 a[252:253], v3 offset:28672
v_mfma_f32_16x16x32_bf16 a[8:11], a[224:227], v[124:127], a[8:11]
ds_read_b64_tr_b16 a[254:255], v3 offset:30720
v_mfma_f32_16x16x32_bf16 a[4:7], a[228:231], v[120:123], a[4:7]
s_waitcnt vmcnt(18)
s_barrier
v_mfma_f32_16x16x32_bf16 a[12:15], a[228:231], v[124:127], a[12:15]
ds_read_b64_tr_b16 a[224:225], v0 offset:32768
ds_read_b64_tr_b16 a[226:227], v0 offset:34816
v_mfma_f32_16x16x32_bf16 a[16:19], a[232:235], v[120:123], a[16:19]
ds_read_b64_tr_b16 a[228:229], v1 offset:32768
v_mfma_f32_16x16x32_bf16 a[24:27], a[232:235], v[124:127], a[24:27]
ds_read_b64_tr_b16 a[230:231], v1 offset:34816
v_mfma_f32_16x16x32_bf16 a[20:23], a[236:239], v[120:123], a[20:23]
ds_read_b64_tr_b16 a[232:233], v0 offset:36864
ds_read_b64_tr_b16 a[234:235], v0 offset:38912
v_accvgpr_read_b32 v32, a0
v_accvgpr_read_b32 v33, a1
v_accvgpr_read_b32 v34, a2
v_mfma_f32_16x16x32_bf16 a[28:31], a[236:239], v[124:127], a[28:31]
v_accvgpr_read_b32 v35, a3
v_accvgpr_read_b32 v36, a4
v_accvgpr_read_b32 v37, a5
v_accvgpr_read_b32 v38, a6
s_waitcnt lgkmcnt(6)
v_mfma_f32_16x16x32_bf16 a[32:35], a[240:243], v[120:123], a[32:35]
ds_read_b64_tr_b16 a[236:237], v1 offset:36864
ds_read_b64_tr_b16 a[238:239], v1 offset:38912
v_accvgpr_read_b32 v39, a7
v_accvgpr_read_b32 v40, a8
v_accvgpr_read_b32 v41, a9
v_mfma_f32_16x16x32_bf16 a[40:43], a[240:243], v[124:127], a[40:43]
v_accvgpr_read_b32 v42, a10
v_accvgpr_read_b32 v43, a11
v_accvgpr_read_b32 v44, a12
v_accvgpr_read_b32 v45, a13
v_accvgpr_read_b32 v46, a14
v_mfma_f32_16x16x32_bf16 a[36:39], a[244:247], v[120:123], a[36:39]
ds_read_b64_tr_b16 a[240:241], v2 offset:32768
ds_read_b64_tr_b16 a[242:243], v2 offset:34816
v_accvgpr_read_b32 v47, a15
v_cvt_pk_bf16_f32 v32, v32, v33
v_cvt_pk_bf16_f32 v33, v34, v35
v_mfma_f32_16x16x32_bf16 a[44:47], a[244:247], v[124:127], a[44:47]
v_cvt_pk_bf16_f32 v34, v36, v37
v_cvt_pk_bf16_f32 v35, v38, v39
v_cvt_pk_bf16_f32 v36, v40, v41
v_cvt_pk_bf16_f32 v37, v42, v43
v_cvt_pk_bf16_f32 v38, v44, v45
v_mfma_f32_16x16x32_bf16 a[48:51], a[248:251], v[120:123], a[48:51]
ds_read_b64_tr_b16 a[244:245], v3 offset:32768
ds_read_b64_tr_b16 a[246:247], v3 offset:34816
v_cvt_pk_bf16_f32 v39, v46, v47
s_waitcnt vmcnt(0)
v_mfma_f32_16x16x32_bf16 a[56:59], a[248:251], v[124:127], a[56:59]
v_cmp_lt_u32 vcc, 0, v25
s_mov_b32 s92, 0
s_or_b32 s32, vcc_lo, s85
s_cmp_lg_u32 s32, 0xff
s_cbranch_scc1 L_gov
L_govb:
v_mfma_f32_16x16x32_bf16 a[52:55], a[252:255], v[120:123], a[52:55]
ds_read_b64_tr_b16 a[248:249], v2 offset:36864
ds_read_b64_tr_b16 a[250:251], v2 offset:38912
buffer_store_dwordx4 v[32:35], v16, s[72:75], 0 offen offset:0 sc1
ds_write_b128 v18, v[32:35] offset:0
v_mfma_f32_16x16x32_bf16 a[60:63], a[252:255], v[124:127], a[60:63]
buffer_store_dwordx4 v[36:39], v17, s[72:75], 0 offen offset:0 sc1
ds_write_b128 v19, v[36:39] offset:0
L_step_119:
s_waitcnt lgkmcnt(8)
v_mfma_f32_16x16x32_bf16 a[64:67], a[224:227], v[112:115], a[64:67]
ds_read_b64_tr_b16 a[252:253], v3 offset:36864
ds_read_b64_tr_b16 a[254:255], v3 offset:38912
v_accvgpr_read_b32 v48, a16
v_accvgpr_read_b32 v49, a17
v_accvgpr_read_b32 v50, a18
v_mfma_f32_16x16x32_bf16 a[72:75], a[224:227], v[116:119], a[72:75]
v_accvgpr_read_b32 v51, a19
v_accvgpr_read_b32 v52, a20
v_accvgpr_read_b32 v53, a21
v_accvgpr_read_b32 v54, a22
v_accvgpr_read_b32 v55, a23
v_mfma_f32_16x16x32_bf16 a[68:71], a[228:231], v[112:115], a[68:71]
ds_read_b64_tr_b16 a[224:225], v0 offset:40960
ds_read_b64_tr_b16 a[226:227], v0 offset:43008
v_accvgpr_read_b32 v56, a24
v_accvgpr_read_b32 v57, a25
v_accvgpr_read_b32 v58, a26
v_mfma_f32_16x16x32_bf16 a[76:79], a[228:231], v[116:119], a[76:79]
v_accvgpr_read_b32 v59, a27
v_accvgpr_read_b32 v60, a28
v_accvgpr_read_b32 v61, a29
v_accvgpr_read_b32 v62, a30
v_accvgpr_read_b32 v63, a31
v_mfma_f32_16x16x32_bf16 a[64:67], a[232:235], v[120:123], a[64:67]
ds_read_b64_tr_b16 a[228:229], v1 offset:40960
ds_read_b64_tr_b16 a[230:231], v1 offset:43008
v_cvt_pk_bf16_f32 v48, v48, v49
v_cvt_pk_bf16_f32 v49, v50, v51
v_cvt_pk_bf16_f32 v50, v52, v53
v_mfma_f32_16x16x32_bf16 a[72:75], a[232:235], v[124:127], a[72:75]
v_cvt_pk_bf16_f32 v51, v54, v55
v_cvt_pk_bf16_f32 v52, v56, v57
v_cvt_pk_bf16_f32 v53, v58, v59
v_cvt_pk_bf16_f32 v54, v60, v61
v_cvt_pk_bf16_f32 v55, v62, v63
v_mfma_f32_16x16x32_bf16 a[68:71], a[236:239], v[120:123], a[68:71]
ds_read_b64_tr_b16 a[232:233], v0 offset:45056
ds_read_b64_tr_b16 a[234:235], v0 offset:47104
buffer_store_dwordx4 v[48:51], v16, s[72:75], 0 offen offset:256 sc1
ds_write_b128 v18, v[48:51] offset:256
v_mfma_f32_16x16x32_bf16 a[76:79], a[236:239], v[124:127], a[76:79]
buffer_store_dwordx4 v[52:55], v17, s[72:75], 0 offen offset:256 sc1
ds_write_b128 v19, v[52:55] offset:256
s_waitcnt lgkmcnt(8)
v_mfma_f32_16x16x32_bf16 a[80:83], a[240:243], v[112:115], a[80:83]
ds_read_b64_tr_b16 a[236:237], v1 offset:45056
ds_read_b64_tr_b16 a[238:239], v1 offset:47104
v_accvgpr_read_b32 v64, a32
v_accvgpr_read_b32 v65, a33
v_accvgpr_read_b32 v66, a34
v_mfma_f32_16x16x32_bf16 a[88:91], a[240:243], v[116:119], a[88:91]
v_accvgpr_read_b32 v67, a35
v_accvgpr_read_b32 v68, a36
v_accvgpr_read_b32 v69, a37
v_accvgpr_read_b32 v70, a38
v_accvgpr_read_b32 v71, a39
v_accvgpr_read_b32 v72, a40
v_mfma_f32_16x16x32_bf16 a[84:87], a[244:247], v[112:115], a[84:87]
ds_read_b64_tr_b16 a[240:241], v2 offset:40960
ds_read_b64_tr_b16 a[242:243], v2 offset:43008
v_accvgpr_read_b32 v73, a41
v_accvgpr_read_b32 v74, a42
v_accvgpr_read_b32 v75, a43
v_mfma_f32_16x16x32_bf16 a[92:95], a[244:247], v[116:119], a[92:95]
v_accvgpr_read_b32 v76, a44
v_accvgpr_read_b32 v77, a45
v_accvgpr_read_b32 v78, a46
v_accvgpr_read_b32 v79, a47
v_cvt_pk_bf16_f32 v64, v64, v65
v_cvt_pk_bf16_f32 v65, v66, v67
v_mfma_f32_16x16x32_bf16 a[80:83], a[248:251], v[120:123], a[80:83]
ds_read_b64_tr_b16 a[244:245], v3 offset:40960
ds_read_b64_tr_b16 a[246:247], v3 offset:43008
v_cvt_pk_bf16_f32 v66, v68, v69
v_cvt_pk_bf16_f32 v67, v70, v71
v_cvt_pk_bf16_f32 v68, v72, v73
v_mfma_f32_16x16x32_bf16 a[88:91], a[248:251], v[124:127], a[88:91]
v_cvt_pk_bf16_f32 v69, v74, v75
v_cvt_pk_bf16_f32 v70, v76, v77
v_cvt_pk_bf16_f32 v71, v78, v79
buffer_store_dwordx4 v[64:67], v16, s[72:75], 0 offen offset:512 sc1
v_mfma_f32_16x16x32_bf16 a[84:87], a[252:255], v[120:123], a[84:87]
ds_read_b64_tr_b16 a[248:249], v2 offset:45056
ds_read_b64_tr_b16 a[250:251], v2 offset:47104
ds_write_b128 v18, v[64:67] offset:512
buffer_store_dwordx4 v[68:71], v17, s[72:75], 0 offen offset:512 sc1
v_mfma_f32_16x16x32_bf16 a[92:95], a[252:255], v[124:127], a[92:95]
ds_write_b128 v19, v[68:71] offset:512
v_add_u32 v0, 0xfffec000, v0
v_add_u32 v1, 0xfffec000, v1
s_waitcnt lgkmcnt(8)
v_mfma_f32_16x16x32_bf16 a[96:99], a[224:227], v[112:115], a[96:99]
ds_read_b64_tr_b16 a[252:253], v3 offset:45056
ds_read_b64_tr_b16 a[254:255], v3 offset:47104
v_add_u32 v2, 0xfffec000, v2
v_add_u32 v3, 0xfffec000, v3
v_accvgpr_read_b32 v80, a48
v_mfma_f32_16x16x32_bf16 a[104:107], a[224:227], v[116:119], a[104:107]
v_accvgpr_read_b32 v81, a49
v_accvgpr_read_b32 v82, a50
v_accvgpr_read_b32 v83, a51
v_accvgpr_read_b32 v84, a52
v_accvgpr_read_b32 v85, a53
L_pg22:
s_cbranch_scc1 L_rt1
v_accvgpr_read_b32 v86, a54
v_mfma_f32_16x16x32_bf16 a[100:103], a[228:231], v[112:115], a[100:103]
s_barrier
ds_read_b64_tr_b16 a[224:225], v0 offset:16384
ds_read_b64_tr_b16 a[226:227], v0 offset:18432
v_accvgpr_read_b32 v87, a55
v_accvgpr_read_b32 v88, a56
v_mfma_f32_16x16x32_bf16 a[108:111], a[228:231], v[116:119], a[108:111]
v_accvgpr_read_b32 v89, a57
v_accvgpr_read_b32 v90, a58
v_accvgpr_read_b32 v91, a59
v_accvgpr_read_b32 v92, a60
v_accvgpr_read_b32 v93, a61
v_accvgpr_read_b32 v94, a62
v_mfma_f32_16x16x32_bf16 a[96:99], a[232:235], v[120:123], a[96:99]
ds_read_b64_tr_b16 a[228:229], v1 offset:16384
ds_read_b64_tr_b16 a[230:231], v1 offset:18432
v_accvgpr_read_b32 v95, a63
v_cvt_pk_bf16_f32 v80, v80, v81
v_cvt_pk_bf16_f32 v81, v82, v83
v_mfma_f32_16x16x32_bf16 a[104:107], a[232:235], v[124:127], a[104:107]
v_cvt_pk_bf16_f32 v82, v84, v85
v_cvt_pk_bf16_f32 v83, v86, v87
v_cvt_pk_bf16_f32 v84, v88, v89
v_cvt_pk_bf16_f32 v85, v90, v91
v_cvt_pk_bf16_f32 v86, v92, v93
v_cvt_pk_bf16_f32 v87, v94, v95
v_mfma_f32_16x16x32_bf16 a[100:103], a[236:239], v[120:123], a[100:103]
ds_read_b64_tr_b16 a[232:233], v2 offset:16384
ds_read_b64_tr_b16 a[234:235], v2 offset:18432
buffer_store_dwordx4 v[80:83], v16, s[72:75], 0 offen offset:768 sc1
ds_write_b128 v18, v[80:83] offset:768
v_mfma_f32_16x16x32_bf16 a[108:111], a[236:239], v[124:127], a[108:111]
buffer_store_dwordx4 v[84:87], v17, s[72:75], 0 offen offset:768 sc1
ds_write_b128 v19, v[84:87] offset:768
s_waitcnt lgkmcnt(8)
v_mfma_f32_16x16x32_bf16 a[112:115], a[240:243], v[112:115], a[112:115]
ds_read_b64_tr_b16 a[236:237], v3 offset:16384
ds_read_b64_tr_b16 a[238:239], v3 offset:18432
v_accvgpr_read_b32 v32, a64
v_accvgpr_read_b32 v33, a65
v_accvgpr_read_b32 v34, a66
v_mfma_f32_16x16x32_bf16 a[120:123], a[240:243], v[116:119], a[120:123]
v_accvgpr_read_b32 v35, a67
v_accvgpr_read_b32 v36, a68
v_accvgpr_read_b32 v37, a69
v_accvgpr_read_b32 v38, a70
v_accvgpr_read_b32 v39, a71
v_mfma_f32_16x16x32_bf16 a[116:119], a[244:247], v[112:115], a[116:119]
ds_read_b64_tr_b16 a[240:241], v0 offset:24576
ds_read_b64_tr_b16 a[242:243], v0 offset:26624
v_accvgpr_read_b32 v40, a72
v_accvgpr_read_b32 v41, a73
v_accvgpr_read_b32 v42, a74
v_mfma_f32_16x16x32_bf16 a[124:127], a[244:247], v[116:119], a[124:127]
v_accvgpr_read_b32 v43, a75
v_accvgpr_read_b32 v44, a76
v_accvgpr_read_b32 v45, a77
v_accvgpr_read_b32 v46, a78
v_accvgpr_read_b32 v47, a79
v_mfma_f32_16x16x32_bf16 a[112:115], a[248:251], v[120:123], a[112:115]
ds_read_b64_tr_b16 a[244:245], v1 offset:24576
ds_read_b64_tr_b16 a[246:247], v1 offset:26624
v_cvt_pk_bf16_f32 v32, v32, v33
v_cvt_pk_bf16_f32 v33, v34, v35
v_cvt_pk_bf16_f32 v34, v36, v37
v_mfma_f32_16x16x32_bf16 a[120:123], a[248:251], v[124:127], a[120:123]
v_cvt_pk_bf16_f32 v35, v38, v39
v_cvt_pk_bf16_f32 v36, v40, v41
v_cvt_pk_bf16_f32 v37, v42, v43
v_cvt_pk_bf16_f32 v38, v44, v45
v_cvt_pk_bf16_f32 v39, v46, v47
v_mfma_f32_16x16x32_bf16 a[116:119], a[252:255], v[120:123], a[116:119]
ds_read_b64_tr_b16 a[248:249], v2 offset:24576
ds_read_b64_tr_b16 a[250:251], v2 offset:26624
buffer_store_dwordx4 v[32:35], v16, s[72:75], 0 offen offset:1024 sc1
ds_write_b128 v18, v[32:35] offset:1024
v_mfma_f32_16x16x32_bf16 a[124:127], a[252:255], v[124:127], a[124:127]
buffer_store_dwordx4 v[36:39], v17, s[72:75], 0 offen offset:1024 sc1
ds_write_b128 v19, v[36:39] offset:1024
L_step_120:
s_waitcnt lgkmcnt(8)
v_mfma_f32_16x16x32_bf16 a[128:131], a[224:227], v[96:99], a[128:131]
ds_read_b64_tr_b16 a[252:253], v3 offset:24576
ds_read_b64_tr_b16 a[254:255], v3 offset:26624
v_accvgpr_read_b32 v48, a80
v_accvgpr_read_b32 v49, a81
v_accvgpr_read_b32 v50, a82
v_mfma_f32_16x16x32_bf16 a[136:139], a[224:227], v[100:103], a[136:139]
v_accvgpr_read_b32 v51, a83
v_accvgpr_read_b32 v52, a84
v_accvgpr_read_b32 v53, a85
v_accvgpr_read_b32 v54, a86
v_accvgpr_read_b32 v55, a87
v_mfma_f32_16x16x32_bf16 a[132:135], a[228:231], v[96:99], a[132:135]
ds_read_b64_tr_b16 a[224:225], v0 offset:20480
ds_read_b64_tr_b16 a[226:227], v0 offset:22528
v_accvgpr_read_b32 v56, a88
v_accvgpr_read_b32 v57, a89
v_accvgpr_read_b32 v58, a90
v_mfma_f32_16x16x32_bf16 a[140:143], a[228:231], v[100:103], a[140:143]
v_accvgpr_read_b32 v59, a91
v_accvgpr_read_b32 v60, a92
v_accvgpr_read_b32 v61, a93
v_accvgpr_read_b32 v62, a94
v_accvgpr_read_b32 v63, a95
v_mfma_f32_16x16x32_bf16 a[144:147], a[232:235], v[96:99], a[144:147]
ds_read_b64_tr_b16 a[228:229], v1 offset:20480
ds_read_b64_tr_b16 a[230:231], v1 offset:22528
v_cvt_pk_bf16_f32 v48, v48, v49
v_cvt_pk_bf16_f32 v49, v50, v51
v_cvt_pk_bf16_f32 v50, v52, v53
v_mfma_f32_16x16x32_bf16 a[152:155], a[232:235], v[100:103], a[152:155]
v_cvt_pk_bf16_f32 v51, v54, v55
v_cvt_pk_bf16_f32 v52, v56, v57
v_cvt_pk_bf16_f32 v53, v58, v59
v_cvt_pk_bf16_f32 v54, v60, v61
v_cvt_pk_bf16_f32 v55, v62, v63
v_mfma_f32_16x16x32_bf16 a[148:151], a[236:239], v[96:99], a[148:151]
ds_read_b64_tr_b16 a[232:233], v2 offset:20480
ds_read_b64_tr_b16 a[234:235], v2 offset:22528
buffer_store_dwordx4 v[48:51], v16, s[72:75], 0 offen offset:1280 sc1
ds_write_b128 v18, v[48:51] offset:1280
v_mfma_f32_16x16x32_bf16 a[156:159], a[236:239], v[100:103], a[156:159]
buffer_store_dwordx4 v[52:55], v17, s[72:75], 0 offen offset:1280 sc1
ds_write_b128 v19, v[52:55] offset:1280
s_waitcnt lgkmcnt(8)
v_mfma_f32_16x16x32_bf16 a[160:163], a[240:243], v[96:99], a[160:163]
ds_read_b64_tr_b16 a[236:237], v3 offset:20480
ds_read_b64_tr_b16 a[238:239], v3 offset:22528
v_accvgpr_read_b32 v64, a96
v_accvgpr_read_b32 v65, a97
v_accvgpr_read_b32 v66, a98
v_mfma_f32_16x16x32_bf16 a[168:171], a[240:243], v[100:103], a[168:171]
v_accvgpr_read_b32 v67, a99
v_accvgpr_read_b32 v68, a100
v_accvgpr_read_b32 v69, a101
v_accvgpr_read_b32 v70, a102
v_accvgpr_read_b32 v71, a103
v_mfma_f32_16x16x32_bf16 a[164:167], a[244:247], v[96:99], a[164:167]
ds_read_b64_tr_b16 a[240:241], v0 offset:28672
ds_read_b64_tr_b16 a[242:243], v0 offset:30720
v_accvgpr_read_b32 v72, a104
v_accvgpr_read_b32 v73, a105
v_accvgpr_read_b32 v74, a106
v_mfma_f32_16x16x32_bf16 a[172:175], a[244:247], v[100:103], a[172:175]
v_accvgpr_read_b32 v75, a107
v_accvgpr_read_b32 v76, a108
v_accvgpr_read_b32 v77, a109
v_accvgpr_read_b32 v78, a110
v_accvgpr_read_b32 v79, a111
v_mfma_f32_16x16x32_bf16 a[176:179], a[248:251], v[96:99], a[176:179]
ds_read_b64_tr_b16 a[244:245], v1 offset:28672
ds_read_b64_tr_b16 a[246:247], v1 offset:30720
v_cvt_pk_bf16_f32 v64, v64, v65
v_cvt_pk_bf16_f32 v65, v66, v67
v_cvt_pk_bf16_f32 v66, v68, v69
v_mfma_f32_16x16x32_bf16 a[184:187], a[248:251], v[100:103], a[184:187]
v_cvt_pk_bf16_f32 v67, v70, v71
v_cvt_pk_bf16_f32 v68, v72, v73
v_cvt_pk_bf16_f32 v69, v74, v75
v_cvt_pk_bf16_f32 v70, v76, v77
v_cvt_pk_bf16_f32 v71, v78, v79
v_mfma_f32_16x16x32_bf16 a[180:183], a[252:255], v[96:99], a[180:183]
ds_read_b64_tr_b16 a[248:249], v2 offset:28672
ds_read_b64_tr_b16 a[250:251], v2 offset:30720
buffer_store_dwordx4 v[64:67], v16, s[72:75], 0 offen offset:1536 sc1
ds_write_b128 v18, v[64:67] offset:1536
v_mfma_f32_16x16x32_bf16 a[188:191], a[252:255], v[100:103], a[188:191]
buffer_store_dwordx4 v[68:71], v17, s[72:75], 0 offen offset:1536 sc1
ds_write_b128 v19, v[68:71] offset:1536
s_waitcnt lgkmcnt(8)
v_mfma_f32_16x16x32_bf16 a[128:131], a[224:227], v[104:107], a[128:131]
ds_read_b64_tr_b16 a[252:253], v3 offset:28672
ds_read_b64_tr_b16 a[254:255], v3 offset:30720
v_accvgpr_read_b32 v80, a112
v_accvgpr_read_b32 v81, a113
v_accvgpr_read_b32 v82, a114
v_mfma_f32_16x16x32_bf16 a[136:139], a[224:227], v[108:111], a[136:139]
v_accvgpr_read_b32 v83, a115
v_accvgpr_read_b32 v84, a116
v_accvgpr_read_b32 v85, a117
v_accvgpr_read_b32 v86, a118
v_accvgpr_read_b32 v87, a119
v_mfma_f32_16x16x32_bf16 a[132:135], a[228:231], v[104:107], a[132:135]
ds_read_b64_tr_b16 a[224:225], v0 offset:0
ds_read_b64_tr_b16 a[226:227], v0 offset:2048
v_accvgpr_read_b32 v88, a120
v_accvgpr_read_b32 v89, a121
v_accvgpr_read_b32 v90, a122
v_mfma_f32_16x16x32_bf16 a[140:143], a[228:231], v[108:111], a[140:143]
v_accvgpr_read_b32 v91, a123
v_accvgpr_read_b32 v92, a124
v_accvgpr_read_b32 v93, a125
v_accvgpr_read_b32 v94, a126
v_accvgpr_read_b32 v95, a127
v_mfma_f32_16x16x32_bf16 a[144:147], a[232:235], v[104:107], a[144:147]
ds_read_b64_tr_b16 a[228:229], v1 offset:0
ds_read_b64_tr_b16 a[230:231], v1 offset:2048
v_cvt_pk_bf16_f32 v80, v80, v81
v_cvt_pk_bf16_f32 v81, v82, v83
v_cvt_pk_bf16_f32 v82, v84, v85
v_mfma_f32_16x16x32_bf16 a[152:155], a[232:235], v[108:111], a[152:155]
v_cvt_pk_bf16_f32 v83, v86, v87
v_cvt_pk_bf16_f32 v84, v88, v89
v_cvt_pk_bf16_f32 v85, v90, v91
v_cvt_pk_bf16_f32 v86, v92, v93
v_cvt_pk_bf16_f32 v87, v94, v95
v_mfma_f32_16x16x32_bf16 a[148:151], a[236:239], v[104:107], a[148:151]
ds_read_b64_tr_b16 a[232:233], v0 offset:4096
ds_read_b64_tr_b16 a[234:235], v0 offset:6144
buffer_store_dwordx4 v[80:83], v16, s[72:75], 0 offen offset:1792 sc1
ds_write_b128 v18, v[80:83] offset:1792
v_mfma_f32_16x16x32_bf16 a[156:159], a[236:239], v[108:111], a[156:159]
buffer_store_dwordx4 v[84:87], v17, s[72:75], 0 offen offset:1792 sc1
ds_write_b128 v19, v[84:87] offset:1792
s_waitcnt lgkmcnt(8)
v_mfma_f32_16x16x32_bf16 a[160:163], a[240:243], v[104:107], a[160:163]
ds_read_b64_tr_b16 a[236:237], v1 offset:4096
ds_read_b64_tr_b16 a[238:239], v1 offset:6144
v_mov_b32 v26, 2
v_mfma_f32_16x16x32_bf16 a[168:171], a[240:243], v[108:111], a[168:171]
s_waitcnt vmcnt(8)
buffer_store_dword v26, v20, s[68:71], s89 offen sc1
v_mfma_f32_16x16x32_bf16 a[164:167], a[244:247], v[104:107], a[164:167]
ds_read_b64_tr_b16 a[240:241], v2 offset:0
v_mfma_f32_16x16x32_bf16 a[172:175], a[244:247], v[108:111], a[172:175]
ds_read_b64_tr_b16 a[242:243], v2 offset:2048
v_mfma_f32_16x16x32_bf16 a[176:179], a[248:251], v[104:107], a[176:179]
ds_read_b64_tr_b16 a[244:245], v3 offset:0
v_mfma_f32_16x16x32_bf16 a[184:187], a[248:251], v[108:111], a[184:187]
ds_read_b64_tr_b16 a[246:247], v3 offset:2048
v_mfma_f32_16x16x32_bf16 a[180:183], a[252:255], v[104:107], a[180:183]
ds_read_b64_tr_b16 a[248:249], v2 offset:4096
v_mfma_f32_16x16x32_bf16 a[188:191], a[252:255], v[108:111], a[188:191]
ds_read_b64_tr_b16 a[250:251], v2 offset:6144
L_step_121:
s_waitcnt lgkmcnt(6)
v_mfma_f32_16x16x32_bf16 a[128:131], a[224:227], v[112:115], a[128:131]
ds_read_b64_tr_b16 a[252:253], v3 offset:4096
v_mfma_f32_16x16x32_bf16 a[136:139], a[224:227], v[116:119], a[136:139]
ds_read_b64_tr_b16 a[254:255], v3 offset:6144
v_mfma_f32_16x16x32_bf16 a[132:135], a[228:231], v[112:115], a[132:135]
ds_read_b64_tr_b16 a[224:225], v0 offset:8192
v_mfma_f32_16x16x32_bf16 a[140:143], a[228:231], v[116:119], a[140:143]
ds_read_b64_tr_b16 a[226:227], v0 offset:10240
v_mfma_f32_16x16x32_bf16 a[128:131], a[232:235], v[120:123], a[128:131]
ds_read_b64_tr_b16 a[228:229], v1 offset:8192
v_mfma_f32_16x16x32_bf16 a[136:139], a[232:235], v[124:127], a[136:139]
ds_read_b64_tr_b16 a[230:231], v1 offset:10240
v_mfma_f32_16x16x32_bf16 a[132:135], a[236:239], v[120:123], a[132:135]
ds_read_b64_tr_b16 a[232:233], v0 offset:12288
v_mfma_f32_16x16x32_bf16 a[140:143], a[236:239], v[124:127], a[140:143]
ds_read_b64_tr_b16 a[234:235], v0 offset:14336
s_waitcnt lgkmcnt(6)
v_mfma_f32_16x16x32_bf16 a[144:147], a[240:243], v[112:115], a[144:147]
ds_read_b64_tr_b16 a[236:237], v1 offset:12288
v_mfma_f32_16x16x32_bf16 a[152:155], a[240:243], v[116:119], a[152:155]
ds_read_b64_tr_b16 a[238:239], v1 offset:14336
v_mfma_f32_16x16x32_bf16 a[148:151], a[244:247], v[112:115], a[148:151]
ds_read_b64_tr_b16 a[240:241], v2 offset:8192
ds_read_b64_tr_b16 a[242:243], v2 offset:10240
v_accvgpr_read_b32 v32, a128
v_accvgpr_read_b32 v33, a129
v_mfma_f32_16x16x32_bf16 a[156:159], a[244:247], v[116:119], a[156:159]
v_accvgpr_read_b32 v34, a130
v_accvgpr_read_b32 v35, a131
v_accvgpr_read_b32 v36, a132
v_accvgpr_read_b32 v37, a133
v_accvgpr_read_b32 v38, a134
v_mfma_f32_16x16x32_bf16 a[144:147], a[248:251], v[120:123], a[144:147]
ds_read_b64_tr_b16 a[244:245], v3 offset:8192
ds_read_b64_tr_b16 a[246:247], v3 offset:10240
v_accvgpr_read_b32 v39, a135
v_accvgpr_read_b32 v40, a136
v_mfma_f32_16x16x32_bf16 a[152:155], a[248:251], v[124:127], a[152:155]
v_accvgpr_read_b32 v41, a137
v_accvgpr_read_b32 v42, a138
v_accvgpr_read_b32 v43, a139
v_accvgpr_read_b32 v44, a140
v_mfma_f32_16x16x32_bf16 a[148:151], a[252:255], v[120:123], a[148:151]
ds_read_b64_tr_b16 a[248:249], v2 offset:12288
ds_read_b64_tr_b16 a[250:251], v2 offset:14336
v_accvgpr_read_b32 v45, a141
v_accvgpr_read_b32 v46, a142
v_mfma_f32_16x16x32_bf16 a[156:159], a[252:255], v[124:127], a[156:159]
v_accvgpr_read_b32 v47, a143
v_cvt_pk_bf16_f32 v32, v32, v33
v_cvt_pk_bf16_f32 v33, v34, v35
v_cvt_pk_bf16_f32 v34, v36, v37
s_waitcnt lgkmcnt(6)
v_mfma_f32_16x16x32_bf16 a[160:163], a[224:227], v[112:115], a[160:163]
ds_read_b64_tr_b16 a[252:253], v3 offset:12288
ds_read_b64_tr_b16 a[254:255], v3 offset:14336
v_cvt_pk_bf16_f32 v35, v38, v39
v_mfma_f32_16x16x32_bf16 a[168:171], a[224:227], v[116:119], a[168:171]
v_cvt_pk_bf16_f32 v36, v40, v41
v_cvt_pk_bf16_f32 v37, v42, v43
v_cvt_pk_bf16_f32 v38, v44, v45
v_cvt_pk_bf16_f32 v39, v46, v47
v_mfma_f32_16x16x32_bf16 a[164:167], a[228:231], v[112:115], a[164:167]
ds_read_b64_tr_b16 a[224:225], v0 offset:32768
ds_read_b64_tr_b16 a[226:227], v0 offset:34816
buffer_store_dwordx4 v[32:35], v16, s[72:75], 0 offen offset:2048 sc1
v_mfma_f32_16x16x32_bf16 a[172:175], a[228:231], v[116:119], a[172:175]
ds_write_b128 v18, v[32:35] offset:2048
buffer_store_dwordx4 v[36:39], v17, s[72:75], 0 offen offset:2048 sc1
ds_write_b128 v19, v[36:39] offset:2048
v_mfma_f32_16x16x32_bf16 a[160:163], a[232:235], v[120:123], a[160:163]
ds_read_b64_tr_b16 a[228:229], v1 offset:32768
ds_read_b64_tr_b16 a[230:231], v1 offset:34816
v_accvgpr_read_b32 v48, a144
v_accvgpr_read_b32 v49, a145
v_accvgpr_read_b32 v50, a146
v_mfma_f32_16x16x32_bf16 a[168:171], a[232:235], v[124:127], a[168:171]
v_accvgpr_read_b32 v51, a147
v_accvgpr_read_b32 v52, a148
v_accvgpr_read_b32 v53, a149
v_accvgpr_read_b32 v54, a150
v_accvgpr_read_b32 v55, a151
v_mfma_f32_16x16x32_bf16 a[164:167], a[236:239], v[120:123], a[164:167]
ds_read_b64_tr_b16 a[232:233], v2 offset:32768
ds_read_b64_tr_b16 a[234:235], v2 offset:34816
v_mov_b32 v26, 3
s_waitcnt vmcnt(3)
buffer_store_dword v26, v20, s[68:71], s89 offen sc1
v_mfma_f32_16x16x32_bf16 a[172:175], a[236:239], v[124:127], a[172:175]
v_accvgpr_read_b32 v56, a152
v_accvgpr_read_b32 v57, a153
v_accvgpr_read_b32 v58, a154
v_accvgpr_read_b32 v59, a155
v_accvgpr_read_b32 v60, a156
s_waitcnt lgkmcnt(8)
v_mfma_f32_16x16x32_bf16 a[176:179], a[240:243], v[112:115], a[176:179]
ds_read_b64_tr_b16 a[236:237], v3 offset:32768
ds_read_b64_tr_b16 a[238:239], v3 offset:34816
v_accvgpr_read_b32 v61, a157
v_accvgpr_read_b32 v62, a158
v_accvgpr_read_b32 v63, a159
v_mfma_f32_16x16x32_bf16 a[184:187], a[240:243], v[116:119], a[184:187]
v_cvt_pk_bf16_f32 v48, v48, v49
v_cvt_pk_bf16_f32 v49, v50, v51
v_cvt_pk_bf16_f32 v50, v52, v53
v_cvt_pk_bf16_f32 v51, v54, v55
v_cvt_pk_bf16_f32 v52, v56, v57
v_cvt_pk_bf16_f32 v53, v58, v59
v_mfma_f32_16x16x32_bf16 a[180:183], a[244:247], v[112:115], a[180:183]
ds_read_b64_tr_b16 a[240:241], v0 offset:36864
ds_read_b64_tr_b16 a[242:243], v0 offset:38912
v_cvt_pk_bf16_f32 v54, v60, v61
v_cvt_pk_bf16_f32 v55, v62, v63
buffer_store_dwordx4 v[48:51], v16, s[72:75], 0 offen offset:2304 sc1
v_mfma_f32_16x16x32_bf16 a[188:191], a[244:247], v[116:119], a[188:191]
ds_write_b128 v18, v[48:51] offset:2304
buffer_store_dwordx4 v[52:55], v17, s[72:75], 0 offen offset:2304 sc1
ds_write_b128 v19, v[52:55] offset:2304
v_mfma_f32_16x16x32_bf16 a[176:179], a[248:251], v[120:123], a[176:179]
ds_read_b64_tr_b16 a[244:245], v1 offset:36864
ds_read_b64_tr_b16 a[246:247], v1 offset:38912
v_accvgpr_read_b32 v64, a160
v_accvgpr_read_b32 v65, a161
v_accvgpr_read_b32 v66, a162
v_mfma_f32_16x16x32_bf16 a[184:187], a[248:251], v[124:127], a[184:187]
v_accvgpr_read_b32 v67, a163
v_accvgpr_read_b32 v68, a164
v_accvgpr_read_b32 v69, a165
v_accvgpr_read_b32 v70, a166
v_accvgpr_read_b32 v71, a167
v_mfma_f32_16x16x32_bf16 a[180:183], a[252:255], v[120:123], a[180:183]
ds_read_b64_tr_b16 a[248:249], v2 offset:36864
ds_read_b64_tr_b16 a[250:251], v2 offset:38912
v_accvgpr_read_b32 v72, a168
v_accvgpr_read_b32 v73, a169
v_accvgpr_read_b32 v74, a170
v_mfma_f32_16x16x32_bf16 a[188:191], a[252:255], v[124:127], a[188:191]
v_accvgpr_read_b32 v75, a171
v_accvgpr_read_b32 v76, a172
v_accvgpr_read_b32 v77, a173
v_accvgpr_read_b32 v78, a174
L_step_122:
s_waitcnt lgkmcnt(8)
v_mfma_f32_16x16x32_bf16 a[192:195], a[224:227], v[96:99], a[192:195]
ds_read_b64_tr_b16 a[252:253], v3 offset:36864
ds_read_b64_tr_b16 a[254:255], v3 offset:38912
v_accvgpr_read_b32 v79, a175
v_cvt_pk_bf16_f32 v64, v64, v65
v_cvt_pk_bf16_f32 v65, v66, v67
v_mfma_f32_16x16x32_bf16 a[200:203], a[224:227], v[100:103], a[200:203]
v_cvt_pk_bf16_f32 v66, v68, v69
v_cvt_pk_bf16_f32 v67, v70, v71
v_cvt_pk_bf16_f32 v68, v72, v73
v_cvt_pk_bf16_f32 v69, v74, v75
v_cvt_pk_bf16_f32 v70, v76, v77
v_mfma_f32_16x16x32_bf16 a[196:199], a[228:231], v[96:99], a[196:199]
ds_read_b64_tr_b16 a[224:225], v0 offset:49152
ds_read_b64_tr_b16 a[226:227], v0 offset:51200
v_cvt_pk_bf16_f32 v71, v78, v79
buffer_store_dwordx4 v[64:67], v16, s[72:75], 0 offen offset:2560 sc1
v_mfma_f32_16x16x32_bf16 a[204:207], a[228:231], v[100:103], a[204:207]
ds_write_b128 v18, v[64:67] offset:2560
buffer_store_dwordx4 v[68:71], v17, s[72:75], 0 offen offset:2560 sc1
ds_write_b128 v19, v[68:71] offset:2560
v_mfma_f32_16x16x32_bf16 a[208:211], a[232:235], v[96:99], a[208:211]
ds_read_b64_tr_b16 a[228:229], v1 offset:49152
ds_read_b64_tr_b16 a[230:231], v1 offset:51200
v_accvgpr_read_b32 v80, a176
v_accvgpr_read_b32 v81, a177
v_accvgpr_read_b32 v82, a178
v_mfma_f32_16x16x32_bf16 a[216:219], a[232:235], v[100:103], a[216:219]
v_accvgpr_read_b32 v83, a179
v_accvgpr_read_b32 v84, a180
v_accvgpr_read_b32 v85, a181
v_accvgpr_read_b32 v86, a182
v_accvgpr_read_b32 v87, a183
v_mfma_f32_16x16x32_bf16 a[212:215], a[236:239], v[96:99], a[212:215]
ds_read_b64_tr_b16 a[232:233], v0 offset:53248
ds_read_b64_tr_b16 a[234:235], v0 offset:55296
v_accvgpr_read_b32 v88, a184
v_accvgpr_read_b32 v89, a185
v_accvgpr_read_b32 v90, a186
v_mfma_f32_16x16x32_bf16 a[220:223], a[236:239], v[100:103], a[220:223]
v_accvgpr_read_b32 v91, a187
v_accvgpr_read_b32 v92, a188
v_accvgpr_read_b32 v93, a189
v_accvgpr_read_b32 v94, a190
s_waitcnt lgkmcnt(8)
v_mfma_f32_16x16x32_bf16 a[192:195], a[240:243], v[104:107], a[192:195]
ds_read_b64_tr_b16 a[236:237], v1 offset:53248
ds_read_b64_tr_b16 a[238:239], v1 offset:55296
v_accvgpr_read_b32 v95, a191
v_cvt_pk_bf16_f32 v80, v80, v81
v_cvt_pk_bf16_f32 v81, v82, v83
v_mfma_f32_16x16x32_bf16 a[200:203], a[240:243], v[108:111], a[200:203]
v_cvt_pk_bf16_f32 v82, v84, v85
v_cvt_pk_bf16_f32 v83, v86, v87
v_cvt_pk_bf16_f32 v84, v88, v89
v_cvt_pk_bf16_f32 v85, v90, v91
v_cvt_pk_bf16_f32 v86, v92, v93
v_mfma_f32_16x16x32_bf16 a[196:199], a[244:247], v[104:107], a[196:199]
ds_read_b64_tr_b16 a[240:241], v2 offset:49152
ds_read_b64_tr_b16 a[242:243], v2 offset:51200
v_cvt_pk_bf16_f32 v87, v94, v95
buffer_store_dwordx4 v[80:83], v16, s[72:75], 0 offen offset:2816 sc1
v_mfma_f32_16x16x32_bf16 a[204:207], a[244:247], v[108:111], a[204:207]
ds_write_b128 v18, v[80:83] offset:2816
buffer_store_dwordx4 v[84:87], v17, s[72:75], 0 offen offset:2816 sc1
ds_write_b128 v19, v[84:87] offset:2816
v_mfma_f32_16x16x32_bf16 a[208:211], a[248:251], v[104:107], a[208:211]
ds_read_b64_tr_b16 a[244:245], v3 offset:49152
v_mfma_f32_16x16x32_bf16 a[216:219], a[248:251], v[108:111], a[216:219]
ds_read_b64_tr_b16 a[246:247], v3 offset:51200
v_mfma_f32_16x16x32_bf16 a[212:215], a[252:255], v[104:107], a[212:215]
ds_read_b64_tr_b16 a[248:249], v2 offset:53248
v_mfma_f32_16x16x32_bf16 a[220:223], a[252:255], v[108:111], a[220:223]
ds_read_b64_tr_b16 a[250:251], v2 offset:55296
L_step_123:
s_waitcnt lgkmcnt(8)
v_mfma_f32_16x16x32_bf16 a[192:195], a[224:227], v[112:115], a[192:195]
ds_read_b64_tr_b16 a[252:253], v3 offset:53248
v_mfma_f32_16x16x32_bf16 a[200:203], a[224:227], v[116:119], a[200:203]
ds_read_b64_tr_b16 a[254:255], v3 offset:55296
v_mfma_f32_16x16x32_bf16 a[196:199], a[228:231], v[112:115], a[196:199]
v_mfma_f32_16x16x32_bf16 a[204:207], a[228:231], v[116:119], a[204:207]
v_mfma_f32_16x16x32_bf16 a[192:195], a[232:235], v[120:123], a[192:195]
v_mfma_f32_16x16x32_bf16 a[200:203], a[232:235], v[124:127], a[200:203]
v_mfma_f32_16x16x32_bf16 a[196:199], a[236:239], v[120:123], a[196:199]
v_mfma_f32_16x16x32_bf16 a[204:207], a[236:239], v[124:127], a[204:207]
s_waitcnt lgkmcnt(0)
v_mfma_f32_16x16x32_bf16 a[208:211], a[240:243], v[112:115], a[208:211]
v_mfma_f32_16x16x32_bf16 a[216:219], a[240:243], v[116:119], a[216:219]
v_mfma_f32_16x16x32_bf16 a[212:215], a[244:247], v[112:115], a[212:215]
s_nop 0
v_accvgpr_read_b32 v32, a192
v_accvgpr_read_b32 v33, a193
v_mfma_f32_16x16x32_bf16 a[220:223], a[244:247], v[116:119], a[220:223]
v_accvgpr_read_b32 v34, a194
v_accvgpr_read_b32 v35, a195
v_mfma_f32_16x16x32_bf16 a[208:211], a[248:251], v[120:123], a[208:211]
v_accvgpr_read_b32 v36, a196
v_accvgpr_read_b32 v37, a197
v_mfma_f32_16x16x32_bf16 a[216:219], a[248:251], v[124:127], a[216:219]
v_accvgpr_read_b32 v38, a198
v_accvgpr_read_b32 v39, a199
v_mfma_f32_16x16x32_bf16 a[212:215], a[252:255], v[120:123], a[212:215]
v_accvgpr_read_b32 v40, a200
v_accvgpr_read_b32 v41, a201
v_mfma_f32_16x16x32_bf16 a[220:223], a[252:255], v[124:127], a[220:223]
v_accvgpr_read_b32 v42, a202
v_accvgpr_read_b32 v43, a203
v_accvgpr_read_b32 v44, a204
v_accvgpr_read_b32 v45, a205
v_accvgpr_read_b32 v46, a206
v_accvgpr_read_b32 v47, a207
v_cvt_pk_bf16_f32 v32, v32, v33
v_cvt_pk_bf16_f32 v33, v34, v35
v_cvt_pk_bf16_f32 v34, v36, v37
v_cvt_pk_bf16_f32 v35, v38, v39
v_cvt_pk_bf16_f32 v36, v40, v41
v_cvt_pk_bf16_f32 v37, v42, v43
v_cvt_pk_bf16_f32 v38, v44, v45
v_cvt_pk_bf16_f32 v39, v46, v47
buffer_store_dwordx4 v[32:35], v16, s[72:75], 0 offen offset:3072 sc1
ds_write_b128 v18, v[32:35] offset:3072
buffer_store_dwordx4 v[36:39], v17, s[72:75], 0 offen offset:3072 sc1
ds_write_b128 v19, v[36:39] offset:3072
v_accvgpr_read_b32 v48, a208
v_accvgpr_read_b32 v49, a209
v_accvgpr_read_b32 v50, a210
v_accvgpr_read_b32 v51, a211
v_accvgpr_read_b32 v52, a212
v_accvgpr_read_b32 v53, a213
v_accvgpr_read_b32 v54, a214
v_accvgpr_read_b32 v55, a215
v_accvgpr_read_b32 v56, a216
v_accvgpr_read_b32 v57, a217
v_accvgpr_read_b32 v58, a218
v_accvgpr_read_b32 v59, a219
v_accvgpr_read_b32 v60, a220
v_accvgpr_read_b32 v61, a221
v_accvgpr_read_b32 v62, a222
v_accvgpr_read_b32 v63, a223
v_cvt_pk_bf16_f32 v48, v48, v49
v_cvt_pk_bf16_f32 v49, v50, v51
v_cvt_pk_bf16_f32 v50, v52, v53
v_cvt_pk_bf16_f32 v51, v54, v55
L_pg23:
s_cbranch_scc1 L_rt1
v_cvt_pk_bf16_f32 v52, v56, v57
v_cvt_pk_bf16_f32 v53, v58, v59
v_cvt_pk_bf16_f32 v54, v60, v61
v_cvt_pk_bf16_f32 v55, v62, v63
buffer_store_dwordx4 v[48:51], v16, s[72:75], 0 offen offset:3328 sc1
ds_write_b128 v18, v[48:51] offset:3328
buffer_store_dwordx4 v[52:55], v17, s[72:75], 0 offen offset:3328 sc1
ds_write_b128 v19, v[52:55] offset:3328
L_ttail:
buffer_load_dword v25, v23, s[68:71], s1 offen sc1
s_mov_b32 s47, 0
ds_read_b128 v[128:131], v27 offset:0
ds_read_b128 v[160:163], v27 offset:1024
ds_read_b128 v[192:195], v27 offset:2048
ds_read_b128 v[224:227], v27 offset:3072
v_mov_b32 v26, 4
v_mov_b32 v24, 5
s_waitcnt vmcnt(5)
buffer_store_dword v26, v20, s[68:71], s89 offen sc1
s_waitcnt vmcnt(2)
buffer_store_dword v24, v20, s[68:71], s89 offen sc1
s_waitcnt lgkmcnt(0)
s_cmp_ge_u32 s93, 8
s_cbranch_scc0 L_poll0
L_go0:
buffer_load_dword v27, v23, s[68:71], s1 offen sc1
s_waitcnt vmcnt(3)
L_p0:
v_cmp_lt_u32 vcc, 1, v25
s_add_u32 s47, s47, 1
s_or_b32 s44, vcc_lo, s85
s_cmp_eq_u32 s44, 0xff
s_cbranch_scc1 L_g0
buffer_load_dword v25, v23, s[68:71], s1 offen sc1
s_sleep 8
s_waitcnt vmcnt(0)
s_cmp_lt_u32 s47, 0x400000
s_cbranch_scc1 L_p0
L_g0:
s_mov_b32 s46, 16384
buffer_load_dwordx4 v[132:135], v21, s[28:31], s46 offen offset:0 sc1
s_mov_b32 s46, 32768
buffer_load_dwordx4 v[136:139], v21, s[28:31], s46 offen offset:0 sc1
s_mov_b32 s46, 49152
buffer_load_dwordx4 v[140:143], v21, s[28:31], s46 offen offset:0 sc1
s_mov_b32 s46, 65536
buffer_load_dwordx4 v[144:147], v21, s[28:31], s46 offen offset:0 sc1
s_mov_b32 s46, 81920
buffer_load_dwordx4 v[148:151], v21, s[28:31], s46 offen offset:0 sc1
s_mov_b32 s46, 98304
buffer_load_dwordx4 v[152:155], v21, s[28:31], s46 offen offset:0 sc1
s_mov_b32 s46, 114688
buffer_load_dwordx4 v[156:159], v21, s[28:31], s46 offen offset:0 sc1
L_p1:
v_cmp_lt_u32 vcc, 2, v25
s_add_u32 s47, s47, 1
s_or_b32 s44, vcc_lo, s85
s_cmp_eq_u32 s44, 0xff
s_cbranch_scc1 L_g1
buffer_load_dword v25, v23, s[68:71], s1 offen sc1
s_sleep 8
s_waitcnt vmcnt(0)
s_cmp_lt_u32 s47, 0x400000
s_cbranch_scc1 L_p1
L_g1:
s_mov_b32 s46, 16384
buffer_load_dwordx4 v[164:167], v21, s[28:31], s46 offen offset:1024 sc1
s_mov_b32 s46, 32768
buffer_load_dwordx4 v[168:171], v21, s[28:31], s46 offen offset:1024 sc1
s_mov_b32 s46, 49152
buffer_load_dwordx4 v[172:175], v21, s[28:31], s46 offen offset:1024 sc1
s_mov_b32 s46, 65536
buffer_load_dwordx4 v[176:179], v21, s[28:31], s46 offen offset:1024 sc1
s_mov_b32 s46, 81920
buffer_load_dwordx4 v[180:183], v21, s[28:31], s46 offen offset:1024 sc1
s_mov_b32 s46, 98304
buffer_load_dwordx4 v[184:187], v21, s[28:31], s46 offen offset:1024 sc1
s_mov_b32 s46, 114688
buffer_load_dwordx4 v[188:191], v21, s[28:31], s46 offen offset:1024 sc1
s_waitcnt vmcnt(14)
v_max_u32 v25, v25, v27
L_p2:
v_cmp_lt_u32 vcc, 3, v25
s_add_u32 s47, s47, 1
s_or_b32 s44, vcc_lo, s85
s_cmp_eq_u32 s44, 0xff
s_cbranch_scc1 L_g2
buffer_load_dword v25, v23, s[68:71], s1 offen sc1
s_sleep 8
s_waitcnt vmcnt(0)
s_cmp_lt_u32 s47, 0x400000
s_cbranch_scc1 L_p2
L_g2:
s_mov_b32 s46, 16384
buffer_load_dwordx4 v[196:199], v21, s[28:31], s46 offen offset:2048 sc1
s_mov_b32 s46, 32768
buffer_load_dwordx4 v[200:203], v21, s[28:31], s46 offen offset:2048 sc1
s_mov_b32 s46, 49152
buffer_load_dwordx4 v[204:207], v21, s[28:31], s46 offen offset:2048 sc1
s_mov_b32 s46, 65536
buffer_load_dwordx4 v[208:211], v21, s[28:31], s46 offen offset:2048 sc1
s_mov_b32 s46, 81920
buffer_load_dwordx4 v[212:215], v21, s[28:31], s46 offen offset:2048 sc1
s_mov_b32 s46, 98304
buffer_load_dwordx4 v[216:219], v21, s[28:31], s46 offen offset:2048 sc1
s_mov_b32 s46, 114688
buffer_load_dwordx4 v[220:223], v21, s[28:31], s46 offen offset:2048 sc1
v_cmp_lt_u32 vcc, 4, v25
s_nop 0
s_or_b32 s44, vcc_lo, s85
s_cmp_eq_u32 s44, 0xff
s_cbranch_scc1 L_all
buffer_load_dword v25, v23, s[68:71], s1 offen sc1
s_waitcnt vmcnt(15)
s_cmp_eq_u32 s3, 77
v_lshlrev_b32 v32, 16, v128
v_and_b32 v33, 0xffff0000, v128
v_lshlrev_b32 v34, 16, v129
v_and_b32 v35, 0xffff0000, v129
v_lshlrev_b32 v36, 16, v130
v_and_b32 v37, 0xffff0000, v130
v_lshlrev_b32 v38, 16, v131
v_and_b32 v39, 0xffff0000, v131
v_lshlrev_b32 v40, 16, v132
v_and_b32 v41, 0xffff0000, v132
v_lshlrev_b32 v42, 16, v133
v_and_b32 v43, 0xffff0000, v133
v_lshlrev_b32 v44, 16, v134
v_and_b32 v45, 0xffff0000, v134
v_lshlrev_b32 v46, 16, v135
v_and_b32 v47, 0xffff0000, v135
v_pk_add_f32 v[32:33], v[32:33], v[40:41]
v_pk_add_f32 v[34:35], v[34:35], v[42:43]
v_pk_add_f32 v[36:37], v[36:37], v[44:45]
v_pk_add_f32 v[38:39], v[38:39], v[46:47]
v_lshlrev_b32 v40, 16, v136
v_and_b32 v41, 0xffff0000, v136
v_lshlrev_b32 v42, 16, v137
v_and_b32 v43, 0xffff0000, v137
v_lshlrev_b32 v44, 16, v138
v_and_b32 v45, 0xffff0000, v138
v_lshlrev_b32 v46, 16, v139
v_and_b32 v47, 0xffff0000, v139
v_pk_add_f32 v[32:33], v[32:33], v[40:41]
v_pk_add_f32 v[34:35], v[34:35], v[42:43]
v_pk_add_f32 v[36:37], v[36:37], v[44:45]
v_pk_add_f32 v[38:39], v[38:39], v[46:47]
v_lshlrev_b32 v40, 16, v140
v_and_b32 v41, 0xffff0000, v140
v_lshlrev_b32 v42, 16, v141
v_and_b32 v43, 0xffff0000, v141
v_lshlrev_b32 v44, 16, v142
v_and_b32 v45, 0xffff0000, v142
v_lshlrev_b32 v46, 16, v143
v_and_b32 v47, 0xffff0000, v143
v_pk_add_f32 v[32:33], v[32:33], v[40:41]
v_pk_add_f32 v[34:35], v[34:35], v[42:43]
v_pk_add_f32 v[36:37], v[36:37], v[44:45]
v_pk_add_f32 v[38:39], v[38:39], v[46:47]
v_lshlrev_b32 v40, 16, v144
v_and_b32 v41, 0xffff0000, v144
v_lshlrev_b32 v42, 16, v145
v_and_b32 v43, 0xffff0000, v145
v_lshlrev_b32 v44, 16, v146
v_and_b32 v45, 0xffff0000, v146
v_lshlrev_b32 v46, 16, v147
v_and_b32 v47, 0xffff0000, v147
v_pk_add_f32 v[32:33], v[32:33], v[40:41]
v_pk_add_f32 v[34:35], v[34:35], v[42:43]
v_pk_add_f32 v[36:37], v[36:37], v[44:45]
v_pk_add_f32 v[38:39], v[38:39], v[46:47]
v_lshlrev_b32 v40, 16, v148
v_and_b32 v41, 0xffff0000, v148
v_lshlrev_b32 v42, 16, v149
v_and_b32 v43, 0xffff0000, v149
v_lshlrev_b32 v44, 16, v150
v_and_b32 v45, 0xffff0000, v150
v_lshlrev_b32 v46, 16, v151
v_and_b32 v47, 0xffff0000, v151
v_pk_add_f32 v[32:33], v[32:33], v[40:41]
v_pk_add_f32 v[34:35], v[34:35], v[42:43]
v_pk_add_f32 v[36:37], v[36:37], v[44:45]
v_pk_add_f32 v[38:39], v[38:39], v[46:47]
v_lshlrev_b32 v40, 16, v152
v_and_b32 v41, 0xffff0000, v152
v_lshlrev_b32 v42, 16, v153
v_and_b32 v43, 0xffff0000, v153
v_lshlrev_b32 v44, 16, v154
v_and_b32 v45, 0xffff0000, v154
v_lshlrev_b32 v46, 16, v155
v_and_b32 v47, 0xffff0000, v155
v_pk_add_f32 v[32:33], v[32:33], v[40:41]
v_pk_add_f32 v[34:35], v[34:35], v[42:43]
v_pk_add_f32 v[36:37], v[36:37], v[44:45]
v_pk_add_f32 v[38:39], v[38:39], v[46:47]
v_lshlrev_b32 v40, 16, v156
v_and_b32 v41, 0xffff0000, v156
v_lshlrev_b32 v42, 16, v157
v_and_b32 v43, 0xffff0000, v157
v_lshlrev_b32 v44, 16, v158
v_and_b32 v45, 0xffff0000, v158
v_lshlrev_b32 v46, 16, v159
v_and_b32 v47, 0xffff0000, v159
v_pk_add_f32 v[32:33], v[32:33], v[40:41]
v_pk_add_f32 v[34:35], v[34:35], v[42:43]
v_pk_add_f32 v[36:37], v[36:37], v[44:45]
v_pk_add_f32 v[38:39], v[38:39], v[46:47]
v_cvt_pk_bf16_f32 v48, v32, v33
v_cvt_pk_bf16_f32 v49, v34, v35
v_cvt_pk_bf16_f32 v50, v36, v37
v_cvt_pk_bf16_f32 v51, v38, v39
buffer_store_dwordx2 v[48:49], v22, s[76:79], s87 offen offset:0
buffer_store_dwordx2 v[50:51], v22, s[76:79], s87 offen offset:32
s_waitcnt vmcnt(10)
s_cmp_eq_u32 s3, 77
v_lshlrev_b32 v32, 16, v160
v_and_b32 v33, 0xffff0000, v160
v_lshlrev_b32 v34, 16, v161
v_and_b32 v35, 0xffff0000, v161
v_lshlrev_b32 v36, 16, v162
v_and_b32 v37, 0xffff0000, v162
v_lshlrev_b32 v38, 16, v163
v_and_b32 v39, 0xffff0000, v163
v_lshlrev_b32 v40, 16, v164
v_and_b32 v41, 0xffff0000, v164
v_lshlrev_b32 v42, 16, v165
v_and_b32 v43, 0xffff0000, v165
v_lshlrev_b32 v44, 16, v166
v_and_b32 v45, 0xffff0000, v166
v_lshlrev_b32 v46, 16, v167
v_and_b32 v47, 0xffff0000, v167
v_pk_add_f32 v[32:33], v[32:33], v[40:41]
v_pk_add_f32 v[34:35], v[34:35], v[42:43]
v_pk_add_f32 v[36:37], v[36:37], v[44:45]
v_pk_add_f32 v[38:39], v[38:39], v[46:47]
v_lshlrev_b32 v40, 16, v168
v_and_b32 v41, 0xffff0000, v168
v_lshlrev_b32 v42, 16, v169
v_and_b32 v43, 0xffff0000, v169
v_lshlrev_b32 v44, 16, v170
v_and_b32 v45, 0xffff0000, v170
v_lshlrev_b32 v46, 16, v171
v_and_b32 v47, 0xffff0000, v171
v_pk_add_f32 v[32:33], v[32:33], v[40:41]
v_pk_add_f32 v[34:35], v[34:35], v[42:43]
v_pk_add_f32 v[36:37], v[36:37], v[44:45]
v_pk_add_f32 v[38:39], v[38:39], v[46:47]
v_lshlrev_b32 v40, 16, v172
v_and_b32 v41, 0xffff0000, v172
v_lshlrev_b32 v42, 16, v173
v_and_b32 v43, 0xffff0000, v173
v_lshlrev_b32 v44, 16, v174
v_and_b32 v45, 0xffff0000, v174
v_lshlrev_b32 v46, 16, v175
v_and_b32 v47, 0xffff0000, v175
v_pk_add_f32 v[32:33], v[32:33], v[40:41]
v_pk_add_f32 v[34:35], v[34:35], v[42:43]
v_pk_add_f32 v[36:37], v[36:37], v[44:45]
v_pk_add_f32 v[38:39], v[38:39], v[46:47]
v_lshlrev_b32 v40, 16, v176
v_and_b32 v41, 0xffff0000, v176
v_lshlrev_b32 v42, 16, v177
v_and_b32 v43, 0xffff0000, v177
v_lshlrev_b32 v44, 16, v178
v_and_b32 v45, 0xffff0000, v178
v_lshlrev_b32 v46, 16, v179
v_and_b32 v47, 0xffff0000, v179
v_pk_add_f32 v[32:33], v[32:33], v[40:41]
v_pk_add_f32 v[34:35], v[34:35], v[42:43]
v_pk_add_f32 v[36:37], v[36:37], v[44:45]
v_pk_add_f32 v[38:39], v[38:39], v[46:47]
v_lshlrev_b32 v40, 16, v180
v_and_b32 v41, 0xffff0000, v180
v_lshlrev_b32 v42, 16, v181
v_and_b32 v43, 0xffff0000, v181
v_lshlrev_b32 v44, 16, v182
v_and_b32 v45, 0xffff0000, v182
v_lshlrev_b32 v46, 16, v183
v_and_b32 v47, 0xffff0000, v183
v_pk_add_f32 v[32:33], v[32:33], v[40:41]
v_pk_add_f32 v[34:35], v[34:35], v[42:43]
v_pk_add_f32 v[36:37], v[36:37], v[44:45]
v_pk_add_f32 v[38:39], v[38:39], v[46:47]
v_lshlrev_b32 v40, 16, v184
v_and_b32 v41, 0xffff0000, v184
v_lshlrev_b32 v42, 16, v185
v_and_b32 v43, 0xffff0000, v185
v_lshlrev_b32 v44, 16, v186
v_and_b32 v45, 0xffff0000, v186
v_lshlrev_b32 v46, 16, v187
v_and_b32 v47, 0xffff0000, v187
v_pk_add_f32 v[32:33], v[32:33], v[40:41]
v_pk_add_f32 v[34:35], v[34:35], v[42:43]
v_pk_add_f32 v[36:37], v[36:37], v[44:45]
v_pk_add_f32 v[38:39], v[38:39], v[46:47]
v_lshlrev_b32 v40, 16, v188
v_and_b32 v41, 0xffff0000, v188
v_lshlrev_b32 v42, 16, v189
v_and_b32 v43, 0xffff0000, v189
v_lshlrev_b32 v44, 16, v190
v_and_b32 v45, 0xffff0000, v190
v_lshlrev_b32 v46, 16, v191
v_and_b32 v47, 0xffff0000, v191
v_pk_add_f32 v[32:33], v[32:33], v[40:41]
v_pk_add_f32 v[34:35], v[34:35], v[42:43]
v_pk_add_f32 v[36:37], v[36:37], v[44:45]
v_pk_add_f32 v[38:39], v[38:39], v[46:47]
v_cvt_pk_bf16_f32 v52, v32, v33
v_cvt_pk_bf16_f32 v53, v34, v35
v_cvt_pk_bf16_f32 v54, v36, v37
v_cvt_pk_bf16_f32 v55, v38, v39
buffer_store_dwordx2 v[52:53], v22, s[76:79], s87 offen offset:256
buffer_store_dwordx2 v[54:55], v22, s[76:79], s87 offen offset:288
s_waitcnt vmcnt(4)
L_p3:
v_cmp_lt_u32 vcc, 4, v25
s_add_u32 s47, s47, 1
s_or_b32 s44, vcc_lo, s85
s_cmp_eq_u32 s44, 0xff
s_cbranch_scc1 L_g3
buffer_load_dword v25, v23, s[68:71], s1 offen sc1
s_sleep 8
s_waitcnt vmcnt(0)
s_cmp_lt_u32 s47, 0x400000
s_cbranch_scc1 L_p3
L_g3:
s_mov_b32 s46, 16384
buffer_load_dwordx4 v[228:231], v28, s[28:31], s46 offen offset:3072 sc1
s_mov_b32 s46, 32768
buffer_load_dwordx4 v[232:235], v28, s[28:31], s46 offen offset:3072 sc1
s_mov_b32 s46, 49152
buffer_load_dwordx4 v[236:239], v28, s[28:31], s46 offen offset:3072 sc1
s_mov_b32 s46, 65536
buffer_load_dwordx4 v[240:243], v28, s[28:31], s46 offen offset:3072 sc1
s_mov_b32 s46, 81920
buffer_load_dwordx4 v[244:247], v28, s[28:31], s46 offen offset:3072 sc1
s_mov_b32 s46, 98304
buffer_load_dwordx4 v[248:251], v28, s[28:31], s46 offen offset:3072 sc1
s_mov_b32 s46, 114688
buffer_load_dwordx4 v[252:255], v28, s[28:31], s46 offen offset:3072 sc1
s_cmp_eq_u32 s3, 77
v_lshlrev_b32 v32, 16, v192
v_and_b32 v33, 0xffff0000, v192
v_lshlrev_b32 v34, 16, v193
v_and_b32 v35, 0xffff0000, v193
v_lshlrev_b32 v36, 16, v194
v_and_b32 v37, 0xffff0000, v194
v_lshlrev_b32 v38, 16, v195
v_and_b32 v39, 0xffff0000, v195
v_lshlrev_b32 v40, 16, v196
v_and_b32 v41, 0xffff0000, v196
v_lshlrev_b32 v42, 16, v197
v_and_b32 v43, 0xffff0000, v197
v_lshlrev_b32 v44, 16, v198
v_and_b32 v45, 0xffff0000, v198
v_lshlrev_b32 v46, 16, v199
v_and_b32 v47, 0xffff0000, v199
v_pk_add_f32 v[32:33], v[32:33], v[40:41]
v_pk_add_f32 v[34:35], v[34:35], v[42:43]
v_pk_add_f32 v[36:37], v[36:37], v[44:45]
v_pk_add_f32 v[38:39], v[38:39], v[46:47]
v_lshlrev_b32 v40, 16, v200
v_and_b32 v41, 0xffff0000, v200
v_lshlrev_b32 v42, 16, v201
v_and_b32 v43, 0xffff0000, v201
v_lshlrev_b32 v44, 16, v202
v_and_b32 v45, 0xffff0000, v202
v_lshlrev_b32 v46, 16, v203
v_and_b32 v47, 0xffff0000, v203
v_pk_add_f32 v[32:33], v[32:33], v[40:41]
v_pk_add_f32 v[34:35], v[34:35], v[42:43]
v_pk_add_f32 v[36:37], v[36:37], v[44:45]
v_pk_add_f32 v[38:39], v[38:39], v[46:47]
v_lshlrev_b32 v40, 16, v204
v_and_b32 v41, 0xffff0000, v204
v_lshlrev_b32 v42, 16, v205
v_and_b32 v43, 0xffff0000, v205
v_lshlrev_b32 v44, 16, v206
v_and_b32 v45, 0xffff0000, v206
v_lshlrev_b32 v46, 16, v207
v_and_b32 v47, 0xffff0000, v207
v_pk_add_f32 v[32:33], v[32:33], v[40:41]
v_pk_add_f32 v[34:35], v[34:35], v[42:43]
v_pk_add_f32 v[36:37], v[36:37], v[44:45]
v_pk_add_f32 v[38:39], v[38:39], v[46:47]
v_lshlrev_b32 v40, 16, v208
v_and_b32 v41, 0xffff0000, v208
v_lshlrev_b32 v42, 16, v209
v_and_b32 v43, 0xffff0000, v209
v_lshlrev_b32 v44, 16, v210
v_and_b32 v45, 0xffff0000, v210
v_lshlrev_b32 v46, 16, v211
v_and_b32 v47, 0xffff0000, v211
v_pk_add_f32 v[32:33], v[32:33], v[40:41]
v_pk_add_f32 v[34:35], v[34:35], v[42:43]
v_pk_add_f32 v[36:37], v[36:37], v[44:45]
v_pk_add_f32 v[38:39], v[38:39], v[46:47]
v_lshlrev_b32 v40, 16, v212
v_and_b32 v41, 0xffff0000, v212
v_lshlrev_b32 v42, 16, v213
v_and_b32 v43, 0xffff0000, v213
v_lshlrev_b32 v44, 16, v214
v_and_b32 v45, 0xffff0000, v214
v_lshlrev_b32 v46, 16, v215
v_and_b32 v47, 0xffff0000, v215
v_pk_add_f32 v[32:33], v[32:33], v[40:41]
v_pk_add_f32 v[34:35], v[34:35], v[42:43]
v_pk_add_f32 v[36:37], v[36:37], v[44:45]
v_pk_add_f32 v[38:39], v[38:39], v[46:47]
v_lshlrev_b32 v40, 16, v216
v_and_b32 v41, 0xffff0000, v216
v_lshlrev_b32 v42, 16, v217
v_and_b32 v43, 0xffff0000, v217
v_lshlrev_b32 v44, 16, v218
v_and_b32 v45, 0xffff0000, v218
v_lshlrev_b32 v46, 16, v219
v_and_b32 v47, 0xffff0000, v219
v_pk_add_f32 v[32:33], v[32:33], v[40:41]
v_pk_add_f32 v[34:35], v[34:35], v[42:43]
v_pk_add_f32 v[36:37], v[36:37], v[44:45]
v_pk_add_f32 v[38:39], v[38:39], v[46:47]
v_lshlrev_b32 v40, 16, v220
v_and_b32 v41, 0xffff0000, v220
v_lshlrev_b32 v42, 16, v221
v_and_b32 v43, 0xffff0000, v221
v_lshlrev_b32 v44, 16, v222
v_and_b32 v45, 0xffff0000, v222
v_lshlrev_b32 v46, 16, v223
v_and_b32 v47, 0xffff0000, v223
v_pk_add_f32 v[32:33], v[32:33], v[40:41]
v_pk_add_f32 v[34:35], v[34:35], v[42:43]
v_pk_add_f32 v[36:37], v[36:37], v[44:45]
v_pk_add_f32 v[38:39], v[38:39], v[46:47]
v_cvt_pk_bf16_f32 v56, v32, v33
v_cvt_pk_bf16_f32 v57, v34, v35
v_cvt_pk_bf16_f32 v58, v36, v37
v_cvt_pk_bf16_f32 v59, v38, v39
buffer_store_dwordx2 v[56:57], v22, s[76:79], s87 offen offset:512
buffer_store_dwordx2 v[58:59], v22, s[76:79], s87 offen offset:544
s_cmp_eq_u32 s3, 77
v_lshlrev_b32 v32, 16, v224
v_and_b32 v33, 0xffff0000, v224
v_lshlrev_b32 v34, 16, v225
v_and_b32 v35, 0xffff0000, v225
v_lshlrev_b32 v36, 16, v226
v_and_b32 v37, 0xffff0000, v226
v_lshlrev_b32 v38, 16, v227
v_and_b32 v39, 0xffff0000, v227
s_waitcnt vmcnt(8)
v_lshlrev_b32 v40, 16, v228
v_and_b32 v41, 0xffff0000, v228
v_lshlrev_b32 v42, 16, v229
v_and_b32 v43, 0xffff0000, v229
v_lshlrev_b32 v44, 16, v230
v_and_b32 v45, 0xffff0000, v230
v_lshlrev_b32 v46, 16, v231
v_and_b32 v47, 0xffff0000, v231
v_pk_add_f32 v[32:33], v[32:33], v[40:41]
v_pk_add_f32 v[34:35], v[34:35], v[42:43]
v_pk_add_f32 v[36:37], v[36:37], v[44:45]
v_pk_add_f32 v[38:39], v[38:39], v[46:47]
s_waitcnt vmcnt(7)
v_lshlrev_b32 v40, 16, v232
v_and_b32 v41, 0xffff0000, v232
v_lshlrev_b32 v42, 16, v233
v_and_b32 v43, 0xffff0000, v233
v_lshlrev_b32 v44, 16, v234
v_and_b32 v45, 0xffff0000, v234
v_lshlrev_b32 v46, 16, v235
v_and_b32 v47, 0xffff0000, v235
v_pk_add_f32 v[32:33], v[32:33], v[40:41]
v_pk_add_f32 v[34:35], v[34:35], v[42:43]
v_pk_add_f32 v[36:37], v[36:37], v[44:45]
v_pk_add_f32 v[38:39], v[38:39], v[46:47]
s_waitcnt vmcnt(6)
v_lshlrev_b32 v40, 16, v236
v_and_b32 v41, 0xffff0000, v236
v_lshlrev_b32 v42, 16, v237
v_and_b32 v43, 0xffff0000, v237
v_lshlrev_b32 v44, 16, v238
v_and_b32 v45, 0xffff0000, v238
v_lshlrev_b32 v46, 16, v239
v_and_b32 v47, 0xffff0000, v239
v_pk_add_f32 v[32:33], v[32:33], v[40:41]
v_pk_add_f32 v[34:35], v[34:35], v[42:43]
v_pk_add_f32 v[36:37], v[36:37], v[44:45]
v_pk_add_f32 v[38:39], v[38:39], v[46:47]
s_waitcnt vmcnt(5)
v_lshlrev_b32 v40, 16, v240
v_and_b32 v41, 0xffff0000, v240
v_lshlrev_b32 v42, 16, v241
v_and_b32 v43, 0xffff0000, v241
v_lshlrev_b32 v44, 16, v242
v_and_b32 v45, 0xffff0000, v242
v_lshlrev_b32 v46, 16, v243
v_and_b32 v47, 0xffff0000, v243
v_pk_add_f32 v[32:33], v[32:33], v[40:41]
v_pk_add_f32 v[34:35], v[34:35], v[42:43]
v_pk_add_f32 v[36:37], v[36:37], v[44:45]
v_pk_add_f32 v[38:39], v[38:39], v[46:47]
s_waitcnt vmcnt(4)
v_lshlrev_b32 v40, 16, v244
v_and_b32 v41, 0xffff0000, v244
v_lshlrev_b32 v42, 16, v245
v_and_b32 v43, 0xffff0000, v245
v_lshlrev_b32 v44, 16, v246
v_and_b32 v45, 0xffff0000, v246
v_lshlrev_b32 v46, 16, v247
v_and_b32 v47, 0xffff0000, v247
v_pk_add_f32 v[32:33], v[32:33], v[40:41]
v_pk_add_f32 v[34:35], v[34:35], v[42:43]
v_pk_add_f32 v[36:37], v[36:37], v[44:45]
v_pk_add_f32 v[38:39], v[38:39], v[46:47]
s_waitcnt vmcnt(3)
v_lshlrev_b32 v40, 16, v248
v_and_b32 v41, 0xffff0000, v248
v_lshlrev_b32 v42, 16, v249
v_and_b32 v43, 0xffff0000, v249
v_lshlrev_b32 v44, 16, v250
v_and_b32 v45, 0xffff0000, v250
v_lshlrev_b32 v46, 16, v251
v_and_b32 v47, 0xffff0000, v251
v_pk_add_f32 v[32:33], v[32:33], v[40:41]
v_pk_add_f32 v[34:35], v[34:35], v[42:43]
v_pk_add_f32 v[36:37], v[36:37], v[44:45]
v_pk_add_f32 v[38:39], v[38:39], v[46:47]
s_waitcnt vmcnt(2)
v_lshlrev_b32 v40, 16, v252
v_and_b32 v41, 0xffff0000, v252
v_lshlrev_b32 v42, 16, v253
v_and_b32 v43, 0xffff0000, v253
v_lshlrev_b32 v44, 16, v254
v_and_b32 v45, 0xffff0000, v254
v_lshlrev_b32 v46, 16, v255
v_and_b32 v47, 0xffff0000, v255
v_pk_add_f32 v[32:33], v[32:33], v[40:41]
v_pk_add_f32 v[34:35], v[34:35], v[42:43]
v_pk_add_f32 v[36:37], v[36:37], v[44:45]
v_pk_add_f32 v[38:39], v[38:39], v[46:47]
v_cvt_pk_bf16_f32 v60, v32, v33
v_cvt_pk_bf16_f32 v61, v34, v35
v_cvt_pk_bf16_f32 v62, v36, v37
v_cvt_pk_bf16_f32 v63, v38, v39
buffer_store_dwordx2 v[60:61], v29, s[76:79], s87 offen offset:768
buffer_store_dwordx2 v[62:63], v29, s[76:79], s87 offen offset:800
s_branch L_fin
L_poll0:
v_mov_b32 v15, 0
buffer_load_dword v10, v15, s[64:67], 0 offen sc1
s_add_u32 s47, s47, 1
s_waitcnt vmcnt(0)
v_readfirstlane_b32 s44, v10
s_sleep 8
v_mov_b32 v25, 0
s_cmp_ge_u32 s44, 8
s_cbranch_scc1 L_go0
s_cmp_lt_u32 s47, 0x200000
s_cbranch_scc1 L_poll0
s_branch L_go0
L_gov:
buffer_load_dword v25, v23, s[68:71], s1 offen sc1
s_sleep 8
s_add_u32 s92, s92, 1
s_waitcnt vmcnt(0)
v_cmp_lt_u32 vcc, 0, v25
s_cmp_lt_u32 s92, 16
s_cbranch_scc0 L_govb
s_or_b32 s32, vcc_lo, s85
s_cmp_lg_u32 s32, 0xff
s_cbranch_scc1 L_gov
s_branch L_govb
L_all:
s_mov_b32 s46, 16384
buffer_load_dwordx4 v[228:231], v28, s[28:31], s46 offen offset:3072 sc1
s_mov_b32 s46, 32768
buffer_load_dwordx4 v[232:235], v28, s[28:31], s46 offen offset:3072 sc1
s_mov_b32 s46, 49152
buffer_load_dwordx4 v[236:239], v28, s[28:31], s46 offen offset:3072 sc1
s_mov_b32 s46, 65536
buffer_load_dwordx4 v[240:243], v28, s[28:31], s46 offen offset:3072 sc1
s_mov_b32 s46, 81920
buffer_load_dwordx4 v[244:247], v28, s[28:31], s46 offen offset:3072 sc1
s_mov_b32 s46, 98304
buffer_load_dwordx4 v[248:251], v28, s[28:31], s46 offen offset:3072 sc1
s_mov_b32 s46, 114688
buffer_load_dwordx4 v[252:255], v28, s[28:31], s46 offen offset:3072 sc1
s_cmp_eq_u32 s3, 77
v_lshlrev_b32 v32, 16, v128
v_and_b32 v33, 0xffff0000, v128
v_lshlrev_b32 v34, 16, v129
v_and_b32 v35, 0xffff0000, v129
v_lshlrev_b32 v36, 16, v130
v_and_b32 v37, 0xffff0000, v130
v_lshlrev_b32 v38, 16, v131
v_and_b32 v39, 0xffff0000, v131
s_waitcnt vmcnt(27)
v_lshlrev_b32 v40, 16, v132
v_and_b32 v41, 0xffff0000, v132
v_lshlrev_b32 v42, 16, v133
v_and_b32 v43, 0xffff0000, v133
v_lshlrev_b32 v44, 16, v134
v_and_b32 v45, 0xffff0000, v134
v_lshlrev_b32 v46, 16, v135
v_and_b32 v47, 0xffff0000, v135
v_pk_add_f32 v[32:33], v[32:33], v[40:41]
v_pk_add_f32 v[34:35], v[34:35], v[42:43]
v_pk_add_f32 v[36:37], v[36:37], v[44:45]
v_pk_add_f32 v[38:39], v[38:39], v[46:47]
s_waitcnt vmcnt(26)
v_lshlrev_b32 v40, 16, v136
v_and_b32 v41, 0xffff0000, v136
v_lshlrev_b32 v42, 16, v137
v_and_b32 v43, 0xffff0000, v137
v_lshlrev_b32 v44, 16, v138
v_and_b32 v45, 0xffff0000, v138
v_lshlrev_b32 v46, 16, v139
v_and_b32 v47, 0xffff0000, v139
v_pk_add_f32 v[32:33], v[32:33], v[40:41]
v_pk_add_f32 v[34:35], v[34:35], v[42:43]
v_pk_add_f32 v[36:37], v[36:37], v[44:45]
v_pk_add_f32 v[38:39], v[38:39], v[46:47]
s_waitcnt vmcnt(25)
v_lshlrev_b32 v40, 16, v140
v_and_b32 v41, 0xffff0000, v140
v_lshlrev_b32 v42, 16, v141
v_and_b32 v43, 0xffff0000, v141
v_lshlrev_b32 v44, 16, v142
v_and_b32 v45, 0xffff0000, v142
v_lshlrev_b32 v46, 16, v143
v_and_b32 v47, 0xffff0000, v143
v_pk_add_f32 v[32:33], v[32:33], v[40:41]
v_pk_add_f32 v[34:35], v[34:35], v[42:43]
v_pk_add_f32 v[36:37], v[36:37], v[44:45]
v_pk_add_f32 v[38:39], v[38:39], v[46:47]
s_waitcnt vmcnt(24)
v_lshlrev_b32 v40, 16, v144
v_and_b32 v41, 0xffff0000, v144
v_lshlrev_b32 v42, 16, v145
v_and_b32 v43, 0xffff0000, v145
v_lshlrev_b32 v44, 16, v146
v_and_b32 v45, 0xffff0000, v146
v_lshlrev_b32 v46, 16, v147
v_and_b32 v47, 0xffff0000, v147
v_pk_add_f32 v[32:33], v[32:33], v[40:41]
v_pk_add_f32 v[34:35], v[34:35], v[42:43]
v_pk_add_f32 v[36:37], v[36:37], v[44:45]
v_pk_add_f32 v[38:39], v[38:39], v[46:47]
L_pg24:
s_cbranch_scc1 L_rt1
s_waitcnt vmcnt(23)
v_lshlrev_b32 v40, 16, v148
v_and_b32 v41, 0xffff0000, v148
v_lshlrev_b32 v42, 16, v149
v_and_b32 v43, 0xffff0000, v149
v_lshlrev_b32 v44, 16, v150
v_and_b32 v45, 0xffff0000, v150
v_lshlrev_b32 v46, 16, v151
v_and_b32 v47, 0xffff0000, v151
v_pk_add_f32 v[32:33], v[32:33], v[40:41]
v_pk_add_f32 v[34:35], v[34:35], v[42:43]
v_pk_add_f32 v[36:37], v[36:37], v[44:45]
v_pk_add_f32 v[38:39], v[38:39], v[46:47]
s_waitcnt vmcnt(22)
v_lshlrev_b32 v40, 16, v152
v_and_b32 v41, 0xffff0000, v152
v_lshlrev_b32 v42, 16, v153
v_and_b32 v43, 0xffff0000, v153
v_lshlrev_b32 v44, 16, v154
v_and_b32 v45, 0xffff0000, v154
v_lshlrev_b32 v46, 16, v155
v_and_b32 v47, 0xffff0000, v155
v_pk_add_f32 v[32:33], v[32:33], v[40:41]
v_pk_add_f32 v[34:35], v[34:35], v[42:43]
v_pk_add_f32 v[36:37], v[36:37], v[44:45]
v_pk_add_f32 v[38:39], v[38:39], v[46:47]
s_waitcnt vmcnt(21)
v_lshlrev_b32 v40, 16, v156
v_and_b32 v41, 0xffff0000, v156
v_lshlrev_b32 v42, 16, v157
v_and_b32 v43, 0xffff0000, v157
v_lshlrev_b32 v44, 16, v158
v_and_b32 v45, 0xffff0000, v158
v_lshlrev_b32 v46, 16, v159
v_and_b32 v47, 0xffff0000, v159
v_pk_add_f32 v[32:33], v[32:33], v[40:41]
v_pk_add_f32 v[34:35], v[34:35], v[42:43]
v_pk_add_f32 v[36:37], v[36:37], v[44:45]
v_pk_add_f32 v[38:39], v[38:39], v[46:47]
v_cvt_pk_bf16_f32 v48, v32, v33
v_cvt_pk_bf16_f32 v49, v34, v35
v_cvt_pk_bf16_f32 v50, v36, v37
v_cvt_pk_bf16_f32 v51, v38, v39
buffer_store_dwordx2 v[48:49], v22, s[76:79], s87 offen offset:0
buffer_store_dwordx2 v[50:51], v22, s[76:79], s87 offen offset:32
s_cmp_eq_u32 s3, 77
v_lshlrev_b32 v32, 16, v160
v_and_b32 v33, 0xffff0000, v160
v_lshlrev_b32 v34, 16, v161
v_and_b32 v35, 0xffff0000, v161
v_lshlrev_b32 v36, 16, v162
v_and_b32 v37, 0xffff0000, v162
v_lshlrev_b32 v38, 16, v163
v_and_b32 v39, 0xffff0000, v163
s_waitcnt vmcnt(22)
v_lshlrev_b32 v40, 16, v164
v_and_b32 v41, 0xffff0000, v164
v_lshlrev_b32 v42, 16, v165
v_and_b32 v43, 0xffff0000, v165
v_lshlrev_b32 v44, 16, v166
v_and_b32 v45, 0xffff0000, v166
v_lshlrev_b32 v46, 16, v167
v_and_b32 v47, 0xffff0000, v167
v_pk_add_f32 v[32:33], v[32:33], v[40:41]
v_pk_add_f32 v[34:35], v[34:35], v[42:43]
v_pk_add_f32 v[36:37], v[36:37], v[44:45]
v_pk_add_f32 v[38:39], v[38:39], v[46:47]
s_waitcnt vmcnt(21)
v_lshlrev_b32 v40, 16, v168
v_and_b32 v41, 0xffff0000, v168
v_lshlrev_b32 v42, 16, v169
v_and_b32 v43, 0xffff0000, v169
v_lshlrev_b32 v44, 16, v170
v_and_b32 v45, 0xffff0000, v170
v_lshlrev_b32 v46, 16, v171
v_and_b32 v47, 0xffff0000, v171
v_pk_add_f32 v[32:33], v[32:33], v[40:41]
v_pk_add_f32 v[34:35], v[34:35], v[42:43]
v_pk_add_f32 v[36:37], v[36:37], v[44:45]
v_pk_add_f32 v[38:39], v[38:39], v[46:47]
s_waitcnt vmcnt(20)
v_lshlrev_b32 v40, 16, v172
v_and_b32 v41, 0xffff0000, v172
v_lshlrev_b32 v42, 16, v173
v_and_b32 v43, 0xffff0000, v173
v_lshlrev_b32 v44, 16, v174
v_and_b32 v45, 0xffff0000, v174
v_lshlrev_b32 v46, 16, v175
v_and_b32 v47, 0xffff0000, v175
v_pk_add_f32 v[32:33], v[32:33], v[40:41]
v_pk_add_f32 v[34:35], v[34:35], v[42:43]
v_pk_add_f32 v[36:37], v[36:37], v[44:45]
v_pk_add_f32 v[38:39], v[38:39], v[46:47]
s_waitcnt vmcnt(19)
v_lshlrev_b32 v40, 16, v176
v_and_b32 v41, 0xffff0000, v176
v_lshlrev_b32 v42, 16, v177
v_and_b32 v43, 0xffff0000, v177
v_lshlrev_b32 v44, 16, v178
v_and_b32 v45, 0xffff0000, v178
v_lshlrev_b32 v46, 16, v179
v_and_b32 v47, 0xffff0000, v179
v_pk_add_f32 v[32:33], v[32:33], v[40:41]
v_pk_add_f32 v[34:35], v[34:35], v[42:43]
v_pk_add_f32 v[36:37], v[36:37], v[44:45]
v_pk_add_f32 v[38:39], v[38:39], v[46:47]
s_waitcnt vmcnt(18)
v_lshlrev_b32 v40, 16, v180
v_and_b32 v41, 0xffff0000, v180
v_lshlrev_b32 v42, 16, v181
v_and_b32 v43, 0xffff0000, v181
v_lshlrev_b32 v44, 16, v182
v_and_b32 v45, 0xffff0000, v182
v_lshlrev_b32 v46, 16, v183
v_and_b32 v47, 0xffff0000, v183
v_pk_add_f32 v[32:33], v[32:33], v[40:41]
v_pk_add_f32 v[34:35], v[34:35], v[42:43]
v_pk_add_f32 v[36:37], v[36:37], v[44:45]
v_pk_add_f32 v[38:39], v[38:39], v[46:47]
s_waitcnt vmcnt(17)
v_lshlrev_b32 v40, 16, v184
v_and_b32 v41, 0xffff0000, v184
v_lshlrev_b32 v42, 16, v185
v_and_b32 v43, 0xffff0000, v185
v_lshlrev_b32 v44, 16, v186
v_and_b32 v45, 0xffff0000, v186
v_lshlrev_b32 v46, 16, v187
v_and_b32 v47, 0xffff0000, v187
v_pk_add_f32 v[32:33], v[32:33], v[40:41]
v_pk_add_f32 v[34:35], v[34:35], v[42:43]
v_pk_add_f32 v[36:37], v[36:37], v[44:45]
v_pk_add_f32 v[38:39], v[38:39], v[46:47]
s_waitcnt vmcnt(16)
v_lshlrev_b32 v40, 16, v188
v_and_b32 v41, 0xffff0000, v188
v_lshlrev_b32 v42, 16, v189
v_and_b32 v43, 0xffff0000, v189
v_lshlrev_b32 v44, 16, v190
v_and_b32 v45, 0xffff0000, v190
v_lshlrev_b32 v46, 16, v191
v_and_b32 v47, 0xffff0000, v191
v_pk_add_f32 v[32:33], v[32:33], v[40:41]
v_pk_add_f32 v[34:35], v[34:35], v[42:43]
v_pk_add_f32 v[36:37], v[36:37], v[44:45]
v_pk_add_f32 v[38:39], v[38:39], v[46:47]
v_cvt_pk_bf16_f32 v52, v32, v33
v_cvt_pk_bf16_f32 v53, v34, v35
v_cvt_pk_bf16_f32 v54, v36, v37
v_cvt_pk_bf16_f32 v55, v38, v39
buffer_store_dwordx2 v[52:53], v22, s[76:79], s87 offen offset:256
buffer_store_dwordx2 v[54:55], v22, s[76:79], s87 offen offset:288
s_cmp_eq_u32 s3, 77
v_lshlrev_b32 v32, 16, v192
v_and_b32 v33, 0xffff0000, v192
v_lshlrev_b32 v34, 16, v193
v_and_b32 v35, 0xffff0000, v193
v_lshlrev_b32 v36, 16, v194
v_and_b32 v37, 0xffff0000, v194
v_lshlrev_b32 v38, 16, v195
v_and_b32 v39, 0xffff0000, v195
s_waitcnt vmcnt(17)
v_lshlrev_b32 v40, 16, v196
v_and_b32 v41, 0xffff0000, v196
v_lshlrev_b32 v42, 16, v197
v_and_b32 v43, 0xffff0000, v197
v_lshlrev_b32 v44, 16, v198
v_and_b32 v45, 0xffff0000, v198
v_lshlrev_b32 v46, 16, v199
v_and_b32 v47, 0xffff0000, v199
v_pk_add_f32 v[32:33], v[32:33], v[40:41]
v_pk_add_f32 v[34:35], v[34:35], v[42:43]
v_pk_add_f32 v[36:37], v[36:37], v[44:45]
v_pk_add_f32 v[38:39], v[38:39], v[46:47]
s_waitcnt vmcnt(16)
v_lshlrev_b32 v40, 16, v200
v_and_b32 v41, 0xffff0000, v200
v_lshlrev_b32 v42, 16, v201
v_and_b32 v43, 0xffff0000, v201
v_lshlrev_b32 v44, 16, v202
v_and_b32 v45, 0xffff0000, v202
v_lshlrev_b32 v46, 16, v203
v_and_b32 v47, 0xffff0000, v203
v_pk_add_f32 v[32:33], v[32:33], v[40:41]
v_pk_add_f32 v[34:35], v[34:35], v[42:43]
v_pk_add_f32 v[36:37], v[36:37], v[44:45]
v_pk_add_f32 v[38:39], v[38:39], v[46:47]
s_waitcnt vmcnt(15)
v_lshlrev_b32 v40, 16, v204
v_and_b32 v41, 0xffff0000, v204
v_lshlrev_b32 v42, 16, v205
v_and_b32 v43, 0xffff0000, v205
v_lshlrev_b32 v44, 16, v206
v_and_b32 v45, 0xffff0000, v206
v_lshlrev_b32 v46, 16, v207
v_and_b32 v47, 0xffff0000, v207
v_pk_add_f32 v[32:33], v[32:33], v[40:41]
v_pk_add_f32 v[34:35], v[34:35], v[42:43]
v_pk_add_f32 v[36:37], v[36:37], v[44:45]
v_pk_add_f32 v[38:39], v[38:39], v[46:47]
s_waitcnt vmcnt(14)
v_lshlrev_b32 v40, 16, v208
v_and_b32 v41, 0xffff0000, v208
v_lshlrev_b32 v42, 16, v209
v_and_b32 v43, 0xffff0000, v209
v_lshlrev_b32 v44, 16, v210
v_and_b32 v45, 0xffff0000, v210
v_lshlrev_b32 v46, 16, v211
v_and_b32 v47, 0xffff0000, v211
v_pk_add_f32 v[32:33], v[32:33], v[40:41]
v_pk_add_f32 v[34:35], v[34:35], v[42:43]
v_pk_add_f32 v[36:37], v[36:37], v[44:45]
v_pk_add_f32 v[38:39], v[38:39], v[46:47]
s_waitcnt vmcnt(13)
v_lshlrev_b32 v40, 16, v212
v_and_b32 v41, 0xffff0000, v212
v_lshlrev_b32 v42, 16, v213
v_and_b32 v43, 0xffff0000, v213
v_lshlrev_b32 v44, 16, v214
v_and_b32 v45, 0xffff0000, v214
v_lshlrev_b32 v46, 16, v215
v_and_b32 v47, 0xffff0000, v215
v_pk_add_f32 v[32:33], v[32:33], v[40:41]
v_pk_add_f32 v[34:35], v[34:35], v[42:43]
v_pk_add_f32 v[36:37], v[36:37], v[44:45]
v_pk_add_f32 v[38:39], v[38:39], v[46:47]
s_waitcnt vmcnt(12)
v_lshlrev_b32 v40, 16, v216
v_and_b32 v41, 0xffff0000, v216
v_lshlrev_b32 v42, 16, v217
v_and_b32 v43, 0xffff0000, v217
v_lshlrev_b32 v44, 16, v218
v_and_b32 v45, 0xffff0000, v218
v_lshlrev_b32 v46, 16, v219
v_and_b32 v47, 0xffff0000, v219
v_pk_add_f32 v[32:33], v[32:33], v[40:41]
v_pk_add_f32 v[34:35], v[34:35], v[42:43]
v_pk_add_f32 v[36:37], v[36:37], v[44:45]
v_pk_add_f32 v[38:39], v[38:39], v[46:47]
s_waitcnt vmcnt(11)
v_lshlrev_b32 v40, 16, v220
v_and_b32 v41, 0xffff0000, v220
v_lshlrev_b32 v42, 16, v221
v_and_b32 v43, 0xffff0000, v221
v_lshlrev_b32 v44, 16, v222
v_and_b32 v45, 0xffff0000, v222
v_lshlrev_b32 v46, 16, v223
v_and_b32 v47, 0xffff0000, v223
v_pk_add_f32 v[32:33], v[32:33], v[40:41]
v_pk_add_f32 v[34:35], v[34:35], v[42:43]
v_pk_add_f32 v[36:37], v[36:37], v[44:45]
v_pk_add_f32 v[38:39], v[38:39], v[46:47]
v_cvt_pk_bf16_f32 v56, v32, v33
v_cvt_pk_bf16_f32 v57, v34, v35
v_cvt_pk_bf16_f32 v58, v36, v37
v_cvt_pk_bf16_f32 v59, v38, v39
buffer_store_dwordx2 v[56:57], v22, s[76:79], s87 offen offset:512
buffer_store_dwordx2 v[58:59], v22, s[76:79], s87 offen offset:544
s_cmp_eq_u32 s3, 77
v_lshlrev_b32 v32, 16, v224
v_and_b32 v33, 0xffff0000, v224
v_lshlrev_b32 v34, 16, v225
v_and_b32 v35, 0xffff0000, v225
v_lshlrev_b32 v36, 16, v226
v_and_b32 v37, 0xffff0000, v226
v_lshlrev_b32 v38, 16, v227
v_and_b32 v39, 0xffff0000, v227
s_waitcnt vmcnt(12)
v_lshlrev_b32 v40, 16, v228
v_and_b32 v41, 0xffff0000, v228
v_lshlrev_b32 v42, 16, v229
v_and_b32 v43, 0xffff0000, v229
v_lshlrev_b32 v44, 16, v230
v_and_b32 v45, 0xffff0000, v230
v_lshlrev_b32 v46, 16, v231
v_and_b32 v47, 0xffff0000, v231
v_pk_add_f32 v[32:33], v[32:33], v[40:41]
v_pk_add_f32 v[34:35], v[34:35], v[42:43]
v_pk_add_f32 v[36:37], v[36:37], v[44:45]
v_pk_add_f32 v[38:39], v[38:39], v[46:47]
s_waitcnt vmcnt(11)
v_lshlrev_b32 v40, 16, v232
v_and_b32 v41, 0xffff0000, v232
v_lshlrev_b32 v42, 16, v233
v_and_b32 v43, 0xffff0000, v233
v_lshlrev_b32 v44, 16, v234
v_and_b32 v45, 0xffff0000, v234
v_lshlrev_b32 v46, 16, v235
v_and_b32 v47, 0xffff0000, v235
v_pk_add_f32 v[32:33], v[32:33], v[40:41]
v_pk_add_f32 v[34:35], v[34:35], v[42:43]
v_pk_add_f32 v[36:37], v[36:37], v[44:45]
v_pk_add_f32 v[38:39], v[38:39], v[46:47]
s_waitcnt vmcnt(10)
v_lshlrev_b32 v40, 16, v236
v_and_b32 v41, 0xffff0000, v236
v_lshlrev_b32 v42, 16, v237
v_and_b32 v43, 0xffff0000, v237
v_lshlrev_b32 v44, 16, v238
v_and_b32 v45, 0xffff0000, v238
v_lshlrev_b32 v46, 16, v239
v_and_b32 v47, 0xffff0000, v239
v_pk_add_f32 v[32:33], v[32:33], v[40:41]
v_pk_add_f32 v[34:35], v[34:35], v[42:43]
v_pk_add_f32 v[36:37], v[36:37], v[44:45]
v_pk_add_f32 v[38:39], v[38:39], v[46:47]
s_waitcnt vmcnt(9)
v_lshlrev_b32 v40, 16, v240
v_and_b32 v41, 0xffff0000, v240
v_lshlrev_b32 v42, 16, v241
v_and_b32 v43, 0xffff0000, v241
v_lshlrev_b32 v44, 16, v242
v_and_b32 v45, 0xffff0000, v242
v_lshlrev_b32 v46, 16, v243
v_and_b32 v47, 0xffff0000, v243
v_pk_add_f32 v[32:33], v[32:33], v[40:41]
v_pk_add_f32 v[34:35], v[34:35], v[42:43]
v_pk_add_f32 v[36:37], v[36:37], v[44:45]
v_pk_add_f32 v[38:39], v[38:39], v[46:47]
s_waitcnt vmcnt(8)
v_lshlrev_b32 v40, 16, v244
v_and_b32 v41, 0xffff0000, v244
v_lshlrev_b32 v42, 16, v245
v_and_b32 v43, 0xffff0000, v245
v_lshlrev_b32 v44, 16, v246
v_and_b32 v45, 0xffff0000, v246
v_lshlrev_b32 v46, 16, v247
v_and_b32 v47, 0xffff0000, v247
v_pk_add_f32 v[32:33], v[32:33], v[40:41]
v_pk_add_f32 v[34:35], v[34:35], v[42:43]
v_pk_add_f32 v[36:37], v[36:37], v[44:45]
v_pk_add_f32 v[38:39], v[38:39], v[46:47]
s_waitcnt vmcnt(7)
v_lshlrev_b32 v40, 16, v248
v_and_b32 v41, 0xffff0000, v248
v_lshlrev_b32 v42, 16, v249
v_and_b32 v43, 0xffff0000, v249
v_lshlrev_b32 v44, 16, v250
v_and_b32 v45, 0xffff0000, v250
v_lshlrev_b32 v46, 16, v251
v_and_b32 v47, 0xffff0000, v251
v_pk_add_f32 v[32:33], v[32:33], v[40:41]
v_pk_add_f32 v[34:35], v[34:35], v[42:43]
v_pk_add_f32 v[36:37], v[36:37], v[44:45]
v_pk_add_f32 v[38:39], v[38:39], v[46:47]
s_waitcnt vmcnt(6)
v_lshlrev_b32 v40, 16, v252
v_and_b32 v41, 0xffff0000, v252
v_lshlrev_b32 v42, 16, v253
v_and_b32 v43, 0xffff0000, v253
v_lshlrev_b32 v44, 16, v254
v_and_b32 v45, 0xffff0000, v254
v_lshlrev_b32 v46, 16, v255
v_and_b32 v47, 0xffff0000, v255
v_pk_add_f32 v[32:33], v[32:33], v[40:41]
v_pk_add_f32 v[34:35], v[34:35], v[42:43]
v_pk_add_f32 v[36:37], v[36:37], v[44:45]
v_pk_add_f32 v[38:39], v[38:39], v[46:47]
v_cvt_pk_bf16_f32 v60, v32, v33
v_cvt_pk_bf16_f32 v61, v34, v35
v_cvt_pk_bf16_f32 v62, v36, v37
v_cvt_pk_bf16_f32 v63, v38, v39
buffer_store_dwordx2 v[60:61], v29, s[76:79], s87 offen offset:768
buffer_store_dwordx2 v[62:63], v29, s[76:79], s87 offen offset:800
L_fin:
L_end:
s_endpgm
L_stub_0_1:
v_max3_f32 v12, v48, v49, v50
v_max3_f32 v13, v56, v57, v58
v_max3_f32 v12, v12, v51, v52
v_max3_f32 v13, v13, v59, v60
v_max3_f32 v12, v12, v53, v54
v_max3_f32 v13, v13, v61, v62
v_max_f32 v12, v12, v55
v_max_f32 v13, v13, v63
s_call_b64 s[90:91], L_rare1
v_sub_f32 v48, v48, v12
v_sub_f32 v49, v49, v12
v_sub_f32 v50, v50, v12
v_sub_f32 v51, v51, v12
v_sub_f32 v52, v52, v12
v_sub_f32 v53, v53, v12
v_sub_f32 v54, v54, v12
v_sub_f32 v55, v55, v12
v_sub_f32 v56, v56, v13
v_sub_f32 v57, v57, v13
v_sub_f32 v58, v58, v13
v_sub_f32 v59, v59, v13
v_sub_f32 v60, v60, v13
v_sub_f32 v61, v61, v13
v_sub_f32 v62, v62, v13
v_sub_f32 v63, v63, v13
s_mov_b32 s32, 0
s_call_b64 s[90:91], L_rare2
s_branch L_back_0_1
L_stub_0_2:
v_max3_f32 v12, v32, v33, v34
v_max3_f32 v13, v40, v41, v42
v_max3_f32 v12, v12, v35, v36
v_max3_f32 v13, v13, v43, v44
v_max3_f32 v12, v12, v37, v38
v_max3_f32 v13, v13, v45, v46
v_max_f32 v12, v12, v39
v_max_f32 v13, v13, v47
s_call_b64 s[90:91], L_rare1
v_sub_f32 v32, v32, v12
v_sub_f32 v33, v33, v12
v_sub_f32 v34, v34, v12
v_sub_f32 v35, v35, v12
v_sub_f32 v36, v36, v12
v_sub_f32 v37, v37, v12
v_sub_f32 v38, v38, v12
v_sub_f32 v39, v39, v12
v_sub_f32 v40, v40, v13
v_sub_f32 v41, v41, v13
v_sub_f32 v42, v42, v13
v_sub_f32 v43, v43, v13
v_sub_f32 v44, v44, v13
v_sub_f32 v45, v45, v13
v_sub_f32 v46, v46, v13
v_sub_f32 v47, v47, v13
s_mov_b32 s32, 0
s_call_b64 s[90:91], L_rare2
s_branch L_back_0_2
L_stub_0_3:
v_max3_f32 v12, v48, v49, v50
v_max3_f32 v13, v56, v57, v58
v_max3_f32 v12, v12, v51, v52
v_max3_f32 v13, v13, v59, v60
v_max3_f32 v12, v12, v53, v54
v_max3_f32 v13, v13, v61, v62
v_max_f32 v12, v12, v55
v_max_f32 v13, v13, v63
s_call_b64 s[90:91], L_rare1
v_sub_f32 v48, v48, v12
v_sub_f32 v49, v49, v12
v_sub_f32 v50, v50, v12
v_sub_f32 v51, v51, v12
v_sub_f32 v52, v52, v12
v_sub_f32 v53, v53, v12
v_sub_f32 v54, v54, v12
v_sub_f32 v55, v55, v12
v_sub_f32 v56, v56, v13
v_sub_f32 v57, v57, v13
v_sub_f32 v58, v58, v13
v_sub_f32 v59, v59, v13
v_sub_f32 v60, v60, v13
v_sub_f32 v61, v61, v13
v_sub_f32 v62, v62, v13
v_sub_f32 v63, v63, v13
s_mov_b32 s32, 0
s_call_b64 s[90:91], L_rare2
s_branch L_back_0_3
L_stub_0_4:
v_max3_f32 v12, v32, v33, v34
v_max3_f32 v13, v40, v41, v42
v_max3_f32 v12, v12, v35, v36
v_max3_f32 v13, v13, v43, v44
v_max3_f32 v12, v12, v37, v38
v_max3_f32 v13, v13, v45, v46
v_max_f32 v12, v12, v39
v_max_f32 v13, v13, v47
s_call_b64 s[90:91], L_rare1
v_sub_f32 v32, v32, v12
v_sub_f32 v33, v33, v12
v_sub_f32 v34, v34, v12
v_sub_f32 v35, v35, v12
v_sub_f32 v36, v36, v12
v_sub_f32 v37, v37, v12
v_sub_f32 v38, v38, v12
v_sub_f32 v39, v39, v12
v_sub_f32 v40, v40, v13
v_sub_f32 v41, v41, v13
v_sub_f32 v42, v42, v13
v_sub_f32 v43, v43, v13
v_sub_f32 v44, v44, v13
v_sub_f32 v45, v45, v13
v_sub_f32 v46, v46, v13
v_sub_f32 v47, v47, v13
s_mov_b32 s32, 0
s_call_b64 s[90:91], L_rare2
s_branch L_back_0_4
L_stub_0_5:
v_max3_f32 v12, v48, v49, v50
v_max3_f32 v13, v56, v57, v58
v_max3_f32 v12, v12, v51, v52
v_max3_f32 v13, v13, v59, v60
v_max3_f32 v12, v12, v53, v54
v_max3_f32 v13, v13, v61, v62
v_max_f32 v12, v12, v55
v_max_f32 v13, v13, v63
s_call_b64 s[90:91], L_rare1
v_sub_f32 v48, v48, v12
v_sub_f32 v49, v49, v12
v_sub_f32 v50, v50, v12
v_sub_f32 v51, v51, v12
v_sub_f32 v52, v52, v12
v_sub_f32 v53, v53, v12
v_sub_f32 v54, v54, v12
v_sub_f32 v55, v55, v12
v_sub_f32 v56, v56, v13
v_sub_f32 v57, v57, v13
v_sub_f32 v58, v58, v13
v_sub_f32 v59, v59, v13
v_sub_f32 v60, v60, v13
v_sub_f32 v61, v61, v13
v_sub_f32 v62, v62, v13
v_sub_f32 v63, v63, v13
s_mov_b32 s32, 0
s_call_b64 s[90:91], L_rare2
s_branch L_back_0_5
L_stub_0_6:
v_max3_f32 v12, v32, v33, v34
v_max3_f32 v13, v40, v41, v42
v_max3_f32 v12, v12, v35, v36
v_max3_f32 v13, v13, v43, v44
v_max3_f32 v12, v12, v37, v38
v_max3_f32 v13, v13, v45, v46
v_max_f32 v12, v12, v39
v_max_f32 v13, v13, v47
s_call_b64 s[90:91], L_rare1
v_sub_f32 v32, v32, v12
v_sub_f32 v33, v33, v12
v_sub_f32 v34, v34, v12
v_sub_f32 v35, v35, v12
v_sub_f32 v36, v36, v12
v_sub_f32 v37, v37, v12
v_sub_f32 v38, v38, v12
v_sub_f32 v39, v39, v12
v_sub_f32 v40, v40, v13
v_sub_f32 v41, v41, v13
v_sub_f32 v42, v42, v13
v_sub_f32 v43, v43, v13
v_sub_f32 v44, v44, v13
v_sub_f32 v45, v45, v13
v_sub_f32 v46, v46, v13
v_sub_f32 v47, v47, v13
s_mov_b32 s32, 0
s_call_b64 s[90:91], L_rare2
s_branch L_back_0_6
L_stub_0_7:
v_max3_f32 v12, v48, v49, v50
v_max3_f32 v13, v56, v57, v58
v_max3_f32 v12, v12, v51, v52
v_max3_f32 v13, v13, v59, v60
v_max3_f32 v12, v12, v53, v54
v_max3_f32 v13, v13, v61, v62
v_max_f32 v12, v12, v55
v_max_f32 v13, v13, v63
s_call_b64 s[90:91], L_rare1
v_sub_f32 v48, v48, v12
v_sub_f32 v49, v49, v12
v_sub_f32 v50, v50, v12
v_sub_f32 v51, v51, v12
v_sub_f32 v52, v52, v12
v_sub_f32 v53, v53, v12
v_sub_f32 v54, v54, v12
v_sub_f32 v55, v55, v12
v_sub_f32 v56, v56, v13
v_sub_f32 v57, v57, v13
v_sub_f32 v58, v58, v13
v_sub_f32 v59, v59, v13
v_sub_f32 v60, v60, v13
v_sub_f32 v61, v61, v13
v_sub_f32 v62, v62, v13
v_sub_f32 v63, v63, v13
s_mov_b32 s32, 0
s_call_b64 s[90:91], L_rare2
s_branch L_back_0_7
L_stub_0_8:
v_max3_f32 v12, v32, v33, v34
v_max3_f32 v13, v40, v41, v42
v_max3_f32 v12, v12, v35, v36
v_max3_f32 v13, v13, v43, v44
v_max3_f32 v12, v12, v37, v38
v_max3_f32 v13, v13, v45, v46
v_max_f32 v12, v12, v39
v_max_f32 v13, v13, v47
s_call_b64 s[90:91], L_rare1
v_sub_f32 v32, v32, v12
v_sub_f32 v33, v33, v12
v_sub_f32 v34, v34, v12
v_sub_f32 v35, v35, v12
v_sub_f32 v36, v36, v12
v_sub_f32 v37, v37, v12
v_sub_f32 v38, v38, v12
v_sub_f32 v39, v39, v12
v_sub_f32 v40, v40, v13
v_sub_f32 v41, v41, v13
v_sub_f32 v42, v42, v13
v_sub_f32 v43, v43, v13
v_sub_f32 v44, v44, v13
v_sub_f32 v45, v45, v13
v_sub_f32 v46, v46, v13
v_sub_f32 v47, v47, v13
s_mov_b32 s32, 0
s_call_b64 s[90:91], L_rare2
s_branch L_back_0_8
L_stub_0_9:
v_max3_f32 v12, v48, v49, v50
v_max3_f32 v13, v56, v57, v58
v_max3_f32 v12, v12, v51, v52
v_max3_f32 v13, v13, v59, v60
v_max3_f32 v12, v12, v53, v54
v_max3_f32 v13, v13, v61, v62
v_max_f32 v12, v12, v55
v_max_f32 v13, v13, v63
s_call_b64 s[90:91], L_rare1
v_sub_f32 v48, v48, v12
v_sub_f32 v49, v49, v12
v_sub_f32 v50, v50, v12
v_sub_f32 v51, v51, v12
v_sub_f32 v52, v52, v12
v_sub_f32 v53, v53, v12
v_sub_f32 v54, v54, v12
v_sub_f32 v55, v55, v12
v_sub_f32 v56, v56, v13
v_sub_f32 v57, v57, v13
v_sub_f32 v58, v58, v13
v_sub_f32 v59, v59, v13
v_sub_f32 v60, v60, v13
v_sub_f32 v61, v61, v13
v_sub_f32 v62, v62, v13
v_sub_f32 v63, v63, v13
s_mov_b32 s32, 0
s_call_b64 s[90:91], L_rare2
s_branch L_back_0_9
L_stub_0_10:
v_max3_f32 v12, v32, v33, v34
v_max3_f32 v13, v40, v41, v42
v_max3_f32 v12, v12, v35, v36
v_max3_f32 v13, v13, v43, v44
v_max3_f32 v12, v12, v37, v38
v_max3_f32 v13, v13, v45, v46
v_max_f32 v12, v12, v39
v_max_f32 v13, v13, v47
s_call_b64 s[90:91], L_rare1
v_sub_f32 v32, v32, v12
v_sub_f32 v33, v33, v12
v_sub_f32 v34, v34, v12
v_sub_f32 v35, v35, v12
v_sub_f32 v36, v36, v12
v_sub_f32 v37, v37, v12
v_sub_f32 v38, v38, v12
v_sub_f32 v39, v39, v12
v_sub_f32 v40, v40, v13
v_sub_f32 v41, v41, v13
v_sub_f32 v42, v42, v13
v_sub_f32 v43, v43, v13
v_sub_f32 v44, v44, v13
v_sub_f32 v45, v45, v13
v_sub_f32 v46, v46, v13
v_sub_f32 v47, v47, v13
s_mov_b32 s32, 0
s_call_b64 s[90:91], L_rare2
s_branch L_back_0_10
L_stub_0_11:
v_max3_f32 v12, v48, v49, v50
v_max3_f32 v13, v56, v57, v58
v_max3_f32 v12, v12, v51, v52
v_max3_f32 v13, v13, v59, v60
v_max3_f32 v12, v12, v53, v54
v_max3_f32 v13, v13, v61, v62
v_max_f32 v12, v12, v55
v_max_f32 v13, v13, v63
s_call_b64 s[90:91], L_rare1
v_sub_f32 v48, v48, v12
v_sub_f32 v49, v49, v12
v_sub_f32 v50, v50, v12
v_sub_f32 v51, v51, v12
v_sub_f32 v52, v52, v12
v_sub_f32 v53, v53, v12
v_sub_f32 v54, v54, v12
v_sub_f32 v55, v55, v12
v_sub_f32 v56, v56, v13
v_sub_f32 v57, v57, v13
v_sub_f32 v58, v58, v13
v_sub_f32 v59, v59, v13
v_sub_f32 v60, v60, v13
v_sub_f32 v61, v61, v13
v_sub_f32 v62, v62, v13
v_sub_f32 v63, v63, v13
s_mov_b32 s32, 1
s_call_b64 s[90:91], L_rare2
s_branch L_back_0_11
L_stub_0_12:
v_max3_f32 v12, v32, v33, v34
v_max3_f32 v13, v40, v41, v42
v_max3_f32 v12, v12, v35, v36
v_max3_f32 v13, v13, v43, v44
v_max3_f32 v12, v12, v37, v38
v_max3_f32 v13, v13, v45, v46
v_max_f32 v12, v12, v39
v_max_f32 v13, v13, v47
s_call_b64 s[90:91], L_rare1
v_sub_f32 v32, v32, v12
v_sub_f32 v33, v33, v12
v_sub_f32 v34, v34, v12
v_sub_f32 v35, v35, v12
v_sub_f32 v36, v36, v12
v_sub_f32 v37, v37, v12
v_sub_f32 v38, v38, v12
v_sub_f32 v39, v39, v12
v_sub_f32 v40, v40, v13
v_sub_f32 v41, v41, v13
v_sub_f32 v42, v42, v13
v_sub_f32 v43, v43, v13
v_sub_f32 v44, v44, v13
v_sub_f32 v45, v45, v13
v_sub_f32 v46, v46, v13
v_sub_f32 v47, v47, v13
s_mov_b32 s32, 1
s_call_b64 s[90:91], L_rare2
s_branch L_back_0_12
L_stub_0_13:
v_max3_f32 v12, v48, v49, v50
v_max3_f32 v13, v56, v57, v58
v_max3_f32 v12, v12, v51, v52
v_max3_f32 v13, v13, v59, v60
v_max3_f32 v12, v12, v53, v54
v_max3_f32 v13, v13, v61, v62
v_max_f32 v12, v12, v55
v_max_f32 v13, v13, v63
s_call_b64 s[90:91], L_rare1
v_sub_f32 v48, v48, v12
v_sub_f32 v49, v49, v12
v_sub_f32 v50, v50, v12
v_sub_f32 v51, v51, v12
v_sub_f32 v52, v52, v12
v_sub_f32 v53, v53, v12
v_sub_f32 v54, v54, v12
v_sub_f32 v55, v55, v12
v_sub_f32 v56, v56, v13
v_sub_f32 v57, v57, v13
v_sub_f32 v58, v58, v13
v_sub_f32 v59, v59, v13
v_sub_f32 v60, v60, v13
v_sub_f32 v61, v61, v13
v_sub_f32 v62, v62, v13
v_sub_f32 v63, v63, v13
s_mov_b32 s32, 1
s_call_b64 s[90:91], L_rare2
s_branch L_back_0_13
L_stub_0_14:
v_max3_f32 v12, v32, v33, v34
v_max3_f32 v13, v40, v41, v42
v_max3_f32 v12, v12, v35, v36
v_max3_f32 v13, v13, v43, v44
v_max3_f32 v12, v12, v37, v38
v_max3_f32 v13, v13, v45, v46
v_max_f32 v12, v12, v39
v_max_f32 v13, v13, v47
s_call_b64 s[90:91], L_rare1
v_sub_f32 v32, v32, v12
v_sub_f32 v33, v33, v12
v_sub_f32 v34, v34, v12
v_sub_f32 v35, v35, v12
v_sub_f32 v36, v36, v12
v_sub_f32 v37, v37, v12
v_sub_f32 v38, v38, v12
v_sub_f32 v39, v39, v12
v_sub_f32 v40, v40, v13
v_sub_f32 v41, v41, v13
v_sub_f32 v42, v42, v13
v_sub_f32 v43, v43, v13
v_sub_f32 v44, v44, v13
v_sub_f32 v45, v45, v13
v_sub_f32 v46, v46, v13
v_sub_f32 v47, v47, v13
s_mov_b32 s32, 1
s_call_b64 s[90:91], L_rare2
s_branch L_back_0_14
L_stub_0_15:
v_max3_f32 v12, v48, v49, v50
v_max3_f32 v13, v56, v57, v58
v_max3_f32 v12, v12, v51, v52
v_max3_f32 v13, v13, v59, v60
v_max3_f32 v12, v12, v53, v54
v_max3_f32 v13, v13, v61, v62
v_max_f32 v12, v12, v55
v_max_f32 v13, v13, v63
s_call_b64 s[90:91], L_rare1
v_sub_f32 v48, v48, v12
v_sub_f32 v49, v49, v12
v_sub_f32 v50, v50, v12
v_sub_f32 v51, v51, v12
v_sub_f32 v52, v52, v12
v_sub_f32 v53, v53, v12
v_sub_f32 v54, v54, v12
v_sub_f32 v55, v55, v12
v_sub_f32 v56, v56, v13
v_sub_f32 v57, v57, v13
v_sub_f32 v58, v58, v13
v_sub_f32 v59, v59, v13
v_sub_f32 v60, v60, v13
v_sub_f32 v61, v61, v13
v_sub_f32 v62, v62, v13
v_sub_f32 v63, v63, v13
s_mov_b32 s32, 1
s_call_b64 s[90:91], L_rare2
s_branch L_back_0_15
L_stub_1_1:
v_max3_f32 v12, v48, v49, v50
v_max3_f32 v13, v56, v57, v58
v_max3_f32 v12, v12, v51, v52
v_max3_f32 v13, v13, v59, v60
v_max3_f32 v12, v12, v53, v54
v_max3_f32 v13, v13, v61, v62
v_max_f32 v12, v12, v55
v_max_f32 v13, v13, v63
s_call_b64 s[90:91], L_rare1
v_sub_f32 v48, v48, v12
v_sub_f32 v49, v49, v12
v_sub_f32 v50, v50, v12
v_sub_f32 v51, v51, v12
v_sub_f32 v52, v52, v12
v_sub_f32 v53, v53, v12
v_sub_f32 v54, v54, v12
v_sub_f32 v55, v55, v12
v_sub_f32 v56, v56, v13
v_sub_f32 v57, v57, v13
v_sub_f32 v58, v58, v13
v_sub_f32 v59, v59, v13
v_sub_f32 v60, v60, v13
v_sub_f32 v61, v61, v13
v_sub_f32 v62, v62, v13
v_sub_f32 v63, v63, v13
s_mov_b32 s32, 0
s_call_b64 s[90:91], L_rare2
s_branch L_back_1_1
L_stub_1_2:
v_max3_f32 v12, v32, v33, v34
v_max3_f32 v13, v40, v41, v42
v_max3_f32 v12, v12, v35, v36
v_max3_f32 v13, v13, v43, v44
v_max3_f32 v12, v12, v37, v38
v_max3_f32 v13, v13, v45, v46
v_max_f32 v12, v12, v39
v_max_f32 v13, v13, v47
s_call_b64 s[90:91], L_rare1
v_sub_f32 v32, v32, v12
v_sub_f32 v33, v33, v12
v_sub_f32 v34, v34, v12
v_sub_f32 v35, v35, v12
v_sub_f32 v36, v36, v12
v_sub_f32 v37, v37, v12
v_sub_f32 v38, v38, v12
v_sub_f32 v39, v39, v12
v_sub_f32 v40, v40, v13
v_sub_f32 v41, v41, v13
v_sub_f32 v42, v42, v13
v_sub_f32 v43, v43, v13
v_sub_f32 v44, v44, v13
v_sub_f32 v45, v45, v13
v_sub_f32 v46, v46, v13
v_sub_f32 v47, v47, v13
s_mov_b32 s32, 0
s_call_b64 s[90:91], L_rare2
s_branch L_back_1_2
L_stub_1_3:
v_max3_f32 v12, v48, v49, v50
v_max3_f32 v13, v56, v57, v58
v_max3_f32 v12, v12, v51, v52
v_max3_f32 v13, v13, v59, v60
v_max3_f32 v12, v12, v53, v54
v_max3_f32 v13, v13, v61, v62
v_max_f32 v12, v12, v55
v_max_f32 v13, v13, v63
s_call_b64 s[90:91], L_rare1
v_sub_f32 v48, v48, v12
v_sub_f32 v49, v49, v12
v_sub_f32 v50, v50, v12
v_sub_f32 v51, v51, v12
v_sub_f32 v52, v52, v12
v_sub_f32 v53, v53, v12
v_sub_f32 v54, v54, v12
v_sub_f32 v55, v55, v12
v_sub_f32 v56, v56, v13
v_sub_f32 v57, v57, v13
v_sub_f32 v58, v58, v13
v_sub_f32 v59, v59, v13
v_sub_f32 v60, v60, v13
v_sub_f32 v61, v61, v13
v_sub_f32 v62, v62, v13
v_sub_f32 v63, v63, v13
s_mov_b32 s32, 0
s_call_b64 s[90:91], L_rare2
s_branch L_back_1_3
L_stub_1_4:
v_max3_f32 v12, v32, v33, v34
v_max3_f32 v13, v40, v41, v42
v_max3_f32 v12, v12, v35, v36
v_max3_f32 v13, v13, v43, v44
v_max3_f32 v12, v12, v37, v38
v_max3_f32 v13, v13, v45, v46
v_max_f32 v12, v12, v39
v_max_f32 v13, v13, v47
s_call_b64 s[90:91], L_rare1
v_sub_f32 v32, v32, v12
v_sub_f32 v33, v33, v12
v_sub_f32 v34, v34, v12
v_sub_f32 v35, v35, v12
v_sub_f32 v36, v36, v12
v_sub_f32 v37, v37, v12
v_sub_f32 v38, v38, v12
v_sub_f32 v39, v39, v12
v_sub_f32 v40, v40, v13
v_sub_f32 v41, v41, v13
v_sub_f32 v42, v42, v13
v_sub_f32 v43, v43, v13
v_sub_f32 v44, v44, v13
v_sub_f32 v45, v45, v13
v_sub_f32 v46, v46, v13
v_sub_f32 v47, v47, v13
s_mov_b32 s32, 0
s_call_b64 s[90:91], L_rare2
s_branch L_back_1_4
L_stub_1_5:
v_max3_f32 v12, v48, v49, v50
v_max3_f32 v13, v56, v57, v58
v_max3_f32 v12, v12, v51, v52
v_max3_f32 v13, v13, v59, v60
v_max3_f32 v12, v12, v53, v54
v_max3_f32 v13, v13, v61, v62
v_max_f32 v12, v12, v55
v_max_f32 v13, v13, v63
s_call_b64 s[90:91], L_rare1
v_sub_f32 v48, v48, v12
v_sub_f32 v49, v49, v12
v_sub_f32 v50, v50, v12
v_sub_f32 v51, v51, v12
v_sub_f32 v52, v52, v12
v_sub_f32 v53, v53, v12
v_sub_f32 v54, v54, v12
v_sub_f32 v55, v55, v12
v_sub_f32 v56, v56, v13
v_sub_f32 v57, v57, v13
v_sub_f32 v58, v58, v13
v_sub_f32 v59, v59, v13
v_sub_f32 v60, v60, v13
v_sub_f32 v61, v61, v13
v_sub_f32 v62, v62, v13
v_sub_f32 v63, v63, v13
s_mov_b32 s32, 0
s_call_b64 s[90:91], L_rare2
s_branch L_back_1_5
L_stub_1_6:
v_max3_f32 v12, v32, v33, v34
v_max3_f32 v13, v40, v41, v42
v_max3_f32 v12, v12, v35, v36
v_max3_f32 v13, v13, v43, v44
v_max3_f32 v12, v12, v37, v38
v_max3_f32 v13, v13, v45, v46
v_max_f32 v12, v12, v39
v_max_f32 v13, v13, v47
s_call_b64 s[90:91], L_rare1
v_sub_f32 v32, v32, v12
v_sub_f32 v33, v33, v12
v_sub_f32 v34, v34, v12
v_sub_f32 v35, v35, v12
v_sub_f32 v36, v36, v12
v_sub_f32 v37, v37, v12
v_sub_f32 v38, v38, v12
v_sub_f32 v39, v39, v12
v_sub_f32 v40, v40, v13
v_sub_f32 v41, v41, v13
v_sub_f32 v42, v42, v13
v_sub_f32 v43, v43, v13
v_sub_f32 v44, v44, v13
v_sub_f32 v45, v45, v13
v_sub_f32 v46, v46, v13
v_sub_f32 v47, v47, v13
s_mov_b32 s32, 0
s_call_b64 s[90:91], L_rare2
s_branch L_back_1_6
L_stub_1_7:
v_max3_f32 v12, v48, v49, v50
v_max3_f32 v13, v56, v57, v58
v_max3_f32 v12, v12, v51, v52
v_max3_f32 v13, v13, v59, v60
v_max3_f32 v12, v12, v53, v54
v_max3_f32 v13, v13, v61, v62
v_max_f32 v12, v12, v55
v_max_f32 v13, v13, v63
s_call_b64 s[90:91], L_rare1
v_sub_f32 v48, v48, v12
v_sub_f32 v49, v49, v12
v_sub_f32 v50, v50, v12
v_sub_f32 v51, v51, v12
v_sub_f32 v52, v52, v12
v_sub_f32 v53, v53, v12
v_sub_f32 v54, v54, v12
v_sub_f32 v55, v55, v12
v_sub_f32 v56, v56, v13
v_sub_f32 v57, v57, v13
v_sub_f32 v58, v58, v13
v_sub_f32 v59, v59, v13
v_sub_f32 v60, v60, v13
v_sub_f32 v61, v61, v13
v_sub_f32 v62, v62, v13
v_sub_f32 v63, v63, v13
s_mov_b32 s32, 0
s_call_b64 s[90:91], L_rare2
s_branch L_back_1_7
L_stub_1_8:
v_max3_f32 v12, v32, v33, v34
v_max3_f32 v13, v40, v41, v42
v_max3_f32 v12, v12, v35, v36
v_max3_f32 v13, v13, v43, v44
v_max3_f32 v12, v12, v37, v38
v_max3_f32 v13, v13, v45, v46
v_max_f32 v12, v12, v39
v_max_f32 v13, v13, v47
s_call_b64 s[90:91], L_rare1
v_sub_f32 v32, v32, v12
v_sub_f32 v33, v33, v12
v_sub_f32 v34, v34, v12
v_sub_f32 v35, v35, v12
v_sub_f32 v36, v36, v12
v_sub_f32 v37, v37, v12
v_sub_f32 v38, v38, v12
v_sub_f32 v39, v39, v12
v_sub_f32 v40, v40, v13
v_sub_f32 v41, v41, v13
v_sub_f32 v42, v42, v13
v_sub_f32 v43, v43, v13
v_sub_f32 v44, v44, v13
v_sub_f32 v45, v45, v13
v_sub_f32 v46, v46, v13
v_sub_f32 v47, v47, v13
s_mov_b32 s32, 0
s_call_b64 s[90:91], L_rare2
s_branch L_back_1_8
L_stub_1_9:
v_max3_f32 v12, v48, v49, v50
v_max3_f32 v13, v56, v57, v58
v_max3_f32 v12, v12, v51, v52
v_max3_f32 v13, v13, v59, v60
v_max3_f32 v12, v12, v53, v54
v_max3_f32 v13, v13, v61, v62
v_max_f32 v12, v12, v55
v_max_f32 v13, v13, v63
s_call_b64 s[90:91], L_rare1
v_sub_f32 v48, v48, v12
v_sub_f32 v49, v49, v12
v_sub_f32 v50, v50, v12
v_sub_f32 v51, v51, v12
v_sub_f32 v52, v52, v12
v_sub_f32 v53, v53, v12
v_sub_f32 v54, v54, v12
v_sub_f32 v55, v55, v12
v_sub_f32 v56, v56, v13
v_sub_f32 v57, v57, v13
v_sub_f32 v58, v58, v13
v_sub_f32 v59, v59, v13
v_sub_f32 v60, v60, v13
v_sub_f32 v61, v61, v13
v_sub_f32 v62, v62, v13
v_sub_f32 v63, v63, v13
s_mov_b32 s32, 0
s_call_b64 s[90:91], L_rare2
s_branch L_back_1_9
L_stub_1_10:
v_max3_f32 v12, v32, v33, v34
v_max3_f32 v13, v40, v41, v42
v_max3_f32 v12, v12, v35, v36
v_max3_f32 v13, v13, v43, v44
v_max3_f32 v12, v12, v37, v38
v_max3_f32 v13, v13, v45, v46
v_max_f32 v12, v12, v39
v_max_f32 v13, v13, v47
s_call_b64 s[90:91], L_rare1
v_sub_f32 v32, v32, v12
v_sub_f32 v33, v33, v12
v_sub_f32 v34, v34, v12
v_sub_f32 v35, v35, v12
v_sub_f32 v36, v36, v12
v_sub_f32 v37, v37, v12
v_sub_f32 v38, v38, v12
v_sub_f32 v39, v39, v12
v_sub_f32 v40, v40, v13
v_sub_f32 v41, v41, v13
v_sub_f32 v42, v42, v13
v_sub_f32 v43, v43, v13
v_sub_f32 v44, v44, v13
v_sub_f32 v45, v45, v13
v_sub_f32 v46, v46, v13
v_sub_f32 v47, v47, v13
s_mov_b32 s32, 0
s_call_b64 s[90:91], L_rare2
s_branch L_back_1_10
L_stub_1_11:
v_max3_f32 v12, v48, v49, v50
v_max3_f32 v13, v56, v57, v58
v_max3_f32 v12, v12, v51, v52
v_max3_f32 v13, v13, v59, v60
v_max3_f32 v12, v12, v53, v54
v_max3_f32 v13, v13, v61, v62
v_max_f32 v12, v12, v55
v_max_f32 v13, v13, v63
s_call_b64 s[90:91], L_rare1
v_sub_f32 v48, v48, v12
v_sub_f32 v49, v49, v12
v_sub_f32 v50, v50, v12
v_sub_f32 v51, v51, v12
v_sub_f32 v52, v52, v12
v_sub_f32 v53, v53, v12
v_sub_f32 v54, v54, v12
v_sub_f32 v55, v55, v12
v_sub_f32 v56, v56, v13
v_sub_f32 v57, v57, v13
v_sub_f32 v58, v58, v13
v_sub_f32 v59, v59, v13
v_sub_f32 v60, v60, v13
v_sub_f32 v61, v61, v13
v_sub_f32 v62, v62, v13
v_sub_f32 v63, v63, v13
s_mov_b32 s32, 1
s_call_b64 s[90:91], L_rare2
s_branch L_back_1_11
L_stub_1_12:
v_max3_f32 v12, v32, v33, v34
v_max3_f32 v13, v40, v41, v42
v_max3_f32 v12, v12, v35, v36
v_max3_f32 v13, v13, v43, v44
v_max3_f32 v12, v12, v37, v38
v_max3_f32 v13, v13, v45, v46
v_max_f32 v12, v12, v39
v_max_f32 v13, v13, v47
s_call_b64 s[90:91], L_rare1
v_sub_f32 v32, v32, v12
v_sub_f32 v33, v33, v12
v_sub_f32 v34, v34, v12
v_sub_f32 v35, v35, v12
v_sub_f32 v36, v36, v12
v_sub_f32 v37, v37, v12
v_sub_f32 v38, v38, v12
v_sub_f32 v39, v39, v12
v_sub_f32 v40, v40, v13
v_sub_f32 v41, v41, v13
v_sub_f32 v42, v42, v13
v_sub_f32 v43, v43, v13
v_sub_f32 v44, v44, v13
v_sub_f32 v45, v45, v13
v_sub_f32 v46, v46, v13
v_sub_f32 v47, v47, v13
s_mov_b32 s32, 1
s_call_b64 s[90:91], L_rare2
s_branch L_back_1_12
L_stub_1_13:
v_max3_f32 v12, v48, v49, v50
v_max3_f32 v13, v56, v57, v58
v_max3_f32 v12, v12, v51, v52
v_max3_f32 v13, v13, v59, v60
v_max3_f32 v12, v12, v53, v54
v_max3_f32 v13, v13, v61, v62
v_max_f32 v12, v12, v55
v_max_f32 v13, v13, v63
s_call_b64 s[90:91], L_rare1
v_sub_f32 v48, v48, v12
v_sub_f32 v49, v49, v12
v_sub_f32 v50, v50, v12
v_sub_f32 v51, v51, v12
v_sub_f32 v52, v52, v12
v_sub_f32 v53, v53, v12
v_sub_f32 v54, v54, v12
v_sub_f32 v55, v55, v12
v_sub_f32 v56, v56, v13
v_sub_f32 v57, v57, v13
v_sub_f32 v58, v58, v13
v_sub_f32 v59, v59, v13
v_sub_f32 v60, v60, v13
v_sub_f32 v61, v61, v13
v_sub_f32 v62, v62, v13
v_sub_f32 v63, v63, v13
s_mov_b32 s32, 1
s_call_b64 s[90:91], L_rare2
s_branch L_back_1_13
L_stub_1_14:
v_max3_f32 v12, v32, v33, v34
v_max3_f32 v13, v40, v41, v42
v_max3_f32 v12, v12, v35, v36
v_max3_f32 v13, v13, v43, v44
v_max3_f32 v12, v12, v37, v38
v_max3_f32 v13, v13, v45, v46
v_max_f32 v12, v12, v39
v_max_f32 v13, v13, v47
s_call_b64 s[90:91], L_rare1
v_sub_f32 v32, v32, v12
v_sub_f32 v33, v33, v12
v_sub_f32 v34, v34, v12
v_sub_f32 v35, v35, v12
v_sub_f32 v36, v36, v12
v_sub_f32 v37, v37, v12
v_sub_f32 v38, v38, v12
v_sub_f32 v39, v39, v12
v_sub_f32 v40, v40, v13
v_sub_f32 v41, v41, v13
v_sub_f32 v42, v42, v13
v_sub_f32 v43, v43, v13
v_sub_f32 v44, v44, v13
v_sub_f32 v45, v45, v13
v_sub_f32 v46, v46, v13
v_sub_f32 v47, v47, v13
s_mov_b32 s32, 1
s_call_b64 s[90:91], L_rare2
s_branch L_back_1_14
L_stub_1_15:
v_max3_f32 v12, v48, v49, v50
v_max3_f32 v13, v56, v57, v58
v_max3_f32 v12, v12, v51, v52
v_max3_f32 v13, v13, v59, v60
v_max3_f32 v12, v12, v53, v54
v_max3_f32 v13, v13, v61, v62
v_max_f32 v12, v12, v55
v_max_f32 v13, v13, v63
s_call_b64 s[90:91], L_rare1
v_sub_f32 v48, v48, v12
v_sub_f32 v49, v49, v12
v_sub_f32 v50, v50, v12
v_sub_f32 v51, v51, v12
v_sub_f32 v52, v52, v12
v_sub_f32 v53, v53, v12
v_sub_f32 v54, v54, v12
v_sub_f32 v55, v55, v12
v_sub_f32 v56, v56, v13
v_sub_f32 v57, v57, v13
v_sub_f32 v58, v58, v13
v_sub_f32 v59, v59, v13
v_sub_f32 v60, v60, v13
v_sub_f32 v61, v61, v13
v_sub_f32 v62, v62, v13
v_sub_f32 v63, v63, v13
s_mov_b32 s32, 2
s_call_b64 s[90:91], L_rare2
s_branch L_back_1_15
L_rare1:
s_nop 1
v_permlane32_swap_b32 v12, v13
v_max_f32 v12, v12, v13
v_mov_b32 v13, v12
s_nop 1
v_permlane16_swap_b32 v12, v13
v_max_f32 v12, v12, v13
v_mov_b32 v13, v12
s_nop 1
v_permlane32_swap_b32 v12, v13
v_max_f32 v12, 0, v12
v_ceil_f32 v12, v12
v_add_f32 v10, v10, v12
v_max_f32 v13, 0, v13
v_ceil_f32 v13, v13
v_add_f32 v11, v11, v13
s_setpc_b64 s[90:91]
L_rare2:
v_min_f32 v12, 0x437f0000, v12
v_cvt_i32_f32 v12, -v12
v_min_f32 v13, 0x437f0000, v13
v_cvt_i32_f32 v13, -v13
s_cmp_lg_u32 s32, 2
s_cbranch_scc1 L_rare_p
v_ldexp_f32 v96, v96, v12
v_ldexp_f32 v97, v97, v12
v_ldexp_f32 v98, v98, v12
v_ldexp_f32 v99, v99, v12
v_ldexp_f32 v100, v100, v12
v_ldexp_f32 v101, v101, v12
v_ldexp_f32 v102, v102, v12
v_ldexp_f32 v103, v103, v12
v_ldexp_f32 v104, v104, v13
v_ldexp_f32 v105, v105, v13
v_ldexp_f32 v106, v106, v13
v_ldexp_f32 v107, v107, v13
v_ldexp_f32 v108, v108, v13
v_ldexp_f32 v109, v109, v13
v_ldexp_f32 v110, v110, v13
v_ldexp_f32 v111, v111, v13
v_ldexp_f32 v112, v112, v12
v_ldexp_f32 v113, v113, v12
v_ldexp_f32 v114, v114, v12
v_ldexp_f32 v115, v115, v12
v_ldexp_f32 v116, v116, v12
v_ldexp_f32 v117, v117, v12
v_ldexp_f32 v118, v118, v12
v_ldexp_f32 v119, v119, v12
v_ldexp_f32 v120, v120, v13
v_ldexp_f32 v121, v121, v13
v_ldexp_f32 v122, v122, v13
v_ldexp_f32 v123, v123, v13
v_ldexp_f32 v124, v124, v13
v_ldexp_f32 v125, v125, v13
v_ldexp_f32 v126, v126, v13
v_ldexp_f32 v127, v127, v13
L_rare_p:
v_mul_lo_u32 v12, v12, s7
v_mul_lo_u32 v13, v13, s7
v_pk_sub_u16 v128, v128, v12 clamp
v_pk_sub_u16 v129, v129, v12 clamp
v_pk_sub_u16 v130, v130, v12 clamp
v_pk_sub_u16 v131, v131, v12 clamp
v_pk_sub_u16 v132, v132, v13 clamp
v_pk_sub_u16 v133, v133, v13 clamp
v_pk_sub_u16 v134, v134, v13 clamp
v_pk_sub_u16 v135, v135, v13 clamp
v_pk_sub_u16 v136, v136, v12 clamp
v_pk_sub_u16 v137, v137, v12 clamp
v_pk_sub_u16 v138, v138, v12 clamp
v_pk_sub_u16 v139, v139, v12 clamp
v_pk_sub_u16 v140, v140, v13 clamp
v_pk_sub_u16 v141, v141, v13 clamp
v_pk_sub_u16 v142, v142, v13 clamp
v_pk_sub_u16 v143, v143, v13 clamp
v_pk_sub_u16 v144, v144, v12 clamp
v_pk_sub_u16 v145, v145, v12 clamp
v_pk_sub_u16 v146, v146, v12 clamp
v_pk_sub_u16 v147, v147, v12 clamp
v_pk_sub_u16 v148, v148, v13 clamp
v_pk_sub_u16 v149, v149, v13 clamp
v_pk_sub_u16 v150, v150, v13 clamp
v_pk_sub_u16 v151, v151, v13 clamp
v_pk_sub_u16 v152, v152, v12 clamp
v_pk_sub_u16 v153, v153, v12 clamp
v_pk_sub_u16 v154, v154, v12 clamp
v_pk_sub_u16 v155, v155, v12 clamp
v_pk_sub_u16 v156, v156, v13 clamp
v_pk_sub_u16 v157, v157, v13 clamp
v_pk_sub_u16 v158, v158, v13 clamp
v_pk_sub_u16 v159, v159, v13 clamp
v_pk_sub_u16 v160, v160, v12 clamp
v_pk_sub_u16 v161, v161, v12 clamp
v_pk_sub_u16 v162, v162, v12 clamp
v_pk_sub_u16 v163, v163, v12 clamp
v_pk_sub_u16 v164, v164, v13 clamp
v_pk_sub_u16 v165, v165, v13 clamp
v_pk_sub_u16 v166, v166, v13 clamp
v_pk_sub_u16 v167, v167, v13 clamp
v_pk_sub_u16 v168, v168, v12 clamp
v_pk_sub_u16 v169, v169, v12 clamp
v_pk_sub_u16 v170, v170, v12 clamp
v_pk_sub_u16 v171, v171, v12 clamp
v_pk_sub_u16 v172, v172, v13 clamp
v_pk_sub_u16 v173, v173, v13 clamp
v_pk_sub_u16 v174, v174, v13 clamp
v_pk_sub_u16 v175, v175, v13 clamp
v_pk_sub_u16 v176, v176, v12 clamp
v_pk_sub_u16 v177, v177, v12 clamp
v_pk_sub_u16 v178, v178, v12 clamp
v_pk_sub_u16 v179, v179, v12 clamp
v_pk_sub_u16 v180, v180, v13 clamp
v_pk_sub_u16 v181, v181, v13 clamp
v_pk_sub_u16 v182, v182, v13 clamp
v_pk_sub_u16 v183, v183, v13 clamp
v_pk_sub_u16 v184, v184, v12 clamp
v_pk_sub_u16 v185, v185, v12 clamp
v_pk_sub_u16 v186, v186, v12 clamp
v_pk_sub_u16 v187, v187, v12 clamp
v_pk_sub_u16 v188, v188, v13 clamp
v_pk_sub_u16 v189, v189, v13 clamp
v_pk_sub_u16 v190, v190, v13 clamp
v_pk_sub_u16 v191, v191, v13 clamp
v_pk_sub_u16 v192, v192, v12 clamp
v_pk_sub_u16 v193, v193, v12 clamp
v_pk_sub_u16 v194, v194, v12 clamp
v_pk_sub_u16 v195, v195, v12 clamp
v_pk_sub_u16 v196, v196, v13 clamp
v_pk_sub_u16 v197, v197, v13 clamp
v_pk_sub_u16 v198, v198, v13 clamp
v_pk_sub_u16 v199, v199, v13 clamp
v_pk_sub_u16 v200, v200, v12 clamp
v_pk_sub_u16 v201, v201, v12 clamp
v_pk_sub_u16 v202, v202, v12 clamp
v_pk_sub_u16 v203, v203, v12 clamp
v_pk_sub_u16 v204, v204, v13 clamp
v_pk_sub_u16 v205, v205, v13 clamp
v_pk_sub_u16 v206, v206, v13 clamp
v_pk_sub_u16 v207, v207, v13 clamp
s_cmp_eq_u32 s32, 0
s_cbranch_scc1 L_rare_done
v_pk_sub_u16 v208, v208, v12 clamp
v_pk_sub_u16 v209, v209, v12 clamp
v_pk_sub_u16 v210, v210, v12 clamp
v_pk_sub_u16 v211, v211, v12 clamp
v_pk_sub_u16 v212, v212, v13 clamp
v_pk_sub_u16 v213, v213, v13 clamp
v_pk_sub_u16 v214, v214, v13 clamp
v_pk_sub_u16 v215, v215, v13 clamp
v_pk_sub_u16 v216, v216, v12 clamp
v_pk_sub_u16 v217, v217, v12 clamp
v_pk_sub_u16 v218, v218, v12 clamp
v_pk_sub_u16 v219, v219, v12 clamp
v_pk_sub_u16 v220, v220, v13 clamp
v_pk_sub_u16 v221, v221, v13 clamp
v_pk_sub_u16 v222, v222, v13 clamp
v_pk_sub_u16 v223, v223, v13 clamp
v_pk_sub_u16 v224, v224, v12 clamp
v_pk_sub_u16 v225, v225, v12 clamp
v_pk_sub_u16 v226, v226, v12 clamp
v_pk_sub_u16 v227, v227, v12 clamp
v_pk_sub_u16 v228, v228, v13 clamp
v_pk_sub_u16 v229, v229, v13 clamp
v_pk_sub_u16 v230, v230, v13 clamp
v_pk_sub_u16 v231, v231, v13 clamp
v_pk_sub_u16 v232, v232, v12 clamp
v_pk_sub_u16 v233, v233, v12 clamp
v_pk_sub_u16 v234, v234, v12 clamp
v_pk_sub_u16 v235, v235, v12 clamp
v_pk_sub_u16 v236, v236, v13 clamp
v_pk_sub_u16 v237, v237, v13 clamp
v_pk_sub_u16 v238, v238, v13 clamp
v_pk_sub_u16 v239, v239, v13 clamp
v_pk_sub_u16 v240, v240, v12 clamp
v_pk_sub_u16 v241, v241, v12 clamp
v_pk_sub_u16 v242, v242, v12 clamp
v_pk_sub_u16 v243, v243, v12 clamp
v_pk_sub_u16 v244, v244, v13 clamp
v_pk_sub_u16 v245, v245, v13 clamp
v_pk_sub_u16 v246, v246, v13 clamp
v_pk_sub_u16 v247, v247, v13 clamp
v_pk_sub_u16 v248, v248, v12 clamp
v_pk_sub_u16 v249, v249, v12 clamp
v_pk_sub_u16 v250, v250, v12 clamp
v_pk_sub_u16 v251, v251, v12 clamp
v_pk_sub_u16 v252, v252, v13 clamp
v_pk_sub_u16 v253, v253, v13 clamp
v_pk_sub_u16 v254, v254, v13 clamp
v_pk_sub_u16 v255, v255, v13 clamp
L_rare_done:
s_cmp_eq_u32 s3, 77
s_nop 1
s_setpc_b64 s[90:91]
L_code_end:
.section .rodata,"a"
.p2align 6
.amdhsa_kernel standalone__mha_block_cached__near_ridge_kernel
  .amdhsa_next_free_vgpr 512
  .amdhsa_next_free_sgpr 102
  .amdhsa_accum_offset 256
  .amdhsa_group_segment_fixed_size 0
  .amdhsa_kernarg_size 64
  .amdhsa_user_sgpr_count 2
  .amdhsa_user_sgpr_kernarg_segment_ptr 1
  .amdhsa_system_sgpr_workgroup_id_x 1
  .amdhsa_float_denorm_mode_32 3
.end_amdhsa_kernel
```
